```python
import torch

def _softmax(x, axis=-1):
    return torch.softmax(x, dim=axis)

def _gelu(x):
    return torch.nn.functional.gelu(x, approximate='tanh')

def _silu(x):
    return torch.nn.functional.silu(x)

def _sigmoid(x):
    return torch.sigmoid(x)

def _layernorm(x, axis=-1, eps=1e-05):
    m = x.mean(dim=axis, keepdim=True)
    v = x.var(dim=axis, keepdim=True, unbiased=False)
    return (x - m) / torch.sqrt(v + eps)

def _scatter_add(tgt, idx, src, axis=0):
    return tgt.clone().index_add_(axis, idx, src)

def _segment_sum(src, seg, n):
    out = torch.zeros((n,) + src.shape[1:], dtype=src.dtype)
    return out.index_add_(0, seg, src)

def _pad(x, pw):
    flat = tuple((v for pair in reversed(pw) for v in pair))
    return torch.nn.functional.pad(x, flat)
kernel_name = 'interleave_layers__memory_aug_recurrent_mem_tr__linear_kernel_hedgehog__prompt'

def setup_inputs():

    _w = lambda a: (lambda t: t.to(torch.bfloat16) if t.is_floating_point() else t)(torch.as_tensor(a))

    def _A_setup():
        B, S, Dm = (1, 2048, 640)
        H, Dh = (32, 192)
        M, seg = (8, 32)
        seg = min(seg, S)
        S = S // seg * seg
        return {'x': _w((lambda *s: torch.randn(*s, dtype=torch.bfloat16) * 0.05)(B, S, Dm)), 'mem0': _w((lambda *s: torch.randn(*s, dtype=torch.bfloat16) * 0.8)(B, M, Dm)), 'Wq': _w((lambda *s: torch.randn(*s, dtype=torch.bfloat16) * 1.6)(Dm, H, Dh) * Dm ** (-0.5)), 'Wk': _w((lambda *s: torch.randn(*s, dtype=torch.bfloat16) * 1.6)(Dm, H, Dh) * Dm ** (-0.5)), 'Wv': _w((lambda *s: torch.randn(*s, dtype=torch.bfloat16) * 0.8)(Dm, H, Dh) * Dm ** (-0.5)), 'Wo': _w((lambda *s: torch.randn(*s, dtype=torch.bfloat16) * 0.8)(H, Dh, Dm) * (H * Dh) ** (-0.5)), 'seg_len': seg}
    _A_in = _A_setup()

    def _B_setup():
        B, S, D, H = (1, 2048, 640, 32)
        Dh = D // H
        return {'x': _w((lambda *s: torch.randn(*s, dtype=torch.bfloat16) * 0.05)(B, S, D)), 'wqkv': _w((lambda *s: torch.randn(*s, dtype=torch.bfloat16) * 0.4)(D, 3 * D)), 'w_phi': _w((lambda *s: torch.randn(*s, dtype=torch.bfloat16) * 0.4)(H, Dh, Dh) * Dh ** (-0.5)), 'wo': _w((lambda *s: torch.randn(*s, dtype=torch.bfloat16) * 0.05)(D, D))}
    _B_in = _B_setup()
    return {'A_x': _A_in['x'], 'A_mem0': _A_in['mem0'], 'A_Wq': _A_in['Wq'], 'A_Wk': _A_in['Wk'], 'A_Wv': _A_in['Wv'], 'A_Wo': _A_in['Wo'], 'A_seg_len': _A_in['seg_len'], 'B_x': _B_in['x'], 'B_wqkv': _B_in['wqkv'], 'B_w_phi': _B_in['w_phi'], 'B_wo': _B_in['wo']}

def reference(A_x, A_mem0, A_Wq, A_Wk, A_Wv, A_Wo, A_seg_len, B_x, B_wqkv, B_w_phi, B_wo):

    def _A_ref(x, mem0, Wq, Wk, Wv, Wo, seg_len):
        B, S, Dm = x.shape
        H, Dh = (Wq.shape[1], Wq.shape[2])
        M = mem0.shape[1]
        scale = Dh ** (-0.5)
        n_seg = S // seg_len
        L = M + seg_len
        idx = torch.arange(L)
        mask = (idx[:, None] < M) | (idx[:, None] >= idx[None, :])
        mem = mem0
        outs = []
        for s in range(n_seg):
            xs = x[:, s * seg_len:(s + 1) * seg_len, :].clone()
            h = torch.concatenate([mem, xs], axis=1)
            q = torch.einsum('btd,dhe->bhte', h, Wq)
            k = torch.einsum('btd,dhe->bhte', h, Wk)
            v = torch.einsum('btd,dhe->bhte', h, Wv)
            scores = torch.einsum('bhqe,bhke->bhqk', q, k) * scale
            scores = torch.where(mask[None, None], scores, -1000000000.0)
            p = _softmax(scores, axis=-1)
            o = torch.einsum('bhqk,bhke->bhqe', p, v)
            o = torch.einsum('bhte,hed->btd', o, Wo)
            mem = o[:, :M, :].clone()
            outs.append(o[:, M:, :])
        return torch.concatenate(outs, axis=1)

    def _B_ref(x, wqkv, w_phi, wo):
        B, S, D = x.shape
        H = 32
        Dh = D // H
        qkv = (lambda x, *d: x.permute(*d))((x @ wqkv).reshape(B, S, 3, H, Dh), 2, 0, 3, 1, 4)
        q, k, v = (qkv[0], qkv[1], qkv[2])
        pq = torch.einsum('bhsd,hdf->bhsf', q, w_phi)
        pk = torch.einsum('bhsd,hdf->bhsf', k, w_phi)
        phi_q = torch.concatenate([_softmax(pq, axis=-1), _softmax(-pq, axis=-1)], axis=-1)
        phi_k = torch.concatenate([_softmax(pk, axis=-1), _softmax(-pk, axis=-1)], axis=-1)
        kv = torch.einsum('bhsf,bhsd->bhfd', phi_k, v)
        z = torch.einsum('bhsf->bhf', phi_k)
        num = torch.einsum('bhqf,bhfd->bhqd', phi_q, kv)
        den = torch.einsum('bhqf,bhf->bhq', phi_q, z)[..., None] + 1e-06
        o = num / den
        return (lambda x, *d: x.permute(*d))(o, 0, 2, 1, 3).reshape(B, S, D) @ wo
    x = A_x
    x = x + _A_ref(_layernorm(x, axis=-1), A_mem0, A_Wq, A_Wk, A_Wv, A_Wo, A_seg_len)
    x = x + _B_ref(_layernorm(x, axis=-1), B_wqkv, B_w_phi, B_wo)
    x = x + _A_ref(_layernorm(x, axis=-1), A_mem0, A_Wq, A_Wk, A_Wv, A_Wo, A_seg_len)
    x = x + _B_ref(_layernorm(x, axis=-1), B_wqkv, B_w_phi, B_wo)
    return x
```

```asm
; @launch kernel=interleave_layers__memory_aug_recurrent_mem_tr__linear_kernel_hedgehog__prompt_kernel grid=(256,1,1) block=(256,1,1) lds=163840
.amdgcn_target "amdgcn-amd-amdhsa--gfx950"
.text
.globl interleave_layers__memory_aug_recurrent_mem_tr__linear_kernel_hedgehog__prompt_kernel
.p2align 8
.type interleave_layers__memory_aug_recurrent_mem_tr__linear_kernel_hedgehog__prompt_kernel,@function
interleave_layers__memory_aug_recurrent_mem_tr__linear_kernel_hedgehog__prompt_kernel:
  s_load_dwordx2 s[4:5], s[0:1], 104
  s_mov_b32 s6, 0x10000000
  s_mov_b32 s7, 0x20000
  s_load_dwordx2 s[44:45], s[0:1], 96
  s_mov_b32 s46, 0x100
  s_mov_b32 s47, 0x20000
  v_lshrrev_b32 v1, 6, v0
  s_nop 0
  v_readfirstlane_b32 s3, v1
  v_and_b32 v1, 63, v0
  s_cmp_ge_u32 s2, 256
  s_cbranch_scc1 mk_end
  s_getreg_b32 s8, hwreg(HW_REG_XCC_ID)
  s_and_b32 s8, s8, 7
  s_lshr_b32 s9, s2, 3
  s_mov_b32 s67, 0
  s_mov_b32 s66, 0
  s_waitcnt lgkmcnt(0)
  s_add_u32 s39, s4, 67047423
  s_and_b32 s39, s39, 0xffe00000
  s_sub_u32 s39, s39, s4
mk_start:
  s_cmp_lt_u32 s8, 4
  s_cbranch_scc1 mk_rec
  s_sub_u32 s72, s8, 4
  s_and_b32 s73, s9, 7
  s_lshr_b32 s74, s9, 3
  s_lshl_b32 s75, s72, 3
  s_add_u32 s75, s75, s73
  s_load_dwordx8 s[12:19], s[0:1], 16
  s_load_dwordx2 s[56:57], s[0:1], 0
  s_mov_b32 s58, 0x280000
  s_mov_b32 s59, 0x20000
  s_mov_b32 s94, 0x780000
  s_mov_b32 s95, 0x20000
  s_mov_b32 s76, -1
  s_mov_b32 s77, 0x0fffffff
  s_waitcnt lgkmcnt(0)
  s_mov_b64 s[92:93], s[12:13]
  s_cmp_eq_u32 s74, 0
  s_cselect_b64 s[92:93], s[14:15], s[92:93]
  s_cmp_eq_u32 s74, 1
  s_cselect_b64 s[92:93], s[16:17], s[92:93]
  s_cmp_eq_u32 s74, 3
  s_cselect_b64 s[92:93], s[18:19], s[92:93]
  s_mul_i32 s11, s3, 30720
  s_cmp_eq_u32 s74, 3
  s_cbranch_scc1 mk_spu
  s_mul_i32 s10, s75, 384
  s_mul_i32 s12, s3, 96
  s_mov_b32 s78, 122880
  v_mul_u32_u24 v18, 10923, v1
  v_lshrrev_b32 v18, 16, v18
  v_mul_u32_u24 v16, 6, v18
  v_sub_u32 v16, v1, v16
  v_lshlrev_b32 v16, 4, v16
  v_mul_u32_u24 v18, 12288, v18
  v_add_u32 v16, v16, v18
  v_lshrrev_b32 v18, 4, v1
  v_mul_u32_u24 v18, 8, v18
  v_bfe_u32 v17, v1, 2, 2
  v_add_u32 v18, v18, v17
  v_mul_u32_u24 v18, 96, v18
  v_and_b32 v17, 3, v1
  v_lshl_add_u32 v17, v17, 3, v18
  s_branch mk_spd
mk_spu:
  s_mul_i32 s10, s75, 245760
  s_mul_i32 s12, s3, 320
  s_mov_b32 s78, 3840
  v_mul_u32_u24 v18, 3277, v1
  v_lshrrev_b32 v18, 16, v18
  v_mul_u32_u24 v16, 20, v18
  v_sub_u32 v16, v1, v16
  v_lshlrev_b32 v16, 4, v16
  v_mul_u32_u24 v18, 1280, v18
  v_add_u32 v16, v16, v18
  v_lshrrev_b32 v18, 4, v1
  v_mul_u32_u24 v18, 4, v18
  v_bfe_u32 v17, v1, 2, 2
  v_add_u32 v18, v18, v17
  v_mul_u32_u24 v18, 320, v18
  v_and_b32 v17, 3, v1
  v_lshl_add_u32 v17, v17, 3, v18
mk_spd:
  s_add_u32 s10, s10, s12
  v_add_u32 v17, s11, v17
  s_lshl_b32 s48, s9, 2
  s_add_u32 s48, s48, s72
  s_mov_b32 s49, 0
  s_mov_b32 s50, 0
  v_lshlrev_b32 v20, 4, v1
  s_mul_i32 s51, s48, 20480
  s_mul_i32 s52, s3, 5120
  s_add_u32 s51, s51, s52
  s_mul_i32 s52, s49, 2621440
  s_add_u32 s51, s51, s52
  v_and_b32 v22, 15, v1
  v_mul_u32_u24 v21, 1280, v22
  v_lshrrev_b32 v22, 4, v1
  v_lshl_add_u32 v21, v22, 4, v21
  s_mul_i32 s52, s48, 20480
  s_mul_i32 s53, s3, 320
  s_add_u32 s52, s52, s53
  buffer_load_dwordx4 v[36:39], v21, s[56:59], s52 offen offset:0
  buffer_load_dwordx4 v[40:43], v21, s[56:59], s52 offen offset:64
  buffer_load_dwordx4 v[44:47], v21, s[56:59], s52 offen offset:128
  buffer_load_dwordx4 v[48:51], v21, s[56:59], s52 offen offset:192
  buffer_load_dwordx4 v[52:55], v21, s[56:59], s52 offen offset:256
  s_mov_b64 exec, s[76:77]
  s_mov_b32 m0, s11
  s_mov_b32 s19, 0
int_sf1:
  buffer_load_dwordx4 v16, s[92:95], s10 offen lds
  s_add_u32 s10, s10, s78
  s_add_u32 m0, m0, 960
  s_nop 0
  buffer_load_dwordx4 v16, s[92:95], s10 offen lds
  s_add_u32 s10, s10, s78
  s_add_u32 m0, m0, 960
  s_nop 0
  buffer_load_dwordx4 v16, s[92:95], s10 offen lds
  s_add_u32 s10, s10, s78
  s_add_u32 m0, m0, 960
  s_nop 0
  buffer_load_dwordx4 v16, s[92:95], s10 offen lds
  s_add_u32 s10, s10, s78
  s_add_u32 m0, m0, 960
  s_add_u32 s19, s19, 1
  s_cmp_lt_u32 s19, 8
  s_cbranch_scc1 int_sf1
  s_mov_b64 exec, -1
  s_mov_b32 s55, 0xffff0000
  s_add_u32 s52, s51, 26214400
  s_add_u32 s53, s52, 4096
  s_waitcnt vmcnt(32)
  buffer_store_dwordx4 v[36:39], v20, s[4:7], s52 offen offset:0 sc1
  buffer_store_dwordx4 v[40:43], v20, s[4:7], s52 offen offset:1024 sc1
  buffer_store_dwordx4 v[44:47], v20, s[4:7], s52 offen offset:2048 sc1
  buffer_store_dwordx4 v[48:51], v20, s[4:7], s52 offen offset:3072 sc1
  buffer_store_dwordx4 v[52:55], v20, s[4:7], s53 offen offset:0 sc1
  v_lshlrev_b32 v56, 16, v36
  v_and_b32 v57, s55, v36
  v_lshlrev_b32 v58, 16, v37
  v_and_b32 v59, s55, v37
  v_lshlrev_b32 v60, 16, v38
  v_and_b32 v61, s55, v38
  v_lshlrev_b32 v62, 16, v39
  v_and_b32 v63, s55, v39
  v_lshlrev_b32 v64, 16, v40
  v_and_b32 v65, s55, v40
  v_lshlrev_b32 v66, 16, v41
  v_and_b32 v67, s55, v41
  v_lshlrev_b32 v68, 16, v42
  v_and_b32 v69, s55, v42
  v_lshlrev_b32 v70, 16, v43
  v_and_b32 v71, s55, v43
  v_lshlrev_b32 v72, 16, v44
  v_and_b32 v73, s55, v44
  v_lshlrev_b32 v74, 16, v45
  v_and_b32 v75, s55, v45
  v_lshlrev_b32 v76, 16, v46
  v_and_b32 v77, s55, v46
  v_lshlrev_b32 v78, 16, v47
  v_and_b32 v79, s55, v47
  v_lshlrev_b32 v80, 16, v48
  v_and_b32 v81, s55, v48
  v_lshlrev_b32 v82, 16, v49
  v_and_b32 v83, s55, v49
  v_lshlrev_b32 v84, 16, v50
  v_and_b32 v85, s55, v50
  v_lshlrev_b32 v86, 16, v51
  v_and_b32 v87, s55, v51
  v_lshlrev_b32 v88, 16, v52
  v_and_b32 v89, s55, v52
  v_lshlrev_b32 v90, 16, v53
  v_and_b32 v91, s55, v53
  v_lshlrev_b32 v92, 16, v54
  v_and_b32 v93, s55, v54
  v_lshlrev_b32 v94, 16, v55
  v_and_b32 v95, s55, v55
  v_pk_add_f32 v[24:25], v[56:57], v[58:59]
  v_pk_add_f32 v[24:25], v[24:25], v[60:61]
  v_pk_add_f32 v[24:25], v[24:25], v[62:63]
  v_pk_add_f32 v[24:25], v[24:25], v[64:65]
  v_pk_add_f32 v[24:25], v[24:25], v[66:67]
  v_pk_add_f32 v[24:25], v[24:25], v[68:69]
  v_pk_add_f32 v[24:25], v[24:25], v[70:71]
  v_pk_add_f32 v[24:25], v[24:25], v[72:73]
  v_pk_add_f32 v[24:25], v[24:25], v[74:75]
  v_pk_add_f32 v[24:25], v[24:25], v[76:77]
  v_pk_add_f32 v[24:25], v[24:25], v[78:79]
  v_pk_add_f32 v[24:25], v[24:25], v[80:81]
  v_pk_add_f32 v[24:25], v[24:25], v[82:83]
  v_pk_add_f32 v[24:25], v[24:25], v[84:85]
  v_pk_add_f32 v[24:25], v[24:25], v[86:87]
  v_pk_add_f32 v[24:25], v[24:25], v[88:89]
  v_pk_add_f32 v[24:25], v[24:25], v[90:91]
  v_pk_add_f32 v[24:25], v[24:25], v[92:93]
  v_pk_add_f32 v[24:25], v[24:25], v[94:95]
  v_add_f32 v24, v24, v25
  v_mov_b32 v22, v24
  s_nop 1
  v_permlane16_swap_b32 v24, v22
  v_add_f32 v24, v24, v22
  v_mov_b32 v22, v24
  s_nop 1
  v_permlane32_swap_b32 v24, v22
  v_add_f32 v24, v24, v22
  v_mul_f32 v24, 0x3bcccccd, v24
  v_pk_add_f32 v[56:57], v[56:57], v[24:25] op_sel_hi:[1,0] neg_lo:[0,1] neg_hi:[0,1]
  v_pk_mul_f32 v[26:27], v[56:57], v[56:57]
  v_pk_add_f32 v[58:59], v[58:59], v[24:25] op_sel_hi:[1,0] neg_lo:[0,1] neg_hi:[0,1]
  v_pk_fma_f32 v[26:27], v[58:59], v[58:59], v[26:27]
  v_pk_add_f32 v[60:61], v[60:61], v[24:25] op_sel_hi:[1,0] neg_lo:[0,1] neg_hi:[0,1]
  v_pk_fma_f32 v[26:27], v[60:61], v[60:61], v[26:27]
  v_pk_add_f32 v[62:63], v[62:63], v[24:25] op_sel_hi:[1,0] neg_lo:[0,1] neg_hi:[0,1]
  v_pk_fma_f32 v[26:27], v[62:63], v[62:63], v[26:27]
  v_pk_add_f32 v[64:65], v[64:65], v[24:25] op_sel_hi:[1,0] neg_lo:[0,1] neg_hi:[0,1]
  v_pk_fma_f32 v[26:27], v[64:65], v[64:65], v[26:27]
  v_pk_add_f32 v[66:67], v[66:67], v[24:25] op_sel_hi:[1,0] neg_lo:[0,1] neg_hi:[0,1]
  v_pk_fma_f32 v[26:27], v[66:67], v[66:67], v[26:27]
  v_pk_add_f32 v[68:69], v[68:69], v[24:25] op_sel_hi:[1,0] neg_lo:[0,1] neg_hi:[0,1]
  v_pk_fma_f32 v[26:27], v[68:69], v[68:69], v[26:27]
  v_pk_add_f32 v[70:71], v[70:71], v[24:25] op_sel_hi:[1,0] neg_lo:[0,1] neg_hi:[0,1]
  v_pk_fma_f32 v[26:27], v[70:71], v[70:71], v[26:27]
  v_pk_add_f32 v[72:73], v[72:73], v[24:25] op_sel_hi:[1,0] neg_lo:[0,1] neg_hi:[0,1]
  v_pk_fma_f32 v[26:27], v[72:73], v[72:73], v[26:27]
  v_pk_add_f32 v[74:75], v[74:75], v[24:25] op_sel_hi:[1,0] neg_lo:[0,1] neg_hi:[0,1]
  v_pk_fma_f32 v[26:27], v[74:75], v[74:75], v[26:27]
  v_pk_add_f32 v[76:77], v[76:77], v[24:25] op_sel_hi:[1,0] neg_lo:[0,1] neg_hi:[0,1]
  v_pk_fma_f32 v[26:27], v[76:77], v[76:77], v[26:27]
  v_pk_add_f32 v[78:79], v[78:79], v[24:25] op_sel_hi:[1,0] neg_lo:[0,1] neg_hi:[0,1]
  v_pk_fma_f32 v[26:27], v[78:79], v[78:79], v[26:27]
  v_pk_add_f32 v[80:81], v[80:81], v[24:25] op_sel_hi:[1,0] neg_lo:[0,1] neg_hi:[0,1]
  v_pk_fma_f32 v[26:27], v[80:81], v[80:81], v[26:27]
  v_pk_add_f32 v[82:83], v[82:83], v[24:25] op_sel_hi:[1,0] neg_lo:[0,1] neg_hi:[0,1]
  v_pk_fma_f32 v[26:27], v[82:83], v[82:83], v[26:27]
  v_pk_add_f32 v[84:85], v[84:85], v[24:25] op_sel_hi:[1,0] neg_lo:[0,1] neg_hi:[0,1]
  v_pk_fma_f32 v[26:27], v[84:85], v[84:85], v[26:27]
  v_pk_add_f32 v[86:87], v[86:87], v[24:25] op_sel_hi:[1,0] neg_lo:[0,1] neg_hi:[0,1]
  v_pk_fma_f32 v[26:27], v[86:87], v[86:87], v[26:27]
  v_pk_add_f32 v[88:89], v[88:89], v[24:25] op_sel_hi:[1,0] neg_lo:[0,1] neg_hi:[0,1]
  v_pk_fma_f32 v[26:27], v[88:89], v[88:89], v[26:27]
  v_pk_add_f32 v[90:91], v[90:91], v[24:25] op_sel_hi:[1,0] neg_lo:[0,1] neg_hi:[0,1]
  v_pk_fma_f32 v[26:27], v[90:91], v[90:91], v[26:27]
  v_pk_add_f32 v[92:93], v[92:93], v[24:25] op_sel_hi:[1,0] neg_lo:[0,1] neg_hi:[0,1]
  v_pk_fma_f32 v[26:27], v[92:93], v[92:93], v[26:27]
  v_pk_add_f32 v[94:95], v[94:95], v[24:25] op_sel_hi:[1,0] neg_lo:[0,1] neg_hi:[0,1]
  v_pk_fma_f32 v[26:27], v[94:95], v[94:95], v[26:27]
  v_add_f32 v25, v26, v27
  v_mov_b32 v22, v25
  s_nop 1
  v_permlane16_swap_b32 v25, v22
  v_add_f32 v25, v25, v22
  v_mov_b32 v22, v25
  s_nop 1
  v_permlane32_swap_b32 v25, v22
  v_add_f32 v25, v25, v22
  v_and_b32 v22, 15, v1
  s_add_u32 s54, s50, 162816
  v_lshl_add_u32 v22, v22, 3, s54
  s_lshl_b32 s54, s3, 7
  v_add_u32 v23, s54, v22
  ds_write_b64 v23, v[24:25]
  s_xor_b32 s50, s50, 512
  s_waitcnt lgkmcnt(0)
  s_barrier
  ds_read_b64 v[28:29], v22 offset:0
  ds_read_b64 v[30:31], v22 offset:128
  ds_read_b64 v[32:33], v22 offset:256
  ds_read_b64 v[34:35], v22 offset:384
  s_add_u32 s52, s51, 36700160
  s_add_u32 s53, s52, 4096
  s_waitcnt lgkmcnt(0)
  v_pk_add_f32 v[26:27], v[28:29], v[30:31]
  v_pk_add_f32 v[26:27], v[26:27], v[32:33]
  v_pk_add_f32 v[26:27], v[26:27], v[34:35]
  v_mul_f32 v26, 0x3e800000, v26
  v_sub_f32 v28, v28, v26
  v_sub_f32 v30, v30, v26
  v_sub_f32 v32, v32, v26
  v_sub_f32 v34, v34, v26
  v_mul_f32 v22, v28, v28
  v_fmac_f32 v22, v30, v30
  v_fmac_f32 v22, v32, v32
  v_fmac_f32 v22, v34, v34
  v_fmac_f32 v27, 0x43200000, v22
  v_mov_b32 v22, 0x3727c5ac
  v_fmac_f32 v22, 0x3acccccd, v27
  v_rsq_f32 v25, v22
  v_sub_f32 v24, v24, v26
  v_mul_f32 v24, v24, v25
  v_pk_fma_f32 v[56:57], v[56:57], v[24:25], v[24:25] op_sel:[0,1,0] op_sel_hi:[1,1,0]
  v_cvt_pk_bf16_f32 v36, v56, v57
  v_pk_fma_f32 v[58:59], v[58:59], v[24:25], v[24:25] op_sel:[0,1,0] op_sel_hi:[1,1,0]
  v_cvt_pk_bf16_f32 v37, v58, v59
  v_pk_fma_f32 v[60:61], v[60:61], v[24:25], v[24:25] op_sel:[0,1,0] op_sel_hi:[1,1,0]
  v_cvt_pk_bf16_f32 v38, v60, v61
  v_pk_fma_f32 v[62:63], v[62:63], v[24:25], v[24:25] op_sel:[0,1,0] op_sel_hi:[1,1,0]
  v_cvt_pk_bf16_f32 v39, v62, v63
  buffer_store_dwordx4 v[36:39], v20, s[4:7], s52 offen offset:0 sc1
  v_pk_fma_f32 v[64:65], v[64:65], v[24:25], v[24:25] op_sel:[0,1,0] op_sel_hi:[1,1,0]
  v_cvt_pk_bf16_f32 v40, v64, v65
  v_pk_fma_f32 v[66:67], v[66:67], v[24:25], v[24:25] op_sel:[0,1,0] op_sel_hi:[1,1,0]
  v_cvt_pk_bf16_f32 v41, v66, v67
  v_pk_fma_f32 v[68:69], v[68:69], v[24:25], v[24:25] op_sel:[0,1,0] op_sel_hi:[1,1,0]
  v_cvt_pk_bf16_f32 v42, v68, v69
  v_pk_fma_f32 v[70:71], v[70:71], v[24:25], v[24:25] op_sel:[0,1,0] op_sel_hi:[1,1,0]
  v_cvt_pk_bf16_f32 v43, v70, v71
  buffer_store_dwordx4 v[40:43], v20, s[4:7], s52 offen offset:1024 sc1
  v_pk_fma_f32 v[72:73], v[72:73], v[24:25], v[24:25] op_sel:[0,1,0] op_sel_hi:[1,1,0]
  v_cvt_pk_bf16_f32 v44, v72, v73
  v_pk_fma_f32 v[74:75], v[74:75], v[24:25], v[24:25] op_sel:[0,1,0] op_sel_hi:[1,1,0]
  v_cvt_pk_bf16_f32 v45, v74, v75
  v_pk_fma_f32 v[76:77], v[76:77], v[24:25], v[24:25] op_sel:[0,1,0] op_sel_hi:[1,1,0]
  v_cvt_pk_bf16_f32 v46, v76, v77
  v_pk_fma_f32 v[78:79], v[78:79], v[24:25], v[24:25] op_sel:[0,1,0] op_sel_hi:[1,1,0]
  v_cvt_pk_bf16_f32 v47, v78, v79
  buffer_store_dwordx4 v[44:47], v20, s[4:7], s52 offen offset:2048 sc1
  v_pk_fma_f32 v[80:81], v[80:81], v[24:25], v[24:25] op_sel:[0,1,0] op_sel_hi:[1,1,0]
  v_cvt_pk_bf16_f32 v48, v80, v81
  v_pk_fma_f32 v[82:83], v[82:83], v[24:25], v[24:25] op_sel:[0,1,0] op_sel_hi:[1,1,0]
  v_cvt_pk_bf16_f32 v49, v82, v83
  v_pk_fma_f32 v[84:85], v[84:85], v[24:25], v[24:25] op_sel:[0,1,0] op_sel_hi:[1,1,0]
  v_cvt_pk_bf16_f32 v50, v84, v85
  v_pk_fma_f32 v[86:87], v[86:87], v[24:25], v[24:25] op_sel:[0,1,0] op_sel_hi:[1,1,0]
  v_cvt_pk_bf16_f32 v51, v86, v87
  buffer_store_dwordx4 v[48:51], v20, s[4:7], s52 offen offset:3072 sc1
  v_pk_fma_f32 v[88:89], v[88:89], v[24:25], v[24:25] op_sel:[0,1,0] op_sel_hi:[1,1,0]
  v_cvt_pk_bf16_f32 v52, v88, v89
  v_pk_fma_f32 v[90:91], v[90:91], v[24:25], v[24:25] op_sel:[0,1,0] op_sel_hi:[1,1,0]
  v_cvt_pk_bf16_f32 v53, v90, v91
  v_pk_fma_f32 v[92:93], v[92:93], v[24:25], v[24:25] op_sel:[0,1,0] op_sel_hi:[1,1,0]
  v_cvt_pk_bf16_f32 v54, v92, v93
  v_pk_fma_f32 v[94:95], v[94:95], v[24:25], v[24:25] op_sel:[0,1,0] op_sel_hi:[1,1,0]
  v_cvt_pk_bf16_f32 v55, v94, v95
  buffer_store_dwordx4 v[52:55], v20, s[4:7], s53 offen offset:0 sc1
  s_lshr_b32 s52, s48, 1
  s_lshl_b32 s52, s52, 7
  s_and_b32 s53, s48, 1
  s_lshl_b32 s53, s53, 2
  s_add_u32 s53, s53, s3
  s_lshl_b32 s53, s53, 2
  s_add_u32 s52, s52, s53
  s_add_u32 s52, s52, 64909312
  s_add_u32 s53, s49, 1
  v_mov_b32 v22, s53
  s_mov_b64 exec, 1
  buffer_store_dword v22, off, s[4:7], s52 sc1
  s_mov_b64 exec, -1
  s_waitcnt vmcnt(0)
  s_barrier
  s_cmp_lg_u32 s3, 0
  s_cbranch_scc1 int_ar2
  s_lshl_b32 s68, 1, s9
  v_mov_b32 v254, s68
  v_mov_b32 v255, 0x100
  s_lshl_b32 s68, s8, 3
  s_add_u32 s68, s68, s67
  s_mov_b64 exec, 1
  buffer_atomic_add_x2 v[254:255], off, s[44:47], s68 sc0 sc1
  s_mov_b64 exec, -1
int_ar2:
  s_cmp_eq_u32 s74, 3
  s_cbranch_scc1 mk_urole
  ds_read_b64_tr_b16 a[0:1], v17 offset:0
  ds_read_b64_tr_b16 a[2:3], v17 offset:384
  ds_read_b64_tr_b16 a[80:81], v17 offset:32
  ds_read_b64_tr_b16 a[82:83], v17 offset:416
  ds_read_b64_tr_b16 a[160:161], v17 offset:64
  ds_read_b64_tr_b16 a[162:163], v17 offset:448
  ds_read_b64_tr_b16 a[4:5], v17 offset:3072
  ds_read_b64_tr_b16 a[6:7], v17 offset:3456
  ds_read_b64_tr_b16 a[84:85], v17 offset:3104
  ds_read_b64_tr_b16 a[86:87], v17 offset:3488
  ds_read_b64_tr_b16 a[164:165], v17 offset:3136
  ds_read_b64_tr_b16 a[166:167], v17 offset:3520
  s_waitcnt lgkmcnt(0)
  s_mov_b64 exec, s[76:77]
  s_add_u32 m0, s11, 0
  s_nop 0
  buffer_load_dwordx4 v16, s[92:95], s10 offen lds
  s_add_u32 s10, s10, 122880
  s_add_u32 m0, s11, 960
  s_nop 0
  buffer_load_dwordx4 v16, s[92:95], s10 offen lds
  s_add_u32 s10, s10, 122880
  s_add_u32 m0, s11, 1920
  s_nop 0
  buffer_load_dwordx4 v16, s[92:95], s10 offen lds
  s_add_u32 s10, s10, 122880
  s_add_u32 m0, s11, 2880
  s_nop 0
  buffer_load_dwordx4 v16, s[92:95], s10 offen lds
  s_add_u32 s10, s10, 122880
  s_add_u32 m0, s11, 3840
  s_nop 0
  buffer_load_dwordx4 v16, s[92:95], s10 offen lds
  s_add_u32 s10, s10, 122880
  s_add_u32 m0, s11, 4800
  s_nop 0
  buffer_load_dwordx4 v16, s[92:95], s10 offen lds
  s_add_u32 s10, s10, 122880
  s_mov_b64 exec, -1
  ds_read_b64_tr_b16 a[8:9], v17 offset:6144
  ds_read_b64_tr_b16 a[10:11], v17 offset:6528
  ds_read_b64_tr_b16 a[88:89], v17 offset:6176
  ds_read_b64_tr_b16 a[90:91], v17 offset:6560
  ds_read_b64_tr_b16 a[168:169], v17 offset:6208
  ds_read_b64_tr_b16 a[170:171], v17 offset:6592
  ds_read_b64_tr_b16 a[12:13], v17 offset:9216
  ds_read_b64_tr_b16 a[14:15], v17 offset:9600
  ds_read_b64_tr_b16 a[92:93], v17 offset:9248
  ds_read_b64_tr_b16 a[94:95], v17 offset:9632
  ds_read_b64_tr_b16 a[172:173], v17 offset:9280
  ds_read_b64_tr_b16 a[174:175], v17 offset:9664
  s_waitcnt lgkmcnt(0)
  s_mov_b64 exec, s[76:77]
  s_add_u32 m0, s11, 5760
  s_nop 0
  buffer_load_dwordx4 v16, s[92:95], s10 offen lds
  s_add_u32 s10, s10, 122880
  s_add_u32 m0, s11, 6720
  s_nop 0
  buffer_load_dwordx4 v16, s[92:95], s10 offen lds
  s_add_u32 s10, s10, 122880
  s_add_u32 m0, s11, 7680
  s_nop 0
  buffer_load_dwordx4 v16, s[92:95], s10 offen lds
  s_add_u32 s10, s10, 122880
  s_add_u32 m0, s11, 8640
  s_nop 0
  buffer_load_dwordx4 v16, s[92:95], s10 offen lds
  s_add_u32 s10, s10, 122880
  s_add_u32 m0, s11, 9600
  s_nop 0
  buffer_load_dwordx4 v16, s[92:95], s10 offen lds
  s_add_u32 s10, s10, 122880
  s_add_u32 m0, s11, 10560
  s_nop 0
  buffer_load_dwordx4 v16, s[92:95], s10 offen lds
  s_add_u32 s10, s10, 122880
  s_mov_b64 exec, -1
  ds_read_b64_tr_b16 a[16:17], v17 offset:12288
  ds_read_b64_tr_b16 a[18:19], v17 offset:12672
  ds_read_b64_tr_b16 a[96:97], v17 offset:12320
  ds_read_b64_tr_b16 a[98:99], v17 offset:12704
  ds_read_b64_tr_b16 a[176:177], v17 offset:12352
  ds_read_b64_tr_b16 a[178:179], v17 offset:12736
  ds_read_b64_tr_b16 a[20:21], v17 offset:15360
  ds_read_b64_tr_b16 a[22:23], v17 offset:15744
  ds_read_b64_tr_b16 a[100:101], v17 offset:15392
  ds_read_b64_tr_b16 a[102:103], v17 offset:15776
  ds_read_b64_tr_b16 a[180:181], v17 offset:15424
  ds_read_b64_tr_b16 a[182:183], v17 offset:15808
  s_waitcnt lgkmcnt(0)
  s_mov_b64 exec, s[76:77]
  s_add_u32 m0, s11, 11520
  s_nop 0
  buffer_load_dwordx4 v16, s[92:95], s10 offen lds
  s_add_u32 s10, s10, 122880
  s_add_u32 m0, s11, 12480
  s_nop 0
  buffer_load_dwordx4 v16, s[92:95], s10 offen lds
  s_add_u32 s10, s10, 122880
  s_add_u32 m0, s11, 13440
  s_nop 0
  buffer_load_dwordx4 v16, s[92:95], s10 offen lds
  s_add_u32 s10, s10, 122880
  s_add_u32 m0, s11, 14400
  s_nop 0
  buffer_load_dwordx4 v16, s[92:95], s10 offen lds
  s_add_u32 s10, s10, 122880
  s_add_u32 m0, s11, 15360
  s_nop 0
  buffer_load_dwordx4 v16, s[92:95], s10 offen lds
  s_add_u32 s10, s10, 122880
  s_add_u32 m0, s11, 16320
  s_nop 0
  buffer_load_dwordx4 v16, s[92:95], s10 offen lds
  s_add_u32 s10, s10, 122880
  s_add_u32 m0, s11, 17280
  s_nop 0
  buffer_load_dwordx4 v16, s[92:95], s10 offen lds
  s_add_u32 s10, s10, 122880
  s_mov_b64 exec, -1
  ds_read_b64_tr_b16 a[24:25], v17 offset:18432
  ds_read_b64_tr_b16 a[26:27], v17 offset:18816
  ds_read_b64_tr_b16 a[104:105], v17 offset:18464
  ds_read_b64_tr_b16 a[106:107], v17 offset:18848
  ds_read_b64_tr_b16 a[184:185], v17 offset:18496
  ds_read_b64_tr_b16 a[186:187], v17 offset:18880
  ds_read_b64_tr_b16 a[28:29], v17 offset:21504
  ds_read_b64_tr_b16 a[30:31], v17 offset:21888
  ds_read_b64_tr_b16 a[108:109], v17 offset:21536
  ds_read_b64_tr_b16 a[110:111], v17 offset:21920
  ds_read_b64_tr_b16 a[188:189], v17 offset:21568
  ds_read_b64_tr_b16 a[190:191], v17 offset:21952
  s_waitcnt lgkmcnt(0)
  s_mov_b64 exec, s[76:77]
  s_add_u32 m0, s11, 18240
  s_nop 0
  buffer_load_dwordx4 v16, s[92:95], s10 offen lds
  s_add_u32 s10, s10, 122880
  s_add_u32 m0, s11, 19200
  s_nop 0
  buffer_load_dwordx4 v16, s[92:95], s10 offen lds
  s_add_u32 s10, s10, 122880
  s_add_u32 m0, s11, 20160
  s_nop 0
  buffer_load_dwordx4 v16, s[92:95], s10 offen lds
  s_add_u32 s10, s10, 122880
  s_add_u32 m0, s11, 21120
  s_nop 0
  buffer_load_dwordx4 v16, s[92:95], s10 offen lds
  s_add_u32 s10, s10, 122880
  s_add_u32 m0, s11, 22080
  s_nop 0
  buffer_load_dwordx4 v16, s[92:95], s10 offen lds
  s_add_u32 s10, s10, 122880
  s_add_u32 m0, s11, 23040
  s_nop 0
  buffer_load_dwordx4 v16, s[92:95], s10 offen lds
  s_add_u32 s10, s10, 122880
  s_mov_b64 exec, -1
  ds_read_b64_tr_b16 a[32:33], v17 offset:24576
  ds_read_b64_tr_b16 a[34:35], v17 offset:24960
  ds_read_b64_tr_b16 a[112:113], v17 offset:24608
  ds_read_b64_tr_b16 a[114:115], v17 offset:24992
  ds_read_b64_tr_b16 a[192:193], v17 offset:24640
  ds_read_b64_tr_b16 a[194:195], v17 offset:25024
  ds_read_b64_tr_b16 a[36:37], v17 offset:27648
  ds_read_b64_tr_b16 a[38:39], v17 offset:28032
  ds_read_b64_tr_b16 a[116:117], v17 offset:27680
  ds_read_b64_tr_b16 a[118:119], v17 offset:28064
  ds_read_b64_tr_b16 a[196:197], v17 offset:27712
  ds_read_b64_tr_b16 a[198:199], v17 offset:28096
  s_waitcnt lgkmcnt(0)
  s_mov_b64 exec, s[76:77]
  s_add_u32 m0, s11, 24000
  s_nop 0
  buffer_load_dwordx4 v16, s[92:95], s10 offen lds
  s_add_u32 s10, s10, 122880
  s_add_u32 m0, s11, 24960
  s_nop 0
  buffer_load_dwordx4 v16, s[92:95], s10 offen lds
  s_add_u32 s10, s10, 122880
  s_add_u32 m0, s11, 25920
  s_nop 0
  buffer_load_dwordx4 v16, s[92:95], s10 offen lds
  s_add_u32 s10, s10, 122880
  s_add_u32 m0, s11, 26880
  s_nop 0
  buffer_load_dwordx4 v16, s[92:95], s10 offen lds
  s_add_u32 s10, s10, 122880
  s_add_u32 m0, s11, 27840
  s_nop 0
  buffer_load_dwordx4 v16, s[92:95], s10 offen lds
  s_add_u32 s10, s10, 122880
  s_add_u32 m0, s11, 28800
  s_nop 0
  buffer_load_dwordx4 v16, s[92:95], s10 offen lds
  s_add_u32 s10, s10, 122880
  s_add_u32 m0, s11, 29760
  s_nop 0
  buffer_load_dwordx4 v16, s[92:95], s10 offen lds
  s_add_u32 s10, s10, 122880
  s_mov_b64 exec, -1
  s_waitcnt vmcnt(28)
  ds_read_b64_tr_b16 a[40:41], v17 offset:0
  ds_read_b64_tr_b16 a[42:43], v17 offset:384
  ds_read_b64_tr_b16 a[120:121], v17 offset:32
  ds_read_b64_tr_b16 a[122:123], v17 offset:416
  ds_read_b64_tr_b16 a[200:201], v17 offset:64
  ds_read_b64_tr_b16 a[202:203], v17 offset:448
  s_waitcnt vmcnt(25)
  ds_read_b64_tr_b16 a[44:45], v17 offset:3072
  ds_read_b64_tr_b16 a[46:47], v17 offset:3456
  ds_read_b64_tr_b16 a[124:125], v17 offset:3104
  ds_read_b64_tr_b16 a[126:127], v17 offset:3488
  ds_read_b64_tr_b16 a[204:205], v17 offset:3136
  ds_read_b64_tr_b16 a[206:207], v17 offset:3520
  s_waitcnt vmcnt(22)
  ds_read_b64_tr_b16 a[48:49], v17 offset:6144
  ds_read_b64_tr_b16 a[50:51], v17 offset:6528
  ds_read_b64_tr_b16 a[128:129], v17 offset:6176
  ds_read_b64_tr_b16 a[130:131], v17 offset:6560
  ds_read_b64_tr_b16 a[208:209], v17 offset:6208
  ds_read_b64_tr_b16 a[210:211], v17 offset:6592
  s_waitcnt vmcnt(19)
  ds_read_b64_tr_b16 a[52:53], v17 offset:9216
  ds_read_b64_tr_b16 a[54:55], v17 offset:9600
  ds_read_b64_tr_b16 a[132:133], v17 offset:9248
  ds_read_b64_tr_b16 a[134:135], v17 offset:9632
  ds_read_b64_tr_b16 a[212:213], v17 offset:9280
  ds_read_b64_tr_b16 a[214:215], v17 offset:9664
  s_waitcnt vmcnt(16)
  ds_read_b64_tr_b16 a[56:57], v17 offset:12288
  ds_read_b64_tr_b16 a[58:59], v17 offset:12672
  ds_read_b64_tr_b16 a[136:137], v17 offset:12320
  ds_read_b64_tr_b16 a[138:139], v17 offset:12704
  ds_read_b64_tr_b16 a[216:217], v17 offset:12352
  ds_read_b64_tr_b16 a[218:219], v17 offset:12736
  s_waitcnt vmcnt(12)
  ds_read_b64_tr_b16 a[60:61], v17 offset:15360
  ds_read_b64_tr_b16 a[62:63], v17 offset:15744
  ds_read_b64_tr_b16 a[140:141], v17 offset:15392
  ds_read_b64_tr_b16 a[142:143], v17 offset:15776
  ds_read_b64_tr_b16 a[220:221], v17 offset:15424
  ds_read_b64_tr_b16 a[222:223], v17 offset:15808
  s_waitcnt vmcnt(9)
  ds_read_b64_tr_b16 a[64:65], v17 offset:18432
  ds_read_b64_tr_b16 a[66:67], v17 offset:18816
  ds_read_b64_tr_b16 a[144:145], v17 offset:18464
  ds_read_b64_tr_b16 a[146:147], v17 offset:18848
  ds_read_b64_tr_b16 a[224:225], v17 offset:18496
  ds_read_b64_tr_b16 a[226:227], v17 offset:18880
  s_waitcnt vmcnt(6)
  ds_read_b64_tr_b16 a[68:69], v17 offset:21504
  ds_read_b64_tr_b16 a[70:71], v17 offset:21888
  ds_read_b64_tr_b16 a[148:149], v17 offset:21536
  ds_read_b64_tr_b16 a[150:151], v17 offset:21920
  ds_read_b64_tr_b16 a[228:229], v17 offset:21568
  ds_read_b64_tr_b16 a[230:231], v17 offset:21952
  s_waitcnt vmcnt(3)
  ds_read_b64_tr_b16 a[72:73], v17 offset:24576
  ds_read_b64_tr_b16 a[74:75], v17 offset:24960
  ds_read_b64_tr_b16 a[152:153], v17 offset:24608
  ds_read_b64_tr_b16 a[154:155], v17 offset:24992
  ds_read_b64_tr_b16 a[232:233], v17 offset:24640
  ds_read_b64_tr_b16 a[234:235], v17 offset:25024
  s_waitcnt vmcnt(0)
  ds_read_b64_tr_b16 a[76:77], v17 offset:27648
  ds_read_b64_tr_b16 a[78:79], v17 offset:28032
  ds_read_b64_tr_b16 a[156:157], v17 offset:27680
  ds_read_b64_tr_b16 a[158:159], v17 offset:28064
  ds_read_b64_tr_b16 a[236:237], v17 offset:27712
  ds_read_b64_tr_b16 a[238:239], v17 offset:28096
  s_waitcnt lgkmcnt(0)
  v_and_b32 v252, 7, v1
  v_lshlrev_b32 v252, 3, v252
  s_mov_b32 s70, 0
int_ce3:
  buffer_load_dwordx2 v[250:251], v252, s[44:47], s67 offen sc1
  s_waitcnt vmcnt(0)
  v_lshrrev_b32 v253, 8, v251
  v_cmp_ne_u32 vcc, 32, v253
  s_nop 0
  s_cbranch_vccz int_ce3_ok
  s_sleep 8
  s_add_u32 s70, s70, 1
  s_cmp_lt_u32 s70, 262144
  s_cbranch_scc1 int_ce3
  s_branch mk_fail
int_ce3_ok:
  v_not_b32 v250, v250
  v_and_b32 v251, 0xff, v251
  v_or_b32 v250, v250, v251
  v_cmp_ne_u32 vcc, 0, v250
  s_nop 0
  s_cbranch_vccnz mk_redo
  v_lshlrev_b32 v252, 2, v1
  s_mov_b32 s68, 64946176
  buffer_load_dword v250, v252, s[4:7], s68 offen sc1
  s_waitcnt vmcnt(0)
  v_cmp_eq_u32 s[64:65], 1, v250
  s_barrier
  s_cmp_eq_u32 s74, 2
  s_cbranch_scc1 mk_qrole
mk_kv_entry:
  v_lshlrev_b32 v2, 4, v1
  s_mul_i32 s13, s3, 10240
  v_lshrrev_b32 v7, 3, v1
  v_lshlrev_b32 v7, 7, v7
  v_and_b32 v8, 7, v1
  v_lshl_add_u32 v7, v8, 2, v7
  v_mov_b32 v12, -1
  v_mov_b32 v13, -1
  v_mov_b32 v14, -1
  v_mov_b32 v15, -1
  v_min_u32 v0, 1, v1
  v_lshlrev_b32 v0, 30, v0
  s_lshl_b32 s15, s3, 10
  v_add_u32 v3, s15, v2
  v_add_u32 v4, s15, v3
  s_lshr_b32 s15, s3, 1
  s_cmp_eq_u32 s73, 7
  s_cselect_b32 s16, 0, s74
  s_andn2_b32 s15, s15, s16
  s_lshl_b32 s15, s15, 30
  v_add_u32 v4, s15, v4
  v_and_b32 v9, 31, v1
  v_lshlrev_b32 v9, 7, v9
  s_add_u32 s30, s73, 40
  s_lshl_b32 s30, s30, 14
  s_add_u32 s30, s30, s39
  s_lshr_b32 s31, s73, 1
  s_sub_u32 s31, s31, s73
  s_add_u32 s31, s31, 8
  s_lshl_b32 s31, s31, 14
  s_and_b32 s15, s73, 1
  s_lshl_b32 s15, s15, 12
  s_add_u32 s31, s31, s15
  s_lshl_b32 s25, s74, 12
  s_lshl_b32 s15, s75, 7
  s_add_u32 s25, s25, s15
  s_lshl_b32 s15, s3, 2
  s_add_u32 s25, s25, s15
  s_add_u32 s25, s25, 64880640
  s_mov_b32 s32, 0
  s_lshl_b32 s14, s66, 1
  s_add_u32 s14, s14, s74
  s_lshl_b32 s14, s14, 5
  s_add_u32 s14, s14, s75
  s_lshl_b32 s14, s14, 13
  s_add_u32 s14, s14, 62914560
  s_add_u32 s15, s14, 4096
  buffer_store_dwordx4 v[12:15], v3, s[4:7], s14 offen
  buffer_store_dwordx4 v[12:15], v3, s[4:7], s15 offen
  s_and_b32 s14, s3, 2
  s_add_u32 s14, s14, s74
  s_lshl_b32 s14, s14, 1
  s_and_b32 s15, s3, 1
  s_add_u32 s14, s14, s15
  s_lshl_b32 s15, s66, 6
  s_add_u32 s14, s14, s15
  s_mul_i32 s14, s14, 40960
  s_add_u32 s14, s14, 47185920
  s_lshl_b32 s15, s75, 8
  s_add_u32 s15, s15, s14
  s_add_u32 s15, s15, 32768
  s_lshl_b32 s68, s75, 10
  s_add_u32 s14, s14, s68
  v_lshrrev_b32 v10, 4, v1
  v_mul_u32_u24 v10, 327424, v10
  v_add_u32 v10, v10, v2
  buffer_store_dwordx4 v[12:15], v2, s[4:7], s14 offen sc1
  s_add_u32 s14, s14, 327680
  buffer_store_dwordx4 v[12:15], v10, s[4:7], s15 offen sc1
  s_add_u32 s15, s15, 1310720
  buffer_store_dwordx4 v[12:15], v2, s[4:7], s14 offen sc1
  s_add_u32 s14, s14, 327680
  buffer_store_dwordx4 v[12:15], v2, s[4:7], s14 offen sc1
  s_add_u32 s14, s14, 327680
  buffer_store_dwordx4 v[12:15], v2, s[4:7], s14 offen sc1
  s_add_u32 s14, s14, 327680
  buffer_store_dwordx4 v[12:15], v2, s[4:7], s14 offen sc1
  s_add_u32 s14, s14, 327680
  buffer_store_dwordx4 v[12:15], v10, s[4:7], s15 offen sc1
  s_add_u32 s15, s15, 1310720
  buffer_store_dwordx4 v[12:15], v2, s[4:7], s14 offen sc1
  s_add_u32 s14, s14, 327680
  buffer_store_dwordx4 v[12:15], v2, s[4:7], s14 offen sc1
  s_add_u32 s14, s14, 327680
  buffer_store_dwordx4 v[12:15], v2, s[4:7], s14 offen sc1
  s_add_u32 s14, s14, 327680
  s_lshl_b32 s28, s66, 1
  s_mul_i32 s12, s28, 2621440
  s_add_u32 s12, s12, s13
  s_add_u32 s12, s12, 36700160
  s_add_u32 s28, s28, 1
  s_cmp_eq_u32 s66, 0
  s_cselect_b32 s26, 64, 0
  s_mov_b32 s27, 0
  s_mov_b32 s20, 0
  s_mov_b32 s21, 40960
  s_mov_b32 s22, 81920
  s_lshl_b32 s24, s66, 6
  s_cmp_ge_u32 s26, 64
  s_cbranch_scc1 int_hn4_ok
  s_mov_b32 s70, 0
int_hn4:
  s_lshl_b32 s29, s26, 7
  s_add_u32 s29, s29, 64909312
  buffer_load_dword v8, v7, s[4:7], s29 offen sc1
  s_waitcnt vmcnt(0)
int_hn4_a:
  v_cmp_gt_u32 vcc, s28, v8
  s_nop 0
  s_ff1_i32_b64 s29, vcc
  s_min_u32 s29, s29, 64
  s_lshr_b32 s29, s29, 3
  s_add_u32 s26, s26, s29
  s_min_u32 s29, s27, 63
  s_cmp_gt_u32 s26, s29
  s_cbranch_scc1 int_hn4_g
  s_sleep 1
  s_add_u32 s70, s70, 1
  s_cmp_lt_u32 s70, 262144
  s_cbranch_scc1 int_hn4
  s_branch mk_fail
int_hn4_g:
int_hn4_ok:
  s_add_u32 s17, s20, s13
  s_min_u32 s18, s27, 63
  s_mul_i32 s18, s18, 40960
  s_add_u32 s18, s18, s12
  s_add_u32 s27, s27, 1
  s_add_u32 m0, s17, 0
  s_nop 0
  buffer_load_dwordx4 v2, s[4:7], s18 offen offset:0 sc1 lds
  buffer_load_dwordx4 v2, s[4:7], s18 offen offset:1024 sc1 lds
  buffer_load_dwordx4 v2, s[4:7], s18 offen offset:2048 sc1 lds
  buffer_load_dwordx4 v2, s[4:7], s18 offen offset:3072 sc1 lds
  s_add_u32 s18, s18, 4096
  s_add_u32 m0, s17, 4096
  s_nop 0
  buffer_load_dwordx4 v2, s[4:7], s18 offen offset:0 sc1 lds
  buffer_load_dwordx4 v2, s[4:7], s18 offen offset:1024 sc1 lds
  buffer_load_dwordx4 v2, s[4:7], s18 offen offset:2048 sc1 lds
  buffer_load_dwordx4 v2, s[4:7], s18 offen offset:3072 sc1 lds
  s_add_u32 s18, s18, 4096
  s_add_u32 m0, s17, 8192
  s_nop 0
  buffer_load_dwordx4 v2, s[4:7], s18 offen offset:0 sc1 lds
  buffer_load_dwordx4 v2, s[4:7], s18 offen offset:1024 sc1 lds
  s_cmp_ge_u32 s26, 64
  s_cbranch_scc1 int_hn5_ok
  s_mov_b32 s70, 0
int_hn5:
  s_lshl_b32 s29, s26, 7
  s_add_u32 s29, s29, 64909312
  buffer_load_dword v8, v7, s[4:7], s29 offen sc1
  s_waitcnt vmcnt(0)
int_hn5_a:
  v_cmp_gt_u32 vcc, s28, v8
  s_nop 0
  s_ff1_i32_b64 s29, vcc
  s_min_u32 s29, s29, 64
  s_lshr_b32 s29, s29, 3
  s_add_u32 s26, s26, s29
  s_min_u32 s29, s27, 63
  s_cmp_gt_u32 s26, s29
  s_cbranch_scc1 int_hn5_g
  s_sleep 1
  s_add_u32 s70, s70, 1
  s_cmp_lt_u32 s70, 262144
  s_cbranch_scc1 int_hn5
  s_branch mk_fail
int_hn5_g:
int_hn5_ok:
  s_add_u32 s17, s21, s13
  s_min_u32 s18, s27, 63
  s_mul_i32 s18, s18, 40960
  s_add_u32 s18, s18, s12
  s_add_u32 s27, s27, 1
  s_add_u32 m0, s17, 0
  s_nop 0
  buffer_load_dwordx4 v2, s[4:7], s18 offen offset:0 sc1 lds
  buffer_load_dwordx4 v2, s[4:7], s18 offen offset:1024 sc1 lds
  buffer_load_dwordx4 v2, s[4:7], s18 offen offset:2048 sc1 lds
  buffer_load_dwordx4 v2, s[4:7], s18 offen offset:3072 sc1 lds
  s_add_u32 s18, s18, 4096
  s_add_u32 m0, s17, 4096
  s_nop 0
  buffer_load_dwordx4 v2, s[4:7], s18 offen offset:0 sc1 lds
  buffer_load_dwordx4 v2, s[4:7], s18 offen offset:1024 sc1 lds
  buffer_load_dwordx4 v2, s[4:7], s18 offen offset:2048 sc1 lds
  buffer_load_dwordx4 v2, s[4:7], s18 offen offset:3072 sc1 lds
  s_add_u32 s18, s18, 4096
  s_add_u32 m0, s17, 8192
  s_nop 0
  buffer_load_dwordx4 v2, s[4:7], s18 offen offset:0 sc1 lds
  buffer_load_dwordx4 v2, s[4:7], s18 offen offset:1024 sc1 lds
  s_lshl_b32 s29, s26, 7
  s_add_u32 s29, s29, 64909312
  buffer_load_dword v8, v7, s[4:7], s29 offen sc1
  v_mov_b32 v5, v2
  s_waitcnt vmcnt(11)
  s_barrier
  ds_read_b128 v[16:19], v5 offset:0
  ds_read_b128 v[20:23], v5 offset:20480
  ds_read_b128 v[24:27], v5 offset:1024
  ds_read_b128 v[28:31], v5 offset:21504
  ds_read_b128 v[32:35], v5 offset:2048
  ds_read_b128 v[36:39], v5 offset:22528
  s_mov_b32 s14, 0x40000000
  s_mov_b32 s15, 0x40000000
  s_mov_b32 s16, 0x40000000
  s_mov_b32 s33, 0x40000000
mk_kv_loop:
  s_waitcnt lgkmcnt(4)
  v_cvt_pk_bf16_f32 v72, v48, v49
  v_cvt_pk_bf16_f32 v73, v50, v51
  v_mfma_f32_16x16x32_bf16 v[48:51], a[0:3], v[16:19], 0
  ds_read_b128 v[40:43], v5 offset:3072
  v_cvt_pk_bf16_f32 v74, v52, v53
  v_cvt_pk_bf16_f32 v75, v54, v55
  v_mfma_f32_16x16x32_bf16 v[52:55], a[80:83], v[16:19], 0
  v_cvt_pk_bf16_f32 v80, v56, v57
  v_cvt_pk_bf16_f32 v81, v58, v59
  v_mfma_f32_16x16x32_bf16 v[56:59], a[160:163], v[16:19], 0
  v_cvt_pk_bf16_f32 v76, v60, v61
  v_cvt_pk_bf16_f32 v77, v62, v63
  v_mfma_f32_16x16x32_bf16 v[60:63], a[0:3], v[20:23], 0
  ds_read_b128 v[44:47], v5 offset:23552
  v_cvt_pk_bf16_f32 v78, v64, v65
  v_cvt_pk_bf16_f32 v79, v66, v67
  v_mfma_f32_16x16x32_bf16 v[64:67], a[80:83], v[20:23], 0
  v_cvt_pk_bf16_f32 v82, v68, v69
  v_cvt_pk_bf16_f32 v83, v70, v71
  v_mfma_f32_16x16x32_bf16 v[68:71], a[160:163], v[20:23], 0
  s_waitcnt lgkmcnt(4)
  v_mfma_f32_16x16x32_bf16 v[48:51], a[4:7], v[24:27], v[48:51]
  ds_read_b128 v[16:19], v5 offset:4096
  v_mfma_f32_16x16x32_bf16 v[52:55], a[84:87], v[24:27], v[52:55]
  v_mfma_f32_16x16x32_bf16 v[56:59], a[164:167], v[24:27], v[56:59]
  v_mfma_f32_16x16x32_bf16 v[60:63], a[4:7], v[28:31], v[60:63]
  ds_read_b128 v[20:23], v5 offset:24576
  v_mfma_f32_16x16x32_bf16 v[64:67], a[84:87], v[28:31], v[64:67]
  v_mfma_f32_16x16x32_bf16 v[68:71], a[164:167], v[28:31], v[68:71]
  s_waitcnt lgkmcnt(4)
  v_mfma_f32_16x16x32_bf16 v[48:51], a[8:11], v[32:35], v[48:51]
  ds_read_b128 v[24:27], v5 offset:5120
  v_mfma_f32_16x16x32_bf16 v[52:55], a[88:91], v[32:35], v[52:55]
  s_waitcnt vmcnt(10)
  s_sub_u32 s29, s24, 1
  s_lshl_b32 s19, s66, 6
  v_mfma_f32_16x16x32_bf16 v[56:59], a[168:171], v[32:35], v[56:59]
  s_max_i32 s29, s29, s19
  v_mfma_f32_16x16x32_bf16 v[60:63], a[8:11], v[36:39], v[60:63]
  ds_read_b128 v[28:31], v5 offset:25600
  v_mfma_f32_16x16x32_bf16 v[64:67], a[88:91], v[36:39], v[64:67]
  v_mov_b32 v10, s29
  v_mfma_f32_16x16x32_bf16 v[68:71], a[168:171], v[36:39], v[68:71]
  s_waitcnt lgkmcnt(4)
  v_mfma_f32_16x16x32_bf16 v[48:51], a[12:15], v[40:43], v[48:51]
  ds_read_b128 v[32:35], v5 offset:6144
  v_mfma_f32_16x16x32_bf16 v[52:55], a[92:95], v[40:43], v[52:55]
  buffer_store_dword v10, v0, s[4:7], s25 offen sc1
  v_mfma_f32_16x16x32_bf16 v[56:59], a[172:175], v[40:43], v[56:59]
  buffer_store_dwordx4 v[72:75], v3, s[4:7], s14 offen sc1
  v_mfma_f32_16x16x32_bf16 v[60:63], a[12:15], v[44:47], v[60:63]
  ds_read_b128 v[36:39], v5 offset:26624
  v_mfma_f32_16x16x32_bf16 v[64:67], a[92:95], v[44:47], v[64:67]
  v_mfma_f32_16x16x32_bf16 v[68:71], a[172:175], v[44:47], v[68:71]
  s_waitcnt lgkmcnt(4)
  v_mfma_f32_16x16x32_bf16 v[48:51], a[16:19], v[16:19], v[48:51]
  ds_read_b128 v[40:43], v5 offset:7168
  v_mfma_f32_16x16x32_bf16 v[52:55], a[96:99], v[16:19], v[52:55]
  buffer_store_dwordx4 v[76:79], v3, s[4:7], s15 offen sc1
  v_mfma_f32_16x16x32_bf16 v[56:59], a[176:179], v[16:19], v[56:59]
  v_mfma_f32_16x16x32_bf16 v[60:63], a[16:19], v[20:23], v[60:63]
  ds_read_b128 v[44:47], v5 offset:27648
  v_mfma_f32_16x16x32_bf16 v[64:67], a[96:99], v[20:23], v[64:67]
  v_mfma_f32_16x16x32_bf16 v[68:71], a[176:179], v[20:23], v[68:71]
  s_waitcnt lgkmcnt(4)
  v_mfma_f32_16x16x32_bf16 v[48:51], a[20:23], v[24:27], v[48:51]
  ds_read_b128 v[16:19], v5 offset:8192
  v_mfma_f32_16x16x32_bf16 v[52:55], a[100:103], v[24:27], v[52:55]
  buffer_store_dwordx4 v[80:83], v3, s[4:7], s16 offen sc1
  v_mfma_f32_16x16x32_bf16 v[56:59], a[180:183], v[24:27], v[56:59]
  v_mfma_f32_16x16x32_bf16 v[60:63], a[20:23], v[28:31], v[60:63]
  ds_read_b128 v[20:23], v5 offset:28672
  v_mfma_f32_16x16x32_bf16 v[64:67], a[100:103], v[28:31], v[64:67]
  v_mfma_f32_16x16x32_bf16 v[68:71], a[180:183], v[28:31], v[68:71]
  s_waitcnt lgkmcnt(4)
  v_mfma_f32_16x16x32_bf16 v[48:51], a[24:27], v[32:35], v[48:51]
  ds_read_b128 v[24:27], v5 offset:9216
  v_mfma_f32_16x16x32_bf16 v[52:55], a[104:107], v[32:35], v[52:55]
  buffer_store_dwordx4 v[12:15], v4, s[4:7], s33 offen sc1
  v_mfma_f32_16x16x32_bf16 v[56:59], a[184:187], v[32:35], v[56:59]
  v_mfma_f32_16x16x32_bf16 v[60:63], a[24:27], v[36:39], v[60:63]
  ds_read_b128 v[28:31], v5 offset:29696
  v_mfma_f32_16x16x32_bf16 v[64:67], a[104:107], v[36:39], v[64:67]
  v_mfma_f32_16x16x32_bf16 v[68:71], a[184:187], v[36:39], v[68:71]
  s_waitcnt lgkmcnt(4)
  v_mfma_f32_16x16x32_bf16 v[48:51], a[28:31], v[40:43], v[48:51]
  ds_read_b128 v[32:35], v5 offset:10240
  v_mfma_f32_16x16x32_bf16 v[52:55], a[108:111], v[40:43], v[52:55]
  buffer_store_dwordx4 v[12:15], v4, s[4:7], s33 offen offset:1024 sc1
  v_mfma_f32_16x16x32_bf16 v[56:59], a[188:191], v[40:43], v[56:59]
  v_mfma_f32_16x16x32_bf16 v[60:63], a[28:31], v[44:47], v[60:63]
  ds_read_b128 v[36:39], v5 offset:30720
  v_mfma_f32_16x16x32_bf16 v[64:67], a[108:111], v[44:47], v[64:67]
  v_mfma_f32_16x16x32_bf16 v[68:71], a[188:191], v[44:47], v[68:71]
  s_waitcnt lgkmcnt(4)
  v_mfma_f32_16x16x32_bf16 v[48:51], a[32:35], v[16:19], v[48:51]
  ds_read_b128 v[40:43], v5 offset:11264
  v_mfma_f32_16x16x32_bf16 v[52:55], a[112:115], v[16:19], v[52:55]
  v_mfma_f32_16x16x32_bf16 v[56:59], a[192:195], v[16:19], v[56:59]
  v_mfma_f32_16x16x32_bf16 v[60:63], a[32:35], v[20:23], v[60:63]
  ds_read_b128 v[44:47], v5 offset:31744
  v_mfma_f32_16x16x32_bf16 v[64:67], a[112:115], v[20:23], v[64:67]
  v_mfma_f32_16x16x32_bf16 v[68:71], a[192:195], v[20:23], v[68:71]
  s_waitcnt lgkmcnt(4)
  v_mfma_f32_16x16x32_bf16 v[48:51], a[36:39], v[24:27], v[48:51]
  ds_read_b128 v[16:19], v5 offset:12288
  v_mfma_f32_16x16x32_bf16 v[52:55], a[116:119], v[24:27], v[52:55]
  s_sub_u32 s29, s24, 31
  s_bitcmp1_b32 s24, 5
  s_cselect_b32 s29, s29, 0
  v_mfma_f32_16x16x32_bf16 v[56:59], a[196:199], v[24:27], v[56:59]
  s_cmp_lt_u32 s32, s29
  s_cbranch_scc1 int_sl6
int_sl6_b:
  s_and_b32 s14, s24, 31
  v_mfma_f32_16x16x32_bf16 v[60:63], a[36:39], v[28:31], v[60:63]
  ds_read_b128 v[20:23], v5 offset:32768
  v_mfma_f32_16x16x32_bf16 v[64:67], a[116:119], v[28:31], v[64:67]
  s_lshl_b32 s14, s14, 2
  s_add_u32 s14, s14, s72
  s_lshr_b32 s68, s14, 1
  v_mfma_f32_16x16x32_bf16 v[68:71], a[196:199], v[28:31], v[68:71]
  s_bitcmp1_b64 s[64:65], s68
  s_cselect_b32 s68, 0x2000, 0
  s_waitcnt lgkmcnt(4)
  v_mfma_f32_16x16x32_bf16 v[48:51], a[40:43], v[32:35], v[48:51]
  ds_read_b128 v[24:27], v5 offset:13312
  v_mfma_f32_16x16x32_bf16 v[52:55], a[120:123], v[32:35], v[52:55]
  s_lshl_b32 s14, s14, 20
  s_add_u32 s14, s14, s68
  s_add_u32 s14, s14, s30
  v_mfma_f32_16x16x32_bf16 v[56:59], a[200:203], v[32:35], v[56:59]
  s_sub_u32 s14, s14, s68
  s_lshl_b32 s15, s74, 13
  s_xor_b32 s15, s15, s68
  v_mfma_f32_16x16x32_bf16 v[60:63], a[40:43], v[36:39], v[60:63]
  ds_read_b128 v[28:31], v5 offset:33792
  v_mfma_f32_16x16x32_bf16 v[64:67], a[120:123], v[36:39], v[64:67]
  s_xor_b32 s33, s15, 0x2000
  s_add_u32 s33, s33, s14
  s_add_u32 s33, s33, 196608
  v_mfma_f32_16x16x32_bf16 v[68:71], a[200:203], v[36:39], v[68:71]
  s_add_u32 s14, s14, s15
  s_add_u32 s15, s14, 4096
  s_waitcnt lgkmcnt(4)
  v_mfma_f32_16x16x32_bf16 v[48:51], a[44:47], v[40:43], v[48:51]
  ds_read_b128 v[32:35], v5 offset:14336
  v_mfma_f32_16x16x32_bf16 v[52:55], a[124:127], v[40:43], v[52:55]
  s_add_u32 s16, s14, s31
  v_mfma_f32_16x16x32_bf16 v[56:59], a[204:207], v[40:43], v[56:59]
  v_mfma_f32_16x16x32_bf16 v[60:63], a[44:47], v[44:47], v[60:63]
  ds_read_b128 v[36:39], v5 offset:34816
  v_mfma_f32_16x16x32_bf16 v[64:67], a[124:127], v[44:47], v[64:67]
  v_mfma_f32_16x16x32_bf16 v[68:71], a[204:207], v[44:47], v[68:71]
  s_waitcnt lgkmcnt(4)
  v_mfma_f32_16x16x32_bf16 v[48:51], a[48:51], v[16:19], v[48:51]
  ds_read_b128 v[40:43], v5 offset:15360
  v_mfma_f32_16x16x32_bf16 v[52:55], a[128:131], v[16:19], v[52:55]
  v_mfma_f32_16x16x32_bf16 v[56:59], a[208:211], v[16:19], v[56:59]
  v_mfma_f32_16x16x32_bf16 v[60:63], a[48:51], v[20:23], v[60:63]
  ds_read_b128 v[44:47], v5 offset:35840
  v_mfma_f32_16x16x32_bf16 v[64:67], a[128:131], v[20:23], v[64:67]
  v_mfma_f32_16x16x32_bf16 v[68:71], a[208:211], v[20:23], v[68:71]
  s_waitcnt lgkmcnt(4)
  v_mfma_f32_16x16x32_bf16 v[48:51], a[52:55], v[24:27], v[48:51]
  ds_read_b128 v[16:19], v5 offset:16384
  v_mfma_f32_16x16x32_bf16 v[52:55], a[132:135], v[24:27], v[52:55]
  v_mfma_f32_16x16x32_bf16 v[56:59], a[212:215], v[24:27], v[56:59]
  v_mfma_f32_16x16x32_bf16 v[60:63], a[52:55], v[28:31], v[60:63]
  ds_read_b128 v[20:23], v5 offset:36864
  v_mfma_f32_16x16x32_bf16 v[64:67], a[132:135], v[28:31], v[64:67]
  v_mfma_f32_16x16x32_bf16 v[68:71], a[212:215], v[28:31], v[68:71]
  s_waitcnt lgkmcnt(4)
  v_mfma_f32_16x16x32_bf16 v[48:51], a[56:59], v[32:35], v[48:51]
  ds_read_b128 v[24:27], v5 offset:17408
  v_mfma_f32_16x16x32_bf16 v[52:55], a[136:139], v[32:35], v[52:55]
  s_waitcnt vmcnt(6)
  s_barrier
  v_mfma_f32_16x16x32_bf16 v[56:59], a[216:219], v[32:35], v[56:59]
  v_add_u32 v6, s21, v2
  v_mfma_f32_16x16x32_bf16 v[60:63], a[56:59], v[36:39], v[60:63]
  ds_read_b128 v[28:31], v5 offset:37888
  v_mfma_f32_16x16x32_bf16 v[64:67], a[136:139], v[36:39], v[64:67]
  s_cmp_lt_u32 s26, 64
  s_cbranch_scc1 int_sl8
int_sl8_b:
  s_add_u32 s17, s22, s13
  v_mfma_f32_16x16x32_bf16 v[68:71], a[216:219], v[36:39], v[68:71]
  s_min_u32 s18, s27, 63
  s_mul_i32 s18, s18, 40960
  s_waitcnt lgkmcnt(4)
  v_mfma_f32_16x16x32_bf16 v[48:51], a[60:63], v[40:43], v[48:51]
  ds_read_b128 v[32:35], v5 offset:18432
  v_mfma_f32_16x16x32_bf16 v[52:55], a[140:143], v[40:43], v[52:55]
  s_add_u32 s18, s18, s12
  s_add_u32 s27, s27, 1
  s_add_u32 m0, s17, 0
  v_mfma_f32_16x16x32_bf16 v[56:59], a[220:223], v[40:43], v[56:59]
  buffer_load_dwordx4 v2, s[4:7], s18 offen offset:0 sc1 lds
  v_mfma_f32_16x16x32_bf16 v[60:63], a[60:63], v[44:47], v[60:63]
  ds_read_b128 v[36:39], v5 offset:38912
  v_mfma_f32_16x16x32_bf16 v[64:67], a[140:143], v[44:47], v[64:67]
  buffer_load_dwordx4 v2, s[4:7], s18 offen offset:1024 sc1 lds
  v_mfma_f32_16x16x32_bf16 v[68:71], a[220:223], v[44:47], v[68:71]
  s_waitcnt lgkmcnt(4)
  v_mfma_f32_16x16x32_bf16 v[48:51], a[64:67], v[16:19], v[48:51]
  ds_read_b128 v[40:43], v5 offset:19456
  v_mfma_f32_16x16x32_bf16 v[52:55], a[144:147], v[16:19], v[52:55]
  buffer_load_dwordx4 v2, s[4:7], s18 offen offset:2048 sc1 lds
  v_mfma_f32_16x16x32_bf16 v[56:59], a[224:227], v[16:19], v[56:59]
  buffer_load_dwordx4 v2, s[4:7], s18 offen offset:3072 sc1 lds
  v_mfma_f32_16x16x32_bf16 v[60:63], a[64:67], v[20:23], v[60:63]
  ds_read_b128 v[44:47], v5 offset:39936
  v_mfma_f32_16x16x32_bf16 v[64:67], a[144:147], v[20:23], v[64:67]
  s_add_u32 s18, s18, 4096
  s_add_u32 m0, s17, 4096
  v_mfma_f32_16x16x32_bf16 v[68:71], a[224:227], v[20:23], v[68:71]
  s_waitcnt lgkmcnt(4)
  v_mfma_f32_16x16x32_bf16 v[48:51], a[68:71], v[24:27], v[48:51]
  ds_read_b128 v[16:19], v6 offset:0
  v_mfma_f32_16x16x32_bf16 v[52:55], a[148:151], v[24:27], v[52:55]
  buffer_load_dwordx4 v2, s[4:7], s18 offen offset:0 sc1 lds
  v_mfma_f32_16x16x32_bf16 v[56:59], a[228:231], v[24:27], v[56:59]
  buffer_load_dwordx4 v2, s[4:7], s18 offen offset:1024 sc1 lds
  v_mfma_f32_16x16x32_bf16 v[60:63], a[68:71], v[28:31], v[60:63]
  ds_read_b128 v[20:23], v6 offset:20480
  v_mfma_f32_16x16x32_bf16 v[64:67], a[148:151], v[28:31], v[64:67]
  buffer_load_dwordx4 v2, s[4:7], s18 offen offset:2048 sc1 lds
  v_mfma_f32_16x16x32_bf16 v[68:71], a[228:231], v[28:31], v[68:71]
  s_waitcnt lgkmcnt(4)
  v_mfma_f32_16x16x32_bf16 v[48:51], a[72:75], v[32:35], v[48:51]
  ds_read_b128 v[24:27], v6 offset:1024
  v_mfma_f32_16x16x32_bf16 v[52:55], a[152:155], v[32:35], v[52:55]
  buffer_load_dwordx4 v2, s[4:7], s18 offen offset:3072 sc1 lds
  v_mfma_f32_16x16x32_bf16 v[56:59], a[232:235], v[32:35], v[56:59]
  s_add_u32 s18, s18, 4096
  s_add_u32 m0, s17, 8192
  v_mfma_f32_16x16x32_bf16 v[60:63], a[72:75], v[36:39], v[60:63]
  ds_read_b128 v[28:31], v6 offset:21504
  v_mfma_f32_16x16x32_bf16 v[64:67], a[152:155], v[36:39], v[64:67]
  buffer_load_dwordx4 v2, s[4:7], s18 offen offset:0 sc1 lds
  v_mfma_f32_16x16x32_bf16 v[68:71], a[232:235], v[36:39], v[68:71]
  s_waitcnt lgkmcnt(4)
  v_mfma_f32_16x16x32_bf16 v[48:51], a[76:79], v[40:43], v[48:51]
  ds_read_b128 v[32:35], v6 offset:2048
  v_mfma_f32_16x16x32_bf16 v[52:55], a[156:159], v[40:43], v[52:55]
  buffer_load_dwordx4 v2, s[4:7], s18 offen offset:1024 sc1 lds
  v_mfma_f32_16x16x32_bf16 v[56:59], a[236:239], v[40:43], v[56:59]
  s_mov_b32 s23, s20
  s_mov_b32 s20, s21
  s_mov_b32 s21, s22
  v_mfma_f32_16x16x32_bf16 v[60:63], a[76:79], v[44:47], v[60:63]
  ds_read_b128 v[36:39], v6 offset:22528
  v_mfma_f32_16x16x32_bf16 v[64:67], a[156:159], v[44:47], v[64:67]
  s_mov_b32 s22, s23
  s_add_u32 s24, s24, 1
  v_mfma_f32_16x16x32_bf16 v[68:71], a[236:239], v[44:47], v[68:71]
  v_mov_b32 v5, v6
  s_and_b32 s29, s24, 63
  s_cbranch_scc1 mk_kv_loop
  v_cvt_pk_bf16_f32 v72, v48, v49
  v_cvt_pk_bf16_f32 v73, v50, v51
  v_cvt_pk_bf16_f32 v74, v52, v53
  v_cvt_pk_bf16_f32 v75, v54, v55
  v_cvt_pk_bf16_f32 v80, v56, v57
  v_cvt_pk_bf16_f32 v81, v58, v59
  v_cvt_pk_bf16_f32 v76, v60, v61
  v_cvt_pk_bf16_f32 v77, v62, v63
  v_cvt_pk_bf16_f32 v78, v64, v65
  v_cvt_pk_bf16_f32 v79, v66, v67
  v_cvt_pk_bf16_f32 v82, v68, v69
  v_cvt_pk_bf16_f32 v83, v70, v71
  buffer_store_dwordx4 v[72:75], v3, s[4:7], s14 offen sc1
  buffer_store_dwordx4 v[76:79], v3, s[4:7], s15 offen sc1
  buffer_store_dwordx4 v[80:83], v3, s[4:7], s16 offen sc1
  buffer_store_dwordx4 v[12:15], v4, s[4:7], s33 offen sc1
  buffer_store_dwordx4 v[12:15], v4, s[4:7], s33 offen offset:1024 sc1
  s_waitcnt vmcnt(0) lgkmcnt(0)
  v_mov_b32 v10, s24
  s_mov_b64 exec, 1
  buffer_store_dword v10, off, s[4:7], s25 sc1
  s_mov_b64 exec, -1
  s_barrier
  s_load_dwordx2 s[48:49], s[0:1], 64
  s_mov_b32 s50, 0x258000
  s_mov_b32 s51, 0x20000
  s_load_dwordx2 s[52:53], s[0:1], 72
  s_mov_b32 s54, 0x6400
  s_mov_b32 s55, 0x20000
  v_and_b32 v4, 15, v1
  v_lshrrev_b32 v5, 4, v1
  v_lshrrev_b32 v6, 2, v4
  v_and_b32 v7, 3, v4
  v_lshl_add_u32 v8, v6, 3, v7
  v_mul_u32_u24 v8, 3840, v8
  v_lshl_add_u32 v8, v5, 4, v8
  v_add_u32 v9, 1, v5
  v_lshrrev_b32 v9, 2, v9
  v_lshl_add_u32 v8, v9, 30, v8
  v_add_u32 v9, 15360, v8
  s_mul_i32 s14, s3, 614400
  s_mul_i32 s15, s75, 40
  s_add_u32 s14, s14, s15
  s_mul_i32 s15, s75, 800
  s_waitcnt lgkmcnt(0)
  v_mul_u32_u24 v10, 5, v6
  v_add_u32 v10, v10, v7
  v_mul_u32_u24 v11, 160, v5
  v_add_lshl_u32 v10, v10, v11, 1
  v_mov_b32 v11, 1073741824
  v_subrev_u32 v192, 0, v7
  v_cmp_gt_u32 vcc, 4, v192
  v_add_u32 v192, 0, v10
  s_nop 0
  v_cndmask_b32 v192, v11, v192, vcc
  v_cmp_gt_u32 vcc, 3, v5
  s_nop 1
  v_cndmask_b32 v192, v11, v192, vcc
  v_cmp_gt_u32 vcc, 2, v5
  s_nop 1
  v_cndmask_b32 v193, v11, v192, vcc
  buffer_load_ushort v16, v192, s[52:55], s15 offen offset:0
  buffer_load_ushort v17, v192, s[52:55], s15 offen offset:40
  buffer_load_ushort v18, v192, s[52:55], s15 offen offset:80
  buffer_load_ushort v19, v192, s[52:55], s15 offen offset:120
  buffer_load_ushort v20, v193, s[52:55], s15 offen offset:160
  buffer_load_ushort v21, v193, s[52:55], s15 offen offset:200
  buffer_load_ushort v22, v193, s[52:55], s15 offen offset:240
  buffer_load_ushort v23, v193, s[52:55], s15 offen offset:280
  v_subrev_u32 v192, 0, v7
  v_cmp_gt_u32 vcc, 1, v192
  v_add_u32 v192, 8, v10
  s_nop 0
  v_cndmask_b32 v192, v11, v192, vcc
  v_cmp_gt_u32 vcc, 3, v5
  s_nop 1
  v_cndmask_b32 v192, v11, v192, vcc
  v_cmp_gt_u32 vcc, 2, v5
  s_nop 1
  v_cndmask_b32 v193, v11, v192, vcc
  buffer_load_ushort v24, v192, s[52:55], s15 offen offset:0
  buffer_load_ushort v25, v192, s[52:55], s15 offen offset:40
  buffer_load_ushort v26, v192, s[52:55], s15 offen offset:80
  buffer_load_ushort v27, v192, s[52:55], s15 offen offset:120
  buffer_load_ushort v28, v193, s[52:55], s15 offen offset:160
  buffer_load_ushort v29, v193, s[52:55], s15 offen offset:200
  buffer_load_ushort v30, v193, s[52:55], s15 offen offset:240
  buffer_load_ushort v31, v193, s[52:55], s15 offen offset:280
  v_subrev_u32 v192, 1, v7
  v_cmp_gt_u32 vcc, 3, v192
  v_add_u32 v192, -2, v10
  s_nop 0
  v_cndmask_b32 v192, v11, v192, vcc
  v_cmp_gt_u32 vcc, 3, v5
  s_nop 1
  v_cndmask_b32 v192, v11, v192, vcc
  v_cmp_gt_u32 vcc, 2, v5
  s_nop 1
  v_cndmask_b32 v193, v11, v192, vcc
  buffer_load_ushort v32, v192, s[52:55], s15 offen offset:0
  buffer_load_ushort v33, v192, s[52:55], s15 offen offset:40
  buffer_load_ushort v34, v192, s[52:55], s15 offen offset:80
  buffer_load_ushort v35, v192, s[52:55], s15 offen offset:120
  buffer_load_ushort v36, v193, s[52:55], s15 offen offset:160
  buffer_load_ushort v37, v193, s[52:55], s15 offen offset:200
  buffer_load_ushort v38, v193, s[52:55], s15 offen offset:240
  buffer_load_ushort v39, v193, s[52:55], s15 offen offset:280
  v_subrev_u32 v192, 0, v7
  v_cmp_gt_u32 vcc, 2, v192
  v_add_u32 v192, 6, v10
  s_nop 0
  v_cndmask_b32 v192, v11, v192, vcc
  v_cmp_gt_u32 vcc, 3, v5
  s_nop 1
  v_cndmask_b32 v192, v11, v192, vcc
  v_cmp_gt_u32 vcc, 2, v5
  s_nop 1
  v_cndmask_b32 v193, v11, v192, vcc
  buffer_load_ushort v40, v192, s[52:55], s15 offen offset:0
  buffer_load_ushort v41, v192, s[52:55], s15 offen offset:40
  buffer_load_ushort v42, v192, s[52:55], s15 offen offset:80
  buffer_load_ushort v43, v192, s[52:55], s15 offen offset:120
  buffer_load_ushort v44, v193, s[52:55], s15 offen offset:160
  buffer_load_ushort v45, v193, s[52:55], s15 offen offset:200
  buffer_load_ushort v46, v193, s[52:55], s15 offen offset:240
  buffer_load_ushort v47, v193, s[52:55], s15 offen offset:280
  buffer_load_dwordx4 v[72:75], v8, s[48:51], s14 offen offset:0
  buffer_load_dwordx4 v[76:79], v8, s[48:51], s14 offen offset:1280
  buffer_load_dwordx4 v[80:83], v8, s[48:51], s14 offen offset:2560
  buffer_load_dwordx4 v[84:87], v9, s[48:51], s14 offen offset:0
  buffer_load_dwordx4 v[88:91], v9, s[48:51], s14 offen offset:1280
  buffer_load_dwordx4 v[92:95], v9, s[48:51], s14 offen offset:2560
  s_add_u32 s14, s14, 122880
  buffer_load_dwordx4 v[96:99], v8, s[48:51], s14 offen offset:0
  buffer_load_dwordx4 v[100:103], v8, s[48:51], s14 offen offset:1280
  buffer_load_dwordx4 v[104:107], v8, s[48:51], s14 offen offset:2560
  buffer_load_dwordx4 v[108:111], v9, s[48:51], s14 offen offset:0
  buffer_load_dwordx4 v[112:115], v9, s[48:51], s14 offen offset:1280
  buffer_load_dwordx4 v[116:119], v9, s[48:51], s14 offen offset:2560
  s_add_u32 s14, s14, 122880
  buffer_load_dwordx4 v[120:123], v8, s[48:51], s14 offen offset:0
  buffer_load_dwordx4 v[124:127], v8, s[48:51], s14 offen offset:1280
  buffer_load_dwordx4 v[128:131], v8, s[48:51], s14 offen offset:2560
  buffer_load_dwordx4 v[132:135], v9, s[48:51], s14 offen offset:0
  buffer_load_dwordx4 v[136:139], v9, s[48:51], s14 offen offset:1280
  buffer_load_dwordx4 v[140:143], v9, s[48:51], s14 offen offset:2560
  s_add_u32 s14, s14, 122880
  buffer_load_dwordx4 v[144:147], v8, s[48:51], s14 offen offset:0
  buffer_load_dwordx4 v[148:151], v8, s[48:51], s14 offen offset:1280
  buffer_load_dwordx4 v[152:155], v8, s[48:51], s14 offen offset:2560
  buffer_load_dwordx4 v[156:159], v9, s[48:51], s14 offen offset:0
  buffer_load_dwordx4 v[160:163], v9, s[48:51], s14 offen offset:1280
  buffer_load_dwordx4 v[164:167], v9, s[48:51], s14 offen offset:2560
  s_add_u32 s14, s14, 122880
  buffer_load_dwordx4 v[168:171], v8, s[48:51], s14 offen offset:0
  buffer_load_dwordx4 v[172:175], v8, s[48:51], s14 offen offset:1280
  buffer_load_dwordx4 v[176:179], v8, s[48:51], s14 offen offset:2560
  buffer_load_dwordx4 v[180:183], v9, s[48:51], s14 offen offset:0
  buffer_load_dwordx4 v[184:187], v9, s[48:51], s14 offen offset:1280
  buffer_load_dwordx4 v[188:191], v9, s[48:51], s14 offen offset:2560
  s_add_u32 s14, s14, 122880
  v_subrev_u32 v192, 2, v4
  v_cmp_lt_u32 vcc, 1, v7
  s_nop 1
  v_cndmask_b32 v192, 64, v192, vcc
  v_add_u32 v193, 2, v4
  v_lshl_add_u32 v194, v6, 1, v7
  v_add_u32 v194, 14, v194
  v_cndmask_b32 v193, v193, v194, vcc
  v_cmp_lt_u32 vcc, 19, v193
  s_nop 1
  v_cndmask_b32 v193, v193, 64, vcc
  v_lshlrev_b32 v194, 3, v5
  s_movk_i32 s16, 0x3f80
  v_sub_u32 v192, v192, v194
  v_and_b32 v195, 1, v192
  v_lshlrev_b32 v195, 4, v195
  v_lshlrev_b32 v195, v195, s16
  v_lshrrev_b32 v192, 1, v192
  v_cmp_eq_u32 vcc, 0, v192
  s_nop 1
  v_cndmask_b32 v64, 0, v195, vcc
  v_cmp_eq_u32 vcc, 1, v192
  s_nop 1
  v_cndmask_b32 v65, 0, v195, vcc
  v_cmp_eq_u32 vcc, 2, v192
  s_nop 1
  v_cndmask_b32 v66, 0, v195, vcc
  v_cmp_eq_u32 vcc, 3, v192
  s_nop 1
  v_cndmask_b32 v67, 0, v195, vcc
  v_sub_u32 v193, v193, v194
  v_and_b32 v195, 1, v193
  v_lshlrev_b32 v195, 4, v195
  v_lshlrev_b32 v195, v195, s16
  v_lshrrev_b32 v193, 1, v193
  v_cmp_eq_u32 vcc, 0, v193
  s_nop 1
  v_cndmask_b32 v68, 0, v195, vcc
  v_cmp_eq_u32 vcc, 1, v193
  s_nop 1
  v_cndmask_b32 v69, 0, v195, vcc
  v_cmp_eq_u32 vcc, 2, v193
  s_nop 1
  v_cndmask_b32 v70, 0, v195, vcc
  v_cmp_eq_u32 vcc, 3, v193
  s_nop 1
  v_cndmask_b32 v71, 0, v195, vcc
  s_mul_i32 s14, s3, 20480
  v_add_u32 v10, s14, v2
  s_waitcnt vmcnt(30)
  v_lshl_or_b32 v48, v17, 16, v16
  v_lshl_or_b32 v49, v19, 16, v18
  v_lshl_or_b32 v50, v21, 16, v20
  v_lshl_or_b32 v51, v23, 16, v22
  v_lshl_or_b32 v52, v25, 16, v24
  v_lshl_or_b32 v53, v27, 16, v26
  v_lshl_or_b32 v54, v29, 16, v28
  v_lshl_or_b32 v55, v31, 16, v30
  v_lshl_or_b32 v56, v33, 16, v32
  v_lshl_or_b32 v57, v35, 16, v34
  v_lshl_or_b32 v58, v37, 16, v36
  v_lshl_or_b32 v59, v39, 16, v38
  v_lshl_or_b32 v60, v41, 16, v40
  v_lshl_or_b32 v61, v43, 16, v42
  v_lshl_or_b32 v62, v45, 16, v44
  v_lshl_or_b32 v63, v47, 16, v46
  s_waitcnt vmcnt(24)
  v_mfma_f32_16x16x32_bf16 v[192:195], v[72:75], v[48:51], 0
  v_mfma_f32_16x16x32_bf16 v[196:199], v[84:87], v[48:51], 0
  v_mfma_f32_16x16x32_bf16 v[200:203], v[72:75], v[52:55], 0
  v_mfma_f32_16x16x32_bf16 v[204:207], v[84:87], v[52:55], 0
  v_mfma_f32_16x16x32_bf16 v[200:203], v[76:79], v[56:59], v[200:203]
  v_mfma_f32_16x16x32_bf16 v[204:207], v[88:91], v[56:59], v[204:207]
  v_mfma_f32_16x16x32_bf16 v[208:211], v[76:79], v[60:63], 0
  v_mfma_f32_16x16x32_bf16 v[212:215], v[88:91], v[60:63], 0
  v_mfma_f32_16x16x32_bf16 v[208:211], v[80:83], v[64:67], v[208:211]
  v_mfma_f32_16x16x32_bf16 v[212:215], v[92:95], v[64:67], v[212:215]
  v_mfma_f32_16x16x32_bf16 v[216:219], v[80:83], v[68:71], 0
  v_mfma_f32_16x16x32_bf16 v[220:223], v[92:95], v[68:71], 0
  v_cvt_pk_bf16_f32 v16, v192, v193
  v_cvt_pk_bf16_f32 v17, v194, v195
  v_cvt_pk_bf16_f32 v18, v196, v197
  v_cvt_pk_bf16_f32 v19, v198, v199
  ds_write_b128 v10, v[16:19] offset:0
  v_cvt_pk_bf16_f32 v20, v200, v201
  v_cvt_pk_bf16_f32 v21, v202, v203
  v_cvt_pk_bf16_f32 v22, v204, v205
  v_cvt_pk_bf16_f32 v23, v206, v207
  ds_write_b128 v10, v[20:23] offset:1024
  v_cvt_pk_bf16_f32 v24, v208, v209
  v_cvt_pk_bf16_f32 v25, v210, v211
  v_cvt_pk_bf16_f32 v26, v212, v213
  v_cvt_pk_bf16_f32 v27, v214, v215
  ds_write_b128 v10, v[24:27] offset:2048
  v_cvt_pk_bf16_f32 v28, v216, v217
  v_cvt_pk_bf16_f32 v29, v218, v219
  v_cvt_pk_bf16_f32 v30, v220, v221
  v_cvt_pk_bf16_f32 v31, v222, v223
  ds_write_b128 v10, v[28:31] offset:3072
  s_waitcnt vmcnt(18)
  v_mfma_f32_16x16x32_bf16 v[192:195], v[96:99], v[48:51], 0
  v_mfma_f32_16x16x32_bf16 v[196:199], v[108:111], v[48:51], 0
  v_mfma_f32_16x16x32_bf16 v[200:203], v[96:99], v[52:55], 0
  v_mfma_f32_16x16x32_bf16 v[204:207], v[108:111], v[52:55], 0
  v_mfma_f32_16x16x32_bf16 v[200:203], v[100:103], v[56:59], v[200:203]
  v_mfma_f32_16x16x32_bf16 v[204:207], v[112:115], v[56:59], v[204:207]
  v_mfma_f32_16x16x32_bf16 v[208:211], v[100:103], v[60:63], 0
  v_mfma_f32_16x16x32_bf16 v[212:215], v[112:115], v[60:63], 0
  v_mfma_f32_16x16x32_bf16 v[208:211], v[104:107], v[64:67], v[208:211]
  v_mfma_f32_16x16x32_bf16 v[212:215], v[116:119], v[64:67], v[212:215]
  v_mfma_f32_16x16x32_bf16 v[216:219], v[104:107], v[68:71], 0
  v_mfma_f32_16x16x32_bf16 v[220:223], v[116:119], v[68:71], 0
  v_cvt_pk_bf16_f32 v32, v192, v193
  v_cvt_pk_bf16_f32 v33, v194, v195
  v_cvt_pk_bf16_f32 v34, v196, v197
  v_cvt_pk_bf16_f32 v35, v198, v199
  ds_write_b128 v10, v[32:35] offset:4096
  v_cvt_pk_bf16_f32 v36, v200, v201
  v_cvt_pk_bf16_f32 v37, v202, v203
  v_cvt_pk_bf16_f32 v38, v204, v205
  v_cvt_pk_bf16_f32 v39, v206, v207
  ds_write_b128 v10, v[36:39] offset:5120
  v_cvt_pk_bf16_f32 v40, v208, v209
  v_cvt_pk_bf16_f32 v41, v210, v211
  v_cvt_pk_bf16_f32 v42, v212, v213
  v_cvt_pk_bf16_f32 v43, v214, v215
  ds_write_b128 v10, v[40:43] offset:6144
  v_cvt_pk_bf16_f32 v44, v216, v217
  v_cvt_pk_bf16_f32 v45, v218, v219
  v_cvt_pk_bf16_f32 v46, v220, v221
  v_cvt_pk_bf16_f32 v47, v222, v223
  ds_write_b128 v10, v[44:47] offset:7168
  s_waitcnt vmcnt(12)
  v_mfma_f32_16x16x32_bf16 v[192:195], v[120:123], v[48:51], 0
  v_mfma_f32_16x16x32_bf16 v[196:199], v[132:135], v[48:51], 0
  v_mfma_f32_16x16x32_bf16 v[200:203], v[120:123], v[52:55], 0
  v_mfma_f32_16x16x32_bf16 v[204:207], v[132:135], v[52:55], 0
  v_mfma_f32_16x16x32_bf16 v[200:203], v[124:127], v[56:59], v[200:203]
  v_mfma_f32_16x16x32_bf16 v[204:207], v[136:139], v[56:59], v[204:207]
  v_mfma_f32_16x16x32_bf16 v[208:211], v[124:127], v[60:63], 0
  v_mfma_f32_16x16x32_bf16 v[212:215], v[136:139], v[60:63], 0
  v_mfma_f32_16x16x32_bf16 v[208:211], v[128:131], v[64:67], v[208:211]
  v_mfma_f32_16x16x32_bf16 v[212:215], v[140:143], v[64:67], v[212:215]
  v_mfma_f32_16x16x32_bf16 v[216:219], v[128:131], v[68:71], 0
  v_mfma_f32_16x16x32_bf16 v[220:223], v[140:143], v[68:71], 0
  v_cvt_pk_bf16_f32 v16, v192, v193
  v_cvt_pk_bf16_f32 v17, v194, v195
  v_cvt_pk_bf16_f32 v18, v196, v197
  v_cvt_pk_bf16_f32 v19, v198, v199
  ds_write_b128 v10, v[16:19] offset:8192
  v_cvt_pk_bf16_f32 v20, v200, v201
  v_cvt_pk_bf16_f32 v21, v202, v203
  v_cvt_pk_bf16_f32 v22, v204, v205
  v_cvt_pk_bf16_f32 v23, v206, v207
  ds_write_b128 v10, v[20:23] offset:9216
  v_cvt_pk_bf16_f32 v24, v208, v209
  v_cvt_pk_bf16_f32 v25, v210, v211
  v_cvt_pk_bf16_f32 v26, v212, v213
  v_cvt_pk_bf16_f32 v27, v214, v215
  ds_write_b128 v10, v[24:27] offset:10240
  v_cvt_pk_bf16_f32 v28, v216, v217
  v_cvt_pk_bf16_f32 v29, v218, v219
  v_cvt_pk_bf16_f32 v30, v220, v221
  v_cvt_pk_bf16_f32 v31, v222, v223
  ds_write_b128 v10, v[28:31] offset:11264
  s_waitcnt vmcnt(6)
  v_mfma_f32_16x16x32_bf16 v[192:195], v[144:147], v[48:51], 0
  v_mfma_f32_16x16x32_bf16 v[196:199], v[156:159], v[48:51], 0
  v_mfma_f32_16x16x32_bf16 v[200:203], v[144:147], v[52:55], 0
  v_mfma_f32_16x16x32_bf16 v[204:207], v[156:159], v[52:55], 0
  v_mfma_f32_16x16x32_bf16 v[200:203], v[148:151], v[56:59], v[200:203]
  v_mfma_f32_16x16x32_bf16 v[204:207], v[160:163], v[56:59], v[204:207]
  v_mfma_f32_16x16x32_bf16 v[208:211], v[148:151], v[60:63], 0
  v_mfma_f32_16x16x32_bf16 v[212:215], v[160:163], v[60:63], 0
  v_mfma_f32_16x16x32_bf16 v[208:211], v[152:155], v[64:67], v[208:211]
  v_mfma_f32_16x16x32_bf16 v[212:215], v[164:167], v[64:67], v[212:215]
  v_mfma_f32_16x16x32_bf16 v[216:219], v[152:155], v[68:71], 0
  v_mfma_f32_16x16x32_bf16 v[220:223], v[164:167], v[68:71], 0
  v_cvt_pk_bf16_f32 v32, v192, v193
  v_cvt_pk_bf16_f32 v33, v194, v195
  v_cvt_pk_bf16_f32 v34, v196, v197
  v_cvt_pk_bf16_f32 v35, v198, v199
  ds_write_b128 v10, v[32:35] offset:12288
  v_cvt_pk_bf16_f32 v36, v200, v201
  v_cvt_pk_bf16_f32 v37, v202, v203
  v_cvt_pk_bf16_f32 v38, v204, v205
  v_cvt_pk_bf16_f32 v39, v206, v207
  ds_write_b128 v10, v[36:39] offset:13312
  v_cvt_pk_bf16_f32 v40, v208, v209
  v_cvt_pk_bf16_f32 v41, v210, v211
  v_cvt_pk_bf16_f32 v42, v212, v213
  v_cvt_pk_bf16_f32 v43, v214, v215
  ds_write_b128 v10, v[40:43] offset:14336
  v_cvt_pk_bf16_f32 v44, v216, v217
  v_cvt_pk_bf16_f32 v45, v218, v219
  v_cvt_pk_bf16_f32 v46, v220, v221
  v_cvt_pk_bf16_f32 v47, v222, v223
  ds_write_b128 v10, v[44:47] offset:15360
  s_waitcnt vmcnt(0)
  v_mfma_f32_16x16x32_bf16 v[192:195], v[168:171], v[48:51], 0
  v_mfma_f32_16x16x32_bf16 v[196:199], v[180:183], v[48:51], 0
  v_mfma_f32_16x16x32_bf16 v[200:203], v[168:171], v[52:55], 0
  v_mfma_f32_16x16x32_bf16 v[204:207], v[180:183], v[52:55], 0
  v_mfma_f32_16x16x32_bf16 v[200:203], v[172:175], v[56:59], v[200:203]
  v_mfma_f32_16x16x32_bf16 v[204:207], v[184:187], v[56:59], v[204:207]
  v_mfma_f32_16x16x32_bf16 v[208:211], v[172:175], v[60:63], 0
  v_mfma_f32_16x16x32_bf16 v[212:215], v[184:187], v[60:63], 0
  v_mfma_f32_16x16x32_bf16 v[208:211], v[176:179], v[64:67], v[208:211]
  v_mfma_f32_16x16x32_bf16 v[212:215], v[188:191], v[64:67], v[212:215]
  v_mfma_f32_16x16x32_bf16 v[216:219], v[176:179], v[68:71], 0
  v_mfma_f32_16x16x32_bf16 v[220:223], v[188:191], v[68:71], 0
  v_cvt_pk_bf16_f32 v16, v192, v193
  v_cvt_pk_bf16_f32 v17, v194, v195
  v_cvt_pk_bf16_f32 v18, v196, v197
  v_cvt_pk_bf16_f32 v19, v198, v199
  ds_write_b128 v10, v[16:19] offset:16384
  v_cvt_pk_bf16_f32 v20, v200, v201
  v_cvt_pk_bf16_f32 v21, v202, v203
  v_cvt_pk_bf16_f32 v22, v204, v205
  v_cvt_pk_bf16_f32 v23, v206, v207
  ds_write_b128 v10, v[20:23] offset:17408
  v_cvt_pk_bf16_f32 v24, v208, v209
  v_cvt_pk_bf16_f32 v25, v210, v211
  v_cvt_pk_bf16_f32 v26, v212, v213
  v_cvt_pk_bf16_f32 v27, v214, v215
  ds_write_b128 v10, v[24:27] offset:18432
  v_cvt_pk_bf16_f32 v28, v216, v217
  v_cvt_pk_bf16_f32 v29, v218, v219
  v_cvt_pk_bf16_f32 v30, v220, v221
  v_cvt_pk_bf16_f32 v31, v222, v223
  ds_write_b128 v10, v[28:31] offset:19456
  s_waitcnt lgkmcnt(0)
  s_barrier
  v_add_u32 v3, 40960, v2
  s_lshl_b32 s14, s3, 12
  s_add_u32 s14, s14, 81920
  v_and_b32 v168, 15, v1
  v_lshrrev_b32 v169, 4, v1
  v_mul_u32_u24 v4, 144, v168
  v_lshl_add_u32 v4, v169, 5, v4
  v_add_u32 v4, s14, v4
  v_mul_u32_u24 v6, 72, v168
  v_add_u32 v6, s14, v6
  v_lshl_add_u32 v5, v169, 3, v6
  v_lshl_add_u32 v6, v169, 2, v6
  v_lshrrev_b32 v168, 2, v1
  v_and_b32 v169, 3, v1
  v_mul_u32_u24 v7, 144, v168
  v_lshl_add_u32 v7, v169, 5, v7
  v_add_u32 v7, s14, v7
  v_mul_u32_u24 v9, 72, v168
  v_add_u32 v9, s14, v9
  v_lshl_add_u32 v8, v169, 3, v9
  v_lshlrev_b32 v10, 2, v169
  v_min_u32 v169, 1, v169
  v_lshl_add_u32 v9, v169, 3, v9
  v_lshlrev_b32 v11, 2, v1
  v_mov_b32 v144, 0
  v_mov_b32 v145, 0
  v_mov_b32 v146, 0
  v_mov_b32 v147, 0
  v_mov_b32 v148, 0
  v_mov_b32 v149, 0
  v_mov_b32 v150, 0
  v_mov_b32 v151, 0
  v_mov_b32 v152, 0
  v_mov_b32 v153, 0
  v_mov_b32 v154, 0
  v_mov_b32 v155, 0
  v_mov_b32 v156, 0
  v_mov_b32 v157, 0
  v_mov_b32 v158, 0
  v_mov_b32 v159, 0
  v_mov_b32 v160, 0
  v_mov_b32 v161, 0
  v_mov_b32 v162, 0
  v_mov_b32 v163, 0
  v_mov_b32 v164, 0
  v_mov_b32 v165, 0
  v_mov_b32 v166, 0
  v_mov_b32 v167, 0
  v_mov_b32 v205, 0
  v_mov_b32 v212, 0x3f803f80
  s_mov_b32 s40, -1
  s_mov_b32 s41, 0
  s_mov_b32 s31, 0x3fb8aa3b
  s_lshl_b32 s12, s74, 2
  s_add_u32 s12, s12, s3
  s_lshl_b32 s28, s66, 1
  s_mul_i32 s13, s28, 2621440
  s_add_u32 s28, s28, 2
  s_mul_i32 s14, s12, 20480
  s_add_u32 s13, s13, s14
  s_add_u32 s13, s13, 39321600
  s_lshr_b32 s20, s12, 1
  s_lshl_b32 s20, s20, 7
  s_and_b32 s14, s12, 1
  s_lshl_b32 s14, s14, 4
  s_add_u32 s20, s20, s14
  s_add_u32 s20, s20, 64909312
  s_lshl_b32 s21, s66, 7
  s_add_u32 s21, s21, s12
  s_lshl_b32 s21, s21, 5
  s_add_u32 s21, s21, s75
  s_mul_i32 s21, s21, 1280
  s_add_u32 s21, s21, 52428800
  s_mov_b32 s22, 0
mk_b1_get:
  s_mov_b32 s70, 0
int_wg10:
  buffer_load_dword v188, v10, s[4:7], s20 offen offset:0 sc1
  s_waitcnt vmcnt(0)
  v_cmp_gt_u32 vcc, s28, v188
  s_nop 0
  s_cbranch_vccz int_wg10_ok
  s_sleep 2
  s_add_u32 s70, s70, 1
  s_cmp_lt_u32 s70, 262144
  s_cbranch_scc1 int_wg10
  s_branch mk_fail
int_wg10_ok:
  s_mov_b32 s15, s13
  buffer_load_dwordx4 v[16:19], v2, s[4:7], s15 offen offset:0 sc1
  buffer_load_dwordx4 v[20:23], v2, s[4:7], s15 offen offset:1024 sc1
  buffer_load_dwordx4 v[24:27], v2, s[4:7], s15 offen offset:2048 sc1
  buffer_load_dwordx4 v[28:31], v2, s[4:7], s15 offen offset:3072 sc1
  s_add_u32 s15, s15, 4096
  buffer_load_dwordx4 v[32:35], v2, s[4:7], s15 offen offset:0 sc1
  buffer_load_dwordx4 v[36:39], v2, s[4:7], s15 offen offset:1024 sc1
  buffer_load_dwordx4 v[40:43], v2, s[4:7], s15 offen offset:2048 sc1
  buffer_load_dwordx4 v[44:47], v2, s[4:7], s15 offen offset:3072 sc1
  s_add_u32 s15, s15, 4096
  buffer_load_dwordx4 v[48:51], v2, s[4:7], s15 offen offset:0 sc1
  buffer_load_dwordx4 v[52:55], v2, s[4:7], s15 offen offset:1024 sc1
  buffer_load_dwordx4 v[56:59], v2, s[4:7], s15 offen offset:2048 sc1
  buffer_load_dwordx4 v[60:63], v2, s[4:7], s15 offen offset:3072 sc1
  s_add_u32 s15, s15, 4096
  buffer_load_dwordx4 v[64:67], v2, s[4:7], s15 offen offset:0 sc1
  buffer_load_dwordx4 v[68:71], v2, s[4:7], s15 offen offset:1024 sc1
  buffer_load_dwordx4 v[72:75], v2, s[4:7], s15 offen offset:2048 sc1
  buffer_load_dwordx4 v[76:79], v2, s[4:7], s15 offen offset:3072 sc1
  s_add_u32 s15, s15, 4096
  buffer_load_dwordx4 v[80:83], v2, s[4:7], s15 offen offset:0 sc1
  buffer_load_dwordx4 v[84:87], v2, s[4:7], s15 offen offset:1024 sc1
  buffer_load_dwordx4 v[88:91], v2, s[4:7], s15 offen offset:2048 sc1
  buffer_load_dwordx4 v[92:95], v2, s[4:7], s15 offen offset:3072 sc1
  buffer_load_dword v191, v10, s[4:7], s20 offen offset:512 sc1
mk_b1_loop:
  ds_read_b128 v[96:99], v2 offset:0
  ds_read_b128 v[100:103], v2 offset:1024
  ds_read_b128 v[104:107], v2 offset:2048
  ds_read_b128 v[108:111], v2 offset:3072
  ds_read_b128 v[112:115], v2 offset:4096
  ds_read_b128 v[116:119], v2 offset:5120
  s_add_u32 s13, s13, 163840
  s_add_u32 s20, s20, 512
  s_add_u32 s22, s22, 1
  s_waitcnt vmcnt(0)
  v_cmp_gt_u32 vcc, s28, v191
  s_cmp_eq_u32 s22, 16
  s_cselect_b64 vcc, -1, vcc
  s_cmp_eq_u64 vcc, 0
  s_cselect_b32 s15, s13, 1073741824
  s_cselect_b32 s23, 1, 0
  s_waitcnt lgkmcnt(4)
  v_mfma_f32_16x16x32_bf16 v[128:131], v[96:99], v[16:19], 0
  ds_read_b128 v[120:123], v2 offset:6144
  v_mfma_f32_16x16x32_bf16 v[132:135], v[100:103], v[16:19], 0
  ds_read_b128 v[124:127], v2 offset:7168
  s_waitcnt lgkmcnt(4)
  v_mfma_f32_16x16x32_bf16 v[136:139], v[104:107], v[16:19], 0
  ds_read_b128 v[96:99], v2 offset:8192
  v_mfma_f32_16x16x32_bf16 v[140:143], v[108:111], v[16:19], 0
  ds_read_b128 v[100:103], v2 offset:9216
  s_waitcnt lgkmcnt(4)
  v_mfma_f32_16x16x32_bf16 v[128:131], v[112:115], v[20:23], v[128:131]
  ds_read_b128 v[104:107], v2 offset:10240
  buffer_load_dwordx4 v[16:19], v2, s[4:7], s15 offen offset:0 sc1
  v_mfma_f32_16x16x32_bf16 v[132:135], v[116:119], v[20:23], v[132:135]
  ds_read_b128 v[108:111], v2 offset:11264
  s_waitcnt lgkmcnt(4)
  v_mfma_f32_16x16x32_bf16 v[136:139], v[120:123], v[20:23], v[136:139]
  ds_read_b128 v[112:115], v2 offset:12288
  v_mfma_f32_16x16x32_bf16 v[140:143], v[124:127], v[20:23], v[140:143]
  ds_read_b128 v[116:119], v2 offset:13312
  s_waitcnt lgkmcnt(4)
  v_mfma_f32_16x16x32_bf16 v[128:131], v[96:99], v[24:27], v[128:131]
  ds_read_b128 v[120:123], v2 offset:14336
  buffer_load_dwordx4 v[20:23], v2, s[4:7], s15 offen offset:1024 sc1
  v_mfma_f32_16x16x32_bf16 v[132:135], v[100:103], v[24:27], v[132:135]
  ds_read_b128 v[124:127], v2 offset:15360
  s_waitcnt lgkmcnt(4)
  v_mfma_f32_16x16x32_bf16 v[136:139], v[104:107], v[24:27], v[136:139]
  ds_read_b128 v[96:99], v2 offset:16384
  v_mfma_f32_16x16x32_bf16 v[140:143], v[108:111], v[24:27], v[140:143]
  ds_read_b128 v[100:103], v2 offset:17408
  s_waitcnt lgkmcnt(4)
  v_mfma_f32_16x16x32_bf16 v[128:131], v[112:115], v[28:31], v[128:131]
  ds_read_b128 v[104:107], v2 offset:18432
  buffer_load_dwordx4 v[24:27], v2, s[4:7], s15 offen offset:2048 sc1
  v_mfma_f32_16x16x32_bf16 v[132:135], v[116:119], v[28:31], v[132:135]
  ds_read_b128 v[108:111], v2 offset:19456
  s_waitcnt lgkmcnt(4)
  v_mfma_f32_16x16x32_bf16 v[136:139], v[120:123], v[28:31], v[136:139]
  ds_read_b128 v[112:115], v2 offset:20480
  v_mfma_f32_16x16x32_bf16 v[140:143], v[124:127], v[28:31], v[140:143]
  ds_read_b128 v[116:119], v2 offset:21504
  s_waitcnt lgkmcnt(4)
  v_mfma_f32_16x16x32_bf16 v[128:131], v[96:99], v[32:35], v[128:131]
  ds_read_b128 v[120:123], v2 offset:22528
  buffer_load_dwordx4 v[28:31], v2, s[4:7], s15 offen offset:3072 sc1
  v_mfma_f32_16x16x32_bf16 v[132:135], v[100:103], v[32:35], v[132:135]
  ds_read_b128 v[124:127], v2 offset:23552
  s_waitcnt lgkmcnt(4)
  v_mfma_f32_16x16x32_bf16 v[136:139], v[104:107], v[32:35], v[136:139]
  ds_read_b128 v[96:99], v2 offset:24576
  v_mfma_f32_16x16x32_bf16 v[140:143], v[108:111], v[32:35], v[140:143]
  ds_read_b128 v[100:103], v2 offset:25600
  s_waitcnt lgkmcnt(4)
  v_mfma_f32_16x16x32_bf16 v[128:131], v[112:115], v[36:39], v[128:131]
  ds_read_b128 v[104:107], v2 offset:26624
  s_add_u32 s15, s15, 4096
  buffer_load_dwordx4 v[32:35], v2, s[4:7], s15 offen offset:0 sc1
  v_mfma_f32_16x16x32_bf16 v[132:135], v[116:119], v[36:39], v[132:135]
  ds_read_b128 v[108:111], v2 offset:27648
  s_waitcnt lgkmcnt(4)
  v_mfma_f32_16x16x32_bf16 v[136:139], v[120:123], v[36:39], v[136:139]
  ds_read_b128 v[112:115], v2 offset:28672
  v_mfma_f32_16x16x32_bf16 v[140:143], v[124:127], v[36:39], v[140:143]
  ds_read_b128 v[116:119], v2 offset:29696
  s_waitcnt lgkmcnt(4)
  v_mfma_f32_16x16x32_bf16 v[128:131], v[96:99], v[40:43], v[128:131]
  ds_read_b128 v[120:123], v2 offset:30720
  buffer_load_dwordx4 v[36:39], v2, s[4:7], s15 offen offset:1024 sc1
  v_mfma_f32_16x16x32_bf16 v[132:135], v[100:103], v[40:43], v[132:135]
  ds_read_b128 v[124:127], v2 offset:31744
  s_waitcnt lgkmcnt(4)
  v_mfma_f32_16x16x32_bf16 v[136:139], v[104:107], v[40:43], v[136:139]
  ds_read_b128 v[96:99], v2 offset:32768
  v_mfma_f32_16x16x32_bf16 v[140:143], v[108:111], v[40:43], v[140:143]
  ds_read_b128 v[100:103], v2 offset:33792
  s_waitcnt lgkmcnt(4)
  v_mfma_f32_16x16x32_bf16 v[128:131], v[112:115], v[44:47], v[128:131]
  ds_read_b128 v[104:107], v2 offset:34816
  buffer_load_dwordx4 v[40:43], v2, s[4:7], s15 offen offset:2048 sc1
  v_mfma_f32_16x16x32_bf16 v[132:135], v[116:119], v[44:47], v[132:135]
  ds_read_b128 v[108:111], v2 offset:35840
  s_waitcnt lgkmcnt(4)
  v_mfma_f32_16x16x32_bf16 v[136:139], v[120:123], v[44:47], v[136:139]
  ds_read_b128 v[112:115], v2 offset:36864
  v_mfma_f32_16x16x32_bf16 v[140:143], v[124:127], v[44:47], v[140:143]
  ds_read_b128 v[116:119], v2 offset:37888
  s_waitcnt lgkmcnt(4)
  v_mfma_f32_16x16x32_bf16 v[128:131], v[96:99], v[48:51], v[128:131]
  ds_read_b128 v[120:123], v2 offset:38912
  buffer_load_dwordx4 v[44:47], v2, s[4:7], s15 offen offset:3072 sc1
  v_mfma_f32_16x16x32_bf16 v[132:135], v[100:103], v[48:51], v[132:135]
  ds_read_b128 v[124:127], v2 offset:39936
  s_waitcnt lgkmcnt(4)
  v_mfma_f32_16x16x32_bf16 v[136:139], v[104:107], v[48:51], v[136:139]
  ds_read_b128 v[96:99], v3 offset:0
  v_mfma_f32_16x16x32_bf16 v[140:143], v[108:111], v[48:51], v[140:143]
  ds_read_b128 v[100:103], v3 offset:1024
  s_waitcnt lgkmcnt(4)
  v_mfma_f32_16x16x32_bf16 v[128:131], v[112:115], v[52:55], v[128:131]
  ds_read_b128 v[104:107], v3 offset:2048
  s_add_u32 s15, s15, 4096
  buffer_load_dwordx4 v[48:51], v2, s[4:7], s15 offen offset:0 sc1
  v_mfma_f32_16x16x32_bf16 v[132:135], v[116:119], v[52:55], v[132:135]
  ds_read_b128 v[108:111], v3 offset:3072
  s_waitcnt lgkmcnt(4)
  v_mfma_f32_16x16x32_bf16 v[136:139], v[120:123], v[52:55], v[136:139]
  ds_read_b128 v[112:115], v3 offset:4096
  v_mfma_f32_16x16x32_bf16 v[140:143], v[124:127], v[52:55], v[140:143]
  ds_read_b128 v[116:119], v3 offset:5120
  s_waitcnt lgkmcnt(4)
  v_mfma_f32_16x16x32_bf16 v[128:131], v[96:99], v[56:59], v[128:131]
  ds_read_b128 v[120:123], v3 offset:6144
  buffer_load_dwordx4 v[52:55], v2, s[4:7], s15 offen offset:1024 sc1
  v_mfma_f32_16x16x32_bf16 v[132:135], v[100:103], v[56:59], v[132:135]
  ds_read_b128 v[124:127], v3 offset:7168
  s_waitcnt lgkmcnt(4)
  v_mfma_f32_16x16x32_bf16 v[136:139], v[104:107], v[56:59], v[136:139]
  ds_read_b128 v[96:99], v3 offset:8192
  v_mfma_f32_16x16x32_bf16 v[140:143], v[108:111], v[56:59], v[140:143]
  ds_read_b128 v[100:103], v3 offset:9216
  s_waitcnt lgkmcnt(4)
  v_mfma_f32_16x16x32_bf16 v[128:131], v[112:115], v[60:63], v[128:131]
  ds_read_b128 v[104:107], v3 offset:10240
  buffer_load_dwordx4 v[56:59], v2, s[4:7], s15 offen offset:2048 sc1
  v_mfma_f32_16x16x32_bf16 v[132:135], v[116:119], v[60:63], v[132:135]
  ds_read_b128 v[108:111], v3 offset:11264
  s_waitcnt lgkmcnt(4)
  v_mfma_f32_16x16x32_bf16 v[136:139], v[120:123], v[60:63], v[136:139]
  ds_read_b128 v[112:115], v3 offset:12288
  v_mfma_f32_16x16x32_bf16 v[140:143], v[124:127], v[60:63], v[140:143]
  ds_read_b128 v[116:119], v3 offset:13312
  s_waitcnt lgkmcnt(4)
  v_mfma_f32_16x16x32_bf16 v[128:131], v[96:99], v[64:67], v[128:131]
  ds_read_b128 v[120:123], v3 offset:14336
  buffer_load_dwordx4 v[60:63], v2, s[4:7], s15 offen offset:3072 sc1
  v_mfma_f32_16x16x32_bf16 v[132:135], v[100:103], v[64:67], v[132:135]
  ds_read_b128 v[124:127], v3 offset:15360
  s_waitcnt lgkmcnt(4)
  v_mfma_f32_16x16x32_bf16 v[136:139], v[104:107], v[64:67], v[136:139]
  ds_read_b128 v[96:99], v3 offset:16384
  v_mfma_f32_16x16x32_bf16 v[140:143], v[108:111], v[64:67], v[140:143]
  ds_read_b128 v[100:103], v3 offset:17408
  s_waitcnt lgkmcnt(4)
  v_mfma_f32_16x16x32_bf16 v[128:131], v[112:115], v[68:71], v[128:131]
  ds_read_b128 v[104:107], v3 offset:18432
  s_add_u32 s15, s15, 4096
  buffer_load_dwordx4 v[64:67], v2, s[4:7], s15 offen offset:0 sc1
  v_mfma_f32_16x16x32_bf16 v[132:135], v[116:119], v[68:71], v[132:135]
  ds_read_b128 v[108:111], v3 offset:19456
  s_waitcnt lgkmcnt(4)
  v_mfma_f32_16x16x32_bf16 v[136:139], v[120:123], v[68:71], v[136:139]
  ds_read_b128 v[112:115], v3 offset:20480
  v_mfma_f32_16x16x32_bf16 v[140:143], v[124:127], v[68:71], v[140:143]
  ds_read_b128 v[116:119], v3 offset:21504
  s_waitcnt lgkmcnt(4)
  v_mfma_f32_16x16x32_bf16 v[128:131], v[96:99], v[72:75], v[128:131]
  ds_read_b128 v[120:123], v3 offset:22528
  buffer_load_dwordx4 v[68:71], v2, s[4:7], s15 offen offset:1024 sc1
  v_mfma_f32_16x16x32_bf16 v[132:135], v[100:103], v[72:75], v[132:135]
  ds_read_b128 v[124:127], v3 offset:23552
  s_waitcnt lgkmcnt(4)
  v_mfma_f32_16x16x32_bf16 v[136:139], v[104:107], v[72:75], v[136:139]
  ds_read_b128 v[96:99], v3 offset:24576
  v_mfma_f32_16x16x32_bf16 v[140:143], v[108:111], v[72:75], v[140:143]
  ds_read_b128 v[100:103], v3 offset:25600
  s_waitcnt lgkmcnt(4)
  v_mfma_f32_16x16x32_bf16 v[128:131], v[112:115], v[76:79], v[128:131]
  ds_read_b128 v[104:107], v3 offset:26624
  buffer_load_dwordx4 v[72:75], v2, s[4:7], s15 offen offset:2048 sc1
  v_mfma_f32_16x16x32_bf16 v[132:135], v[116:119], v[76:79], v[132:135]
  ds_read_b128 v[108:111], v3 offset:27648
  s_waitcnt lgkmcnt(4)
  v_mfma_f32_16x16x32_bf16 v[136:139], v[120:123], v[76:79], v[136:139]
  ds_read_b128 v[112:115], v3 offset:28672
  v_mfma_f32_16x16x32_bf16 v[140:143], v[124:127], v[76:79], v[140:143]
  ds_read_b128 v[116:119], v3 offset:29696
  s_waitcnt lgkmcnt(4)
  v_mfma_f32_16x16x32_bf16 v[128:131], v[96:99], v[80:83], v[128:131]
  ds_read_b128 v[120:123], v3 offset:30720
  buffer_load_dwordx4 v[76:79], v2, s[4:7], s15 offen offset:3072 sc1
  v_mfma_f32_16x16x32_bf16 v[132:135], v[100:103], v[80:83], v[132:135]
  ds_read_b128 v[124:127], v3 offset:31744
  s_waitcnt lgkmcnt(4)
  v_mfma_f32_16x16x32_bf16 v[136:139], v[104:107], v[80:83], v[136:139]
  ds_read_b128 v[96:99], v3 offset:32768
  v_mfma_f32_16x16x32_bf16 v[140:143], v[108:111], v[80:83], v[140:143]
  ds_read_b128 v[100:103], v3 offset:33792
  s_waitcnt lgkmcnt(4)
  v_mfma_f32_16x16x32_bf16 v[128:131], v[112:115], v[84:87], v[128:131]
  ds_read_b128 v[104:107], v3 offset:34816
  s_add_u32 s15, s15, 4096
  buffer_load_dwordx4 v[80:83], v2, s[4:7], s15 offen offset:0 sc1
  v_mfma_f32_16x16x32_bf16 v[132:135], v[116:119], v[84:87], v[132:135]
  ds_read_b128 v[108:111], v3 offset:35840
  s_waitcnt lgkmcnt(4)
  v_mfma_f32_16x16x32_bf16 v[136:139], v[120:123], v[84:87], v[136:139]
  ds_read_b128 v[112:115], v3 offset:36864
  v_mfma_f32_16x16x32_bf16 v[140:143], v[124:127], v[84:87], v[140:143]
  ds_read_b128 v[116:119], v3 offset:37888
  s_waitcnt lgkmcnt(4)
  v_mfma_f32_16x16x32_bf16 v[128:131], v[96:99], v[88:91], v[128:131]
  ds_read_b128 v[120:123], v3 offset:38912
  buffer_load_dwordx4 v[84:87], v2, s[4:7], s15 offen offset:1024 sc1
  v_mfma_f32_16x16x32_bf16 v[132:135], v[100:103], v[88:91], v[132:135]
  ds_read_b128 v[124:127], v3 offset:39936
  s_waitcnt lgkmcnt(4)
  v_mfma_f32_16x16x32_bf16 v[136:139], v[104:107], v[88:91], v[136:139]
  v_mfma_f32_16x16x32_bf16 v[140:143], v[108:111], v[88:91], v[140:143]
  s_waitcnt lgkmcnt(2)
  v_mfma_f32_16x16x32_bf16 v[128:131], v[112:115], v[92:95], v[128:131]
  buffer_load_dwordx4 v[88:91], v2, s[4:7], s15 offen offset:2048 sc1
  v_mfma_f32_16x16x32_bf16 v[132:135], v[116:119], v[92:95], v[132:135]
  s_waitcnt lgkmcnt(0)
  v_mfma_f32_16x16x32_bf16 v[136:139], v[120:123], v[92:95], v[136:139]
  v_mfma_f32_16x16x32_bf16 v[140:143], v[124:127], v[92:95], v[140:143]
  buffer_load_dwordx4 v[92:95], v2, s[4:7], s15 offen offset:3072 sc1
  buffer_load_dword v213, v10, s[4:7], s20 offen offset:512 sc1
  s_nop 0
  v_max3_f32 v188, v128, v129, v130
  v_max3_f32 v189, -v128, -v129, -v130
  v_max3_f32 v188, v188, v131, v132
  v_max3_f32 v189, v189, -v131, -v132
  v_max3_f32 v190, v133, v134, v135
  v_max3_f32 v191, -v133, -v134, -v135
  v_max3_f32 v190, v190, v136, v137
  v_max3_f32 v191, v191, -v136, -v137
  v_cvt_pk_bf16_f32 v208, v138, v139
  v_cvt_pk_bf16_f32 v209, v140, v141
  v_cvt_pk_bf16_f32 v210, v142, v143
  v_permlane16_swap_b32 v188, v189
  v_permlane16_swap_b32 v190, v191
  v_max_f32 v188, v188, v189
  v_max_f32 v190, v190, v191
  s_nop 1
  v_permlane32_swap_b32 v188, v190
  v_max_f32 v188, v188, v190
  v_cndmask_b32 v210, v212, v210, s[40:41]
  v_mul_f32 v188, s31, v188
  ds_write_b64 v5, v[208:209] offset:2304
  ds_write_b32 v6, v210 offset:2336
  v_mov_b32 v190, v188
  s_nop 1
  v_permlane32_swap_b32 v188, v190
  v_mov_b32 v189, v188
  v_mov_b32 v191, v190
  s_nop 0
  v_permlane16_swap_b32 v188, v189
  v_permlane16_swap_b32 v190, v191
  v_fma_f32 v168, v128, s31, -v188
  v_fma_f32 v169, v129, s31, -v188
  v_fma_f32 v170, v130, s31, -v188
  v_fma_f32 v171, v131, s31, -v188
  v_fma_f32 v172, v132, s31, -v188
  v_fma_f32 v173, -v128, s31, -v189
  v_fma_f32 v174, -v129, s31, -v189
  v_fma_f32 v175, -v130, s31, -v189
  v_fma_f32 v176, -v131, s31, -v189
  v_fma_f32 v177, -v132, s31, -v189
  v_fma_f32 v178, v133, s31, -v190
  v_fma_f32 v179, v134, s31, -v190
  v_fma_f32 v180, v135, s31, -v190
  v_fma_f32 v181, v136, s31, -v190
  v_fma_f32 v182, v137, s31, -v190
  v_fma_f32 v183, -v133, s31, -v191
  v_fma_f32 v184, -v134, s31, -v191
  v_fma_f32 v185, -v135, s31, -v191
  v_fma_f32 v186, -v136, s31, -v191
  v_fma_f32 v187, -v137, s31, -v191
  v_exp_f32 v168, v168
  v_exp_f32 v169, v169
  v_exp_f32 v170, v170
  v_exp_f32 v171, v171
  v_exp_f32 v172, v172
  v_exp_f32 v173, v173
  v_exp_f32 v174, v174
  v_exp_f32 v175, v175
  v_exp_f32 v176, v176
  v_exp_f32 v177, v177
  v_exp_f32 v178, v178
  v_exp_f32 v179, v179
  v_exp_f32 v180, v180
  v_exp_f32 v181, v181
  v_exp_f32 v182, v182
  v_exp_f32 v183, v183
  v_exp_f32 v184, v184
  v_exp_f32 v185, v185
  v_exp_f32 v186, v186
  v_exp_f32 v187, v187
  v_add_f32 v188, v168, v169
  v_add_f32 v188, v188, v170
  v_add_f32 v188, v188, v171
  v_add_f32 v188, v188, v172
  v_add_f32 v189, v173, v174
  v_add_f32 v189, v189, v175
  v_add_f32 v189, v189, v176
  v_add_f32 v189, v189, v177
  v_add_f32 v190, v178, v179
  v_add_f32 v190, v190, v180
  v_add_f32 v190, v190, v181
  v_add_f32 v190, v190, v182
  v_add_f32 v191, v183, v184
  v_add_f32 v191, v191, v185
  v_add_f32 v191, v191, v186
  v_add_f32 v191, v191, v187
  v_permlane16_swap_b32 v188, v189
  s_nop 0
  v_permlane16_swap_b32 v190, v191
  v_add_f32 v188, v188, v189
  v_add_f32 v190, v190, v191
  s_nop 1
  v_permlane32_swap_b32 v188, v190
  v_add_f32 v188, v188, v190
  v_rcp_f32 v188, v188
  s_nop 0
  v_mov_b32 v190, v188
  s_nop 1
  v_permlane32_swap_b32 v188, v190
  v_mov_b32 v189, v188
  v_mov_b32 v191, v190
  s_nop 0
  v_permlane16_swap_b32 v188, v189
  v_permlane16_swap_b32 v190, v191
  v_pk_mul_f32 v[178:179], v[178:179], v[190:191] op_sel_hi:[1,0]
  v_cvt_pk_bf16_f32 v200, v178, v179
  v_pk_mul_f32 v[180:181], v[180:181], v[190:191] op_sel_hi:[1,0]
  v_cvt_pk_bf16_f32 v201, v180, v181
  v_pk_mul_f32 v[182:183], v[182:183], v[190:191]
  v_cvt_pk_bf16_f32 v202, v182, v183
  v_pk_mul_f32 v[184:185], v[184:185], v[190:191] op_sel:[0,1]
  v_cvt_pk_bf16_f32 v203, v184, v185
  v_pk_mul_f32 v[186:187], v[186:187], v[190:191] op_sel:[0,1]
  v_cvt_pk_bf16_f32 v204, v186, v187
  ds_write_b128 v4, v[200:203]
  ds_write_b64 v4, v[204:205] offset:16
  ds_read_b64_tr_b16 v[128:129], v7 offset:0
  ds_read_b64_tr_b16 v[130:131], v7 offset:8
  ds_read_b64_tr_b16 v[132:133], v7 offset:16
  ds_read_b64_tr_b16 v[134:135], v8 offset:2304
  ds_read_b64_tr_b16 v[136:137], v9 offset:2336
  v_pk_mul_f32 v[168:169], v[168:169], v[188:189] op_sel_hi:[1,0]
  v_cvt_pk_bf16_f32 v192, v168, v169
  v_pk_mul_f32 v[170:171], v[170:171], v[188:189] op_sel_hi:[1,0]
  v_cvt_pk_bf16_f32 v193, v170, v171
  v_pk_mul_f32 v[172:173], v[172:173], v[188:189]
  v_cvt_pk_bf16_f32 v194, v172, v173
  v_pk_mul_f32 v[174:175], v[174:175], v[188:189] op_sel:[0,1]
  v_cvt_pk_bf16_f32 v195, v174, v175
  v_pk_mul_f32 v[176:177], v[176:177], v[188:189] op_sel:[0,1]
  v_cvt_pk_bf16_f32 v196, v176, v177
  buffer_store_dwordx4 v[192:195], v2, s[4:7], s21 offen
  buffer_store_dword v196, v11, s[4:7], s21 offen offset:1024
  s_add_u32 s21, s21, 327680
  s_waitcnt lgkmcnt(0)
  v_mfma_f32_16x16x16_bf16 v[144:147], v[128:129], v[134:135], v[144:147]
  v_mfma_f32_16x16x16_bf16 v[148:151], v[130:131], v[134:135], v[148:151]
  v_mfma_f32_16x16x16_bf16 v[152:155], v[132:133], v[134:135], v[152:155]
  v_mfma_f32_16x16x16_bf16 v[156:159], v[128:129], v[136:137], v[156:159]
  v_mfma_f32_16x16x16_bf16 v[160:163], v[130:131], v[136:137], v[160:163]
  v_mfma_f32_16x16x16_bf16 v[164:167], v[132:133], v[136:137], v[164:167]
  s_cmp_eq_u32 s22, 16
  s_cbranch_scc1 mk_b1_done
  s_cmp_eq_u32 s23, 0
  s_cbranch_scc1 mk_b1_get
  s_waitcnt vmcnt(2)
  v_mov_b32 v191, v213
  s_branch mk_b1_loop
mk_b1_done:
  s_mul_i32 s14, s3, 6144
  s_add_u32 s14, s14, 98304
  v_add_u32 v3, s14, v2
  ds_write_b128 v3, v[144:147] offset:0
  ds_write_b128 v3, v[148:151] offset:1024
  ds_write_b128 v3, v[152:155] offset:2048
  ds_write_b128 v3, v[156:159] offset:3072
  ds_write_b128 v3, v[160:163] offset:4096
  ds_write_b128 v3, v[164:167] offset:5120
  s_lshl_b32 s14, s3, 11
  s_add_u32 s15, s14, 98304
  v_add_u32 v3, s15, v2
  s_lshl_b32 s16, s66, 6
  s_add_u32 s16, s16, s75
  s_lshl_b32 s16, s16, 13
  s_add_u32 s16, s16, s14
  s_add_u32 s16, s16, 62914560
  s_lshl_b32 s14, s74, 18
  s_xor_b32 s15, s14, 0x40000
  s_add_u32 s15, s15, s16
  s_add_u32 s14, s14, s16
  s_and_b32 s21, s3, 2
  s_add_u32 s21, s21, s74
  s_lshl_b32 s21, s21, 1
  s_and_b32 s16, s3, 1
  s_add_u32 s21, s21, s16
  s_lshl_b32 s16, s66, 6
  s_add_u32 s21, s21, s16
  s_lshl_b32 s21, s21, 6
  s_add_u32 s21, s21, s75
  s_mul_i32 s21, s21, 1280
  s_add_u32 s21, s21, 52428800
  s_and_b32 s12, s3, 2
  s_add_u32 s12, s12, s74
  s_lshl_b32 s12, s12, 1
  s_and_b32 s13, s3, 1
  s_add_u32 s12, s12, s13
  s_lshl_b32 s13, s66, 6
  s_add_u32 s12, s12, s13
  s_mul_i32 s12, s12, 40960
  s_add_u32 s12, s12, 47185920
  s_lshl_b32 s13, s75, 8
  s_add_u32 s13, s13, s12
  s_add_u32 s13, s13, 32768
  s_lshl_b32 s68, s75, 10
  s_add_u32 s12, s12, s68
  v_lshlrev_b32 v4, 3, v1
  v_add_u32 v4, 122880, v4
  v_lshrrev_b32 v5, 4, v1
  v_min_u32 v5, 1, v5
  v_lshl_add_u32 v5, v5, 30, v2
  s_waitcnt vmcnt(0) lgkmcnt(0)
  s_barrier
  s_cmp_eq_u32 s3, 3
  s_cbranch_scc1 mk_b1_x2
  ds_read_b128 v[96:99], v3 offset:0
  ds_read_b128 v[100:103], v3 offset:1024
  ds_read_b128 v[104:107], v3 offset:6144
  ds_read_b128 v[108:111], v3 offset:7168
  ds_read_b128 v[112:115], v3 offset:12288
  ds_read_b128 v[116:119], v3 offset:13312
  ds_read_b128 v[120:123], v3 offset:18432
  ds_read_b128 v[124:127], v3 offset:19456
  s_waitcnt lgkmcnt(0)
  v_pk_add_f32 v[96:97], v[96:97], v[104:105]
  v_pk_add_f32 v[98:99], v[98:99], v[106:107]
  v_pk_add_f32 v[100:101], v[100:101], v[108:109]
  v_pk_add_f32 v[102:103], v[102:103], v[110:111]
  v_pk_add_f32 v[96:97], v[96:97], v[112:113]
  v_pk_add_f32 v[98:99], v[98:99], v[114:115]
  v_pk_add_f32 v[100:101], v[100:101], v[116:117]
  v_pk_add_f32 v[102:103], v[102:103], v[118:119]
  v_pk_add_f32 v[96:97], v[96:97], v[120:121]
  v_pk_add_f32 v[98:99], v[98:99], v[122:123]
  v_pk_add_f32 v[100:101], v[100:101], v[124:125]
  v_pk_add_f32 v[102:103], v[102:103], v[126:127]
  buffer_store_dwordx4 v[96:99], v2, s[4:7], s14 offen offset:0
  buffer_store_dwordx4 v[100:103], v2, s[4:7], s14 offen offset:1024
  s_mov_b32 s70, 0
mk_b1_x0:
  buffer_load_dwordx4 v[104:107], v2, s[4:7], s15 offen offset:0 sc1
  buffer_load_dwordx4 v[108:111], v2, s[4:7], s15 offen offset:1024 sc1
  s_waitcnt vmcnt(0)
  v_max3_u32 v188, v104, v105, v106
  v_max3_u32 v188, v188, v107, v108
  v_max3_u32 v188, v188, v109, v110
  v_max_u32 v188, v188, v111
  v_cmp_eq_u32 vcc, -1, v188
  s_nop 0
  s_cbranch_vccz mk_b1_x1
  s_add_u32 s70, s70, 1
  s_cmp_lt_u32 s70, 262144
  s_cbranch_scc1 mk_b1_x0
  s_branch mk_fail
mk_b1_x1:
  s_lshl_b32 s14, s3, 10
  v_add_u32 v6, s14, v4
  v_pk_add_f32 v[96:97], v[96:97], v[104:105]
  v_cvt_pk_bf16_f32 v112, v96, v97
  v_pk_add_f32 v[98:99], v[98:99], v[106:107]
  v_cvt_pk_bf16_f32 v113, v98, v99
  v_pk_add_f32 v[100:101], v[100:101], v[108:109]
  v_cvt_pk_bf16_f32 v114, v100, v101
  v_pk_add_f32 v[102:103], v[102:103], v[110:111]
  v_cvt_pk_bf16_f32 v115, v102, v103
  ds_write_b64 v6, v[112:113] offset:0
  ds_write_b64 v6, v[114:115] offset:512
  s_waitcnt lgkmcnt(0)
mk_b1_x2:
  s_barrier
  ds_read_b64 v[96:97], v4 offset:0
  ds_read_b64 v[98:99], v4 offset:512
  ds_read_b64 v[100:101], v4 offset:1024
  ds_read_b64 v[104:105], v4 offset:1536
  ds_read_b64 v[106:107], v4 offset:2048
  ds_read_b64 v[108:109], v4 offset:2560
  buffer_load_dwordx4 v[16:19], v2, s[4:7], s21 offen sc1
  buffer_load_dword v80, v11, s[4:7], s21 offen offset:1024 sc1
  s_add_u32 s21, s21, 40960
  buffer_load_dwordx4 v[20:23], v2, s[4:7], s21 offen sc1
  buffer_load_dword v81, v11, s[4:7], s21 offen offset:1024 sc1
  s_add_u32 s21, s21, 614400
  buffer_load_dwordx4 v[24:27], v2, s[4:7], s21 offen sc1
  buffer_load_dword v82, v11, s[4:7], s21 offen offset:1024 sc1
  s_add_u32 s21, s21, 40960
  buffer_load_dwordx4 v[28:31], v2, s[4:7], s21 offen sc1
  buffer_load_dword v83, v11, s[4:7], s21 offen offset:1024 sc1
  s_add_u32 s21, s21, 614400
  buffer_load_dwordx4 v[32:35], v2, s[4:7], s21 offen sc1
  buffer_load_dword v84, v11, s[4:7], s21 offen offset:1024 sc1
  s_add_u32 s21, s21, 40960
  buffer_load_dwordx4 v[36:39], v2, s[4:7], s21 offen sc1
  buffer_load_dword v85, v11, s[4:7], s21 offen offset:1024 sc1
  s_add_u32 s21, s21, 614400
  buffer_load_dwordx4 v[40:43], v2, s[4:7], s21 offen sc1
  buffer_load_dword v86, v11, s[4:7], s21 offen offset:1024 sc1
  s_add_u32 s21, s21, 40960
  buffer_load_dwordx4 v[44:47], v2, s[4:7], s21 offen sc1
  buffer_load_dword v87, v11, s[4:7], s21 offen offset:1024 sc1
  s_add_u32 s21, s21, 614400
  buffer_load_dwordx4 v[48:51], v2, s[4:7], s21 offen sc1
  buffer_load_dword v88, v11, s[4:7], s21 offen offset:1024 sc1
  s_add_u32 s21, s21, 40960
  buffer_load_dwordx4 v[52:55], v2, s[4:7], s21 offen sc1
  buffer_load_dword v89, v11, s[4:7], s21 offen offset:1024 sc1
  s_add_u32 s21, s21, 614400
  buffer_load_dwordx4 v[56:59], v2, s[4:7], s21 offen sc1
  buffer_load_dword v90, v11, s[4:7], s21 offen offset:1024 sc1
  s_add_u32 s21, s21, 40960
  buffer_load_dwordx4 v[60:63], v2, s[4:7], s21 offen sc1
  buffer_load_dword v91, v11, s[4:7], s21 offen offset:1024 sc1
  s_add_u32 s21, s21, 614400
  buffer_load_dwordx4 v[64:67], v2, s[4:7], s21 offen sc1
  buffer_load_dword v92, v11, s[4:7], s21 offen offset:1024 sc1
  s_add_u32 s21, s21, 40960
  buffer_load_dwordx4 v[68:71], v2, s[4:7], s21 offen sc1
  buffer_load_dword v93, v11, s[4:7], s21 offen offset:1024 sc1
  s_add_u32 s21, s21, 614400
  buffer_load_dwordx4 v[72:75], v2, s[4:7], s21 offen sc1
  buffer_load_dword v94, v11, s[4:7], s21 offen offset:1024 sc1
  s_add_u32 s21, s21, 40960
  buffer_load_dwordx4 v[76:79], v2, s[4:7], s21 offen sc1
  buffer_load_dword v95, v11, s[4:7], s21 offen offset:1024 sc1
  s_add_u32 s21, s21, 614400
  s_waitcnt lgkmcnt(0)
  v_mov_b32 v102, 0
  v_mov_b32 v103, v100
  v_mov_b32 v110, 0
  v_mov_b32 v111, v108
  v_mov_b32 v7, 0x358637bd
  s_waitcnt vmcnt(28)
  v_mfma_f32_16x16x32_bf16 v[112:115], v[96:99], v[16:19], 0
  v_mfma_f32_16x16x32_bf16 v[116:119], v[104:107], v[16:19], 0
  v_mfma_f32_16x16x32_bf16 v[120:123], v[96:99], v[20:23], 0
  v_mfma_f32_16x16x32_bf16 v[124:127], v[104:107], v[20:23], 0
  s_nop 2
  v_mfma_f32_16x16x16_bf16 v[128:131], v[100:101], v[80:81], v[112:115]
  v_mfma_f32_16x16x16_bf16 v[132:135], v[108:109], v[80:81], v[116:119]
  v_mfma_f32_16x16x16_bf16 v[136:139], v[102:103], v[80:81], v[120:123]
  v_mfma_f32_16x16x16_bf16 v[140:143], v[110:111], v[80:81], v[124:127]
  s_nop 5
  v_add_f32 v8, v132, v7
  v_mov_b32 v9, v8
  s_nop 1
  v_permlane16_swap_b32 v9, v8
  v_rcp_f32 v8, v8
  s_nop 0
  v_pk_mul_f32 v[128:129], v[128:129], v[8:9] op_sel_hi:[1,0]
  v_cvt_pk_bf16_f32 v176, v128, v129
  v_pk_mul_f32 v[130:131], v[130:131], v[8:9] op_sel_hi:[1,0]
  v_cvt_pk_bf16_f32 v177, v130, v131
  v_pk_mul_f32 v[132:133], v[132:133], v[8:9] op_sel_hi:[1,0]
  v_cvt_pk_bf16_f32 v180, v132, v133
  v_pk_mul_f32 v[134:135], v[134:135], v[8:9] op_sel_hi:[1,0]
  v_cvt_pk_bf16_f32 v181, v134, v135
  v_add_f32 v8, v140, v7
  v_mov_b32 v9, v8
  s_nop 1
  v_permlane16_swap_b32 v9, v8
  v_rcp_f32 v8, v8
  s_nop 0
  v_pk_mul_f32 v[136:137], v[136:137], v[8:9] op_sel_hi:[1,0]
  v_cvt_pk_bf16_f32 v178, v136, v137
  v_pk_mul_f32 v[138:139], v[138:139], v[8:9] op_sel_hi:[1,0]
  v_cvt_pk_bf16_f32 v179, v138, v139
  v_pk_mul_f32 v[140:141], v[140:141], v[8:9] op_sel_hi:[1,0]
  v_cvt_pk_bf16_f32 v182, v140, v141
  v_pk_mul_f32 v[142:143], v[142:143], v[8:9] op_sel_hi:[1,0]
  v_cvt_pk_bf16_f32 v183, v142, v143
  buffer_store_dwordx4 v[176:179], v2, s[4:7], s12 offen sc1
  buffer_store_dwordx4 v[180:183], v5, s[4:7], s13 offen sc1
  s_add_u32 s12, s12, 327680
  s_add_u32 s13, s13, 327680
  s_waitcnt vmcnt(26)
  v_mfma_f32_16x16x32_bf16 v[144:147], v[96:99], v[24:27], 0
  v_mfma_f32_16x16x32_bf16 v[148:151], v[104:107], v[24:27], 0
  v_mfma_f32_16x16x32_bf16 v[152:155], v[96:99], v[28:31], 0
  v_mfma_f32_16x16x32_bf16 v[156:159], v[104:107], v[28:31], 0
  s_nop 2
  v_mfma_f32_16x16x16_bf16 v[160:163], v[100:101], v[82:83], v[144:147]
  v_mfma_f32_16x16x16_bf16 v[164:167], v[108:109], v[82:83], v[148:151]
  v_mfma_f32_16x16x16_bf16 v[168:171], v[102:103], v[82:83], v[152:155]
  v_mfma_f32_16x16x16_bf16 v[172:175], v[110:111], v[82:83], v[156:159]
  s_nop 5
  v_add_f32 v8, v164, v7
  v_mov_b32 v9, v8
  s_nop 1
  v_permlane16_swap_b32 v9, v8
  v_rcp_f32 v8, v8
  s_nop 0
  v_pk_mul_f32 v[160:161], v[160:161], v[8:9] op_sel_hi:[1,0]
  v_cvt_pk_bf16_f32 v184, v160, v161
  v_pk_mul_f32 v[162:163], v[162:163], v[8:9] op_sel_hi:[1,0]
  v_cvt_pk_bf16_f32 v185, v162, v163
  v_pk_mul_f32 v[164:165], v[164:165], v[8:9] op_sel_hi:[1,0]
  v_cvt_pk_bf16_f32 v188, v164, v165
  v_pk_mul_f32 v[166:167], v[166:167], v[8:9] op_sel_hi:[1,0]
  v_cvt_pk_bf16_f32 v189, v166, v167
  v_add_f32 v8, v172, v7
  v_mov_b32 v9, v8
  s_nop 1
  v_permlane16_swap_b32 v9, v8
  v_rcp_f32 v8, v8
  s_nop 0
  v_pk_mul_f32 v[168:169], v[168:169], v[8:9] op_sel_hi:[1,0]
  v_cvt_pk_bf16_f32 v186, v168, v169
  v_pk_mul_f32 v[170:171], v[170:171], v[8:9] op_sel_hi:[1,0]
  v_cvt_pk_bf16_f32 v187, v170, v171
  v_pk_mul_f32 v[172:173], v[172:173], v[8:9] op_sel_hi:[1,0]
  v_cvt_pk_bf16_f32 v190, v172, v173
  v_pk_mul_f32 v[174:175], v[174:175], v[8:9] op_sel_hi:[1,0]
  v_cvt_pk_bf16_f32 v191, v174, v175
  buffer_store_dwordx4 v[184:187], v2, s[4:7], s12 offen sc1
  buffer_store_dwordx4 v[188:191], v5, s[4:7], s13 offen sc1
  s_add_u32 s12, s12, 327680
  s_add_u32 s13, s13, 327680
  s_waitcnt vmcnt(24)
  v_mfma_f32_16x16x32_bf16 v[112:115], v[96:99], v[32:35], 0
  v_mfma_f32_16x16x32_bf16 v[116:119], v[104:107], v[32:35], 0
  v_mfma_f32_16x16x32_bf16 v[120:123], v[96:99], v[36:39], 0
  v_mfma_f32_16x16x32_bf16 v[124:127], v[104:107], v[36:39], 0
  s_nop 2
  v_mfma_f32_16x16x16_bf16 v[128:131], v[100:101], v[84:85], v[112:115]
  v_mfma_f32_16x16x16_bf16 v[132:135], v[108:109], v[84:85], v[116:119]
  v_mfma_f32_16x16x16_bf16 v[136:139], v[102:103], v[84:85], v[120:123]
  v_mfma_f32_16x16x16_bf16 v[140:143], v[110:111], v[84:85], v[124:127]
  s_nop 5
  v_add_f32 v8, v132, v7
  v_mov_b32 v9, v8
  s_nop 1
  v_permlane16_swap_b32 v9, v8
  v_rcp_f32 v8, v8
  s_nop 0
  v_pk_mul_f32 v[128:129], v[128:129], v[8:9] op_sel_hi:[1,0]
  v_cvt_pk_bf16_f32 v176, v128, v129
  v_pk_mul_f32 v[130:131], v[130:131], v[8:9] op_sel_hi:[1,0]
  v_cvt_pk_bf16_f32 v177, v130, v131
  v_pk_mul_f32 v[132:133], v[132:133], v[8:9] op_sel_hi:[1,0]
  v_cvt_pk_bf16_f32 v180, v132, v133
  v_pk_mul_f32 v[134:135], v[134:135], v[8:9] op_sel_hi:[1,0]
  v_cvt_pk_bf16_f32 v181, v134, v135
  v_add_f32 v8, v140, v7
  v_mov_b32 v9, v8
  s_nop 1
  v_permlane16_swap_b32 v9, v8
  v_rcp_f32 v8, v8
  s_nop 0
  v_pk_mul_f32 v[136:137], v[136:137], v[8:9] op_sel_hi:[1,0]
  v_cvt_pk_bf16_f32 v178, v136, v137
  v_pk_mul_f32 v[138:139], v[138:139], v[8:9] op_sel_hi:[1,0]
  v_cvt_pk_bf16_f32 v179, v138, v139
  v_pk_mul_f32 v[140:141], v[140:141], v[8:9] op_sel_hi:[1,0]
  v_cvt_pk_bf16_f32 v182, v140, v141
  v_pk_mul_f32 v[142:143], v[142:143], v[8:9] op_sel_hi:[1,0]
  v_cvt_pk_bf16_f32 v183, v142, v143
  buffer_store_dwordx4 v[176:179], v2, s[4:7], s12 offen sc1
  buffer_store_dwordx4 v[180:183], v5, s[4:7], s13 offen sc1
  s_add_u32 s12, s12, 327680
  s_add_u32 s13, s13, 327680
  s_waitcnt vmcnt(22)
  v_mfma_f32_16x16x32_bf16 v[144:147], v[96:99], v[40:43], 0
  v_mfma_f32_16x16x32_bf16 v[148:151], v[104:107], v[40:43], 0
  v_mfma_f32_16x16x32_bf16 v[152:155], v[96:99], v[44:47], 0
  v_mfma_f32_16x16x32_bf16 v[156:159], v[104:107], v[44:47], 0
  s_nop 2
  v_mfma_f32_16x16x16_bf16 v[160:163], v[100:101], v[86:87], v[144:147]
  v_mfma_f32_16x16x16_bf16 v[164:167], v[108:109], v[86:87], v[148:151]
  v_mfma_f32_16x16x16_bf16 v[168:171], v[102:103], v[86:87], v[152:155]
  v_mfma_f32_16x16x16_bf16 v[172:175], v[110:111], v[86:87], v[156:159]
  s_nop 5
  v_add_f32 v8, v164, v7
  v_mov_b32 v9, v8
  s_nop 1
  v_permlane16_swap_b32 v9, v8
  v_rcp_f32 v8, v8
  s_nop 0
  v_pk_mul_f32 v[160:161], v[160:161], v[8:9] op_sel_hi:[1,0]
  v_cvt_pk_bf16_f32 v184, v160, v161
  v_pk_mul_f32 v[162:163], v[162:163], v[8:9] op_sel_hi:[1,0]
  v_cvt_pk_bf16_f32 v185, v162, v163
  v_pk_mul_f32 v[164:165], v[164:165], v[8:9] op_sel_hi:[1,0]
  v_cvt_pk_bf16_f32 v188, v164, v165
  v_pk_mul_f32 v[166:167], v[166:167], v[8:9] op_sel_hi:[1,0]
  v_cvt_pk_bf16_f32 v189, v166, v167
  v_add_f32 v8, v172, v7
  v_mov_b32 v9, v8
  s_nop 1
  v_permlane16_swap_b32 v9, v8
  v_rcp_f32 v8, v8
  s_nop 0
  v_pk_mul_f32 v[168:169], v[168:169], v[8:9] op_sel_hi:[1,0]
  v_cvt_pk_bf16_f32 v186, v168, v169
  v_pk_mul_f32 v[170:171], v[170:171], v[8:9] op_sel_hi:[1,0]
  v_cvt_pk_bf16_f32 v187, v170, v171
  v_pk_mul_f32 v[172:173], v[172:173], v[8:9] op_sel_hi:[1,0]
  v_cvt_pk_bf16_f32 v190, v172, v173
  v_pk_mul_f32 v[174:175], v[174:175], v[8:9] op_sel_hi:[1,0]
  v_cvt_pk_bf16_f32 v191, v174, v175
  buffer_store_dwordx4 v[184:187], v2, s[4:7], s12 offen sc1
  buffer_store_dwordx4 v[188:191], v5, s[4:7], s13 offen sc1
  s_add_u32 s12, s12, 327680
  s_add_u32 s13, s13, 327680
  s_waitcnt vmcnt(20)
  v_mfma_f32_16x16x32_bf16 v[112:115], v[96:99], v[48:51], 0
  v_mfma_f32_16x16x32_bf16 v[116:119], v[104:107], v[48:51], 0
  v_mfma_f32_16x16x32_bf16 v[120:123], v[96:99], v[52:55], 0
  v_mfma_f32_16x16x32_bf16 v[124:127], v[104:107], v[52:55], 0
  s_nop 2
  v_mfma_f32_16x16x16_bf16 v[128:131], v[100:101], v[88:89], v[112:115]
  v_mfma_f32_16x16x16_bf16 v[132:135], v[108:109], v[88:89], v[116:119]
  v_mfma_f32_16x16x16_bf16 v[136:139], v[102:103], v[88:89], v[120:123]
  v_mfma_f32_16x16x16_bf16 v[140:143], v[110:111], v[88:89], v[124:127]
  s_nop 5
  v_add_f32 v8, v132, v7
  v_mov_b32 v9, v8
  s_nop 1
  v_permlane16_swap_b32 v9, v8
  v_rcp_f32 v8, v8
  s_nop 0
  v_pk_mul_f32 v[128:129], v[128:129], v[8:9] op_sel_hi:[1,0]
  v_cvt_pk_bf16_f32 v176, v128, v129
  v_pk_mul_f32 v[130:131], v[130:131], v[8:9] op_sel_hi:[1,0]
  v_cvt_pk_bf16_f32 v177, v130, v131
  v_pk_mul_f32 v[132:133], v[132:133], v[8:9] op_sel_hi:[1,0]
  v_cvt_pk_bf16_f32 v180, v132, v133
  v_pk_mul_f32 v[134:135], v[134:135], v[8:9] op_sel_hi:[1,0]
  v_cvt_pk_bf16_f32 v181, v134, v135
  v_add_f32 v8, v140, v7
  v_mov_b32 v9, v8
  s_nop 1
  v_permlane16_swap_b32 v9, v8
  v_rcp_f32 v8, v8
  s_nop 0
  v_pk_mul_f32 v[136:137], v[136:137], v[8:9] op_sel_hi:[1,0]
  v_cvt_pk_bf16_f32 v178, v136, v137
  v_pk_mul_f32 v[138:139], v[138:139], v[8:9] op_sel_hi:[1,0]
  v_cvt_pk_bf16_f32 v179, v138, v139
  v_pk_mul_f32 v[140:141], v[140:141], v[8:9] op_sel_hi:[1,0]
  v_cvt_pk_bf16_f32 v182, v140, v141
  v_pk_mul_f32 v[142:143], v[142:143], v[8:9] op_sel_hi:[1,0]
  v_cvt_pk_bf16_f32 v183, v142, v143
  buffer_store_dwordx4 v[176:179], v2, s[4:7], s12 offen sc1
  buffer_store_dwordx4 v[180:183], v5, s[4:7], s13 offen sc1
  s_add_u32 s12, s12, 327680
  s_add_u32 s13, s13, 327680
  s_waitcnt vmcnt(18)
  v_mfma_f32_16x16x32_bf16 v[144:147], v[96:99], v[56:59], 0
  v_mfma_f32_16x16x32_bf16 v[148:151], v[104:107], v[56:59], 0
  v_mfma_f32_16x16x32_bf16 v[152:155], v[96:99], v[60:63], 0
  v_mfma_f32_16x16x32_bf16 v[156:159], v[104:107], v[60:63], 0
  s_nop 2
  v_mfma_f32_16x16x16_bf16 v[160:163], v[100:101], v[90:91], v[144:147]
  v_mfma_f32_16x16x16_bf16 v[164:167], v[108:109], v[90:91], v[148:151]
  v_mfma_f32_16x16x16_bf16 v[168:171], v[102:103], v[90:91], v[152:155]
  v_mfma_f32_16x16x16_bf16 v[172:175], v[110:111], v[90:91], v[156:159]
  s_nop 5
  v_add_f32 v8, v164, v7
  v_mov_b32 v9, v8
  s_nop 1
  v_permlane16_swap_b32 v9, v8
  v_rcp_f32 v8, v8
  s_nop 0
  v_pk_mul_f32 v[160:161], v[160:161], v[8:9] op_sel_hi:[1,0]
  v_cvt_pk_bf16_f32 v184, v160, v161
  v_pk_mul_f32 v[162:163], v[162:163], v[8:9] op_sel_hi:[1,0]
  v_cvt_pk_bf16_f32 v185, v162, v163
  v_pk_mul_f32 v[164:165], v[164:165], v[8:9] op_sel_hi:[1,0]
  v_cvt_pk_bf16_f32 v188, v164, v165
  v_pk_mul_f32 v[166:167], v[166:167], v[8:9] op_sel_hi:[1,0]
  v_cvt_pk_bf16_f32 v189, v166, v167
  v_add_f32 v8, v172, v7
  v_mov_b32 v9, v8
  s_nop 1
  v_permlane16_swap_b32 v9, v8
  v_rcp_f32 v8, v8
  s_nop 0
  v_pk_mul_f32 v[168:169], v[168:169], v[8:9] op_sel_hi:[1,0]
  v_cvt_pk_bf16_f32 v186, v168, v169
  v_pk_mul_f32 v[170:171], v[170:171], v[8:9] op_sel_hi:[1,0]
  v_cvt_pk_bf16_f32 v187, v170, v171
  v_pk_mul_f32 v[172:173], v[172:173], v[8:9] op_sel_hi:[1,0]
  v_cvt_pk_bf16_f32 v190, v172, v173
  v_pk_mul_f32 v[174:175], v[174:175], v[8:9] op_sel_hi:[1,0]
  v_cvt_pk_bf16_f32 v191, v174, v175
  buffer_store_dwordx4 v[184:187], v2, s[4:7], s12 offen sc1
  buffer_store_dwordx4 v[188:191], v5, s[4:7], s13 offen sc1
  s_add_u32 s12, s12, 327680
  s_add_u32 s13, s13, 327680
  s_waitcnt vmcnt(16)
  v_mfma_f32_16x16x32_bf16 v[112:115], v[96:99], v[64:67], 0
  v_mfma_f32_16x16x32_bf16 v[116:119], v[104:107], v[64:67], 0
  v_mfma_f32_16x16x32_bf16 v[120:123], v[96:99], v[68:71], 0
  v_mfma_f32_16x16x32_bf16 v[124:127], v[104:107], v[68:71], 0
  s_nop 2
  v_mfma_f32_16x16x16_bf16 v[128:131], v[100:101], v[92:93], v[112:115]
  v_mfma_f32_16x16x16_bf16 v[132:135], v[108:109], v[92:93], v[116:119]
  v_mfma_f32_16x16x16_bf16 v[136:139], v[102:103], v[92:93], v[120:123]
  v_mfma_f32_16x16x16_bf16 v[140:143], v[110:111], v[92:93], v[124:127]
  s_nop 5
  v_add_f32 v8, v132, v7
  v_mov_b32 v9, v8
  s_nop 1
  v_permlane16_swap_b32 v9, v8
  v_rcp_f32 v8, v8
  s_nop 0
  v_pk_mul_f32 v[128:129], v[128:129], v[8:9] op_sel_hi:[1,0]
  v_cvt_pk_bf16_f32 v176, v128, v129
  v_pk_mul_f32 v[130:131], v[130:131], v[8:9] op_sel_hi:[1,0]
  v_cvt_pk_bf16_f32 v177, v130, v131
  v_pk_mul_f32 v[132:133], v[132:133], v[8:9] op_sel_hi:[1,0]
  v_cvt_pk_bf16_f32 v180, v132, v133
  v_pk_mul_f32 v[134:135], v[134:135], v[8:9] op_sel_hi:[1,0]
  v_cvt_pk_bf16_f32 v181, v134, v135
  v_add_f32 v8, v140, v7
  v_mov_b32 v9, v8
  s_nop 1
  v_permlane16_swap_b32 v9, v8
  v_rcp_f32 v8, v8
  s_nop 0
  v_pk_mul_f32 v[136:137], v[136:137], v[8:9] op_sel_hi:[1,0]
  v_cvt_pk_bf16_f32 v178, v136, v137
  v_pk_mul_f32 v[138:139], v[138:139], v[8:9] op_sel_hi:[1,0]
  v_cvt_pk_bf16_f32 v179, v138, v139
  v_pk_mul_f32 v[140:141], v[140:141], v[8:9] op_sel_hi:[1,0]
  v_cvt_pk_bf16_f32 v182, v140, v141
  v_pk_mul_f32 v[142:143], v[142:143], v[8:9] op_sel_hi:[1,0]
  v_cvt_pk_bf16_f32 v183, v142, v143
  buffer_store_dwordx4 v[176:179], v2, s[4:7], s12 offen sc1
  buffer_store_dwordx4 v[180:183], v5, s[4:7], s13 offen sc1
  s_add_u32 s12, s12, 327680
  s_add_u32 s13, s13, 327680
  s_waitcnt vmcnt(14)
  v_mfma_f32_16x16x32_bf16 v[144:147], v[96:99], v[72:75], 0
  v_mfma_f32_16x16x32_bf16 v[148:151], v[104:107], v[72:75], 0
  v_mfma_f32_16x16x32_bf16 v[152:155], v[96:99], v[76:79], 0
  v_mfma_f32_16x16x32_bf16 v[156:159], v[104:107], v[76:79], 0
  s_nop 2
  v_mfma_f32_16x16x16_bf16 v[160:163], v[100:101], v[94:95], v[144:147]
  v_mfma_f32_16x16x16_bf16 v[164:167], v[108:109], v[94:95], v[148:151]
  v_mfma_f32_16x16x16_bf16 v[168:171], v[102:103], v[94:95], v[152:155]
  v_mfma_f32_16x16x16_bf16 v[172:175], v[110:111], v[94:95], v[156:159]
  s_nop 5
  v_add_f32 v8, v164, v7
  v_mov_b32 v9, v8
  s_nop 1
  v_permlane16_swap_b32 v9, v8
  v_rcp_f32 v8, v8
  s_nop 0
  v_pk_mul_f32 v[160:161], v[160:161], v[8:9] op_sel_hi:[1,0]
  v_cvt_pk_bf16_f32 v184, v160, v161
  v_pk_mul_f32 v[162:163], v[162:163], v[8:9] op_sel_hi:[1,0]
  v_cvt_pk_bf16_f32 v185, v162, v163
  v_pk_mul_f32 v[164:165], v[164:165], v[8:9] op_sel_hi:[1,0]
  v_cvt_pk_bf16_f32 v188, v164, v165
  v_pk_mul_f32 v[166:167], v[166:167], v[8:9] op_sel_hi:[1,0]
  v_cvt_pk_bf16_f32 v189, v166, v167
  v_add_f32 v8, v172, v7
  v_mov_b32 v9, v8
  s_nop 1
  v_permlane16_swap_b32 v9, v8
  v_rcp_f32 v8, v8
  s_nop 0
  v_pk_mul_f32 v[168:169], v[168:169], v[8:9] op_sel_hi:[1,0]
  v_cvt_pk_bf16_f32 v186, v168, v169
  v_pk_mul_f32 v[170:171], v[170:171], v[8:9] op_sel_hi:[1,0]
  v_cvt_pk_bf16_f32 v187, v170, v171
  v_pk_mul_f32 v[172:173], v[172:173], v[8:9] op_sel_hi:[1,0]
  v_cvt_pk_bf16_f32 v190, v172, v173
  v_pk_mul_f32 v[174:175], v[174:175], v[8:9] op_sel_hi:[1,0]
  v_cvt_pk_bf16_f32 v191, v174, v175
  buffer_store_dwordx4 v[184:187], v2, s[4:7], s12 offen sc1
  buffer_store_dwordx4 v[188:191], v5, s[4:7], s13 offen sc1
  s_add_u32 s12, s12, 327680
  s_add_u32 s13, s13, 327680
  s_add_u32 s66, s66, 1
  s_cmp_ge_u32 s66, 2
  s_cbranch_scc1 mk_end
  s_waitcnt lgkmcnt(0)
  s_barrier
  s_branch mk_kv_entry
mk_urole:
  ds_read_b64_tr_b16 a[0:1], v17 offset:0
  ds_read_b64_tr_b16 a[24:25], v17 offset:32
  ds_read_b64_tr_b16 a[48:49], v17 offset:64
  ds_read_b64_tr_b16 a[72:73], v17 offset:96
  ds_read_b64_tr_b16 a[96:97], v17 offset:128
  ds_read_b64_tr_b16 a[120:121], v17 offset:160
  ds_read_b64_tr_b16 a[144:145], v17 offset:192
  ds_read_b64_tr_b16 a[168:169], v17 offset:224
  ds_read_b64_tr_b16 a[192:193], v17 offset:256
  ds_read_b64_tr_b16 a[216:217], v17 offset:288
  s_waitcnt lgkmcnt(0)
  s_mov_b64 exec, s[76:77]
  s_add_u32 m0, s11, 0
  s_nop 0
  buffer_load_dwordx4 v16, s[92:95], s10 offen lds
  s_add_u32 s10, s10, 3840
  s_add_u32 m0, s11, 960
  s_nop 0
  buffer_load_dwordx4 v16, s[92:95], s10 offen lds
  s_add_u32 s10, s10, 3840
  s_add_u32 m0, s11, 1920
  s_nop 0
  buffer_load_dwordx4 v16, s[92:95], s10 offen lds
  s_add_u32 s10, s10, 3840
  s_add_u32 m0, s11, 2880
  s_nop 0
  buffer_load_dwordx4 v16, s[92:95], s10 offen lds
  s_add_u32 s10, s10, 3840
  s_add_u32 m0, s11, 3840
  s_nop 0
  buffer_load_dwordx4 v16, s[92:95], s10 offen lds
  s_add_u32 s10, s10, 3840
  s_mov_b64 exec, -1
  ds_read_b64_tr_b16 a[2:3], v17 offset:5120
  ds_read_b64_tr_b16 a[26:27], v17 offset:5152
  ds_read_b64_tr_b16 a[50:51], v17 offset:5184
  ds_read_b64_tr_b16 a[74:75], v17 offset:5216
  ds_read_b64_tr_b16 a[98:99], v17 offset:5248
  ds_read_b64_tr_b16 a[122:123], v17 offset:5280
  ds_read_b64_tr_b16 a[146:147], v17 offset:5312
  ds_read_b64_tr_b16 a[170:171], v17 offset:5344
  ds_read_b64_tr_b16 a[194:195], v17 offset:5376
  ds_read_b64_tr_b16 a[218:219], v17 offset:5408
  s_waitcnt lgkmcnt(0)
  s_mov_b64 exec, s[76:77]
  s_add_u32 m0, s11, 4800
  s_nop 0
  buffer_load_dwordx4 v16, s[92:95], s10 offen lds
  s_add_u32 s10, s10, 3840
  s_add_u32 m0, s11, 5760
  s_nop 0
  buffer_load_dwordx4 v16, s[92:95], s10 offen lds
  s_add_u32 s10, s10, 3840
  s_add_u32 m0, s11, 6720
  s_nop 0
  buffer_load_dwordx4 v16, s[92:95], s10 offen lds
  s_add_u32 s10, s10, 3840
  s_add_u32 m0, s11, 7680
  s_nop 0
  buffer_load_dwordx4 v16, s[92:95], s10 offen lds
  s_add_u32 s10, s10, 3840
  s_add_u32 m0, s11, 8640
  s_nop 0
  buffer_load_dwordx4 v16, s[92:95], s10 offen lds
  s_add_u32 s10, s10, 3840
  s_mov_b64 exec, -1
  ds_read_b64_tr_b16 a[16:17], v17 offset:10240
  ds_read_b64_tr_b16 a[40:41], v17 offset:10272
  ds_read_b64_tr_b16 a[64:65], v17 offset:10304
  ds_read_b64_tr_b16 a[88:89], v17 offset:10336
  ds_read_b64_tr_b16 a[112:113], v17 offset:10368
  ds_read_b64_tr_b16 a[136:137], v17 offset:10400
  ds_read_b64_tr_b16 a[160:161], v17 offset:10432
  ds_read_b64_tr_b16 a[184:185], v17 offset:10464
  ds_read_b64_tr_b16 a[208:209], v17 offset:10496
  ds_read_b64_tr_b16 a[232:233], v17 offset:10528
  s_waitcnt lgkmcnt(0)
  s_mov_b64 exec, s[76:77]
  s_add_u32 m0, s11, 9600
  s_nop 0
  buffer_load_dwordx4 v16, s[92:95], s10 offen lds
  s_add_u32 s10, s10, 3840
  s_add_u32 m0, s11, 10560
  s_nop 0
  buffer_load_dwordx4 v16, s[92:95], s10 offen lds
  s_add_u32 s10, s10, 3840
  s_add_u32 m0, s11, 11520
  s_nop 0
  buffer_load_dwordx4 v16, s[92:95], s10 offen lds
  s_add_u32 s10, s10, 3840
  s_add_u32 m0, s11, 12480
  s_nop 0
  buffer_load_dwordx4 v16, s[92:95], s10 offen lds
  s_add_u32 s10, s10, 3840
  s_add_u32 m0, s11, 13440
  s_nop 0
  buffer_load_dwordx4 v16, s[92:95], s10 offen lds
  s_add_u32 s10, s10, 3840
  s_add_u32 m0, s11, 14400
  s_nop 0
  buffer_load_dwordx4 v16, s[92:95], s10 offen lds
  s_add_u32 s10, s10, 3840
  s_mov_b64 exec, -1
  ds_read_b64_tr_b16 a[4:5], v17 offset:15360
  ds_read_b64_tr_b16 a[28:29], v17 offset:15392
  ds_read_b64_tr_b16 a[52:53], v17 offset:15424
  ds_read_b64_tr_b16 a[76:77], v17 offset:15456
  ds_read_b64_tr_b16 a[100:101], v17 offset:15488
  ds_read_b64_tr_b16 a[124:125], v17 offset:15520
  ds_read_b64_tr_b16 a[148:149], v17 offset:15552
  ds_read_b64_tr_b16 a[172:173], v17 offset:15584
  ds_read_b64_tr_b16 a[196:197], v17 offset:15616
  ds_read_b64_tr_b16 a[220:221], v17 offset:15648
  s_waitcnt lgkmcnt(0)
  s_mov_b64 exec, s[76:77]
  s_add_u32 m0, s11, 15360
  s_nop 0
  buffer_load_dwordx4 v16, s[92:95], s10 offen lds
  s_add_u32 s10, s10, 3840
  s_add_u32 m0, s11, 16320
  s_nop 0
  buffer_load_dwordx4 v16, s[92:95], s10 offen lds
  s_add_u32 s10, s10, 3840
  s_add_u32 m0, s11, 17280
  s_nop 0
  buffer_load_dwordx4 v16, s[92:95], s10 offen lds
  s_add_u32 s10, s10, 3840
  s_add_u32 m0, s11, 18240
  s_nop 0
  buffer_load_dwordx4 v16, s[92:95], s10 offen lds
  s_add_u32 s10, s10, 3840
  s_add_u32 m0, s11, 19200
  s_nop 0
  buffer_load_dwordx4 v16, s[92:95], s10 offen lds
  s_add_u32 s10, s10, 3840
  s_mov_b64 exec, -1
  ds_read_b64_tr_b16 a[6:7], v17 offset:20480
  ds_read_b64_tr_b16 a[30:31], v17 offset:20512
  ds_read_b64_tr_b16 a[54:55], v17 offset:20544
  ds_read_b64_tr_b16 a[78:79], v17 offset:20576
  ds_read_b64_tr_b16 a[102:103], v17 offset:20608
  ds_read_b64_tr_b16 a[126:127], v17 offset:20640
  ds_read_b64_tr_b16 a[150:151], v17 offset:20672
  ds_read_b64_tr_b16 a[174:175], v17 offset:20704
  ds_read_b64_tr_b16 a[198:199], v17 offset:20736
  ds_read_b64_tr_b16 a[222:223], v17 offset:20768
  s_waitcnt lgkmcnt(0)
  s_mov_b64 exec, s[76:77]
  s_add_u32 m0, s11, 20160
  s_nop 0
  buffer_load_dwordx4 v16, s[92:95], s10 offen lds
  s_add_u32 s10, s10, 3840
  s_add_u32 m0, s11, 21120
  s_nop 0
  buffer_load_dwordx4 v16, s[92:95], s10 offen lds
  s_add_u32 s10, s10, 3840
  s_add_u32 m0, s11, 22080
  s_nop 0
  buffer_load_dwordx4 v16, s[92:95], s10 offen lds
  s_add_u32 s10, s10, 3840
  s_add_u32 m0, s11, 23040
  s_nop 0
  buffer_load_dwordx4 v16, s[92:95], s10 offen lds
  s_add_u32 s10, s10, 3840
  s_add_u32 m0, s11, 24000
  s_nop 0
  buffer_load_dwordx4 v16, s[92:95], s10 offen lds
  s_add_u32 s10, s10, 3840
  s_mov_b64 exec, -1
  ds_read_b64_tr_b16 a[18:19], v17 offset:25600
  ds_read_b64_tr_b16 a[42:43], v17 offset:25632
  ds_read_b64_tr_b16 a[66:67], v17 offset:25664
  ds_read_b64_tr_b16 a[90:91], v17 offset:25696
  ds_read_b64_tr_b16 a[114:115], v17 offset:25728
  ds_read_b64_tr_b16 a[138:139], v17 offset:25760
  ds_read_b64_tr_b16 a[162:163], v17 offset:25792
  ds_read_b64_tr_b16 a[186:187], v17 offset:25824
  ds_read_b64_tr_b16 a[210:211], v17 offset:25856
  ds_read_b64_tr_b16 a[234:235], v17 offset:25888
  s_waitcnt lgkmcnt(0)
  s_mov_b64 exec, s[76:77]
  s_add_u32 m0, s11, 24960
  s_nop 0
  buffer_load_dwordx4 v16, s[92:95], s10 offen lds
  s_add_u32 s10, s10, 3840
  s_add_u32 m0, s11, 25920
  s_nop 0
  buffer_load_dwordx4 v16, s[92:95], s10 offen lds
  s_add_u32 s10, s10, 3840
  s_add_u32 m0, s11, 26880
  s_nop 0
  buffer_load_dwordx4 v16, s[92:95], s10 offen lds
  s_add_u32 s10, s10, 3840
  s_add_u32 m0, s11, 27840
  s_nop 0
  buffer_load_dwordx4 v16, s[92:95], s10 offen lds
  s_add_u32 s10, s10, 3840
  s_add_u32 m0, s11, 28800
  s_nop 0
  buffer_load_dwordx4 v16, s[92:95], s10 offen lds
  s_add_u32 s10, s10, 3840
  s_add_u32 m0, s11, 29760
  s_nop 0
  buffer_load_dwordx4 v16, s[92:95], s10 offen lds
  s_add_u32 s10, s10, 3840
  s_mov_b64 exec, -1
  s_waitcnt vmcnt(26)
  ds_read_b64_tr_b16 a[8:9], v17 offset:0
  ds_read_b64_tr_b16 a[32:33], v17 offset:32
  ds_read_b64_tr_b16 a[56:57], v17 offset:64
  ds_read_b64_tr_b16 a[80:81], v17 offset:96
  ds_read_b64_tr_b16 a[104:105], v17 offset:128
  ds_read_b64_tr_b16 a[128:129], v17 offset:160
  ds_read_b64_tr_b16 a[152:153], v17 offset:192
  ds_read_b64_tr_b16 a[176:177], v17 offset:224
  ds_read_b64_tr_b16 a[200:201], v17 offset:256
  ds_read_b64_tr_b16 a[224:225], v17 offset:288
  s_waitcnt vmcnt(21)
  ds_read_b64_tr_b16 a[10:11], v17 offset:5120
  ds_read_b64_tr_b16 a[34:35], v17 offset:5152
  ds_read_b64_tr_b16 a[58:59], v17 offset:5184
  ds_read_b64_tr_b16 a[82:83], v17 offset:5216
  ds_read_b64_tr_b16 a[106:107], v17 offset:5248
  ds_read_b64_tr_b16 a[130:131], v17 offset:5280
  ds_read_b64_tr_b16 a[154:155], v17 offset:5312
  ds_read_b64_tr_b16 a[178:179], v17 offset:5344
  ds_read_b64_tr_b16 a[202:203], v17 offset:5376
  ds_read_b64_tr_b16 a[226:227], v17 offset:5408
  s_waitcnt vmcnt(16)
  ds_read_b64_tr_b16 a[20:21], v17 offset:10240
  ds_read_b64_tr_b16 a[44:45], v17 offset:10272
  ds_read_b64_tr_b16 a[68:69], v17 offset:10304
  ds_read_b64_tr_b16 a[92:93], v17 offset:10336
  ds_read_b64_tr_b16 a[116:117], v17 offset:10368
  ds_read_b64_tr_b16 a[140:141], v17 offset:10400
  ds_read_b64_tr_b16 a[164:165], v17 offset:10432
  ds_read_b64_tr_b16 a[188:189], v17 offset:10464
  ds_read_b64_tr_b16 a[212:213], v17 offset:10496
  ds_read_b64_tr_b16 a[236:237], v17 offset:10528
  s_waitcnt vmcnt(10)
  ds_read_b64_tr_b16 a[12:13], v17 offset:15360
  ds_read_b64_tr_b16 a[36:37], v17 offset:15392
  ds_read_b64_tr_b16 a[60:61], v17 offset:15424
  ds_read_b64_tr_b16 a[84:85], v17 offset:15456
  ds_read_b64_tr_b16 a[108:109], v17 offset:15488
  ds_read_b64_tr_b16 a[132:133], v17 offset:15520
  ds_read_b64_tr_b16 a[156:157], v17 offset:15552
  ds_read_b64_tr_b16 a[180:181], v17 offset:15584
  ds_read_b64_tr_b16 a[204:205], v17 offset:15616
  ds_read_b64_tr_b16 a[228:229], v17 offset:15648
  s_waitcnt vmcnt(5)
  ds_read_b64_tr_b16 a[14:15], v17 offset:20480
  ds_read_b64_tr_b16 a[38:39], v17 offset:20512
  ds_read_b64_tr_b16 a[62:63], v17 offset:20544
  ds_read_b64_tr_b16 a[86:87], v17 offset:20576
  ds_read_b64_tr_b16 a[110:111], v17 offset:20608
  ds_read_b64_tr_b16 a[134:135], v17 offset:20640
  ds_read_b64_tr_b16 a[158:159], v17 offset:20672
  ds_read_b64_tr_b16 a[182:183], v17 offset:20704
  ds_read_b64_tr_b16 a[206:207], v17 offset:20736
  ds_read_b64_tr_b16 a[230:231], v17 offset:20768
  s_waitcnt vmcnt(0)
  ds_read_b64_tr_b16 a[22:23], v17 offset:25600
  ds_read_b64_tr_b16 a[46:47], v17 offset:25632
  ds_read_b64_tr_b16 a[70:71], v17 offset:25664
  ds_read_b64_tr_b16 a[94:95], v17 offset:25696
  ds_read_b64_tr_b16 a[118:119], v17 offset:25728
  ds_read_b64_tr_b16 a[142:143], v17 offset:25760
  ds_read_b64_tr_b16 a[166:167], v17 offset:25792
  ds_read_b64_tr_b16 a[190:191], v17 offset:25824
  ds_read_b64_tr_b16 a[214:215], v17 offset:25856
  ds_read_b64_tr_b16 a[238:239], v17 offset:25888
  s_waitcnt lgkmcnt(0)
  v_and_b32 v252, 7, v1
  v_lshlrev_b32 v252, 3, v252
  s_mov_b32 s70, 0
int_ce11:
  buffer_load_dwordx2 v[250:251], v252, s[44:47], s67 offen sc1
  s_waitcnt vmcnt(0)
  v_lshrrev_b32 v253, 8, v251
  v_cmp_ne_u32 vcc, 32, v253
  s_nop 0
  s_cbranch_vccz int_ce11_ok
  s_sleep 8
  s_add_u32 s70, s70, 1
  s_cmp_lt_u32 s70, 262144
  s_cbranch_scc1 int_ce11
  s_branch mk_fail
int_ce11_ok:
  v_not_b32 v250, v250
  v_and_b32 v251, 0xff, v251
  v_or_b32 v250, v250, v251
  v_cmp_ne_u32 vcc, 0, v250
  s_nop 0
  s_cbranch_vccnz mk_redo
  v_lshlrev_b32 v252, 2, v1
  s_mov_b32 s68, 64946176
  buffer_load_dword v250, v252, s[4:7], s68 offen sc1
  s_waitcnt vmcnt(0)
  v_cmp_eq_u32 s[64:65], 1, v250
  s_barrier
mk_u_entry:
  v_lshlrev_b32 v2, 4, v1
  v_and_b32 v7, 3, v1
  v_lshlrev_b32 v7, 2, v7
  v_min_u32 v0, 1, v1
  v_lshlrev_b32 v0, 30, v0
  s_add_u32 s30, s73, 40
  s_lshl_b32 s30, s30, 14
  s_add_u32 s30, s30, s39
  s_lshl_b32 s13, s3, 10
  s_add_u32 s30, s30, s13
  s_lshr_b32 s31, s73, 1
  s_sub_u32 s31, s31, s73
  s_add_u32 s31, s31, 8
  s_lshl_b32 s31, s31, 14
  s_and_b32 s15, s73, 1
  s_lshl_b32 s15, s15, 12
  s_add_u32 s31, s31, s15
  s_mul_i32 s34, s3, 163840
  s_lshl_b32 s15, s73, 10
  s_add_u32 s34, s34, s15
  s_add_u32 s34, s34, s39
  s_lshl_b32 s20, s75, 7
  s_add_u32 s20, s20, 64884736
  s_lshl_b32 s21, s3, 2
  s_add_u32 s21, s21, s20
  s_add_u32 s21, s21, 4096
  s_mov_b32 s22, 0
mk_u_layer:
  s_lshl_b32 s24, s66, 6
  s_mov_b32 s27, s24
  s_add_u32 s28, s24, 63
  s_mov_b32 s26, 0
  v_mov_b32 v5, v2
  v_add_u32 v9, 8192, v2
  v_add_u32 v10, 10240, v2
  s_add_u32 s23, s27, 1
  s_cmp_lt_u32 s22, s23
  s_cbranch_scc1 int_sl12
int_sl12_b:
  s_and_b32 s12, s27, 31
  s_lshl_b32 s12, s12, 2
  s_add_u32 s12, s12, s72
  s_lshr_b32 s68, s12, 1
  s_bitcmp0_b64 s[64:65], s68
  s_cselect_b32 s68, 0x2000, 0
  s_lshl_b32 s12, s12, 20
  s_add_u32 s12, s12, s68
  s_add_u32 s12, s12, s30
  s_add_u32 m0, s26, s13
  s_add_u32 s15, s12, 4096
  buffer_load_dwordx4 v2, s[4:7], s12 offen sc1 lds
  s_add_u32 m0, m0, 4096
  s_add_u32 s12, s12, s31
  buffer_load_dwordx4 v2, s[4:7], s15 offen sc1 lds
  s_add_u32 m0, m0, 4096
  s_min_u32 s27, s23, s28
  buffer_load_dwordx4 v2, s[4:7], s12 offen sc1 lds
  s_xor_b32 s26, s26, 16384
  buffer_load_dword v8, v7, s[4:7], s20 offen sc1
  s_waitcnt vmcnt(0)
  s_barrier
  ds_read_b128 v[16:19], v5 offset:0
  ds_read_b128 v[20:23], v5 offset:1024
  ds_read_b128 v[24:27], v5 offset:2048
  ds_read_b128 v[28:31], v5 offset:3072
  ds_read2_b64 v[32:35], v9 offset0:0 offset1:128
  ds_read2_b64 v[36:39], v10 offset0:0 offset1:128
  ds_read_b128 v[40:43], v5 offset:4096
  ds_read_b128 v[44:47], v5 offset:5120
  ds_read_b128 v[48:51], v5 offset:6144
  ds_read_b128 v[52:55], v5 offset:7168
  ds_read2_b64 v[56:59], v9 offset0:1 offset1:129
  ds_read2_b64 v[60:63], v10 offset0:1 offset1:129
  v_xor_b32 v5, 16384, v5
  v_xor_b32 v9, 16384, v9
  v_xor_b32 v10, 16384, v10
  s_mov_b32 s16, 0x40000000
mk_u_loop:
  s_waitcnt lgkmcnt(0)
  v_mfma_f32_16x16x32_bf16 v[112:115], v[16:19], a[0:3], 0
  v_mfma_f32_16x16x32_bf16 v[116:119], v[40:43], a[0:3], 0
  v_mfma_f32_16x16x32_bf16 v[112:115], v[20:23], a[4:7], v[112:115]
  v_cvt_pk_bf16_f32 v132, v120, v121
  v_cvt_pk_bf16_f32 v133, v124, v125
  v_mfma_f32_16x16x32_bf16 v[116:119], v[44:47], a[4:7], v[116:119]
  v_cvt_pk_bf16_f32 v134, v122, v123
  v_cvt_pk_bf16_f32 v135, v126, v127
  v_mfma_f32_16x16x32_bf16 v[112:115], v[24:27], a[8:11], v[112:115]
  buffer_store_dwordx4 v[132:135], v2, s[4:7], s16 offen sc1
  s_add_u32 s16, s16, 16384
  v_mfma_f32_16x16x32_bf16 v[116:119], v[48:51], a[8:11], v[116:119]
  s_and_b32 s16, s24, 31
  s_lshl_b32 s16, s16, 2
  s_add_u32 s16, s16, s72
  v_mfma_f32_16x16x32_bf16 v[112:115], v[28:31], a[12:15], v[112:115]
  s_lshr_b32 s68, s16, 1
  s_bitcmp1_b64 s[64:65], s68
  s_cselect_b32 s68, 0x2000, 0
  v_mfma_f32_16x16x32_bf16 v[116:119], v[52:55], a[12:15], v[116:119]
  s_lshl_b32 s16, s16, 20
  s_add_u32 s16, s16, s68
  s_add_u32 s16, s16, s34
  v_mfma_f32_16x16x32_bf16 v[112:115], v[32:35], a[16:19], v[112:115]
  v_min_u32_dpp v8, v8, v8 quad_perm:[1,0,3,2] row_mask:0xf bank_mask:0xf
  v_mfma_f32_16x16x32_bf16 v[116:119], v[56:59], a[16:19], v[116:119]
  s_nop 0
  v_min_u32_dpp v8, v8, v8 quad_perm:[2,3,0,1] row_mask:0xf bank_mask:0xf
  v_mfma_f32_16x16x32_bf16 v[112:115], v[36:39], a[20:23], v[112:115]
  v_readfirstlane_b32 s29, v8
  v_mfma_f32_16x16x32_bf16 v[116:119], v[60:63], a[20:23], v[116:119]
  s_max_u32 s22, s22, s29
  s_add_u32 s23, s27, 1
  s_cmp_lt_u32 s22, s23
  s_cbranch_scc1 int_sl14
int_sl14_b:
  v_mfma_f32_16x16x32_bf16 v[120:123], v[16:19], a[24:27], 0
  v_mfma_f32_16x16x32_bf16 v[124:127], v[40:43], a[24:27], 0
  v_mfma_f32_16x16x32_bf16 v[120:123], v[20:23], a[28:31], v[120:123]
  v_cvt_pk_bf16_f32 v128, v112, v113
  v_cvt_pk_bf16_f32 v129, v116, v117
  v_mfma_f32_16x16x32_bf16 v[124:127], v[44:47], a[28:31], v[124:127]
  v_cvt_pk_bf16_f32 v130, v114, v115
  v_cvt_pk_bf16_f32 v131, v118, v119
  v_mfma_f32_16x16x32_bf16 v[120:123], v[24:27], a[32:35], v[120:123]
  buffer_store_dwordx4 v[128:131], v2, s[4:7], s16 offen sc1
  s_add_u32 s16, s16, 16384
  v_mfma_f32_16x16x32_bf16 v[124:127], v[48:51], a[32:35], v[124:127]
  s_and_b32 s12, s27, 31
  s_lshl_b32 s12, s12, 2
  s_add_u32 s12, s12, s72
  v_mfma_f32_16x16x32_bf16 v[120:123], v[28:31], a[36:39], v[120:123]
  s_lshr_b32 s68, s12, 1
  s_bitcmp0_b64 s[64:65], s68
  s_cselect_b32 s68, 0x2000, 0
  v_mfma_f32_16x16x32_bf16 v[124:127], v[52:55], a[36:39], v[124:127]
  s_lshl_b32 s12, s12, 20
  s_add_u32 s12, s12, s68
  s_add_u32 s12, s12, s30
  v_mfma_f32_16x16x32_bf16 v[120:123], v[32:35], a[40:43], v[120:123]
  s_add_u32 m0, s26, s13
  s_add_u32 s15, s12, 4096
  v_mfma_f32_16x16x32_bf16 v[124:127], v[56:59], a[40:43], v[124:127]
  buffer_load_dwordx4 v2, s[4:7], s12 offen sc1 lds
  v_mfma_f32_16x16x32_bf16 v[120:123], v[36:39], a[44:47], v[120:123]
  s_add_u32 m0, m0, 4096
  s_add_u32 s12, s12, s31
  v_mfma_f32_16x16x32_bf16 v[124:127], v[60:63], a[44:47], v[124:127]
  buffer_load_dwordx4 v2, s[4:7], s15 offen sc1 lds
  v_mfma_f32_16x16x32_bf16 v[112:115], v[16:19], a[48:51], 0
  v_mfma_f32_16x16x32_bf16 v[116:119], v[40:43], a[48:51], 0
  v_mfma_f32_16x16x32_bf16 v[112:115], v[20:23], a[52:55], v[112:115]
  v_cvt_pk_bf16_f32 v132, v120, v121
  v_cvt_pk_bf16_f32 v133, v124, v125
  v_mfma_f32_16x16x32_bf16 v[116:119], v[44:47], a[52:55], v[116:119]
  v_cvt_pk_bf16_f32 v134, v122, v123
  v_cvt_pk_bf16_f32 v135, v126, v127
  v_mfma_f32_16x16x32_bf16 v[112:115], v[24:27], a[56:59], v[112:115]
  buffer_store_dwordx4 v[132:135], v2, s[4:7], s16 offen sc1
  s_add_u32 s16, s16, 16384
  v_mfma_f32_16x16x32_bf16 v[116:119], v[48:51], a[56:59], v[116:119]
  s_add_u32 m0, m0, 4096
  s_min_u32 s27, s23, s28
  v_mfma_f32_16x16x32_bf16 v[112:115], v[28:31], a[60:63], v[112:115]
  buffer_load_dwordx4 v2, s[4:7], s12 offen sc1 lds
  v_mfma_f32_16x16x32_bf16 v[116:119], v[52:55], a[60:63], v[116:119]
  s_xor_b32 s26, s26, 16384
  v_mfma_f32_16x16x32_bf16 v[112:115], v[32:35], a[64:67], v[112:115]
  buffer_load_dword v8, v7, s[4:7], s20 offen sc1
  v_mfma_f32_16x16x32_bf16 v[116:119], v[56:59], a[64:67], v[116:119]
  v_mfma_f32_16x16x32_bf16 v[112:115], v[36:39], a[68:71], v[112:115]
  v_mfma_f32_16x16x32_bf16 v[116:119], v[60:63], a[68:71], v[116:119]
  v_mfma_f32_16x16x32_bf16 v[120:123], v[16:19], a[72:75], 0
  v_mfma_f32_16x16x32_bf16 v[124:127], v[40:43], a[72:75], 0
  v_mfma_f32_16x16x32_bf16 v[120:123], v[20:23], a[76:79], v[120:123]
  v_cvt_pk_bf16_f32 v128, v112, v113
  v_cvt_pk_bf16_f32 v129, v116, v117
  v_mfma_f32_16x16x32_bf16 v[124:127], v[44:47], a[76:79], v[124:127]
  v_cvt_pk_bf16_f32 v130, v114, v115
  v_cvt_pk_bf16_f32 v131, v118, v119
  v_mfma_f32_16x16x32_bf16 v[120:123], v[24:27], a[80:83], v[120:123]
  buffer_store_dwordx4 v[128:131], v2, s[4:7], s16 offen sc1
  s_add_u32 s16, s16, 16384
  v_mfma_f32_16x16x32_bf16 v[124:127], v[48:51], a[80:83], v[124:127]
  v_mfma_f32_16x16x32_bf16 v[120:123], v[28:31], a[84:87], v[120:123]
  v_mfma_f32_16x16x32_bf16 v[124:127], v[52:55], a[84:87], v[124:127]
  v_mfma_f32_16x16x32_bf16 v[120:123], v[32:35], a[88:91], v[120:123]
  v_mfma_f32_16x16x32_bf16 v[124:127], v[56:59], a[88:91], v[124:127]
  v_mfma_f32_16x16x32_bf16 v[120:123], v[36:39], a[92:95], v[120:123]
  v_mfma_f32_16x16x32_bf16 v[124:127], v[60:63], a[92:95], v[124:127]
  v_mfma_f32_16x16x32_bf16 v[112:115], v[16:19], a[96:99], 0
  v_mfma_f32_16x16x32_bf16 v[116:119], v[40:43], a[96:99], 0
  v_mfma_f32_16x16x32_bf16 v[112:115], v[20:23], a[100:103], v[112:115]
  v_cvt_pk_bf16_f32 v132, v120, v121
  v_cvt_pk_bf16_f32 v133, v124, v125
  v_mfma_f32_16x16x32_bf16 v[116:119], v[44:47], a[100:103], v[116:119]
  v_cvt_pk_bf16_f32 v134, v122, v123
  v_cvt_pk_bf16_f32 v135, v126, v127
  v_mfma_f32_16x16x32_bf16 v[112:115], v[24:27], a[104:107], v[112:115]
  buffer_store_dwordx4 v[132:135], v2, s[4:7], s16 offen sc1
  s_add_u32 s16, s16, 16384
  v_mfma_f32_16x16x32_bf16 v[116:119], v[48:51], a[104:107], v[116:119]
  v_mfma_f32_16x16x32_bf16 v[112:115], v[28:31], a[108:111], v[112:115]
  v_mfma_f32_16x16x32_bf16 v[116:119], v[52:55], a[108:111], v[116:119]
  v_mfma_f32_16x16x32_bf16 v[112:115], v[32:35], a[112:115], v[112:115]
  v_mfma_f32_16x16x32_bf16 v[116:119], v[56:59], a[112:115], v[116:119]
  v_mfma_f32_16x16x32_bf16 v[112:115], v[36:39], a[116:119], v[112:115]
  v_mfma_f32_16x16x32_bf16 v[116:119], v[60:63], a[116:119], v[116:119]
  v_mfma_f32_16x16x32_bf16 v[120:123], v[16:19], a[120:123], 0
  v_mfma_f32_16x16x32_bf16 v[124:127], v[40:43], a[120:123], 0
  v_mfma_f32_16x16x32_bf16 v[120:123], v[20:23], a[124:127], v[120:123]
  v_cvt_pk_bf16_f32 v128, v112, v113
  v_cvt_pk_bf16_f32 v129, v116, v117
  v_mfma_f32_16x16x32_bf16 v[124:127], v[44:47], a[124:127], v[124:127]
  v_cvt_pk_bf16_f32 v130, v114, v115
  v_cvt_pk_bf16_f32 v131, v118, v119
  v_mfma_f32_16x16x32_bf16 v[120:123], v[24:27], a[128:131], v[120:123]
  buffer_store_dwordx4 v[128:131], v2, s[4:7], s16 offen sc1
  s_add_u32 s16, s16, 16384
  v_mfma_f32_16x16x32_bf16 v[124:127], v[48:51], a[128:131], v[124:127]
  v_mfma_f32_16x16x32_bf16 v[120:123], v[28:31], a[132:135], v[120:123]
  v_mfma_f32_16x16x32_bf16 v[124:127], v[52:55], a[132:135], v[124:127]
  v_mfma_f32_16x16x32_bf16 v[120:123], v[32:35], a[136:139], v[120:123]
  v_mfma_f32_16x16x32_bf16 v[124:127], v[56:59], a[136:139], v[124:127]
  v_mfma_f32_16x16x32_bf16 v[120:123], v[36:39], a[140:143], v[120:123]
  v_mfma_f32_16x16x32_bf16 v[124:127], v[60:63], a[140:143], v[124:127]
  v_mfma_f32_16x16x32_bf16 v[112:115], v[16:19], a[144:147], 0
  v_mfma_f32_16x16x32_bf16 v[116:119], v[40:43], a[144:147], 0
  v_mfma_f32_16x16x32_bf16 v[112:115], v[20:23], a[148:151], v[112:115]
  v_cvt_pk_bf16_f32 v132, v120, v121
  v_cvt_pk_bf16_f32 v133, v124, v125
  v_mfma_f32_16x16x32_bf16 v[116:119], v[44:47], a[148:151], v[116:119]
  v_cvt_pk_bf16_f32 v134, v122, v123
  v_cvt_pk_bf16_f32 v135, v126, v127
  v_mfma_f32_16x16x32_bf16 v[112:115], v[24:27], a[152:155], v[112:115]
  buffer_store_dwordx4 v[132:135], v2, s[4:7], s16 offen sc1
  s_add_u32 s16, s16, 16384
  v_mfma_f32_16x16x32_bf16 v[116:119], v[48:51], a[152:155], v[116:119]
  v_mfma_f32_16x16x32_bf16 v[112:115], v[28:31], a[156:159], v[112:115]
  v_mfma_f32_16x16x32_bf16 v[116:119], v[52:55], a[156:159], v[116:119]
  v_mfma_f32_16x16x32_bf16 v[112:115], v[32:35], a[160:163], v[112:115]
  v_mfma_f32_16x16x32_bf16 v[116:119], v[56:59], a[160:163], v[116:119]
  v_mfma_f32_16x16x32_bf16 v[112:115], v[36:39], a[164:167], v[112:115]
  v_mfma_f32_16x16x32_bf16 v[116:119], v[60:63], a[164:167], v[116:119]
  v_mfma_f32_16x16x32_bf16 v[120:123], v[16:19], a[168:171], 0
  v_mfma_f32_16x16x32_bf16 v[124:127], v[40:43], a[168:171], 0
  v_mfma_f32_16x16x32_bf16 v[120:123], v[20:23], a[172:175], v[120:123]
  v_cvt_pk_bf16_f32 v128, v112, v113
  v_cvt_pk_bf16_f32 v129, v116, v117
  v_mfma_f32_16x16x32_bf16 v[124:127], v[44:47], a[172:175], v[124:127]
  v_cvt_pk_bf16_f32 v130, v114, v115
  v_cvt_pk_bf16_f32 v131, v118, v119
  v_mfma_f32_16x16x32_bf16 v[120:123], v[24:27], a[176:179], v[120:123]
  buffer_store_dwordx4 v[128:131], v2, s[4:7], s16 offen sc1
  s_add_u32 s16, s16, 16384
  v_mfma_f32_16x16x32_bf16 v[124:127], v[48:51], a[176:179], v[124:127]
  s_waitcnt vmcnt(5)
  s_barrier
  v_mfma_f32_16x16x32_bf16 v[120:123], v[28:31], a[180:183], v[120:123]
  v_mov_b32 v11, s24
  v_mfma_f32_16x16x32_bf16 v[124:127], v[52:55], a[180:183], v[124:127]
  buffer_store_dword v11, v0, s[4:7], s21 offen sc1
  v_mfma_f32_16x16x32_bf16 v[120:123], v[32:35], a[184:187], v[120:123]
  ds_read_b128 v[64:67], v5 offset:0
  v_mfma_f32_16x16x32_bf16 v[124:127], v[56:59], a[184:187], v[124:127]
  ds_read_b128 v[68:71], v5 offset:1024
  v_mfma_f32_16x16x32_bf16 v[120:123], v[36:39], a[188:191], v[120:123]
  ds_read_b128 v[72:75], v5 offset:2048
  v_mfma_f32_16x16x32_bf16 v[124:127], v[60:63], a[188:191], v[124:127]
  ds_read_b128 v[76:79], v5 offset:3072
  v_mfma_f32_16x16x32_bf16 v[112:115], v[16:19], a[192:195], 0
  v_mfma_f32_16x16x32_bf16 v[116:119], v[40:43], a[192:195], 0
  v_mfma_f32_16x16x32_bf16 v[112:115], v[20:23], a[196:199], v[112:115]
  v_cvt_pk_bf16_f32 v132, v120, v121
  v_cvt_pk_bf16_f32 v133, v124, v125
  v_mfma_f32_16x16x32_bf16 v[116:119], v[44:47], a[196:199], v[116:119]
  v_cvt_pk_bf16_f32 v134, v122, v123
  v_cvt_pk_bf16_f32 v135, v126, v127
  v_mfma_f32_16x16x32_bf16 v[112:115], v[24:27], a[200:203], v[112:115]
  buffer_store_dwordx4 v[132:135], v2, s[4:7], s16 offen sc1
  s_add_u32 s16, s16, 16384
  v_mfma_f32_16x16x32_bf16 v[116:119], v[48:51], a[200:203], v[116:119]
  ds_read2_b64 v[80:83], v9 offset0:0 offset1:128
  v_mfma_f32_16x16x32_bf16 v[112:115], v[28:31], a[204:207], v[112:115]
  ds_read2_b64 v[84:87], v10 offset0:0 offset1:128
  v_mfma_f32_16x16x32_bf16 v[116:119], v[52:55], a[204:207], v[116:119]
  ds_read_b128 v[88:91], v5 offset:4096
  v_mfma_f32_16x16x32_bf16 v[112:115], v[32:35], a[208:211], v[112:115]
  ds_read_b128 v[92:95], v5 offset:5120
  v_mfma_f32_16x16x32_bf16 v[116:119], v[56:59], a[208:211], v[116:119]
  ds_read_b128 v[96:99], v5 offset:6144
  v_mfma_f32_16x16x32_bf16 v[112:115], v[36:39], a[212:215], v[112:115]
  ds_read_b128 v[100:103], v5 offset:7168
  v_mfma_f32_16x16x32_bf16 v[116:119], v[60:63], a[212:215], v[116:119]
  ds_read2_b64 v[104:107], v9 offset0:1 offset1:129
  v_mfma_f32_16x16x32_bf16 v[120:123], v[16:19], a[216:219], 0
  v_mfma_f32_16x16x32_bf16 v[124:127], v[40:43], a[216:219], 0
  v_mfma_f32_16x16x32_bf16 v[120:123], v[20:23], a[220:223], v[120:123]
  v_cvt_pk_bf16_f32 v128, v112, v113
  v_cvt_pk_bf16_f32 v129, v116, v117
  v_mfma_f32_16x16x32_bf16 v[124:127], v[44:47], a[220:223], v[124:127]
  v_cvt_pk_bf16_f32 v130, v114, v115
  v_cvt_pk_bf16_f32 v131, v118, v119
  v_mfma_f32_16x16x32_bf16 v[120:123], v[24:27], a[224:227], v[120:123]
  buffer_store_dwordx4 v[128:131], v2, s[4:7], s16 offen sc1
  s_add_u32 s16, s16, 16384
  v_mfma_f32_16x16x32_bf16 v[124:127], v[48:51], a[224:227], v[124:127]
  ds_read2_b64 v[108:111], v10 offset0:1 offset1:129
  v_mfma_f32_16x16x32_bf16 v[120:123], v[28:31], a[228:231], v[120:123]
  v_xor_b32 v5, 16384, v5
  v_mfma_f32_16x16x32_bf16 v[124:127], v[52:55], a[228:231], v[124:127]
  v_xor_b32 v9, 16384, v9
  v_mfma_f32_16x16x32_bf16 v[120:123], v[32:35], a[232:235], v[120:123]
  v_xor_b32 v10, 16384, v10
  v_mfma_f32_16x16x32_bf16 v[124:127], v[56:59], a[232:235], v[124:127]
  s_add_u32 s24, s24, 1
  v_mfma_f32_16x16x32_bf16 v[120:123], v[36:39], a[236:239], v[120:123]
  v_mfma_f32_16x16x32_bf16 v[124:127], v[60:63], a[236:239], v[124:127]
  s_waitcnt lgkmcnt(0)
  v_mfma_f32_16x16x32_bf16 v[112:115], v[64:67], a[0:3], 0
  v_mfma_f32_16x16x32_bf16 v[116:119], v[88:91], a[0:3], 0
  v_mfma_f32_16x16x32_bf16 v[112:115], v[68:71], a[4:7], v[112:115]
  v_cvt_pk_bf16_f32 v132, v120, v121
  v_cvt_pk_bf16_f32 v133, v124, v125
  v_mfma_f32_16x16x32_bf16 v[116:119], v[92:95], a[4:7], v[116:119]
  v_cvt_pk_bf16_f32 v134, v122, v123
  v_cvt_pk_bf16_f32 v135, v126, v127
  v_mfma_f32_16x16x32_bf16 v[112:115], v[72:75], a[8:11], v[112:115]
  buffer_store_dwordx4 v[132:135], v2, s[4:7], s16 offen sc1
  s_add_u32 s16, s16, 16384
  v_mfma_f32_16x16x32_bf16 v[116:119], v[96:99], a[8:11], v[116:119]
  s_and_b32 s16, s24, 31
  s_lshl_b32 s16, s16, 2
  s_add_u32 s16, s16, s72
  v_mfma_f32_16x16x32_bf16 v[112:115], v[76:79], a[12:15], v[112:115]
  s_lshr_b32 s68, s16, 1
  s_bitcmp1_b64 s[64:65], s68
  s_cselect_b32 s68, 0x2000, 0
  v_mfma_f32_16x16x32_bf16 v[116:119], v[100:103], a[12:15], v[116:119]
  s_lshl_b32 s16, s16, 20
  s_add_u32 s16, s16, s68
  s_add_u32 s16, s16, s34
  v_mfma_f32_16x16x32_bf16 v[112:115], v[80:83], a[16:19], v[112:115]
  v_min_u32_dpp v8, v8, v8 quad_perm:[1,0,3,2] row_mask:0xf bank_mask:0xf
  v_mfma_f32_16x16x32_bf16 v[116:119], v[104:107], a[16:19], v[116:119]
  s_nop 0
  v_min_u32_dpp v8, v8, v8 quad_perm:[2,3,0,1] row_mask:0xf bank_mask:0xf
  v_mfma_f32_16x16x32_bf16 v[112:115], v[84:87], a[20:23], v[112:115]
  v_readfirstlane_b32 s29, v8
  v_mfma_f32_16x16x32_bf16 v[116:119], v[108:111], a[20:23], v[116:119]
  s_max_u32 s22, s22, s29
  s_add_u32 s23, s27, 1
  s_cmp_lt_u32 s22, s23
  s_cbranch_scc1 int_sl16
int_sl16_b:
  v_mfma_f32_16x16x32_bf16 v[120:123], v[64:67], a[24:27], 0
  v_mfma_f32_16x16x32_bf16 v[124:127], v[88:91], a[24:27], 0
  v_mfma_f32_16x16x32_bf16 v[120:123], v[68:71], a[28:31], v[120:123]
  v_cvt_pk_bf16_f32 v128, v112, v113
  v_cvt_pk_bf16_f32 v129, v116, v117
  v_mfma_f32_16x16x32_bf16 v[124:127], v[92:95], a[28:31], v[124:127]
  v_cvt_pk_bf16_f32 v130, v114, v115
  v_cvt_pk_bf16_f32 v131, v118, v119
  v_mfma_f32_16x16x32_bf16 v[120:123], v[72:75], a[32:35], v[120:123]
  buffer_store_dwordx4 v[128:131], v2, s[4:7], s16 offen sc1
  s_add_u32 s16, s16, 16384
  v_mfma_f32_16x16x32_bf16 v[124:127], v[96:99], a[32:35], v[124:127]
  s_and_b32 s12, s27, 31
  s_lshl_b32 s12, s12, 2
  s_add_u32 s12, s12, s72
  v_mfma_f32_16x16x32_bf16 v[120:123], v[76:79], a[36:39], v[120:123]
  s_lshr_b32 s68, s12, 1
  s_bitcmp0_b64 s[64:65], s68
  s_cselect_b32 s68, 0x2000, 0
  v_mfma_f32_16x16x32_bf16 v[124:127], v[100:103], a[36:39], v[124:127]
  s_lshl_b32 s12, s12, 20
  s_add_u32 s12, s12, s68
  s_add_u32 s12, s12, s30
  v_mfma_f32_16x16x32_bf16 v[120:123], v[80:83], a[40:43], v[120:123]
  s_add_u32 m0, s26, s13
  s_add_u32 s15, s12, 4096
  v_mfma_f32_16x16x32_bf16 v[124:127], v[104:107], a[40:43], v[124:127]
  buffer_load_dwordx4 v2, s[4:7], s12 offen sc1 lds
  v_mfma_f32_16x16x32_bf16 v[120:123], v[84:87], a[44:47], v[120:123]
  s_add_u32 m0, m0, 4096
  s_add_u32 s12, s12, s31
  v_mfma_f32_16x16x32_bf16 v[124:127], v[108:111], a[44:47], v[124:127]
  buffer_load_dwordx4 v2, s[4:7], s15 offen sc1 lds
  v_mfma_f32_16x16x32_bf16 v[112:115], v[64:67], a[48:51], 0
  v_mfma_f32_16x16x32_bf16 v[116:119], v[88:91], a[48:51], 0
  v_mfma_f32_16x16x32_bf16 v[112:115], v[68:71], a[52:55], v[112:115]
  v_cvt_pk_bf16_f32 v132, v120, v121
  v_cvt_pk_bf16_f32 v133, v124, v125
  v_mfma_f32_16x16x32_bf16 v[116:119], v[92:95], a[52:55], v[116:119]
  v_cvt_pk_bf16_f32 v134, v122, v123
  v_cvt_pk_bf16_f32 v135, v126, v127
  v_mfma_f32_16x16x32_bf16 v[112:115], v[72:75], a[56:59], v[112:115]
  buffer_store_dwordx4 v[132:135], v2, s[4:7], s16 offen sc1
  s_add_u32 s16, s16, 16384
  v_mfma_f32_16x16x32_bf16 v[116:119], v[96:99], a[56:59], v[116:119]
  s_add_u32 m0, m0, 4096
  s_min_u32 s27, s23, s28
  v_mfma_f32_16x16x32_bf16 v[112:115], v[76:79], a[60:63], v[112:115]
  buffer_load_dwordx4 v2, s[4:7], s12 offen sc1 lds
  v_mfma_f32_16x16x32_bf16 v[116:119], v[100:103], a[60:63], v[116:119]
  s_xor_b32 s26, s26, 16384
  v_mfma_f32_16x16x32_bf16 v[112:115], v[80:83], a[64:67], v[112:115]
  buffer_load_dword v8, v7, s[4:7], s20 offen sc1
  v_mfma_f32_16x16x32_bf16 v[116:119], v[104:107], a[64:67], v[116:119]
  v_mfma_f32_16x16x32_bf16 v[112:115], v[84:87], a[68:71], v[112:115]
  v_mfma_f32_16x16x32_bf16 v[116:119], v[108:111], a[68:71], v[116:119]
  v_mfma_f32_16x16x32_bf16 v[120:123], v[64:67], a[72:75], 0
  v_mfma_f32_16x16x32_bf16 v[124:127], v[88:91], a[72:75], 0
  v_mfma_f32_16x16x32_bf16 v[120:123], v[68:71], a[76:79], v[120:123]
  v_cvt_pk_bf16_f32 v128, v112, v113
  v_cvt_pk_bf16_f32 v129, v116, v117
  v_mfma_f32_16x16x32_bf16 v[124:127], v[92:95], a[76:79], v[124:127]
  v_cvt_pk_bf16_f32 v130, v114, v115
  v_cvt_pk_bf16_f32 v131, v118, v119
  v_mfma_f32_16x16x32_bf16 v[120:123], v[72:75], a[80:83], v[120:123]
  buffer_store_dwordx4 v[128:131], v2, s[4:7], s16 offen sc1
  s_add_u32 s16, s16, 16384
  v_mfma_f32_16x16x32_bf16 v[124:127], v[96:99], a[80:83], v[124:127]
  v_mfma_f32_16x16x32_bf16 v[120:123], v[76:79], a[84:87], v[120:123]
  v_mfma_f32_16x16x32_bf16 v[124:127], v[100:103], a[84:87], v[124:127]
  v_mfma_f32_16x16x32_bf16 v[120:123], v[80:83], a[88:91], v[120:123]
  v_mfma_f32_16x16x32_bf16 v[124:127], v[104:107], a[88:91], v[124:127]
  v_mfma_f32_16x16x32_bf16 v[120:123], v[84:87], a[92:95], v[120:123]
  v_mfma_f32_16x16x32_bf16 v[124:127], v[108:111], a[92:95], v[124:127]
  v_mfma_f32_16x16x32_bf16 v[112:115], v[64:67], a[96:99], 0
  v_mfma_f32_16x16x32_bf16 v[116:119], v[88:91], a[96:99], 0
  v_mfma_f32_16x16x32_bf16 v[112:115], v[68:71], a[100:103], v[112:115]
  v_cvt_pk_bf16_f32 v132, v120, v121
  v_cvt_pk_bf16_f32 v133, v124, v125
  v_mfma_f32_16x16x32_bf16 v[116:119], v[92:95], a[100:103], v[116:119]
  v_cvt_pk_bf16_f32 v134, v122, v123
  v_cvt_pk_bf16_f32 v135, v126, v127
  v_mfma_f32_16x16x32_bf16 v[112:115], v[72:75], a[104:107], v[112:115]
  buffer_store_dwordx4 v[132:135], v2, s[4:7], s16 offen sc1
  s_add_u32 s16, s16, 16384
  v_mfma_f32_16x16x32_bf16 v[116:119], v[96:99], a[104:107], v[116:119]
  v_mfma_f32_16x16x32_bf16 v[112:115], v[76:79], a[108:111], v[112:115]
  v_mfma_f32_16x16x32_bf16 v[116:119], v[100:103], a[108:111], v[116:119]
  v_mfma_f32_16x16x32_bf16 v[112:115], v[80:83], a[112:115], v[112:115]
  v_mfma_f32_16x16x32_bf16 v[116:119], v[104:107], a[112:115], v[116:119]
  v_mfma_f32_16x16x32_bf16 v[112:115], v[84:87], a[116:119], v[112:115]
  v_mfma_f32_16x16x32_bf16 v[116:119], v[108:111], a[116:119], v[116:119]
  v_mfma_f32_16x16x32_bf16 v[120:123], v[64:67], a[120:123], 0
  v_mfma_f32_16x16x32_bf16 v[124:127], v[88:91], a[120:123], 0
  v_mfma_f32_16x16x32_bf16 v[120:123], v[68:71], a[124:127], v[120:123]
  v_cvt_pk_bf16_f32 v128, v112, v113
  v_cvt_pk_bf16_f32 v129, v116, v117
  v_mfma_f32_16x16x32_bf16 v[124:127], v[92:95], a[124:127], v[124:127]
  v_cvt_pk_bf16_f32 v130, v114, v115
  v_cvt_pk_bf16_f32 v131, v118, v119
  v_mfma_f32_16x16x32_bf16 v[120:123], v[72:75], a[128:131], v[120:123]
  buffer_store_dwordx4 v[128:131], v2, s[4:7], s16 offen sc1
  s_add_u32 s16, s16, 16384
  v_mfma_f32_16x16x32_bf16 v[124:127], v[96:99], a[128:131], v[124:127]
  v_mfma_f32_16x16x32_bf16 v[120:123], v[76:79], a[132:135], v[120:123]
  v_mfma_f32_16x16x32_bf16 v[124:127], v[100:103], a[132:135], v[124:127]
  v_mfma_f32_16x16x32_bf16 v[120:123], v[80:83], a[136:139], v[120:123]
  v_mfma_f32_16x16x32_bf16 v[124:127], v[104:107], a[136:139], v[124:127]
  v_mfma_f32_16x16x32_bf16 v[120:123], v[84:87], a[140:143], v[120:123]
  v_mfma_f32_16x16x32_bf16 v[124:127], v[108:111], a[140:143], v[124:127]
  v_mfma_f32_16x16x32_bf16 v[112:115], v[64:67], a[144:147], 0
  v_mfma_f32_16x16x32_bf16 v[116:119], v[88:91], a[144:147], 0
  v_mfma_f32_16x16x32_bf16 v[112:115], v[68:71], a[148:151], v[112:115]
  v_cvt_pk_bf16_f32 v132, v120, v121
  v_cvt_pk_bf16_f32 v133, v124, v125
  v_mfma_f32_16x16x32_bf16 v[116:119], v[92:95], a[148:151], v[116:119]
  v_cvt_pk_bf16_f32 v134, v122, v123
  v_cvt_pk_bf16_f32 v135, v126, v127
  v_mfma_f32_16x16x32_bf16 v[112:115], v[72:75], a[152:155], v[112:115]
  buffer_store_dwordx4 v[132:135], v2, s[4:7], s16 offen sc1
  s_add_u32 s16, s16, 16384
  v_mfma_f32_16x16x32_bf16 v[116:119], v[96:99], a[152:155], v[116:119]
  v_mfma_f32_16x16x32_bf16 v[112:115], v[76:79], a[156:159], v[112:115]
  v_mfma_f32_16x16x32_bf16 v[116:119], v[100:103], a[156:159], v[116:119]
  v_mfma_f32_16x16x32_bf16 v[112:115], v[80:83], a[160:163], v[112:115]
  v_mfma_f32_16x16x32_bf16 v[116:119], v[104:107], a[160:163], v[116:119]
  v_mfma_f32_16x16x32_bf16 v[112:115], v[84:87], a[164:167], v[112:115]
  v_mfma_f32_16x16x32_bf16 v[116:119], v[108:111], a[164:167], v[116:119]
  v_mfma_f32_16x16x32_bf16 v[120:123], v[64:67], a[168:171], 0
  v_mfma_f32_16x16x32_bf16 v[124:127], v[88:91], a[168:171], 0
  v_mfma_f32_16x16x32_bf16 v[120:123], v[68:71], a[172:175], v[120:123]
  v_cvt_pk_bf16_f32 v128, v112, v113
  v_cvt_pk_bf16_f32 v129, v116, v117
  v_mfma_f32_16x16x32_bf16 v[124:127], v[92:95], a[172:175], v[124:127]
  v_cvt_pk_bf16_f32 v130, v114, v115
  v_cvt_pk_bf16_f32 v131, v118, v119
  v_mfma_f32_16x16x32_bf16 v[120:123], v[72:75], a[176:179], v[120:123]
  buffer_store_dwordx4 v[128:131], v2, s[4:7], s16 offen sc1
  s_add_u32 s16, s16, 16384
  v_mfma_f32_16x16x32_bf16 v[124:127], v[96:99], a[176:179], v[124:127]
  s_waitcnt vmcnt(5)
  s_barrier
  v_mfma_f32_16x16x32_bf16 v[120:123], v[76:79], a[180:183], v[120:123]
  v_mov_b32 v11, s24
  v_mfma_f32_16x16x32_bf16 v[124:127], v[100:103], a[180:183], v[124:127]
  buffer_store_dword v11, v0, s[4:7], s21 offen sc1
  v_mfma_f32_16x16x32_bf16 v[120:123], v[80:83], a[184:187], v[120:123]
  ds_read_b128 v[16:19], v5 offset:0
  v_mfma_f32_16x16x32_bf16 v[124:127], v[104:107], a[184:187], v[124:127]
  ds_read_b128 v[20:23], v5 offset:1024
  v_mfma_f32_16x16x32_bf16 v[120:123], v[84:87], a[188:191], v[120:123]
  ds_read_b128 v[24:27], v5 offset:2048
  v_mfma_f32_16x16x32_bf16 v[124:127], v[108:111], a[188:191], v[124:127]
  ds_read_b128 v[28:31], v5 offset:3072
  v_mfma_f32_16x16x32_bf16 v[112:115], v[64:67], a[192:195], 0
  v_mfma_f32_16x16x32_bf16 v[116:119], v[88:91], a[192:195], 0
  v_mfma_f32_16x16x32_bf16 v[112:115], v[68:71], a[196:199], v[112:115]
  v_cvt_pk_bf16_f32 v132, v120, v121
  v_cvt_pk_bf16_f32 v133, v124, v125
  v_mfma_f32_16x16x32_bf16 v[116:119], v[92:95], a[196:199], v[116:119]
  v_cvt_pk_bf16_f32 v134, v122, v123
  v_cvt_pk_bf16_f32 v135, v126, v127
  v_mfma_f32_16x16x32_bf16 v[112:115], v[72:75], a[200:203], v[112:115]
  buffer_store_dwordx4 v[132:135], v2, s[4:7], s16 offen sc1
  s_add_u32 s16, s16, 16384
  v_mfma_f32_16x16x32_bf16 v[116:119], v[96:99], a[200:203], v[116:119]
  ds_read2_b64 v[32:35], v9 offset0:0 offset1:128
  v_mfma_f32_16x16x32_bf16 v[112:115], v[76:79], a[204:207], v[112:115]
  ds_read2_b64 v[36:39], v10 offset0:0 offset1:128
  v_mfma_f32_16x16x32_bf16 v[116:119], v[100:103], a[204:207], v[116:119]
  ds_read_b128 v[40:43], v5 offset:4096
  v_mfma_f32_16x16x32_bf16 v[112:115], v[80:83], a[208:211], v[112:115]
  ds_read_b128 v[44:47], v5 offset:5120
  v_mfma_f32_16x16x32_bf16 v[116:119], v[104:107], a[208:211], v[116:119]
  ds_read_b128 v[48:51], v5 offset:6144
  v_mfma_f32_16x16x32_bf16 v[112:115], v[84:87], a[212:215], v[112:115]
  ds_read_b128 v[52:55], v5 offset:7168
  v_mfma_f32_16x16x32_bf16 v[116:119], v[108:111], a[212:215], v[116:119]
  ds_read2_b64 v[56:59], v9 offset0:1 offset1:129
  v_mfma_f32_16x16x32_bf16 v[120:123], v[64:67], a[216:219], 0
  v_mfma_f32_16x16x32_bf16 v[124:127], v[88:91], a[216:219], 0
  v_mfma_f32_16x16x32_bf16 v[120:123], v[68:71], a[220:223], v[120:123]
  v_cvt_pk_bf16_f32 v128, v112, v113
  v_cvt_pk_bf16_f32 v129, v116, v117
  v_mfma_f32_16x16x32_bf16 v[124:127], v[92:95], a[220:223], v[124:127]
  v_cvt_pk_bf16_f32 v130, v114, v115
  v_cvt_pk_bf16_f32 v131, v118, v119
  v_mfma_f32_16x16x32_bf16 v[120:123], v[72:75], a[224:227], v[120:123]
  buffer_store_dwordx4 v[128:131], v2, s[4:7], s16 offen sc1
  s_add_u32 s16, s16, 16384
  v_mfma_f32_16x16x32_bf16 v[124:127], v[96:99], a[224:227], v[124:127]
  ds_read2_b64 v[60:63], v10 offset0:1 offset1:129
  v_mfma_f32_16x16x32_bf16 v[120:123], v[76:79], a[228:231], v[120:123]
  v_xor_b32 v5, 16384, v5
  v_mfma_f32_16x16x32_bf16 v[124:127], v[100:103], a[228:231], v[124:127]
  v_xor_b32 v9, 16384, v9
  v_mfma_f32_16x16x32_bf16 v[120:123], v[80:83], a[232:235], v[120:123]
  v_xor_b32 v10, 16384, v10
  v_mfma_f32_16x16x32_bf16 v[124:127], v[104:107], a[232:235], v[124:127]
  s_add_u32 s24, s24, 1
  v_mfma_f32_16x16x32_bf16 v[120:123], v[84:87], a[236:239], v[120:123]
  v_mfma_f32_16x16x32_bf16 v[124:127], v[108:111], a[236:239], v[124:127]
  s_and_b32 s29, s24, 63
  s_cbranch_scc1 mk_u_loop
  s_nop 4
  v_cvt_pk_bf16_f32 v132, v120, v121
  v_cvt_pk_bf16_f32 v133, v124, v125
  v_cvt_pk_bf16_f32 v134, v122, v123
  v_cvt_pk_bf16_f32 v135, v126, v127
  buffer_store_dwordx4 v[132:135], v2, s[4:7], s16 offen sc1
  s_add_u32 s16, s16, 16384
  s_waitcnt vmcnt(0) lgkmcnt(0)
  v_mov_b32 v11, s24
  s_mov_b64 exec, 1
  buffer_store_dword v11, off, s[4:7], s21 sc1
  s_mov_b64 exec, -1
  s_mov_b32 s48, s75
  s_lshl_b32 s49, s66, 1
  s_add_u32 s49, s49, 1
  s_mov_b32 s50, 0
  v_and_b32 v16, 31, v1
  v_lshlrev_b32 v16, 7, v16
  v_lshrrev_b32 v18, 5, v1
  v_lshl_add_u32 v16, v18, 20, v16
  s_mov_b32 s12, 0
  s_lshr_b32 s68, s12, 1
  s_bitcmp1_b64 s[64:65], s68
  s_cselect_b32 s68, 0x2000, 0
  s_lshl_b32 s14, s12, 20
  s_add_u32 s14, s14, s68
  s_add_u32 s14, s14, s39
  s_add_u32 s14, s14, 970752
  s_mov_b32 s12, 2
  s_lshr_b32 s68, s12, 1
  s_bitcmp1_b64 s[64:65], s68
  s_cselect_b32 s68, 0x2000, 0
  s_lshl_b32 s15, s12, 20
  s_add_u32 s15, s15, s68
  s_add_u32 s15, s15, s39
  s_add_u32 s15, s15, 970752
mk_xj:
  s_lshr_b32 s12, s48, 1
  s_lshl_b32 s16, s66, 6
  s_add_u32 s12, s12, s16
  s_mov_b32 s70, 0
  s_cmp_lg_u32 s3, 0
  s_cbranch_scc1 mk_xj2
mk_xj1:
  v_mov_b32 v18, 0
  v_mov_b32 v19, 0
  buffer_atomic_or v18, v16, s[4:7], s14 offen sc0 sc1
  buffer_atomic_or v19, v16, s[4:7], s15 offen sc0 sc1
  s_waitcnt vmcnt(0)
  v_min_u32 v18, v18, v19
  v_cmp_ge_u32 vcc, s12, v18
  s_nop 0
  s_cbranch_vccz mk_xj2
  s_sleep 20
  s_add_u32 s70, s70, 1
  s_cmp_lt_u32 s70, 262144
  s_cbranch_scc1 mk_xj1
  s_branch mk_fail
mk_xj2:
  s_barrier
  v_lshlrev_b32 v20, 4, v1
  s_mul_i32 s51, s48, 20480
  s_mul_i32 s52, s3, 5120
  s_add_u32 s51, s51, s52
  s_mul_i32 s52, s49, 2621440
  s_add_u32 s51, s51, s52
  s_add_u32 s52, s51, 23592960
  s_add_u32 s53, s52, 4096
  s_mov_b32 s70, 0
int_xp18:
  buffer_load_dwordx4 v[36:39], v20, s[4:7], s52 offen offset:0 sc1
  buffer_load_dwordx4 v[40:43], v20, s[4:7], s52 offen offset:1024 sc1
  buffer_load_dwordx4 v[44:47], v20, s[4:7], s52 offen offset:2048 sc1
  buffer_load_dwordx4 v[48:51], v20, s[4:7], s52 offen offset:3072 sc1
  buffer_load_dwordx4 v[52:55], v20, s[4:7], s53 offen offset:0 sc1
  s_lshr_b32 s52, s48, 1
  s_and_b32 s53, s52, 31
  s_lshl_b32 s54, s53, 1
  s_lshr_b64 s[68:69], s[64:65], s54
  s_not_b32 s68, s68
  v_lshrrev_b32 v22, 5, v1
  v_lshrrev_b32 v22, v22, s68
  v_and_b32 v22, 1, v22
  v_lshlrev_b32 v21, 13, v22
  v_lshrrev_b32 v22, 4, v1
  v_lshl_add_u32 v21, v22, 20, v21
  v_bfe_u32 v22, v1, 3, 1
  v_lshl_add_u32 v21, v22, 10, v21
  v_bfe_u32 v22, v1, 2, 1
  v_lshl_add_u32 v21, v22, 7, v21
  v_and_b32 v22, 3, v1
  v_lshl_add_u32 v21, v22, 4, v21
  s_lshl_b32 s53, s53, 22
  s_add_u32 s53, s53, s39
  s_lshr_b32 s69, s52, 5
  s_and_b32 s52, s48, 1
  s_lshl_b32 s52, s52, 9
  s_add_u32 s53, s53, s52
  s_mul_i32 s52, s3, 5
  s_cmp_lt_u32 s52, 12
  s_cselect_b32 s54, s69, 57
  s_cselect_b32 s55, 0, 0x2000
  v_xor_b32 v22, s55, v21
  s_lshl_b32 s55, s69, 1
  s_add_u32 s54, s54, s55
  s_lshr_b32 s55, s52, 2
  s_add_u32 s54, s54, s55
  s_lshl_b32 s54, s54, 14
  s_and_b32 s55, s52, 3
  s_lshl_b32 s55, s55, 11
  s_add_u32 s54, s54, s55
  s_add_u32 s54, s54, s53
  buffer_load_dwordx4 v[96:99], v22, s[4:7], s54 offen offset:0 sc1
  buffer_load_dwordx4 v[100:103], v22, s[4:7], s54 offen offset:256 sc1
  buffer_load_dwordx4 v[104:107], v22, s[4:7], s54 offen offset:64 sc1
  buffer_load_dwordx4 v[108:111], v22, s[4:7], s54 offen offset:320 sc1
  s_add_u32 s52, s52, 1
  s_cmp_lt_u32 s52, 12
  s_cselect_b32 s54, s69, 57
  s_cselect_b32 s55, 0, 0x2000
  v_xor_b32 v22, s55, v21
  s_lshl_b32 s55, s69, 1
  s_add_u32 s54, s54, s55
  s_lshr_b32 s55, s52, 2
  s_add_u32 s54, s54, s55
  s_lshl_b32 s54, s54, 14
  s_and_b32 s55, s52, 3
  s_lshl_b32 s55, s55, 11
  s_add_u32 s54, s54, s55
  s_add_u32 s54, s54, s53
  buffer_load_dwordx4 v[112:115], v22, s[4:7], s54 offen offset:0 sc1
  buffer_load_dwordx4 v[116:119], v22, s[4:7], s54 offen offset:256 sc1
  buffer_load_dwordx4 v[120:123], v22, s[4:7], s54 offen offset:64 sc1
  buffer_load_dwordx4 v[124:127], v22, s[4:7], s54 offen offset:320 sc1
  s_add_u32 s52, s52, 1
  s_cmp_lt_u32 s52, 12
  s_cselect_b32 s54, s69, 57
  s_cselect_b32 s55, 0, 0x2000
  v_xor_b32 v22, s55, v21
  s_lshl_b32 s55, s69, 1
  s_add_u32 s54, s54, s55
  s_lshr_b32 s55, s52, 2
  s_add_u32 s54, s54, s55
  s_lshl_b32 s54, s54, 14
  s_and_b32 s55, s52, 3
  s_lshl_b32 s55, s55, 11
  s_add_u32 s54, s54, s55
  s_add_u32 s54, s54, s53
  buffer_load_dwordx4 v[128:131], v22, s[4:7], s54 offen offset:0 sc1
  buffer_load_dwordx4 v[132:135], v22, s[4:7], s54 offen offset:256 sc1
  buffer_load_dwordx4 v[136:139], v22, s[4:7], s54 offen offset:64 sc1
  buffer_load_dwordx4 v[140:143], v22, s[4:7], s54 offen offset:320 sc1
  s_add_u32 s52, s52, 1
  s_cmp_lt_u32 s52, 12
  s_cselect_b32 s54, s69, 57
  s_cselect_b32 s55, 0, 0x2000
  v_xor_b32 v22, s55, v21
  s_lshl_b32 s55, s69, 1
  s_add_u32 s54, s54, s55
  s_lshr_b32 s55, s52, 2
  s_add_u32 s54, s54, s55
  s_lshl_b32 s54, s54, 14
  s_and_b32 s55, s52, 3
  s_lshl_b32 s55, s55, 11
  s_add_u32 s54, s54, s55
  s_add_u32 s54, s54, s53
  buffer_load_dwordx4 v[144:147], v22, s[4:7], s54 offen offset:0 sc1
  buffer_load_dwordx4 v[148:151], v22, s[4:7], s54 offen offset:256 sc1
  buffer_load_dwordx4 v[152:155], v22, s[4:7], s54 offen offset:64 sc1
  buffer_load_dwordx4 v[156:159], v22, s[4:7], s54 offen offset:320 sc1
  s_add_u32 s52, s52, 1
  s_cmp_lt_u32 s52, 12
  s_cselect_b32 s54, s69, 57
  s_cselect_b32 s55, 0, 0x2000
  v_xor_b32 v22, s55, v21
  s_lshl_b32 s55, s69, 1
  s_add_u32 s54, s54, s55
  s_lshr_b32 s55, s52, 2
  s_add_u32 s54, s54, s55
  s_lshl_b32 s54, s54, 14
  s_and_b32 s55, s52, 3
  s_lshl_b32 s55, s55, 11
  s_add_u32 s54, s54, s55
  s_add_u32 s54, s54, s53
  buffer_load_dwordx4 v[160:163], v22, s[4:7], s54 offen offset:0 sc1
  buffer_load_dwordx4 v[164:167], v22, s[4:7], s54 offen offset:256 sc1
  buffer_load_dwordx4 v[168:171], v22, s[4:7], s54 offen offset:64 sc1
  buffer_load_dwordx4 v[172:175], v22, s[4:7], s54 offen offset:320 sc1
  s_add_u32 s52, s52, 1
  v_and_b32 v22, 1, v1
  v_lshlrev_b32 v22, 4, v22
  v_mov_b32 v23, 0x3f80
  v_lshlrev_b32 v23, v22, v23
  v_bfe_u32 v22, v1, 1, 3
  v_cmp_eq_u32 vcc, 0, v22
  s_nop 1
  v_cndmask_b32 v28, 0, v23, vcc
  v_cmp_eq_u32 vcc, 1, v22
  s_nop 1
  v_cndmask_b32 v29, 0, v23, vcc
  v_cmp_eq_u32 vcc, 2, v22
  s_nop 1
  v_cndmask_b32 v30, 0, v23, vcc
  v_cmp_eq_u32 vcc, 3, v22
  s_nop 1
  v_cndmask_b32 v31, 0, v23, vcc
  v_cmp_eq_u32 vcc, 4, v22
  s_nop 1
  v_cndmask_b32 v32, 0, v23, vcc
  v_cmp_eq_u32 vcc, 5, v22
  s_nop 1
  v_cndmask_b32 v33, 0, v23, vcc
  v_cmp_eq_u32 vcc, 6, v22
  s_nop 1
  v_cndmask_b32 v34, 0, v23, vcc
  v_cmp_eq_u32 vcc, 7, v22
  s_nop 1
  v_cndmask_b32 v35, 0, v23, vcc
  s_mov_b32 s55, 0xffff0000
  s_add_u32 s52, s51, 26214400
  s_add_u32 s53, s52, 4096
  s_waitcnt vmcnt(20)
  v_lshlrev_b32 v56, 16, v36
  v_and_b32 v57, s55, v36
  v_lshlrev_b32 v58, 16, v37
  v_and_b32 v59, s55, v37
  v_lshlrev_b32 v60, 16, v38
  v_and_b32 v61, s55, v38
  v_lshlrev_b32 v62, 16, v39
  v_and_b32 v63, s55, v39
  v_lshlrev_b32 v64, 16, v40
  v_and_b32 v65, s55, v40
  v_lshlrev_b32 v66, 16, v41
  v_and_b32 v67, s55, v41
  v_lshlrev_b32 v68, 16, v42
  v_and_b32 v69, s55, v42
  v_lshlrev_b32 v70, 16, v43
  v_and_b32 v71, s55, v43
  v_lshlrev_b32 v72, 16, v44
  v_and_b32 v73, s55, v44
  v_lshlrev_b32 v74, 16, v45
  v_and_b32 v75, s55, v45
  v_lshlrev_b32 v76, 16, v46
  v_and_b32 v77, s55, v46
  v_lshlrev_b32 v78, 16, v47
  v_and_b32 v79, s55, v47
  v_lshlrev_b32 v80, 16, v48
  v_and_b32 v81, s55, v48
  v_lshlrev_b32 v82, 16, v49
  v_and_b32 v83, s55, v49
  v_lshlrev_b32 v84, 16, v50
  v_and_b32 v85, s55, v50
  v_lshlrev_b32 v86, 16, v51
  v_and_b32 v87, s55, v51
  v_lshlrev_b32 v88, 16, v52
  v_and_b32 v89, s55, v52
  v_lshlrev_b32 v90, 16, v53
  v_and_b32 v91, s55, v53
  v_lshlrev_b32 v92, 16, v54
  v_and_b32 v93, s55, v54
  v_lshlrev_b32 v94, 16, v55
  v_and_b32 v95, s55, v55
  s_waitcnt vmcnt(16)
  v_mfma_f32_16x16x32_bf16 v[56:59], v[96:99], v[28:31], v[56:59]
  v_mfma_f32_16x16x32_bf16 v[60:63], v[104:107], v[28:31], v[60:63]
  v_mfma_f32_16x16x32_bf16 v[56:59], v[100:103], v[32:35], v[56:59]
  v_mfma_f32_16x16x32_bf16 v[60:63], v[108:111], v[32:35], v[60:63]
  s_waitcnt vmcnt(12)
  v_mfma_f32_16x16x32_bf16 v[64:67], v[112:115], v[28:31], v[64:67]
  v_mfma_f32_16x16x32_bf16 v[68:71], v[120:123], v[28:31], v[68:71]
  v_mfma_f32_16x16x32_bf16 v[64:67], v[116:119], v[32:35], v[64:67]
  v_mfma_f32_16x16x32_bf16 v[68:71], v[124:127], v[32:35], v[68:71]
  s_waitcnt vmcnt(8)
  v_mfma_f32_16x16x32_bf16 v[72:75], v[128:131], v[28:31], v[72:75]
  v_mfma_f32_16x16x32_bf16 v[76:79], v[136:139], v[28:31], v[76:79]
  v_mfma_f32_16x16x32_bf16 v[72:75], v[132:135], v[32:35], v[72:75]
  v_mfma_f32_16x16x32_bf16 v[76:79], v[140:143], v[32:35], v[76:79]
  s_waitcnt vmcnt(4)
  v_mfma_f32_16x16x32_bf16 v[80:83], v[144:147], v[28:31], v[80:83]
  v_mfma_f32_16x16x32_bf16 v[84:87], v[152:155], v[28:31], v[84:87]
  v_mfma_f32_16x16x32_bf16 v[80:83], v[148:151], v[32:35], v[80:83]
  v_mfma_f32_16x16x32_bf16 v[84:87], v[156:159], v[32:35], v[84:87]
  s_waitcnt vmcnt(0)
  v_mfma_f32_16x16x32_bf16 v[88:91], v[160:163], v[28:31], v[88:91]
  v_mfma_f32_16x16x32_bf16 v[92:95], v[168:171], v[28:31], v[92:95]
  v_mfma_f32_16x16x32_bf16 v[88:91], v[164:167], v[32:35], v[88:91]
  v_mfma_f32_16x16x32_bf16 v[92:95], v[172:175], v[32:35], v[92:95]
  v_cvt_pk_bf16_f32 v36, v56, v57
  v_cvt_pk_bf16_f32 v37, v58, v59
  v_cvt_pk_bf16_f32 v38, v60, v61
  v_cvt_pk_bf16_f32 v39, v62, v63
  v_cvt_pk_bf16_f32 v40, v64, v65
  v_cvt_pk_bf16_f32 v41, v66, v67
  v_cvt_pk_bf16_f32 v42, v68, v69
  v_cvt_pk_bf16_f32 v43, v70, v71
  v_cvt_pk_bf16_f32 v44, v72, v73
  v_cvt_pk_bf16_f32 v45, v74, v75
  v_cvt_pk_bf16_f32 v46, v76, v77
  v_cvt_pk_bf16_f32 v47, v78, v79
  v_cvt_pk_bf16_f32 v48, v80, v81
  v_cvt_pk_bf16_f32 v49, v82, v83
  v_cvt_pk_bf16_f32 v50, v84, v85
  v_cvt_pk_bf16_f32 v51, v86, v87
  v_cvt_pk_bf16_f32 v52, v88, v89
  v_cvt_pk_bf16_f32 v53, v90, v91
  v_cvt_pk_bf16_f32 v54, v92, v93
  v_cvt_pk_bf16_f32 v55, v94, v95
  buffer_store_dwordx4 v[36:39], v20, s[4:7], s52 offen offset:0 sc1
  buffer_store_dwordx4 v[40:43], v20, s[4:7], s52 offen offset:1024 sc1
  buffer_store_dwordx4 v[44:47], v20, s[4:7], s52 offen offset:2048 sc1
  buffer_store_dwordx4 v[48:51], v20, s[4:7], s52 offen offset:3072 sc1
  buffer_store_dwordx4 v[52:55], v20, s[4:7], s53 offen offset:0 sc1
  v_lshlrev_b32 v56, 16, v36
  v_and_b32 v57, s55, v36
  v_lshlrev_b32 v58, 16, v37
  v_and_b32 v59, s55, v37
  v_lshlrev_b32 v60, 16, v38
  v_and_b32 v61, s55, v38
  v_lshlrev_b32 v62, 16, v39
  v_and_b32 v63, s55, v39
  v_lshlrev_b32 v64, 16, v40
  v_and_b32 v65, s55, v40
  v_lshlrev_b32 v66, 16, v41
  v_and_b32 v67, s55, v41
  v_lshlrev_b32 v68, 16, v42
  v_and_b32 v69, s55, v42
  v_lshlrev_b32 v70, 16, v43
  v_and_b32 v71, s55, v43
  v_lshlrev_b32 v72, 16, v44
  v_and_b32 v73, s55, v44
  v_lshlrev_b32 v74, 16, v45
  v_and_b32 v75, s55, v45
  v_lshlrev_b32 v76, 16, v46
  v_and_b32 v77, s55, v46
  v_lshlrev_b32 v78, 16, v47
  v_and_b32 v79, s55, v47
  v_lshlrev_b32 v80, 16, v48
  v_and_b32 v81, s55, v48
  v_lshlrev_b32 v82, 16, v49
  v_and_b32 v83, s55, v49
  v_lshlrev_b32 v84, 16, v50
  v_and_b32 v85, s55, v50
  v_lshlrev_b32 v86, 16, v51
  v_and_b32 v87, s55, v51
  v_lshlrev_b32 v88, 16, v52
  v_and_b32 v89, s55, v52
  v_lshlrev_b32 v90, 16, v53
  v_and_b32 v91, s55, v53
  v_lshlrev_b32 v92, 16, v54
  v_and_b32 v93, s55, v54
  v_lshlrev_b32 v94, 16, v55
  v_and_b32 v95, s55, v55
  v_pk_add_f32 v[24:25], v[56:57], v[58:59]
  v_pk_add_f32 v[24:25], v[24:25], v[60:61]
  v_pk_add_f32 v[24:25], v[24:25], v[62:63]
  v_pk_add_f32 v[24:25], v[24:25], v[64:65]
  v_pk_add_f32 v[24:25], v[24:25], v[66:67]
  v_pk_add_f32 v[24:25], v[24:25], v[68:69]
  v_pk_add_f32 v[24:25], v[24:25], v[70:71]
  v_pk_add_f32 v[24:25], v[24:25], v[72:73]
  v_pk_add_f32 v[24:25], v[24:25], v[74:75]
  v_pk_add_f32 v[24:25], v[24:25], v[76:77]
  v_pk_add_f32 v[24:25], v[24:25], v[78:79]
  v_pk_add_f32 v[24:25], v[24:25], v[80:81]
  v_pk_add_f32 v[24:25], v[24:25], v[82:83]
  v_pk_add_f32 v[24:25], v[24:25], v[84:85]
  v_pk_add_f32 v[24:25], v[24:25], v[86:87]
  v_pk_add_f32 v[24:25], v[24:25], v[88:89]
  v_pk_add_f32 v[24:25], v[24:25], v[90:91]
  v_pk_add_f32 v[24:25], v[24:25], v[92:93]
  v_pk_add_f32 v[24:25], v[24:25], v[94:95]
  v_add_f32 v24, v24, v25
  v_mov_b32 v22, v24
  s_nop 1
  v_permlane16_swap_b32 v24, v22
  v_add_f32 v24, v24, v22
  v_mov_b32 v22, v24
  s_nop 1
  v_permlane32_swap_b32 v24, v22
  v_add_f32 v24, v24, v22
  v_mul_f32 v24, 0x3bcccccd, v24
  v_pk_add_f32 v[56:57], v[56:57], v[24:25] op_sel_hi:[1,0] neg_lo:[0,1] neg_hi:[0,1]
  v_pk_mul_f32 v[26:27], v[56:57], v[56:57]
  v_pk_add_f32 v[58:59], v[58:59], v[24:25] op_sel_hi:[1,0] neg_lo:[0,1] neg_hi:[0,1]
  v_pk_fma_f32 v[26:27], v[58:59], v[58:59], v[26:27]
  v_pk_add_f32 v[60:61], v[60:61], v[24:25] op_sel_hi:[1,0] neg_lo:[0,1] neg_hi:[0,1]
  v_pk_fma_f32 v[26:27], v[60:61], v[60:61], v[26:27]
  v_pk_add_f32 v[62:63], v[62:63], v[24:25] op_sel_hi:[1,0] neg_lo:[0,1] neg_hi:[0,1]
  v_pk_fma_f32 v[26:27], v[62:63], v[62:63], v[26:27]
  v_pk_add_f32 v[64:65], v[64:65], v[24:25] op_sel_hi:[1,0] neg_lo:[0,1] neg_hi:[0,1]
  v_pk_fma_f32 v[26:27], v[64:65], v[64:65], v[26:27]
  v_pk_add_f32 v[66:67], v[66:67], v[24:25] op_sel_hi:[1,0] neg_lo:[0,1] neg_hi:[0,1]
  v_pk_fma_f32 v[26:27], v[66:67], v[66:67], v[26:27]
  v_pk_add_f32 v[68:69], v[68:69], v[24:25] op_sel_hi:[1,0] neg_lo:[0,1] neg_hi:[0,1]
  v_pk_fma_f32 v[26:27], v[68:69], v[68:69], v[26:27]
  v_pk_add_f32 v[70:71], v[70:71], v[24:25] op_sel_hi:[1,0] neg_lo:[0,1] neg_hi:[0,1]
  v_pk_fma_f32 v[26:27], v[70:71], v[70:71], v[26:27]
  v_pk_add_f32 v[72:73], v[72:73], v[24:25] op_sel_hi:[1,0] neg_lo:[0,1] neg_hi:[0,1]
  v_pk_fma_f32 v[26:27], v[72:73], v[72:73], v[26:27]
  v_pk_add_f32 v[74:75], v[74:75], v[24:25] op_sel_hi:[1,0] neg_lo:[0,1] neg_hi:[0,1]
  v_pk_fma_f32 v[26:27], v[74:75], v[74:75], v[26:27]
  v_pk_add_f32 v[76:77], v[76:77], v[24:25] op_sel_hi:[1,0] neg_lo:[0,1] neg_hi:[0,1]
  v_pk_fma_f32 v[26:27], v[76:77], v[76:77], v[26:27]
  v_pk_add_f32 v[78:79], v[78:79], v[24:25] op_sel_hi:[1,0] neg_lo:[0,1] neg_hi:[0,1]
  v_pk_fma_f32 v[26:27], v[78:79], v[78:79], v[26:27]
  v_pk_add_f32 v[80:81], v[80:81], v[24:25] op_sel_hi:[1,0] neg_lo:[0,1] neg_hi:[0,1]
  v_pk_fma_f32 v[26:27], v[80:81], v[80:81], v[26:27]
  v_pk_add_f32 v[82:83], v[82:83], v[24:25] op_sel_hi:[1,0] neg_lo:[0,1] neg_hi:[0,1]
  v_pk_fma_f32 v[26:27], v[82:83], v[82:83], v[26:27]
  v_pk_add_f32 v[84:85], v[84:85], v[24:25] op_sel_hi:[1,0] neg_lo:[0,1] neg_hi:[0,1]
  v_pk_fma_f32 v[26:27], v[84:85], v[84:85], v[26:27]
  v_pk_add_f32 v[86:87], v[86:87], v[24:25] op_sel_hi:[1,0] neg_lo:[0,1] neg_hi:[0,1]
  v_pk_fma_f32 v[26:27], v[86:87], v[86:87], v[26:27]
  v_pk_add_f32 v[88:89], v[88:89], v[24:25] op_sel_hi:[1,0] neg_lo:[0,1] neg_hi:[0,1]
  v_pk_fma_f32 v[26:27], v[88:89], v[88:89], v[26:27]
  v_pk_add_f32 v[90:91], v[90:91], v[24:25] op_sel_hi:[1,0] neg_lo:[0,1] neg_hi:[0,1]
  v_pk_fma_f32 v[26:27], v[90:91], v[90:91], v[26:27]
  v_pk_add_f32 v[92:93], v[92:93], v[24:25] op_sel_hi:[1,0] neg_lo:[0,1] neg_hi:[0,1]
  v_pk_fma_f32 v[26:27], v[92:93], v[92:93], v[26:27]
  v_pk_add_f32 v[94:95], v[94:95], v[24:25] op_sel_hi:[1,0] neg_lo:[0,1] neg_hi:[0,1]
  v_pk_fma_f32 v[26:27], v[94:95], v[94:95], v[26:27]
  v_add_f32 v25, v26, v27
  v_mov_b32 v22, v25
  s_nop 1
  v_permlane16_swap_b32 v25, v22
  v_add_f32 v25, v25, v22
  v_mov_b32 v22, v25
  s_nop 1
  v_permlane32_swap_b32 v25, v22
  v_add_f32 v25, v25, v22
  v_and_b32 v22, 15, v1
  s_add_u32 s54, s50, 162816
  v_lshl_add_u32 v22, v22, 3, s54
  s_lshl_b32 s54, s3, 7
  v_add_u32 v23, s54, v22
  ds_write_b64 v23, v[24:25]
  s_xor_b32 s50, s50, 512
  s_waitcnt lgkmcnt(0)
  s_barrier
  ds_read_b64 v[28:29], v22 offset:0
  ds_read_b64 v[30:31], v22 offset:128
  ds_read_b64 v[32:33], v22 offset:256
  ds_read_b64 v[34:35], v22 offset:384
  s_add_u32 s52, s51, 36700160
  s_add_u32 s53, s52, 4096
  s_waitcnt lgkmcnt(0)
  v_pk_add_f32 v[26:27], v[28:29], v[30:31]
  v_pk_add_f32 v[26:27], v[26:27], v[32:33]
  v_pk_add_f32 v[26:27], v[26:27], v[34:35]
  v_mul_f32 v26, 0x3e800000, v26
  v_sub_f32 v28, v28, v26
  v_sub_f32 v30, v30, v26
  v_sub_f32 v32, v32, v26
  v_sub_f32 v34, v34, v26
  v_mul_f32 v22, v28, v28
  v_fmac_f32 v22, v30, v30
  v_fmac_f32 v22, v32, v32
  v_fmac_f32 v22, v34, v34
  v_fmac_f32 v27, 0x43200000, v22
  v_mov_b32 v22, 0x3727c5ac
  v_fmac_f32 v22, 0x3acccccd, v27
  v_rsq_f32 v25, v22
  v_sub_f32 v24, v24, v26
  v_mul_f32 v24, v24, v25
  v_pk_fma_f32 v[56:57], v[56:57], v[24:25], v[24:25] op_sel:[0,1,0] op_sel_hi:[1,1,0]
  v_cvt_pk_bf16_f32 v36, v56, v57
  v_pk_fma_f32 v[58:59], v[58:59], v[24:25], v[24:25] op_sel:[0,1,0] op_sel_hi:[1,1,0]
  v_cvt_pk_bf16_f32 v37, v58, v59
  v_pk_fma_f32 v[60:61], v[60:61], v[24:25], v[24:25] op_sel:[0,1,0] op_sel_hi:[1,1,0]
  v_cvt_pk_bf16_f32 v38, v60, v61
  v_pk_fma_f32 v[62:63], v[62:63], v[24:25], v[24:25] op_sel:[0,1,0] op_sel_hi:[1,1,0]
  v_cvt_pk_bf16_f32 v39, v62, v63
  buffer_store_dwordx4 v[36:39], v20, s[4:7], s52 offen offset:0 sc1
  v_pk_fma_f32 v[64:65], v[64:65], v[24:25], v[24:25] op_sel:[0,1,0] op_sel_hi:[1,1,0]
  v_cvt_pk_bf16_f32 v40, v64, v65
  v_pk_fma_f32 v[66:67], v[66:67], v[24:25], v[24:25] op_sel:[0,1,0] op_sel_hi:[1,1,0]
  v_cvt_pk_bf16_f32 v41, v66, v67
  v_pk_fma_f32 v[68:69], v[68:69], v[24:25], v[24:25] op_sel:[0,1,0] op_sel_hi:[1,1,0]
  v_cvt_pk_bf16_f32 v42, v68, v69
  v_pk_fma_f32 v[70:71], v[70:71], v[24:25], v[24:25] op_sel:[0,1,0] op_sel_hi:[1,1,0]
  v_cvt_pk_bf16_f32 v43, v70, v71
  buffer_store_dwordx4 v[40:43], v20, s[4:7], s52 offen offset:1024 sc1
  v_pk_fma_f32 v[72:73], v[72:73], v[24:25], v[24:25] op_sel:[0,1,0] op_sel_hi:[1,1,0]
  v_cvt_pk_bf16_f32 v44, v72, v73
  v_pk_fma_f32 v[74:75], v[74:75], v[24:25], v[24:25] op_sel:[0,1,0] op_sel_hi:[1,1,0]
  v_cvt_pk_bf16_f32 v45, v74, v75
  v_pk_fma_f32 v[76:77], v[76:77], v[24:25], v[24:25] op_sel:[0,1,0] op_sel_hi:[1,1,0]
  v_cvt_pk_bf16_f32 v46, v76, v77
  v_pk_fma_f32 v[78:79], v[78:79], v[24:25], v[24:25] op_sel:[0,1,0] op_sel_hi:[1,1,0]
  v_cvt_pk_bf16_f32 v47, v78, v79
  buffer_store_dwordx4 v[44:47], v20, s[4:7], s52 offen offset:2048 sc1
  v_pk_fma_f32 v[80:81], v[80:81], v[24:25], v[24:25] op_sel:[0,1,0] op_sel_hi:[1,1,0]
  v_cvt_pk_bf16_f32 v48, v80, v81
  v_pk_fma_f32 v[82:83], v[82:83], v[24:25], v[24:25] op_sel:[0,1,0] op_sel_hi:[1,1,0]
  v_cvt_pk_bf16_f32 v49, v82, v83
  v_pk_fma_f32 v[84:85], v[84:85], v[24:25], v[24:25] op_sel:[0,1,0] op_sel_hi:[1,1,0]
  v_cvt_pk_bf16_f32 v50, v84, v85
  v_pk_fma_f32 v[86:87], v[86:87], v[24:25], v[24:25] op_sel:[0,1,0] op_sel_hi:[1,1,0]
  v_cvt_pk_bf16_f32 v51, v86, v87
  buffer_store_dwordx4 v[48:51], v20, s[4:7], s52 offen offset:3072 sc1
  v_pk_fma_f32 v[88:89], v[88:89], v[24:25], v[24:25] op_sel:[0,1,0] op_sel_hi:[1,1,0]
  v_cvt_pk_bf16_f32 v52, v88, v89
  v_pk_fma_f32 v[90:91], v[90:91], v[24:25], v[24:25] op_sel:[0,1,0] op_sel_hi:[1,1,0]
  v_cvt_pk_bf16_f32 v53, v90, v91
  v_pk_fma_f32 v[92:93], v[92:93], v[24:25], v[24:25] op_sel:[0,1,0] op_sel_hi:[1,1,0]
  v_cvt_pk_bf16_f32 v54, v92, v93
  v_pk_fma_f32 v[94:95], v[94:95], v[24:25], v[24:25] op_sel:[0,1,0] op_sel_hi:[1,1,0]
  v_cvt_pk_bf16_f32 v55, v94, v95
  buffer_store_dwordx4 v[52:55], v20, s[4:7], s53 offen offset:0 sc1
  s_lshr_b32 s52, s48, 1
  s_lshl_b32 s52, s52, 7
  s_and_b32 s53, s48, 1
  s_lshl_b32 s53, s53, 2
  s_add_u32 s53, s53, s3
  s_lshl_b32 s53, s53, 2
  s_add_u32 s52, s52, s53
  s_add_u32 s52, s52, 64909312
  s_add_u32 s53, s49, 1
  s_waitcnt vmcnt(0)
  v_mov_b32 v22, s53
  s_mov_b64 exec, 1
  buffer_store_dword v22, off, s[4:7], s52 sc1
  s_mov_b64 exec, -1
  s_add_u32 s48, s48, 32
  s_cmp_lt_u32 s48, 128
  s_cbranch_scc1 mk_xj
  s_branch mk_s2
mk_qrole:
  v_lshlrev_b32 v2, 4, v1
  s_mul_i32 s13, s3, 10240
  v_lshrrev_b32 v7, 3, v1
  v_lshlrev_b32 v7, 7, v7
  v_and_b32 v8, 7, v1
  v_lshl_add_u32 v7, v8, 2, v7
  v_mov_b32 v12, -1
  v_mov_b32 v13, -1
  v_mov_b32 v14, -1
  v_mov_b32 v15, -1
  v_min_u32 v0, 1, v1
  v_lshlrev_b32 v0, 30, v0
  s_lshl_b32 s15, s3, 10
  s_add_u32 s15, s15, 122880
  v_add_u32 v3, s15, v2
  v_and_b32 v9, 15, v1
  v_lshrrev_b32 v10, 4, v1
  v_and_b32 v209, 7, v1
  v_lshlrev_b32 v209, 4, v209
  v_lshl_add_u32 v209, v10, 7, v209
  v_lshlrev_b32 v211, 7, v1
  v_cmp_lt_u32 vcc, 23, v1
  s_nop 1
  v_cndmask_b32 v211, v211, v0, vcc
  v_mov_b32 v216, 0
  v_mov_b32 v210, 0
  v_bfe_u32 v11, v1, 0, 1
  v_lshl_add_u32 v216, v11, 4, v216
  v_lshl_add_u32 v210, v11, 4, v210
  v_bfe_u32 v11, v1, 1, 1
  v_lshl_add_u32 v216, v11, 12, v216
  v_lshl_add_u32 v210, v11, 10, v210
  v_bfe_u32 v11, v1, 2, 1
  v_lshl_add_u32 v216, v11, 14, v216
  v_lshl_add_u32 v210, v11, 11, v210
  v_bfe_u32 v11, v1, 3, 1
  v_lshl_add_u32 v216, v11, 6, v216
  v_lshl_add_u32 v210, v11, 6, v210
  v_bfe_u32 v11, v1, 4, 1
  v_lshl_add_u32 v216, v11, 5, v216
  v_lshl_add_u32 v210, v11, 29, v210
  v_bfe_u32 v11, v1, 5, 1
  v_lshl_add_u32 v216, v11, 8, v216
  v_lshl_add_u32 v210, v11, 30, v210
  v_and_b32 v215, 3, v1
  v_lshlrev_b32 v215, 2, v215
  v_mov_b32 v208, 0xd04e79ff
  v_lshlrev_b32 v10, 2, v10
  v_add_u32 v11, 0, v10
  v_cmp_le_u32 vcc, v11, v9
  s_bitcmp0_b32 s3, 0
  s_cselect_b64 s[48:49], vcc, -1
  s_cselect_b64 s[56:57], 0, vcc
  v_add_u32 v11, 1, v10
  v_cmp_le_u32 vcc, v11, v9
  s_bitcmp0_b32 s3, 0
  s_cselect_b64 s[50:51], vcc, -1
  s_cselect_b64 s[58:59], 0, vcc
  v_add_u32 v11, 2, v10
  v_cmp_le_u32 vcc, v11, v9
  s_bitcmp0_b32 s3, 0
  s_cselect_b64 s[52:53], vcc, -1
  s_cselect_b64 s[60:61], 0, vcc
  v_add_u32 v11, 3, v10
  v_cmp_le_u32 vcc, v11, v9
  s_bitcmp0_b32 s3, 0
  s_cselect_b64 s[54:55], vcc, -1
  s_cselect_b64 s[62:63], 0, vcc
  s_mov_b32 s40, -1
  s_mov_b32 s41, 0
  s_mov_b32 s42, 0x3dd53b95
  s_add_u32 s30, s73, 40
  s_lshl_b32 s30, s30, 14
  s_add_u32 s30, s30, s39
  s_lshr_b32 s31, s73, 1
  s_sub_u32 s31, s31, s73
  s_add_u32 s31, s31, 8
  s_lshl_b32 s31, s31, 14
  s_and_b32 s15, s73, 1
  s_lshl_b32 s15, s15, 12
  s_add_u32 s31, s31, s15
  s_and_b32 s16, s3, 1
  s_lshl_b32 s16, s16, 7
  s_mul_i32 s33, s73, -15872
  s_add_u32 s33, s33, 278528
  s_add_u32 s33, s33, s16
  s_sub_u32 s34, 19, s73
  s_lshl_b32 s34, s34, 14
  s_add_u32 s34, s34, s16
  s_bfe_u32 s15, s73, 0x10000
  s_lshl_b32 s15, s15, 8
  s_add_u32 s34, s34, s15
  s_bfe_u32 s15, s73, 0x10001
  s_lshl_b32 s15, s15, 5
  s_add_u32 s34, s34, s15
  s_bfe_u32 s15, s73, 0x10002
  s_lshl_b32 s15, s15, 9
  s_add_u32 s34, s34, s15
  s_lshl_b32 s25, s75, 7
  s_add_u32 s25, s25, 64880640
  s_mov_b32 s32, 0
mk_q_layer:
  s_lshl_b32 s28, s66, 1
  s_mul_i32 s12, s28, 2621440
  s_add_u32 s12, s12, s13
  s_add_u32 s12, s12, 36700160
  s_add_u32 s28, s28, 1
  s_cmp_eq_u32 s66, 0
  s_cselect_b32 s26, 64, 0
  s_mov_b32 s27, 0
  s_mov_b32 s20, 0
  s_mov_b32 s21, 40960
  s_mov_b32 s22, 81920
  s_lshl_b32 s24, s66, 6
  s_cmp_ge_u32 s26, 64
  s_cbranch_scc1 int_hn19_ok
  s_mov_b32 s70, 0
int_hn19:
  s_lshl_b32 s29, s26, 7
  s_add_u32 s29, s29, 64909312
  buffer_load_dword v8, v7, s[4:7], s29 offen sc1
  s_waitcnt vmcnt(0)
int_hn19_a:
  v_cmp_gt_u32 vcc, s28, v8
  s_nop 0
  s_ff1_i32_b64 s29, vcc
  s_min_u32 s29, s29, 64
  s_lshr_b32 s29, s29, 3
  s_add_u32 s26, s26, s29
  s_min_u32 s29, s27, 63
  s_cmp_gt_u32 s26, s29
  s_cbranch_scc1 int_hn19_g
  s_sleep 1
  s_add_u32 s70, s70, 1
  s_cmp_lt_u32 s70, 262144
  s_cbranch_scc1 int_hn19
  s_branch mk_fail
int_hn19_g:
int_hn19_ok:
  s_add_u32 s17, s20, s13
  s_min_u32 s18, s27, 63
  s_mul_i32 s18, s18, 40960
  s_add_u32 s18, s18, s12
  s_add_u32 s27, s27, 1
  s_add_u32 m0, s17, 0
  s_nop 0
  buffer_load_dwordx4 v2, s[4:7], s18 offen offset:0 sc1 lds
  buffer_load_dwordx4 v2, s[4:7], s18 offen offset:1024 sc1 lds
  buffer_load_dwordx4 v2, s[4:7], s18 offen offset:2048 sc1 lds
  buffer_load_dwordx4 v2, s[4:7], s18 offen offset:3072 sc1 lds
  s_add_u32 s18, s18, 4096
  s_add_u32 m0, s17, 4096
  s_nop 0
  buffer_load_dwordx4 v2, s[4:7], s18 offen offset:0 sc1 lds
  buffer_load_dwordx4 v2, s[4:7], s18 offen offset:1024 sc1 lds
  buffer_load_dwordx4 v2, s[4:7], s18 offen offset:2048 sc1 lds
  buffer_load_dwordx4 v2, s[4:7], s18 offen offset:3072 sc1 lds
  s_add_u32 s18, s18, 4096
  s_add_u32 m0, s17, 8192
  s_nop 0
  buffer_load_dwordx4 v2, s[4:7], s18 offen offset:0 sc1 lds
  buffer_load_dwordx4 v2, s[4:7], s18 offen offset:1024 sc1 lds
  s_cmp_ge_u32 s26, 64
  s_cbranch_scc1 int_hn20_ok
  s_mov_b32 s70, 0
int_hn20:
  s_lshl_b32 s29, s26, 7
  s_add_u32 s29, s29, 64909312
  buffer_load_dword v8, v7, s[4:7], s29 offen sc1
  s_waitcnt vmcnt(0)
int_hn20_a:
  v_cmp_gt_u32 vcc, s28, v8
  s_nop 0
  s_ff1_i32_b64 s29, vcc
  s_min_u32 s29, s29, 64
  s_lshr_b32 s29, s29, 3
  s_add_u32 s26, s26, s29
  s_min_u32 s29, s27, 63
  s_cmp_gt_u32 s26, s29
  s_cbranch_scc1 int_hn20_g
  s_sleep 1
  s_add_u32 s70, s70, 1
  s_cmp_lt_u32 s70, 262144
  s_cbranch_scc1 int_hn20
  s_branch mk_fail
int_hn20_g:
int_hn20_ok:
  s_add_u32 s17, s21, s13
  s_min_u32 s18, s27, 63
  s_mul_i32 s18, s18, 40960
  s_add_u32 s18, s18, s12
  s_add_u32 s27, s27, 1
  s_add_u32 m0, s17, 0
  s_nop 0
  buffer_load_dwordx4 v2, s[4:7], s18 offen offset:0 sc1 lds
  buffer_load_dwordx4 v2, s[4:7], s18 offen offset:1024 sc1 lds
  buffer_load_dwordx4 v2, s[4:7], s18 offen offset:2048 sc1 lds
  s_lshl_b32 s29, s26, 7
  s_add_u32 s29, s29, 64909312
  buffer_load_dword v8, v7, s[4:7], s29 offen sc1
  v_mov_b32 v5, v2
  s_waitcnt vmcnt(4)
  s_barrier
  ds_read_b128 v[16:19], v5 offset:0
  ds_read_b128 v[20:23], v5 offset:20480
  ds_read_b128 v[24:27], v5 offset:1024
  ds_read_b128 v[28:31], v5 offset:21504
  ds_read_b128 v[32:35], v5 offset:2048
  ds_read_b128 v[36:39], v5 offset:22528
  s_mov_b32 s35, 24576
  s_lshr_b32 s36, s3, 1
  s_mul_i32 s37, s36, 12288
  s_add_u32 s36, s36, s24
  s_mov_b32 s38, 0
  s_mov_b32 s43, 1073741824
  s_branch mk_q_even
mk_q_loop:
  s_waitcnt lgkmcnt(4)
  v_cvt_pk_bf16_f32 v72, v48, v49
  v_cvt_pk_bf16_f32 v73, v50, v51
  v_mfma_f32_16x16x32_bf16 v[48:51], a[0:3], v[16:19], 0
  ds_read_b128 v[40:43], v5 offset:3072
  v_cvt_pk_bf16_f32 v74, v52, v53
  v_cvt_pk_bf16_f32 v75, v54, v55
  v_mfma_f32_16x16x32_bf16 v[52:55], a[80:83], v[16:19], 0
  v_cvt_pk_bf16_f32 v80, v56, v57
  v_cvt_pk_bf16_f32 v81, v58, v59
  v_mfma_f32_16x16x32_bf16 v[56:59], a[160:163], v[16:19], 0
  v_cvt_pk_bf16_f32 v76, v60, v61
  v_cvt_pk_bf16_f32 v77, v62, v63
  v_mfma_f32_16x16x32_bf16 v[60:63], a[0:3], v[20:23], 0
  ds_read_b128 v[44:47], v5 offset:23552
  v_cvt_pk_bf16_f32 v78, v64, v65
  v_cvt_pk_bf16_f32 v79, v66, v67
  v_mfma_f32_16x16x32_bf16 v[64:67], a[80:83], v[20:23], 0
  v_cvt_pk_bf16_f32 v82, v68, v69
  v_cvt_pk_bf16_f32 v83, v70, v71
  v_mfma_f32_16x16x32_bf16 v[68:71], a[160:163], v[20:23], 0
  s_waitcnt lgkmcnt(4)
  v_mfma_f32_16x16x32_bf16 v[48:51], a[4:7], v[24:27], v[48:51]
  ds_read_b128 v[16:19], v5 offset:4096
  v_mfma_f32_16x16x32_bf16 v[52:55], a[84:87], v[24:27], v[52:55]
  buffer_load_dwordx4 v2, s[4:7], s18 offen offset:3072 sc1 lds
  v_mfma_f32_16x16x32_bf16 v[56:59], a[164:167], v[24:27], v[56:59]
  v_add_u32 v4, s35, v3
  v_mfma_f32_16x16x32_bf16 v[60:63], a[4:7], v[28:31], v[60:63]
  ds_read_b128 v[20:23], v5 offset:24576
  v_mfma_f32_16x16x32_bf16 v[64:67], a[84:87], v[28:31], v[64:67]
  s_add_u32 s35, s35, 12288
  s_cmp_eq_u32 s35, 36864
  s_cselect_b32 s35, 0, s35
  v_mfma_f32_16x16x32_bf16 v[68:71], a[164:167], v[28:31], v[68:71]
  s_add_u32 s29, s36, 1
  s_cmp_lt_u32 s32, s29
  s_cbranch_scc1 int_sl21
int_sl21_b:
  s_waitcnt lgkmcnt(4)
  v_mfma_f32_16x16x32_bf16 v[48:51], a[8:11], v[32:35], v[48:51]
  ds_read_b128 v[24:27], v5 offset:5120
  v_mfma_f32_16x16x32_bf16 v[52:55], a[88:91], v[32:35], v[52:55]
  s_and_b32 s14, s36, 31
  s_lshl_b32 s14, s14, 2
  s_add_u32 s14, s14, s72
  v_mfma_f32_16x16x32_bf16 v[56:59], a[168:171], v[32:35], v[56:59]
  s_lshr_b32 s68, s14, 1
  s_bitcmp1_b64 s[64:65], s68
  s_cselect_b32 s68, 0x2000, 0
  v_mfma_f32_16x16x32_bf16 v[60:63], a[8:11], v[36:39], v[60:63]
  ds_read_b128 v[28:31], v5 offset:25600
  v_mfma_f32_16x16x32_bf16 v[64:67], a[88:91], v[36:39], v[64:67]
  s_lshl_b32 s14, s14, 20
  s_add_u32 s14, s14, s68
  s_add_u32 s14, s14, s30
  v_mfma_f32_16x16x32_bf16 v[68:71], a[168:171], v[36:39], v[68:71]
  s_sub_u32 s43, s14, s68
  s_xor_b32 s68, s68, 0x2000
  s_waitcnt lgkmcnt(4)
  v_mfma_f32_16x16x32_bf16 v[48:51], a[12:15], v[40:43], v[48:51]
  ds_read_b128 v[32:35], v5 offset:6144
  v_mfma_f32_16x16x32_bf16 v[52:55], a[92:95], v[40:43], v[52:55]
  s_add_u32 s43, s43, s68
  s_add_u32 s43, s43, 196608
  s_add_u32 s15, s14, 4096
  v_mfma_f32_16x16x32_bf16 v[56:59], a[172:175], v[40:43], v[56:59]
  s_bitcmp0_b32 s3, 0
  s_cselect_b32 s15, 1073741824, s15
  s_add_u32 s16, s14, s31
  v_mfma_f32_16x16x32_bf16 v[60:63], a[12:15], v[44:47], v[60:63]
  ds_read_b128 v[36:39], v5 offset:26624
  v_mfma_f32_16x16x32_bf16 v[64:67], a[92:95], v[44:47], v[64:67]
  s_add_u32 s18, s18, 4096
  s_add_u32 m0, s17, 4096
  v_mfma_f32_16x16x32_bf16 v[68:71], a[172:175], v[44:47], v[68:71]
  s_waitcnt lgkmcnt(4)
  v_mfma_f32_16x16x32_bf16 v[48:51], a[16:19], v[16:19], v[48:51]
  ds_read_b128 v[40:43], v5 offset:7168
  v_mfma_f32_16x16x32_bf16 v[52:55], a[96:99], v[16:19], v[52:55]
  buffer_load_dwordx4 v2, s[4:7], s18 offen offset:0 sc1 lds
  v_mfma_f32_16x16x32_bf16 v[56:59], a[176:179], v[16:19], v[56:59]
  buffer_load_dwordx4 v2, s[4:7], s18 offen offset:1024 sc1 lds
  v_mfma_f32_16x16x32_bf16 v[60:63], a[16:19], v[20:23], v[60:63]
  ds_read_b128 v[44:47], v5 offset:27648
  v_mfma_f32_16x16x32_bf16 v[64:67], a[96:99], v[20:23], v[64:67]
  ds_write_b128 v4, v[72:75] offset:0
  v_mfma_f32_16x16x32_bf16 v[68:71], a[176:179], v[20:23], v[68:71]
  s_waitcnt lgkmcnt(4)
  v_mfma_f32_16x16x32_bf16 v[48:51], a[20:23], v[24:27], v[48:51]
  ds_read_b128 v[16:19], v5 offset:8192
  v_mfma_f32_16x16x32_bf16 v[52:55], a[100:103], v[24:27], v[52:55]
  buffer_load_dwordx4 v2, s[4:7], s18 offen offset:2048 sc1 lds
  v_mfma_f32_16x16x32_bf16 v[56:59], a[180:183], v[24:27], v[56:59]
  ds_write_b128 v4, v[76:79] offset:4096
  v_mfma_f32_16x16x32_bf16 v[60:63], a[20:23], v[28:31], v[60:63]
  ds_read_b128 v[20:23], v5 offset:28672
  v_mfma_f32_16x16x32_bf16 v[64:67], a[100:103], v[28:31], v[64:67]
  buffer_load_dwordx4 v2, s[4:7], s18 offen offset:3072 sc1 lds
  v_mfma_f32_16x16x32_bf16 v[68:71], a[180:183], v[28:31], v[68:71]
  s_waitcnt lgkmcnt(4)
  v_mfma_f32_16x16x32_bf16 v[48:51], a[24:27], v[32:35], v[48:51]
  ds_read_b128 v[24:27], v5 offset:9216
  v_mfma_f32_16x16x32_bf16 v[52:55], a[104:107], v[32:35], v[52:55]
  ds_write_b128 v4, v[80:83] offset:8192
  v_mfma_f32_16x16x32_bf16 v[56:59], a[184:187], v[32:35], v[56:59]
  s_add_u32 s18, s18, 4096
  s_add_u32 m0, s17, 8192
  v_mfma_f32_16x16x32_bf16 v[60:63], a[24:27], v[36:39], v[60:63]
  ds_read_b128 v[28:31], v5 offset:29696
  v_mfma_f32_16x16x32_bf16 v[64:67], a[104:107], v[36:39], v[64:67]
  buffer_load_dwordx4 v2, s[4:7], s18 offen offset:0 sc1 lds
  v_mfma_f32_16x16x32_bf16 v[68:71], a[184:187], v[36:39], v[68:71]
  s_waitcnt lgkmcnt(4)
  v_mfma_f32_16x16x32_bf16 v[48:51], a[28:31], v[40:43], v[48:51]
  ds_read_b128 v[32:35], v5 offset:10240
  v_mfma_f32_16x16x32_bf16 v[52:55], a[108:111], v[40:43], v[52:55]
  buffer_load_dwordx4 v2, s[4:7], s18 offen offset:1024 sc1 lds
  v_mfma_f32_16x16x32_bf16 v[56:59], a[188:191], v[40:43], v[56:59]
  v_mfma_f32_16x16x32_bf16 v[60:63], a[28:31], v[44:47], v[60:63]
  ds_read_b128 v[36:39], v5 offset:30720
  v_mfma_f32_16x16x32_bf16 v[64:67], a[108:111], v[44:47], v[64:67]
  v_mfma_f32_16x16x32_bf16 v[68:71], a[188:191], v[44:47], v[68:71]
  s_waitcnt lgkmcnt(4)
  v_mfma_f32_16x16x32_bf16 v[48:51], a[32:35], v[16:19], v[48:51]
  ds_read_b128 v[40:43], v5 offset:11264
  v_mfma_f32_16x16x32_bf16 v[52:55], a[112:115], v[16:19], v[52:55]
  buffer_load_dwordx4 v[112:115], v2, s[4:7], s14 offen offset:0 sc1
  v_mfma_f32_16x16x32_bf16 v[56:59], a[192:195], v[16:19], v[56:59]
  v_mfma_f32_16x16x32_bf16 v[60:63], a[32:35], v[20:23], v[60:63]
  ds_read_b128 v[44:47], v5 offset:31744
  v_mfma_f32_16x16x32_bf16 v[64:67], a[112:115], v[20:23], v[64:67]
  v_mfma_f32_16x16x32_bf16 v[68:71], a[192:195], v[20:23], v[68:71]
  s_waitcnt lgkmcnt(4)
  v_mfma_f32_16x16x32_bf16 v[48:51], a[36:39], v[24:27], v[48:51]
  ds_read_b128 v[16:19], v5 offset:12288
  v_mfma_f32_16x16x32_bf16 v[52:55], a[116:119], v[24:27], v[52:55]
  buffer_load_dwordx4 v[116:119], v2, s[4:7], s14 offen offset:1024 sc1
  v_mfma_f32_16x16x32_bf16 v[56:59], a[196:199], v[24:27], v[56:59]
  buffer_load_dwordx4 v[120:123], v2, s[4:7], s14 offen offset:2048 sc1
  v_mfma_f32_16x16x32_bf16 v[60:63], a[36:39], v[28:31], v[60:63]
  ds_read_b128 v[20:23], v5 offset:32768
  v_mfma_f32_16x16x32_bf16 v[64:67], a[116:119], v[28:31], v[64:67]
  v_mfma_f32_16x16x32_bf16 v[68:71], a[196:199], v[28:31], v[68:71]
  s_waitcnt lgkmcnt(4)
  v_mfma_f32_16x16x32_bf16 v[48:51], a[40:43], v[32:35], v[48:51]
  ds_read_b128 v[24:27], v5 offset:13312
  v_mfma_f32_16x16x32_bf16 v[52:55], a[120:123], v[32:35], v[52:55]
  buffer_load_dwordx4 v[124:127], v2, s[4:7], s14 offen offset:3072 sc1
  v_mfma_f32_16x16x32_bf16 v[56:59], a[200:203], v[32:35], v[56:59]
  v_mfma_f32_16x16x32_bf16 v[60:63], a[40:43], v[36:39], v[60:63]
  ds_read_b128 v[28:31], v5 offset:33792
  v_mfma_f32_16x16x32_bf16 v[64:67], a[120:123], v[36:39], v[64:67]
  v_mfma_f32_16x16x32_bf16 v[68:71], a[200:203], v[36:39], v[68:71]
  s_waitcnt lgkmcnt(4)
  v_mfma_f32_16x16x32_bf16 v[48:51], a[44:47], v[40:43], v[48:51]
  ds_read_b128 v[32:35], v5 offset:14336
  v_mfma_f32_16x16x32_bf16 v[52:55], a[124:127], v[40:43], v[52:55]
  buffer_load_dwordx4 v[144:147], v2, s[4:7], s16 offen offset:0 sc1
  v_mfma_f32_16x16x32_bf16 v[56:59], a[204:207], v[40:43], v[56:59]
  buffer_load_dwordx4 v[148:151], v2, s[4:7], s16 offen offset:1024 sc1
  v_mfma_f32_16x16x32_bf16 v[60:63], a[44:47], v[44:47], v[60:63]
  ds_read_b128 v[36:39], v5 offset:34816
  v_mfma_f32_16x16x32_bf16 v[64:67], a[124:127], v[44:47], v[64:67]
  v_mfma_f32_16x16x32_bf16 v[68:71], a[204:207], v[44:47], v[68:71]
  s_waitcnt lgkmcnt(4)
  v_mfma_f32_16x16x32_bf16 v[48:51], a[48:51], v[16:19], v[48:51]
  ds_read_b128 v[40:43], v5 offset:15360
  v_mfma_f32_16x16x32_bf16 v[52:55], a[128:131], v[16:19], v[52:55]
  buffer_load_dwordx4 v[152:155], v2, s[4:7], s16 offen offset:2048 sc1
  v_mfma_f32_16x16x32_bf16 v[56:59], a[208:211], v[16:19], v[56:59]
  v_mfma_f32_16x16x32_bf16 v[60:63], a[48:51], v[20:23], v[60:63]
  ds_read_b128 v[44:47], v5 offset:35840
  v_mfma_f32_16x16x32_bf16 v[64:67], a[128:131], v[20:23], v[64:67]
  v_mfma_f32_16x16x32_bf16 v[68:71], a[208:211], v[20:23], v[68:71]
  s_waitcnt lgkmcnt(4)
  v_mfma_f32_16x16x32_bf16 v[48:51], a[52:55], v[24:27], v[48:51]
  ds_read_b128 v[16:19], v5 offset:16384
  v_mfma_f32_16x16x32_bf16 v[52:55], a[132:135], v[24:27], v[52:55]
  buffer_load_dwordx4 v[156:159], v2, s[4:7], s16 offen offset:3072 sc1
  v_mfma_f32_16x16x32_bf16 v[56:59], a[212:215], v[24:27], v[56:59]
  buffer_load_dwordx4 v[128:131], v2, s[4:7], s15 offen offset:0 sc1
  v_mfma_f32_16x16x32_bf16 v[60:63], a[52:55], v[28:31], v[60:63]
  ds_read_b128 v[20:23], v5 offset:36864
  v_mfma_f32_16x16x32_bf16 v[64:67], a[132:135], v[28:31], v[64:67]
  v_mfma_f32_16x16x32_bf16 v[68:71], a[212:215], v[28:31], v[68:71]
  s_waitcnt lgkmcnt(4)
  v_mfma_f32_16x16x32_bf16 v[48:51], a[56:59], v[32:35], v[48:51]
  ds_read_b128 v[24:27], v5 offset:17408
  v_mfma_f32_16x16x32_bf16 v[52:55], a[136:139], v[32:35], v[52:55]
  buffer_load_dwordx4 v[132:135], v2, s[4:7], s15 offen offset:1024 sc1
  v_mfma_f32_16x16x32_bf16 v[56:59], a[216:219], v[32:35], v[56:59]
  v_mfma_f32_16x16x32_bf16 v[60:63], a[56:59], v[36:39], v[60:63]
  ds_read_b128 v[28:31], v5 offset:37888
  v_mfma_f32_16x16x32_bf16 v[64:67], a[136:139], v[36:39], v[64:67]
  v_mfma_f32_16x16x32_bf16 v[68:71], a[216:219], v[36:39], v[68:71]
  s_waitcnt lgkmcnt(4)
  v_mfma_f32_16x16x32_bf16 v[48:51], a[60:63], v[40:43], v[48:51]
  ds_read_b128 v[32:35], v5 offset:18432
  v_mfma_f32_16x16x32_bf16 v[52:55], a[140:143], v[40:43], v[52:55]
  buffer_load_dwordx4 v[136:139], v2, s[4:7], s15 offen offset:2048 sc1
  v_mfma_f32_16x16x32_bf16 v[56:59], a[220:223], v[40:43], v[56:59]
  buffer_load_dwordx4 v[140:143], v2, s[4:7], s15 offen offset:3072 sc1
  v_mfma_f32_16x16x32_bf16 v[60:63], a[60:63], v[44:47], v[60:63]
  ds_read_b128 v[36:39], v5 offset:38912
  v_mfma_f32_16x16x32_bf16 v[64:67], a[140:143], v[44:47], v[64:67]
  v_mfma_f32_16x16x32_bf16 v[68:71], a[220:223], v[44:47], v[68:71]
  s_waitcnt lgkmcnt(4)
  v_mfma_f32_16x16x32_bf16 v[48:51], a[64:67], v[16:19], v[48:51]
  ds_read_b128 v[40:43], v5 offset:19456
  v_mfma_f32_16x16x32_bf16 v[52:55], a[144:147], v[16:19], v[52:55]
  s_waitcnt vmcnt(12)
  s_barrier
  v_mfma_f32_16x16x32_bf16 v[56:59], a[224:227], v[16:19], v[56:59]
  v_add_u32 v6, s21, v2
  v_mfma_f32_16x16x32_bf16 v[60:63], a[64:67], v[20:23], v[60:63]
  ds_read_b128 v[44:47], v5 offset:39936
  v_mfma_f32_16x16x32_bf16 v[64:67], a[144:147], v[20:23], v[64:67]
  s_cmp_lt_u32 s26, 64
  s_cbranch_scc1 int_sl23
int_sl23_b:
  s_add_u32 s17, s22, s13
  v_mfma_f32_16x16x32_bf16 v[68:71], a[224:227], v[20:23], v[68:71]
  s_min_u32 s18, s27, 63
  s_mul_i32 s18, s18, 40960
  s_waitcnt lgkmcnt(4)
  v_mfma_f32_16x16x32_bf16 v[48:51], a[68:71], v[24:27], v[48:51]
  ds_read_b128 v[16:19], v6 offset:0
  v_mfma_f32_16x16x32_bf16 v[52:55], a[148:151], v[24:27], v[52:55]
  s_add_u32 s18, s18, s12
  s_add_u32 s27, s27, 1
  s_mov_b32 s23, s20
  v_mfma_f32_16x16x32_bf16 v[56:59], a[228:231], v[24:27], v[56:59]
  s_mov_b32 s20, s21
  s_mov_b32 s21, s22
  s_mov_b32 s22, s23
  v_mfma_f32_16x16x32_bf16 v[60:63], a[68:71], v[28:31], v[60:63]
  ds_read_b128 v[20:23], v6 offset:20480
  v_mfma_f32_16x16x32_bf16 v[64:67], a[148:151], v[28:31], v[64:67]
  s_add_u32 s24, s24, 1
  s_add_u32 m0, s17, 0
  v_mfma_f32_16x16x32_bf16 v[68:71], a[228:231], v[28:31], v[68:71]
  s_waitcnt lgkmcnt(4)
  v_mfma_f32_16x16x32_bf16 v[48:51], a[72:75], v[32:35], v[48:51]
  ds_read_b128 v[24:27], v6 offset:1024
  v_mfma_f32_16x16x32_bf16 v[52:55], a[152:155], v[32:35], v[52:55]
  buffer_load_dwordx4 v2, s[4:7], s18 offen offset:0 sc1 lds
  v_mfma_f32_16x16x32_bf16 v[56:59], a[232:235], v[32:35], v[56:59]
  buffer_load_dwordx4 v2, s[4:7], s18 offen offset:1024 sc1 lds
  v_mfma_f32_16x16x32_bf16 v[60:63], a[72:75], v[36:39], v[60:63]
  ds_read_b128 v[28:31], v6 offset:21504
  v_mfma_f32_16x16x32_bf16 v[64:67], a[152:155], v[36:39], v[64:67]
  v_mfma_f32_16x16x32_bf16 v[68:71], a[232:235], v[36:39], v[68:71]
  s_waitcnt lgkmcnt(4)
  v_mfma_f32_16x16x32_bf16 v[48:51], a[76:79], v[40:43], v[48:51]
  ds_read_b128 v[32:35], v6 offset:2048
  v_mfma_f32_16x16x32_bf16 v[52:55], a[156:159], v[40:43], v[52:55]
  buffer_load_dwordx4 v2, s[4:7], s18 offen offset:2048 sc1 lds
  v_mfma_f32_16x16x32_bf16 v[56:59], a[236:239], v[40:43], v[56:59]
  v_mfma_f32_16x16x32_bf16 v[60:63], a[76:79], v[44:47], v[60:63]
  ds_read_b128 v[36:39], v6 offset:22528
  v_mfma_f32_16x16x32_bf16 v[64:67], a[156:159], v[44:47], v[64:67]
  v_mfma_f32_16x16x32_bf16 v[68:71], a[236:239], v[44:47], v[68:71]
  v_mov_b32 v5, v6
mk_q_even:
  s_waitcnt lgkmcnt(4)
  v_cvt_pk_bf16_f32 v72, v48, v49
  v_cvt_pk_bf16_f32 v73, v50, v51
  v_mfma_f32_16x16x32_bf16 v[48:51], a[0:3], v[16:19], 0
  ds_read_b128 v[40:43], v5 offset:3072
  v_cvt_pk_bf16_f32 v74, v52, v53
  v_cvt_pk_bf16_f32 v75, v54, v55
  v_mfma_f32_16x16x32_bf16 v[52:55], a[80:83], v[16:19], 0
  v_cvt_pk_bf16_f32 v80, v56, v57
  v_cvt_pk_bf16_f32 v81, v58, v59
  v_mfma_f32_16x16x32_bf16 v[56:59], a[160:163], v[16:19], 0
  v_cvt_pk_bf16_f32 v76, v60, v61
  v_cvt_pk_bf16_f32 v77, v62, v63
  v_mfma_f32_16x16x32_bf16 v[60:63], a[0:3], v[20:23], 0
  ds_read_b128 v[44:47], v5 offset:23552
  v_cvt_pk_bf16_f32 v78, v64, v65
  v_cvt_pk_bf16_f32 v79, v66, v67
  v_mfma_f32_16x16x32_bf16 v[64:67], a[80:83], v[20:23], 0
  v_cvt_pk_bf16_f32 v82, v68, v69
  v_cvt_pk_bf16_f32 v83, v70, v71
  v_mfma_f32_16x16x32_bf16 v[68:71], a[160:163], v[20:23], 0
  s_waitcnt lgkmcnt(4)
  v_mfma_f32_16x16x32_bf16 v[48:51], a[4:7], v[24:27], v[48:51]
  ds_read_b128 v[16:19], v5 offset:4096
  v_mfma_f32_16x16x32_bf16 v[52:55], a[84:87], v[24:27], v[52:55]
  buffer_load_dwordx4 v2, s[4:7], s18 offen offset:3072 sc1 lds
  v_mfma_f32_16x16x32_bf16 v[56:59], a[164:167], v[24:27], v[56:59]
  v_add_u32 v4, s35, v3
  v_mfma_f32_16x16x32_bf16 v[60:63], a[4:7], v[28:31], v[60:63]
  ds_read_b128 v[20:23], v5 offset:24576
  v_mfma_f32_16x16x32_bf16 v[64:67], a[84:87], v[28:31], v[64:67]
  s_add_u32 s35, s35, 12288
  s_cmp_eq_u32 s35, 36864
  s_cselect_b32 s35, 0, s35
  v_mfma_f32_16x16x32_bf16 v[68:71], a[164:167], v[28:31], v[68:71]
  s_waitcnt lgkmcnt(4)
  v_mfma_f32_16x16x32_bf16 v[48:51], a[8:11], v[32:35], v[48:51]
  ds_read_b128 v[24:27], v5 offset:5120
  v_mfma_f32_16x16x32_bf16 v[52:55], a[88:91], v[32:35], v[52:55]
  s_add_u32 s18, s18, 4096
  s_add_u32 m0, s17, 4096
  v_mfma_f32_16x16x32_bf16 v[56:59], a[168:171], v[32:35], v[56:59]
  buffer_load_dwordx4 v2, s[4:7], s18 offen offset:0 sc1 lds
  v_mfma_f32_16x16x32_bf16 v[60:63], a[8:11], v[36:39], v[60:63]
  ds_read_b128 v[28:31], v5 offset:25600
  v_mfma_f32_16x16x32_bf16 v[64:67], a[88:91], v[36:39], v[64:67]
  ds_write_b128 v4, v[72:75] offset:0
  v_mfma_f32_16x16x32_bf16 v[68:71], a[168:171], v[36:39], v[68:71]
  s_waitcnt lgkmcnt(4)
  v_mfma_f32_16x16x32_bf16 v[48:51], a[12:15], v[40:43], v[48:51]
  ds_read_b128 v[32:35], v5 offset:6144
  v_mfma_f32_16x16x32_bf16 v[52:55], a[92:95], v[40:43], v[52:55]
  buffer_load_dwordx4 v2, s[4:7], s18 offen offset:1024 sc1 lds
  v_mfma_f32_16x16x32_bf16 v[56:59], a[172:175], v[40:43], v[56:59]
  ds_write_b128 v4, v[76:79] offset:4096
  v_mfma_f32_16x16x32_bf16 v[60:63], a[12:15], v[44:47], v[60:63]
  ds_read_b128 v[36:39], v5 offset:26624
  v_mfma_f32_16x16x32_bf16 v[64:67], a[92:95], v[44:47], v[64:67]
  v_mfma_f32_16x16x32_bf16 v[68:71], a[172:175], v[44:47], v[68:71]
  s_waitcnt lgkmcnt(4)
  v_mfma_f32_16x16x32_bf16 v[48:51], a[16:19], v[16:19], v[48:51]
  ds_read_b128 v[40:43], v5 offset:7168
  v_mfma_f32_16x16x32_bf16 v[52:55], a[96:99], v[16:19], v[52:55]
  buffer_load_dwordx4 v2, s[4:7], s18 offen offset:2048 sc1 lds
  v_mfma_f32_16x16x32_bf16 v[56:59], a[176:179], v[16:19], v[56:59]
  ds_write_b128 v4, v[80:83] offset:8192
  v_mfma_f32_16x16x32_bf16 v[60:63], a[16:19], v[20:23], v[60:63]
  ds_read_b128 v[44:47], v5 offset:27648
  v_mfma_f32_16x16x32_bf16 v[64:67], a[96:99], v[20:23], v[64:67]
  v_mfma_f32_16x16x32_bf16 v[68:71], a[176:179], v[20:23], v[68:71]
  s_waitcnt lgkmcnt(4)
  v_mfma_f32_16x16x32_bf16 v[48:51], a[20:23], v[24:27], v[48:51]
  ds_read_b128 v[16:19], v5 offset:8192
  v_mfma_f32_16x16x32_bf16 v[52:55], a[100:103], v[24:27], v[52:55]
  buffer_load_dwordx4 v2, s[4:7], s18 offen offset:3072 sc1 lds
  v_mfma_f32_16x16x32_bf16 v[56:59], a[180:183], v[24:27], v[56:59]
  v_mfma_f32_16x16x32_bf16 v[60:63], a[20:23], v[28:31], v[60:63]
  ds_read_b128 v[20:23], v5 offset:28672
  v_mfma_f32_16x16x32_bf16 v[64:67], a[100:103], v[28:31], v[64:67]
  v_mfma_f32_16x16x32_bf16 v[68:71], a[180:183], v[28:31], v[68:71]
  s_waitcnt lgkmcnt(4)
  v_mfma_f32_16x16x32_bf16 v[48:51], a[24:27], v[32:35], v[48:51]
  ds_read_b128 v[24:27], v5 offset:9216
  v_mfma_f32_16x16x32_bf16 v[52:55], a[104:107], v[32:35], v[52:55]
  s_add_u32 s18, s18, 4096
  s_add_u32 m0, s17, 8192
  v_mfma_f32_16x16x32_bf16 v[56:59], a[184:187], v[32:35], v[56:59]
  buffer_load_dwordx4 v2, s[4:7], s18 offen offset:0 sc1 lds
  v_mfma_f32_16x16x32_bf16 v[60:63], a[24:27], v[36:39], v[60:63]
  ds_read_b128 v[28:31], v5 offset:29696
  v_mfma_f32_16x16x32_bf16 v[64:67], a[104:107], v[36:39], v[64:67]
  v_mfma_f32_16x16x32_bf16 v[68:71], a[184:187], v[36:39], v[68:71]
  s_waitcnt lgkmcnt(4)
  v_mfma_f32_16x16x32_bf16 v[48:51], a[28:31], v[40:43], v[48:51]
  ds_read_b128 v[32:35], v5 offset:10240
  v_mfma_f32_16x16x32_bf16 v[52:55], a[108:111], v[40:43], v[52:55]
  buffer_load_dwordx4 v2, s[4:7], s18 offen offset:1024 sc1 lds
  v_mfma_f32_16x16x32_bf16 v[56:59], a[188:191], v[40:43], v[56:59]
  v_mfma_f32_16x16x32_bf16 v[60:63], a[28:31], v[44:47], v[60:63]
  ds_read_b128 v[36:39], v5 offset:30720
  v_mfma_f32_16x16x32_bf16 v[64:67], a[108:111], v[44:47], v[64:67]
  v_mfma_f32_16x16x32_bf16 v[68:71], a[188:191], v[44:47], v[68:71]
  s_waitcnt lgkmcnt(4)
  v_mfma_f32_16x16x32_bf16 v[48:51], a[32:35], v[16:19], v[48:51]
  ds_read_b128 v[40:43], v5 offset:11264
  v_mfma_f32_16x16x32_bf16 v[52:55], a[112:115], v[16:19], v[52:55]
  v_mov_b32 v197, 0
  v_mfma_f32_16x16x32_bf16 v[56:59], a[192:195], v[16:19], v[56:59]
  buffer_atomic_or v197, v211, s[4:7], s43 offen sc0 sc1
  v_mfma_f32_16x16x32_bf16 v[60:63], a[32:35], v[20:23], v[60:63]
  ds_read_b128 v[44:47], v5 offset:31744
  v_mfma_f32_16x16x32_bf16 v[64:67], a[112:115], v[20:23], v[64:67]
  v_mfma_f32_16x16x32_bf16 v[68:71], a[192:195], v[20:23], v[68:71]
  s_waitcnt lgkmcnt(4)
  v_mfma_f32_16x16x32_bf16 v[48:51], a[36:39], v[24:27], v[48:51]
  ds_read_b128 v[16:19], v5 offset:12288
  v_mfma_f32_16x16x32_bf16 v[52:55], a[116:119], v[24:27], v[52:55]
  v_mfma_f32_16x16x32_bf16 v[56:59], a[196:199], v[24:27], v[56:59]
  v_mfma_f32_16x16x32_bf16 v[60:63], a[36:39], v[28:31], v[60:63]
  ds_read_b128 v[20:23], v5 offset:32768
  v_mfma_f32_16x16x32_bf16 v[64:67], a[116:119], v[28:31], v[64:67]
  v_mfma_f32_16x16x32_bf16 v[68:71], a[196:199], v[28:31], v[68:71]
  s_waitcnt lgkmcnt(4)
  v_mfma_f32_16x16x32_bf16 v[48:51], a[40:43], v[32:35], v[48:51]
  ds_read_b128 v[24:27], v5 offset:13312
  v_mfma_f32_16x16x32_bf16 v[52:55], a[120:123], v[32:35], v[52:55]
  v_mfma_f32_16x16x32_bf16 v[56:59], a[200:203], v[32:35], v[56:59]
  v_mfma_f32_16x16x32_bf16 v[60:63], a[40:43], v[36:39], v[60:63]
  ds_read_b128 v[28:31], v5 offset:33792
  v_mfma_f32_16x16x32_bf16 v[64:67], a[120:123], v[36:39], v[64:67]
  v_mfma_f32_16x16x32_bf16 v[68:71], a[200:203], v[36:39], v[68:71]
  s_waitcnt lgkmcnt(4)
  v_mfma_f32_16x16x32_bf16 v[48:51], a[44:47], v[40:43], v[48:51]
  ds_read_b128 v[32:35], v5 offset:14336
  v_mfma_f32_16x16x32_bf16 v[52:55], a[124:127], v[40:43], v[52:55]
  v_mfma_f32_16x16x32_bf16 v[56:59], a[204:207], v[40:43], v[56:59]
  v_mfma_f32_16x16x32_bf16 v[60:63], a[44:47], v[44:47], v[60:63]
  ds_read_b128 v[36:39], v5 offset:34816
  v_mfma_f32_16x16x32_bf16 v[64:67], a[124:127], v[44:47], v[64:67]
  v_mfma_f32_16x16x32_bf16 v[68:71], a[204:207], v[44:47], v[68:71]
  s_waitcnt lgkmcnt(4)
  v_mfma_f32_16x16x32_bf16 v[48:51], a[48:51], v[16:19], v[48:51]
  ds_read_b128 v[40:43], v5 offset:15360
  v_mfma_f32_16x16x32_bf16 v[52:55], a[128:131], v[16:19], v[52:55]
  v_mfma_f32_16x16x32_bf16 v[56:59], a[208:211], v[16:19], v[56:59]
  v_mfma_f32_16x16x32_bf16 v[60:63], a[48:51], v[20:23], v[60:63]
  ds_read_b128 v[44:47], v5 offset:35840
  v_mfma_f32_16x16x32_bf16 v[64:67], a[128:131], v[20:23], v[64:67]
  v_mfma_f32_16x16x32_bf16 v[68:71], a[208:211], v[20:23], v[68:71]
  s_waitcnt lgkmcnt(4)
  v_mfma_f32_16x16x32_bf16 v[48:51], a[52:55], v[24:27], v[48:51]
  ds_read_b128 v[16:19], v5 offset:16384
  v_mfma_f32_16x16x32_bf16 v[52:55], a[132:135], v[24:27], v[52:55]
  v_mfma_f32_16x16x32_bf16 v[56:59], a[212:215], v[24:27], v[56:59]
  v_mfma_f32_16x16x32_bf16 v[60:63], a[52:55], v[28:31], v[60:63]
  ds_read_b128 v[20:23], v5 offset:36864
  v_mfma_f32_16x16x32_bf16 v[64:67], a[132:135], v[28:31], v[64:67]
  v_mfma_f32_16x16x32_bf16 v[68:71], a[212:215], v[28:31], v[68:71]
  s_waitcnt lgkmcnt(4)
  v_mfma_f32_16x16x32_bf16 v[48:51], a[56:59], v[32:35], v[48:51]
  ds_read_b128 v[24:27], v5 offset:17408
  v_mfma_f32_16x16x32_bf16 v[52:55], a[136:139], v[32:35], v[52:55]
  v_mfma_f32_16x16x32_bf16 v[56:59], a[216:219], v[32:35], v[56:59]
  v_mfma_f32_16x16x32_bf16 v[60:63], a[56:59], v[36:39], v[60:63]
  ds_read_b128 v[28:31], v5 offset:37888
  v_mfma_f32_16x16x32_bf16 v[64:67], a[136:139], v[36:39], v[64:67]
  v_mfma_f32_16x16x32_bf16 v[68:71], a[216:219], v[36:39], v[68:71]
  s_waitcnt lgkmcnt(4)
  v_mfma_f32_16x16x32_bf16 v[48:51], a[60:63], v[40:43], v[48:51]
  ds_read_b128 v[32:35], v5 offset:18432
  v_mfma_f32_16x16x32_bf16 v[52:55], a[140:143], v[40:43], v[52:55]
  v_mfma_f32_16x16x32_bf16 v[56:59], a[220:223], v[40:43], v[56:59]
  v_mfma_f32_16x16x32_bf16 v[60:63], a[60:63], v[44:47], v[60:63]
  ds_read_b128 v[36:39], v5 offset:38912
  v_mfma_f32_16x16x32_bf16 v[64:67], a[140:143], v[44:47], v[64:67]
  v_mfma_f32_16x16x32_bf16 v[68:71], a[220:223], v[44:47], v[68:71]
  s_waitcnt lgkmcnt(4)
  v_mfma_f32_16x16x32_bf16 v[48:51], a[64:67], v[16:19], v[48:51]
  ds_read_b128 v[40:43], v5 offset:19456
  v_mfma_f32_16x16x32_bf16 v[52:55], a[144:147], v[16:19], v[52:55]
  s_waitcnt vmcnt(0)
  s_barrier
  v_mfma_f32_16x16x32_bf16 v[56:59], a[224:227], v[16:19], v[56:59]
  v_add_u32 v6, s21, v2
  v_mfma_f32_16x16x32_bf16 v[60:63], a[64:67], v[20:23], v[60:63]
  ds_read_b128 v[44:47], v5 offset:39936
  v_mfma_f32_16x16x32_bf16 v[64:67], a[144:147], v[20:23], v[64:67]
  v_cmp_eq_u32 vcc, -1, v197
  v_mfma_f32_16x16x32_bf16 v[68:71], a[224:227], v[20:23], v[68:71]
  s_mov_b32 s19, 1
  s_add_u32 s38, s38, 1
  s_waitcnt lgkmcnt(4)
  v_mfma_f32_16x16x32_bf16 v[48:51], a[68:71], v[24:27], v[48:51]
  ds_read_b128 v[16:19], v6 offset:0
  v_mfma_f32_16x16x32_bf16 v[52:55], a[148:151], v[24:27], v[52:55]
  s_nop 0
  s_cbranch_vccz int_sl25
int_sl25_b:
  s_cmp_lt_u32 s26, 64
  s_cbranch_scc1 int_sl26
int_sl26_b:
  v_mfma_f32_16x16x32_bf16 v[56:59], a[228:231], v[24:27], v[56:59]
  s_add_u32 s17, s22, s13
  s_min_u32 s18, s27, 63
  s_mul_i32 s18, s18, 40960
  v_mfma_f32_16x16x32_bf16 v[60:63], a[68:71], v[28:31], v[60:63]
  ds_read_b128 v[20:23], v6 offset:20480
  v_mfma_f32_16x16x32_bf16 v[64:67], a[148:151], v[28:31], v[64:67]
  s_add_u32 s18, s18, s12
  s_add_u32 s27, s27, 1
  s_mov_b32 s23, s20
  v_mfma_f32_16x16x32_bf16 v[68:71], a[228:231], v[28:31], v[68:71]
  s_mov_b32 s20, s21
  s_mov_b32 s21, s22
  s_waitcnt lgkmcnt(4)
  v_mfma_f32_16x16x32_bf16 v[48:51], a[72:75], v[32:35], v[48:51]
  ds_read_b128 v[24:27], v6 offset:1024
  v_mfma_f32_16x16x32_bf16 v[52:55], a[152:155], v[32:35], v[52:55]
  s_mov_b32 s22, s23
  s_add_u32 s24, s24, 1
  s_add_u32 m0, s17, 0
  v_mfma_f32_16x16x32_bf16 v[56:59], a[232:235], v[32:35], v[56:59]
  buffer_load_dwordx4 v2, s[4:7], s18 offen offset:0 sc1 lds
  v_mfma_f32_16x16x32_bf16 v[60:63], a[72:75], v[36:39], v[60:63]
  ds_read_b128 v[28:31], v6 offset:21504
  v_mfma_f32_16x16x32_bf16 v[64:67], a[152:155], v[36:39], v[64:67]
  buffer_load_dwordx4 v2, s[4:7], s18 offen offset:1024 sc1 lds
  v_mfma_f32_16x16x32_bf16 v[68:71], a[232:235], v[36:39], v[68:71]
  s_waitcnt lgkmcnt(4)
  v_mfma_f32_16x16x32_bf16 v[48:51], a[76:79], v[40:43], v[48:51]
  ds_read_b128 v[32:35], v6 offset:2048
  v_mfma_f32_16x16x32_bf16 v[52:55], a[156:159], v[40:43], v[52:55]
  buffer_load_dwordx4 v2, s[4:7], s18 offen offset:2048 sc1 lds
  v_mfma_f32_16x16x32_bf16 v[56:59], a[236:239], v[40:43], v[56:59]
  v_mfma_f32_16x16x32_bf16 v[60:63], a[76:79], v[44:47], v[60:63]
  ds_read_b128 v[36:39], v6 offset:22528
  v_mfma_f32_16x16x32_bf16 v[64:67], a[156:159], v[44:47], v[64:67]
  v_mfma_f32_16x16x32_bf16 v[68:71], a[236:239], v[44:47], v[68:71]
  v_mov_b32 v5, v6
  s_cmp_eq_u32 s38, 1
  s_cbranch_scc1 mk_q_loop
  s_and_b32 s15, s3, 1
  s_lshl_b32 s16, s15, 12
  s_add_u32 s16, s16, s37
  s_add_u32 s16, s16, 122880
  v_add_u32 v212, s16, v2
  s_lshl_b32 s16, s15, 3
  s_add_u32 s16, s16, s37
  s_add_u32 s16, s16, 131072
  v_add_u32 v213, s16, v2
  v_add_u32 v214, 2048, v213
  ds_read_b128 v[88:91], v212 offset:0
  ds_read_b128 v[92:95], v212 offset:1024
  ds_read_b128 v[96:99], v212 offset:2048
  ds_read_b128 v[100:103], v212 offset:3072
  ds_read2_b64 v[104:107], v213 offset0:0 offset1:128
  ds_read2_b64 v[108:111], v214 offset0:0 offset1:128
  s_sub_u32 s37, s37, 12288
  s_cselect_b32 s37, 24576, s37
  s_mov_b32 s70, 0
  s_cmp_eq_u32 s19, 1
  s_cbranch_scc1 int_sl28
int_sl28_b:
  v_swap_b32 v146, v148
  v_swap_b32 v147, v149
  v_swap_b32 v154, v156
  v_swap_b32 v155, v157
  s_waitcnt lgkmcnt(0)
  v_mfma_f32_16x16x32_bf16 v[184:187], v[112:115], v[88:91], 0
  v_mfma_f32_16x16x32_bf16 v[188:191], v[128:131], v[88:91], 0
  v_mfma_f32_16x16x32_bf16 v[184:187], v[116:119], v[92:95], v[184:187]
  v_mfma_f32_16x16x32_bf16 v[188:191], v[132:135], v[92:95], v[188:191]
  v_mfma_f32_16x16x32_bf16 v[184:187], v[120:123], v[96:99], v[184:187]
  v_mfma_f32_16x16x32_bf16 v[188:191], v[136:139], v[96:99], v[188:191]
  v_mfma_f32_16x16x32_bf16 v[184:187], v[124:127], v[100:103], v[184:187]
  v_mfma_f32_16x16x32_bf16 v[188:191], v[140:143], v[100:103], v[188:191]
  v_mfma_f32_16x16x32_bf16 v[184:187], v[144:147], v[104:107], v[184:187]
  v_mfma_f32_16x16x32_bf16 v[188:191], v[148:151], v[104:107], v[188:191]
  v_mfma_f32_16x16x32_bf16 v[184:187], v[152:155], v[108:111], v[184:187]
  v_mfma_f32_16x16x32_bf16 v[188:191], v[156:159], v[108:111], v[188:191]
  s_nop 6
  v_cndmask_b32 v184, v208, v184, s[48:49]
  v_cndmask_b32 v188, v208, v188, s[56:57]
  v_cndmask_b32 v185, v208, v185, s[50:51]
  v_cndmask_b32 v189, v208, v189, s[58:59]
  v_cndmask_b32 v186, v208, v186, s[52:53]
  v_cndmask_b32 v190, v208, v190, s[60:61]
  v_cndmask_b32 v187, v208, v187, s[54:55]
  v_cndmask_b32 v191, v208, v191, s[62:63]
  v_max3_f32 v196, v184, v185, v186
  v_max3_f32 v196, v196, v187, v188
  v_max3_f32 v196, v196, v189, v190
  s_cmp_eq_u32 s19, 1
  s_cbranch_scc1 mk_q_p1
  s_waitcnt vmcnt(3)
  s_branch mk_q_p3
mk_q_p0:
  v_mov_b32 v197, 0
  buffer_atomic_or v197, v211, s[4:7], s43 offen sc0 sc1
mk_q_p1:
  s_waitcnt vmcnt(0)
  v_cmp_eq_u32 vcc, -1, v197
  s_nop 0
  s_cbranch_vccz mk_q_p2
mk_q_pr:
  s_sleep 2
  s_add_u32 s70, s70, 1
  s_cmp_lt_u32 s70, 262144
  s_cbranch_scc1 mk_q_p0
  s_branch mk_fail
mk_q_p2:
  buffer_load_dwordx4 v[160:163], v209, s[4:7], s43 offen offset:0 sc1
  buffer_load_dwordx4 v[164:167], v209, s[4:7], s43 offen offset:512 sc1
  buffer_load_dwordx4 v[168:171], v209, s[4:7], s43 offen offset:1024 sc1
  buffer_load_dwordx4 v[172:175], v209, s[4:7], s43 offen offset:1536 sc1
  buffer_load_dwordx4 v[176:179], v209, s[4:7], s43 offen offset:2048 sc1
  buffer_load_dwordx4 v[180:183], v209, s[4:7], s43 offen offset:2560 sc1
  s_waitcnt vmcnt(0)
mk_q_p3:
  s_add_u32 s15, s14, s33
  s_add_u32 s16, s14, s34
  v_mfma_f32_16x16x32_bf16 v[192:195], v[160:163], v[88:91], 0
  v_mfma_f32_16x16x32_bf16 v[192:195], v[164:167], v[92:95], v[192:195]
  v_mfma_f32_16x16x32_bf16 v[192:195], v[168:171], v[96:99], v[192:195]
  v_mfma_f32_16x16x32_bf16 v[192:195], v[172:175], v[100:103], v[192:195]
  v_mfma_f32_16x16x32_bf16 v[192:195], v[176:179], v[104:107], v[192:195]
  v_mfma_f32_16x16x32_bf16 v[192:195], v[180:183], v[108:111], v[192:195]
  s_nop 7
  v_maximum3_f32 v197, v192, v193, v194
  v_maximum3_f32 v197, v197, v195, v191
  v_cmp_u_f32 vcc, v197, v197
  s_nop 0
  s_cbranch_vccnz mk_q_pr
  v_max_f32 v196, v196, v197
  v_mov_b32 v197, v196
  s_nop 1
  v_permlane16_swap_b32 v196, v197
  v_max_f32 v196, v196, v197
  v_mov_b32 v197, v196
  s_nop 1
  v_permlane32_swap_b32 v196, v197
  v_max_f32 v196, v196, v197
  v_mul_f32 v196, s42, v196
  v_fma_f32 v184, v184, s42, -v196
  v_fma_f32 v185, v185, s42, -v196
  v_fma_f32 v186, v186, s42, -v196
  v_fma_f32 v187, v187, s42, -v196
  v_fma_f32 v188, v188, s42, -v196
  v_fma_f32 v189, v189, s42, -v196
  v_fma_f32 v190, v190, s42, -v196
  v_fma_f32 v191, v191, s42, -v196
  v_fma_f32 v192, v192, s42, -v196
  v_fma_f32 v193, v193, s42, -v196
  v_fma_f32 v194, v194, s42, -v196
  v_fma_f32 v195, v195, s42, -v196
  v_exp_f32 v184, v184
  v_exp_f32 v185, v185
  v_exp_f32 v186, v186
  v_exp_f32 v187, v187
  v_exp_f32 v188, v188
  v_exp_f32 v189, v189
  v_exp_f32 v190, v190
  v_exp_f32 v191, v191
  v_exp_f32 v192, v192
  v_exp_f32 v193, v193
  v_exp_f32 v194, v194
  v_exp_f32 v195, v195
  s_nop 0
  v_pk_add_f32 v[196:197], v[192:193], v[194:195]
  v_pk_mul_f32 v[196:197], v[196:197], 0.5 op_sel_hi:[1,0]
  v_pk_add_f32 v[196:197], v[196:197], v[184:185]
  v_pk_add_f32 v[196:197], v[196:197], v[186:187]
  v_pk_add_f32 v[196:197], v[196:197], v[188:189]
  v_pk_add_f32 v[196:197], v[196:197], v[190:191]
  v_add_f32 v196, v196, v197
  v_mov_b32 v197, v196
  s_nop 1
  v_permlane16_swap_b32 v196, v197
  v_add_f32 v196, v196, v197
  v_mov_b32 v197, v196
  s_nop 1
  v_permlane32_swap_b32 v196, v197
  v_add_f32 v196, v196, v197
  v_rcp_f32 v196, v196
  s_nop 0
  v_pk_mul_f32 v[184:185], v[184:185], v[196:197] op_sel_hi:[1,0]
  v_cvt_pk_bf16_f32 v200, v184, v185
  v_pk_mul_f32 v[186:187], v[186:187], v[196:197] op_sel_hi:[1,0]
  v_cvt_pk_bf16_f32 v201, v186, v187
  v_pk_mul_f32 v[188:189], v[188:189], v[196:197] op_sel_hi:[1,0]
  v_cvt_pk_bf16_f32 v202, v188, v189
  v_pk_mul_f32 v[190:191], v[190:191], v[196:197] op_sel_hi:[1,0]
  v_cvt_pk_bf16_f32 v203, v190, v191
  v_pk_mul_f32 v[192:193], v[192:193], v[196:197] op_sel_hi:[1,0]
  v_cvt_pk_bf16_f32 v204, v192, v193
  v_pk_mul_f32 v[194:195], v[194:195], v[196:197] op_sel_hi:[1,0]
  v_cvt_pk_bf16_f32 v205, v194, v195
  v_mov_b32 v206, v204
  v_mov_b32 v207, v205
  v_permlane16_swap_b32 v200, v202
  v_permlane16_swap_b32 v201, v203
  v_permlane16_swap_b32 v204, v206
  v_permlane16_swap_b32 v205, v207
  buffer_store_dwordx4 v[200:203], v216, s[4:7], s15 offen sc1
  buffer_store_dwordx4 v[204:207], v210, s[4:7], s16 offen sc1
  s_add_u32 s36, s36, 2
  s_cmp_lt_u32 s38, 33
  s_cbranch_scc1 mk_q_loop
  s_waitcnt vmcnt(0) lgkmcnt(0)
mk_s2:
  s_load_dwordx2 s[48:49], s[0:1], 80
  s_mov_b32 s50, 0xc8000
  s_mov_b32 s51, 0x20000
  s_load_dwordx2 s[52:53], s[0:1], 88
  s_mov_b32 s54, 0x280000
  s_mov_b32 s55, 0x20000
  s_sub_u32 s12, s74, 2
  s_lshl_b32 s12, s12, 5
  s_add_u32 s12, s12, s75
  s_cmp_ge_u32 s12, 60
  s_cbranch_scc1 mk_s2_done
  s_mul_hi_u32 s13, s12, 0x33333334
  s_mul_i32 s14, s13, 5
  s_sub_u32 s14, s12, s14
  s_lshl_b32 s14, s14, 2
  s_add_u32 s14, s14, s3
  v_lshlrev_b32 v2, 4, v1
  v_lshrrev_b32 v3, 2, v1
  v_mul_u32_u24 v3, 1280, v3
  v_and_b32 v4, 3, v1
  v_lshl_add_u32 v3, v4, 4, v3
  s_lshl_b32 s15, s14, 6
  s_mul_i32 s16, s3, 40960
  s_mov_b32 s17, 0
  s_waitcnt lgkmcnt(0)
  s_barrier
  s_mov_b32 m0, s16
mk_s2_w:
  s_nop 0
  buffer_load_dwordx4 v3, s[48:51], s15 offen lds
  s_add_u32 s15, s15, 20480
  s_add_u32 m0, m0, 1024
  s_nop 0
  buffer_load_dwordx4 v3, s[48:51], s15 offen lds
  s_add_u32 s15, s15, 20480
  s_add_u32 m0, m0, 1024
  s_nop 0
  buffer_load_dwordx4 v3, s[48:51], s15 offen lds
  s_add_u32 s15, s15, 20480
  s_add_u32 m0, m0, 1024
  s_nop 0
  buffer_load_dwordx4 v3, s[48:51], s15 offen lds
  s_add_u32 s15, s15, 20480
  s_add_u32 m0, m0, 1024
  s_add_u32 s17, s17, 1
  s_cmp_lt_u32 s17, 10
  s_cbranch_scc1 mk_s2_w
  v_add_u32 v5, s16, v2
  v_lshrrev_b32 v6, 4, v1
  v_mul_u32_u24 v6, 2304, v6
  v_add_u32 v6, v6, v5
  v_lshrrev_b32 v7, 4, v1
  v_lshl_add_u32 v7, v7, 8, v2
  v_lshlrev_b32 v8, 10, v1
  v_lshlrev_b32 v9, 8, v1
  v_add_u32 v9, 24576, v9
  v_cmp_lt_u32 vcc, 31, v1
  s_nop 1
  v_cndmask_b32 v8, v8, v9, vcc
  v_add_u32 v9, 20480, v2
  v_and_b32 v10, 15, v1
  v_mul_u32_u24 v10, 1280, v10
  v_lshrrev_b32 v11, 4, v1
  v_lshl_add_u32 v10, v11, 4, v10
  s_lshl_b32 s15, s66, 6
  s_add_u32 s15, s15, s13
  s_mul_i32 s18, s15, 40960
  s_add_u32 s18, s18, 47185920
  s_lshl_b32 s15, s66, 7
  s_add_u32 s15, s15, s13
  s_mul_i32 s19, s15, 40960
  s_lshl_b32 s15, s14, 10
  s_add_u32 s19, s19, s15
  s_add_u32 s19, s19, 28835840
  s_mul_i32 s20, s13, 40960
  s_lshl_b32 s15, s14, 6
  s_add_u32 s20, s20, s15
  s_mul_i32 s21, s3, 10240
  s_mov_b32 s23, 0xffff0000
  s_waitcnt vmcnt(0)
  ds_read_b64_tr_b16 v[96:97], v5 offset:0
  ds_read_b64_tr_b16 v[98:99], v5 offset:1280
  ds_read_b64_tr_b16 v[100:101], v5 offset:8
  ds_read_b64_tr_b16 v[102:103], v5 offset:1288
  ds_read_b64_tr_b16 v[104:105], v5 offset:2560
  ds_read_b64_tr_b16 v[106:107], v5 offset:3840
  ds_read_b64_tr_b16 v[108:109], v5 offset:2568
  ds_read_b64_tr_b16 v[110:111], v5 offset:3848
  ds_read_b64_tr_b16 v[112:113], v5 offset:5120
  ds_read_b64_tr_b16 v[114:115], v5 offset:6400
  ds_read_b64_tr_b16 v[116:117], v5 offset:5128
  ds_read_b64_tr_b16 v[118:119], v5 offset:6408
  ds_read_b64_tr_b16 v[120:121], v5 offset:7680
  ds_read_b64_tr_b16 v[122:123], v5 offset:8960
  ds_read_b64_tr_b16 v[124:125], v5 offset:7688
  ds_read_b64_tr_b16 v[126:127], v5 offset:8968
  ds_read_b64_tr_b16 v[128:129], v5 offset:10240
  ds_read_b64_tr_b16 v[130:131], v5 offset:11520
  ds_read_b64_tr_b16 v[132:133], v5 offset:10248
  ds_read_b64_tr_b16 v[134:135], v5 offset:11528
  ds_read_b64_tr_b16 v[136:137], v5 offset:12800
  ds_read_b64_tr_b16 v[138:139], v5 offset:14080
  ds_read_b64_tr_b16 v[140:141], v5 offset:12808
  ds_read_b64_tr_b16 v[142:143], v5 offset:14088
  ds_read_b64_tr_b16 v[144:145], v5 offset:15360
  ds_read_b64_tr_b16 v[146:147], v5 offset:16640
  ds_read_b64_tr_b16 v[148:149], v5 offset:15368
  ds_read_b64_tr_b16 v[150:151], v5 offset:16648
  ds_read_b64_tr_b16 v[152:153], v5 offset:17920
  ds_read_b64_tr_b16 v[154:155], v5 offset:19200
  ds_read_b64_tr_b16 v[156:157], v5 offset:17928
  ds_read_b64_tr_b16 v[158:159], v5 offset:19208
  ds_read_b64_tr_b16 v[160:161], v5 offset:20480
  ds_read_b64_tr_b16 v[162:163], v5 offset:21760
  ds_read_b64_tr_b16 v[164:165], v5 offset:20488
  ds_read_b64_tr_b16 v[166:167], v5 offset:21768
  ds_read_b64_tr_b16 v[168:169], v5 offset:23040
  ds_read_b64_tr_b16 v[170:171], v5 offset:24320
  ds_read_b64_tr_b16 v[172:173], v5 offset:23048
  ds_read_b64_tr_b16 v[174:175], v5 offset:24328
  ds_read_b64_tr_b16 v[176:177], v5 offset:25600
  ds_read_b64_tr_b16 v[178:179], v5 offset:26880
  ds_read_b64_tr_b16 v[180:181], v5 offset:25608
  ds_read_b64_tr_b16 v[182:183], v5 offset:26888
  ds_read_b64_tr_b16 v[184:185], v5 offset:28160
  ds_read_b64_tr_b16 v[186:187], v5 offset:29440
  ds_read_b64_tr_b16 v[188:189], v5 offset:28168
  ds_read_b64_tr_b16 v[190:191], v5 offset:29448
  ds_read_b64_tr_b16 v[192:193], v5 offset:30720
  ds_read_b64_tr_b16 v[194:195], v5 offset:32000
  ds_read_b64_tr_b16 v[196:197], v5 offset:30728
  ds_read_b64_tr_b16 v[198:199], v5 offset:32008
  ds_read_b64_tr_b16 v[200:201], v5 offset:33280
  ds_read_b64_tr_b16 v[202:203], v5 offset:34560
  ds_read_b64_tr_b16 v[204:205], v5 offset:33288
  ds_read_b64_tr_b16 v[206:207], v5 offset:34568
  ds_read_b64_tr_b16 v[208:209], v5 offset:35840
  ds_read_b64_tr_b16 v[210:211], v5 offset:37120
  ds_read_b64_tr_b16 v[212:213], v5 offset:35848
  ds_read_b64_tr_b16 v[214:215], v5 offset:37128
  ds_read_b64_tr_b16 v[216:217], v5 offset:38400
  ds_read_b64_tr_b16 v[218:219], v5 offset:39680
  ds_read_b64_tr_b16 v[220:221], v5 offset:38408
  ds_read_b64_tr_b16 v[222:223], v5 offset:39688
  ds_read_b64_tr_b16 v[224:225], v6 offset:1024
  ds_read_b64_tr_b16 v[226:227], v6 offset:2304
  ds_read_b64_tr_b16 v[228:229], v6 offset:1032
  ds_read_b64_tr_b16 v[230:231], v6 offset:2312
  ds_read_b64_tr_b16 v[232:233], v6 offset:11264
  ds_read_b64_tr_b16 v[234:235], v6 offset:12544
  ds_read_b64_tr_b16 v[236:237], v6 offset:11272
  ds_read_b64_tr_b16 v[238:239], v6 offset:12552
  ds_read_b64_tr_b16 v[240:241], v6 offset:21504
  ds_read_b64_tr_b16 v[242:243], v6 offset:22784
  ds_read_b64_tr_b16 v[244:245], v6 offset:21512
  ds_read_b64_tr_b16 v[246:247], v6 offset:22792
  ds_read_b64_tr_b16 v[248:249], v6 offset:31744
  ds_read_b64_tr_b16 v[250:251], v6 offset:33024
  ds_read_b64_tr_b16 v[252:253], v6 offset:31752
  ds_read_b64_tr_b16 v[254:255], v6 offset:33032
  s_waitcnt lgkmcnt(0)
  s_barrier
  s_mov_b32 s24, 0
  s_mov_b32 s25, 40960
  s_mov_b32 s26, 81920
  s_mov_b32 s70, 0
int_s229:
  buffer_load_dword v11, v8, s[4:7], s18 offen sc1
  s_waitcnt vmcnt(0)
  v_cmp_eq_u32 vcc, -1, v11
  s_nop 0
  s_cbranch_vccz int_s229_ok
  s_sleep 1
  s_add_u32 s70, s70, 1
  s_cmp_lt_u32 s70, 262144
  s_cbranch_scc1 int_s229
  s_branch mk_fail
int_s229_ok:
  s_add_u32 s15, s18, s21
  s_add_u32 m0, s24, s21
  s_nop 0
  buffer_load_dwordx4 v2, s[4:7], s15 offen offset:0 sc1 lds
  buffer_load_dwordx4 v2, s[4:7], s15 offen offset:1024 sc1 lds
  buffer_load_dwordx4 v2, s[4:7], s15 offen offset:2048 sc1 lds
  buffer_load_dwordx4 v2, s[4:7], s15 offen offset:3072 sc1 lds
  s_add_u32 s15, s15, 4096
  s_add_u32 m0, m0, 4096
  s_nop 0
  buffer_load_dwordx4 v2, s[4:7], s15 offen offset:0 sc1 lds
  buffer_load_dwordx4 v2, s[4:7], s15 offen offset:1024 sc1 lds
  buffer_load_dwordx4 v2, s[4:7], s15 offen offset:2048 sc1 lds
  buffer_load_dwordx4 v2, s[4:7], s15 offen offset:3072 sc1 lds
  s_add_u32 s15, s15, 4096
  s_add_u32 m0, m0, 4096
  s_nop 0
  buffer_load_dwordx4 v2, s[4:7], s15 offen offset:0 sc1 lds
  buffer_load_dwordx4 v2, s[4:7], s15 offen offset:1024 sc1 lds
mk_s2_loop:
  buffer_load_dwordx4 v[64:67], v2, s[4:7], s19 offen sc1
  buffer_load_dwordx4 v[68:71], v9, s[4:7], s19 offen sc1
  s_mov_b32 s27, s18
  s_add_u32 s18, s18, 491520
  s_add_u32 s13, s13, 12
  s_cmp_ge_u32 s13, 64
  s_cbranch_scc1 mk_s2_l1
  s_mov_b32 s70, 0
int_s230:
  buffer_load_dword v11, v8, s[4:7], s18 offen sc1
  s_waitcnt vmcnt(0)
  v_cmp_eq_u32 vcc, -1, v11
  s_nop 0
  s_cbranch_vccz int_s230_ok
  s_sleep 1
  s_add_u32 s70, s70, 1
  s_cmp_lt_u32 s70, 262144
  s_cbranch_scc1 int_s230
  s_branch mk_fail
int_s230_ok:
  s_add_u32 s15, s18, s21
  s_add_u32 m0, s25, s21
  s_nop 0
  buffer_load_dwordx4 v2, s[4:7], s15 offen offset:0 sc1 lds
  buffer_load_dwordx4 v2, s[4:7], s15 offen offset:1024 sc1 lds
  buffer_load_dwordx4 v2, s[4:7], s15 offen offset:2048 sc1 lds
  buffer_load_dwordx4 v2, s[4:7], s15 offen offset:3072 sc1 lds
  s_add_u32 s15, s15, 4096
  s_add_u32 m0, m0, 4096
  s_nop 0
  buffer_load_dwordx4 v2, s[4:7], s15 offen offset:0 sc1 lds
  buffer_load_dwordx4 v2, s[4:7], s15 offen offset:1024 sc1 lds
  buffer_load_dwordx4 v2, s[4:7], s15 offen offset:2048 sc1 lds
  buffer_load_dwordx4 v2, s[4:7], s15 offen offset:3072 sc1 lds
  s_add_u32 s15, s15, 4096
  s_add_u32 m0, m0, 4096
  s_nop 0
  buffer_load_dwordx4 v2, s[4:7], s15 offen offset:0 sc1 lds
  buffer_load_dwordx4 v2, s[4:7], s15 offen offset:1024 sc1 lds
  s_branch mk_s2_l2
mk_s2_re:
  s_add_u32 s70, s70, 1
  s_cmp_lt_u32 s70, 262144
  s_cbranch_scc0 mk_fail
  s_barrier
  s_add_u32 s15, s27, s21
  s_add_u32 m0, s24, s21
  s_nop 0
  buffer_load_dwordx4 v2, s[4:7], s15 offen offset:0 sc1 lds
  buffer_load_dwordx4 v2, s[4:7], s15 offen offset:1024 sc1 lds
  buffer_load_dwordx4 v2, s[4:7], s15 offen offset:2048 sc1 lds
  buffer_load_dwordx4 v2, s[4:7], s15 offen offset:3072 sc1 lds
  s_add_u32 s15, s15, 4096
  s_add_u32 m0, m0, 4096
  s_nop 0
  buffer_load_dwordx4 v2, s[4:7], s15 offen offset:0 sc1 lds
  buffer_load_dwordx4 v2, s[4:7], s15 offen offset:1024 sc1 lds
  buffer_load_dwordx4 v2, s[4:7], s15 offen offset:2048 sc1 lds
  buffer_load_dwordx4 v2, s[4:7], s15 offen offset:3072 sc1 lds
  s_add_u32 s15, s15, 4096
  s_add_u32 m0, m0, 4096
  s_nop 0
  buffer_load_dwordx4 v2, s[4:7], s15 offen offset:0 sc1 lds
  buffer_load_dwordx4 v2, s[4:7], s15 offen offset:1024 sc1 lds
mk_s2_l1:
  s_waitcnt vmcnt(0)
mk_s2_l2:
  s_barrier
  v_add_u32 v12, s24, v2
  v_add_u32 v13, s24, v7
  v_add_u32 v14, 8, v12
  ds_read2st64_b64 v[16:19], v12 offset0:0 offset1:2
  ds_read2st64_b64 v[20:23], v14 offset0:0 offset1:2
  ds_read2st64_b64 v[24:27], v12 offset0:4 offset1:6
  ds_read2st64_b64 v[28:31], v14 offset0:4 offset1:6
  ds_read2st64_b64 v[32:35], v12 offset0:8 offset1:10
  ds_read2st64_b64 v[36:39], v14 offset0:8 offset1:10
  s_waitcnt lgkmcnt(4)
  v_mfma_f32_16x16x32_bf16 v[48:51], v[96:99], v[16:19], 0
  ds_read2st64_b64 v[40:43], v12 offset0:12 offset1:14
  v_mfma_f32_16x16x32_bf16 v[52:55], v[100:103], v[16:19], 0
  v_mfma_f32_16x16x32_bf16 v[56:59], v[96:99], v[20:23], 0
  ds_read2st64_b64 v[44:47], v14 offset0:12 offset1:14
  v_mfma_f32_16x16x32_bf16 v[60:63], v[100:103], v[20:23], 0
  s_waitcnt lgkmcnt(4)
  v_mfma_f32_16x16x32_bf16 v[48:51], v[104:107], v[24:27], v[48:51]
  ds_read2st64_b64 v[16:19], v12 offset0:16 offset1:18
  v_mfma_f32_16x16x32_bf16 v[52:55], v[108:111], v[24:27], v[52:55]
  v_mfma_f32_16x16x32_bf16 v[56:59], v[104:107], v[28:31], v[56:59]
  ds_read2st64_b64 v[20:23], v14 offset0:16 offset1:18
  v_mfma_f32_16x16x32_bf16 v[60:63], v[108:111], v[28:31], v[60:63]
  s_waitcnt lgkmcnt(4)
  v_mfma_f32_16x16x32_bf16 v[48:51], v[112:115], v[32:35], v[48:51]
  ds_read2st64_b64 v[24:27], v12 offset0:20 offset1:22
  v_mfma_f32_16x16x32_bf16 v[52:55], v[116:119], v[32:35], v[52:55]
  v_mfma_f32_16x16x32_bf16 v[56:59], v[112:115], v[36:39], v[56:59]
  ds_read2st64_b64 v[28:31], v14 offset0:20 offset1:22
  v_mfma_f32_16x16x32_bf16 v[60:63], v[116:119], v[36:39], v[60:63]
  s_waitcnt lgkmcnt(4)
  v_mfma_f32_16x16x32_bf16 v[48:51], v[120:123], v[40:43], v[48:51]
  ds_read2st64_b64 v[32:35], v12 offset0:24 offset1:26
  v_mfma_f32_16x16x32_bf16 v[52:55], v[124:127], v[40:43], v[52:55]
  v_mfma_f32_16x16x32_bf16 v[56:59], v[120:123], v[44:47], v[56:59]
  ds_read2st64_b64 v[36:39], v14 offset0:24 offset1:26
  v_mfma_f32_16x16x32_bf16 v[60:63], v[124:127], v[44:47], v[60:63]
  s_waitcnt lgkmcnt(4)
  v_mfma_f32_16x16x32_bf16 v[48:51], v[128:131], v[16:19], v[48:51]
  ds_read2st64_b64 v[40:43], v12 offset0:28 offset1:30
  v_mfma_f32_16x16x32_bf16 v[52:55], v[132:135], v[16:19], v[52:55]
  v_mfma_f32_16x16x32_bf16 v[56:59], v[128:131], v[20:23], v[56:59]
  ds_read2st64_b64 v[44:47], v14 offset0:28 offset1:30
  v_mfma_f32_16x16x32_bf16 v[60:63], v[132:135], v[20:23], v[60:63]
  s_waitcnt lgkmcnt(4)
  v_mfma_f32_16x16x32_bf16 v[48:51], v[136:139], v[24:27], v[48:51]
  ds_read2st64_b64 v[16:19], v12 offset0:32 offset1:34
  v_mfma_f32_16x16x32_bf16 v[52:55], v[140:143], v[24:27], v[52:55]
  v_mfma_f32_16x16x32_bf16 v[56:59], v[136:139], v[28:31], v[56:59]
  ds_read2st64_b64 v[20:23], v14 offset0:32 offset1:34
  v_mfma_f32_16x16x32_bf16 v[60:63], v[140:143], v[28:31], v[60:63]
  s_waitcnt lgkmcnt(4)
  v_mfma_f32_16x16x32_bf16 v[48:51], v[144:147], v[32:35], v[48:51]
  ds_read2st64_b64 v[24:27], v12 offset0:36 offset1:38
  v_mfma_f32_16x16x32_bf16 v[52:55], v[148:151], v[32:35], v[52:55]
  v_mfma_f32_16x16x32_bf16 v[56:59], v[144:147], v[36:39], v[56:59]
  ds_read2st64_b64 v[28:31], v14 offset0:36 offset1:38
  v_mfma_f32_16x16x32_bf16 v[60:63], v[148:151], v[36:39], v[60:63]
  s_waitcnt lgkmcnt(4)
  v_mfma_f32_16x16x32_bf16 v[48:51], v[152:155], v[40:43], v[48:51]
  ds_read2st64_b64 v[32:35], v12 offset0:40 offset1:42
  v_mfma_f32_16x16x32_bf16 v[52:55], v[156:159], v[40:43], v[52:55]
  v_mfma_f32_16x16x32_bf16 v[56:59], v[152:155], v[44:47], v[56:59]
  ds_read2st64_b64 v[36:39], v14 offset0:40 offset1:42
  v_mfma_f32_16x16x32_bf16 v[60:63], v[156:159], v[44:47], v[60:63]
  s_waitcnt lgkmcnt(4)
  v_mfma_f32_16x16x32_bf16 v[48:51], v[160:163], v[16:19], v[48:51]
  ds_read2st64_b64 v[40:43], v12 offset0:44 offset1:46
  v_mfma_f32_16x16x32_bf16 v[52:55], v[164:167], v[16:19], v[52:55]
  v_mfma_f32_16x16x32_bf16 v[56:59], v[160:163], v[20:23], v[56:59]
  ds_read2st64_b64 v[44:47], v14 offset0:44 offset1:46
  v_mfma_f32_16x16x32_bf16 v[60:63], v[164:167], v[20:23], v[60:63]
  s_waitcnt lgkmcnt(4)
  v_mfma_f32_16x16x32_bf16 v[48:51], v[168:171], v[24:27], v[48:51]
  ds_read2st64_b64 v[16:19], v12 offset0:48 offset1:50
  v_mfma_f32_16x16x32_bf16 v[52:55], v[172:175], v[24:27], v[52:55]
  v_mfma_f32_16x16x32_bf16 v[56:59], v[168:171], v[28:31], v[56:59]
  ds_read2st64_b64 v[20:23], v14 offset0:48 offset1:50
  v_mfma_f32_16x16x32_bf16 v[60:63], v[172:175], v[28:31], v[60:63]
  s_waitcnt lgkmcnt(4)
  v_mfma_f32_16x16x32_bf16 v[48:51], v[176:179], v[32:35], v[48:51]
  ds_read2st64_b64 v[24:27], v12 offset0:52 offset1:54
  v_mfma_f32_16x16x32_bf16 v[52:55], v[180:183], v[32:35], v[52:55]
  v_mfma_f32_16x16x32_bf16 v[56:59], v[176:179], v[36:39], v[56:59]
  ds_read2st64_b64 v[28:31], v14 offset0:52 offset1:54
  v_mfma_f32_16x16x32_bf16 v[60:63], v[180:183], v[36:39], v[60:63]
  s_waitcnt lgkmcnt(4)
  v_mfma_f32_16x16x32_bf16 v[48:51], v[184:187], v[40:43], v[48:51]
  ds_read2st64_b64 v[32:35], v12 offset0:56 offset1:58
  v_mfma_f32_16x16x32_bf16 v[52:55], v[188:191], v[40:43], v[52:55]
  v_mfma_f32_16x16x32_bf16 v[56:59], v[184:187], v[44:47], v[56:59]
  ds_read2st64_b64 v[36:39], v14 offset0:56 offset1:58
  v_mfma_f32_16x16x32_bf16 v[60:63], v[188:191], v[44:47], v[60:63]
  s_waitcnt lgkmcnt(4)
  v_mfma_f32_16x16x32_bf16 v[48:51], v[192:195], v[16:19], v[48:51]
  ds_read2st64_b64 v[40:43], v12 offset0:60 offset1:62
  v_mfma_f32_16x16x32_bf16 v[52:55], v[196:199], v[16:19], v[52:55]
  v_mfma_f32_16x16x32_bf16 v[56:59], v[192:195], v[20:23], v[56:59]
  ds_read2st64_b64 v[44:47], v14 offset0:60 offset1:62
  v_mfma_f32_16x16x32_bf16 v[60:63], v[196:199], v[20:23], v[60:63]
  s_waitcnt lgkmcnt(4)
  v_mfma_f32_16x16x32_bf16 v[48:51], v[200:203], v[24:27], v[48:51]
  ds_read_b64 v[16:17], v13 offset:32768
  ds_read_b64 v[18:19], v13 offset:33024
  v_mfma_f32_16x16x32_bf16 v[52:55], v[204:207], v[24:27], v[52:55]
  v_mfma_f32_16x16x32_bf16 v[56:59], v[200:203], v[28:31], v[56:59]
  ds_read_b64 v[20:21], v13 offset:32776
  ds_read_b64 v[22:23], v13 offset:33032
  v_mfma_f32_16x16x32_bf16 v[60:63], v[204:207], v[28:31], v[60:63]
  s_waitcnt lgkmcnt(6)
  v_mfma_f32_16x16x32_bf16 v[48:51], v[208:211], v[32:35], v[48:51]
  ds_read_b64 v[24:25], v13 offset:34816
  ds_read_b64 v[26:27], v13 offset:35072
  v_mfma_f32_16x16x32_bf16 v[52:55], v[212:215], v[32:35], v[52:55]
  v_mfma_f32_16x16x32_bf16 v[56:59], v[208:211], v[36:39], v[56:59]
  ds_read_b64 v[28:29], v13 offset:34824
  ds_read_b64 v[30:31], v13 offset:35080
  v_mfma_f32_16x16x32_bf16 v[60:63], v[212:215], v[36:39], v[60:63]
  s_waitcnt lgkmcnt(8)
  v_mfma_f32_16x16x32_bf16 v[48:51], v[216:219], v[40:43], v[48:51]
  ds_read_b64 v[32:33], v13 offset:36864
  ds_read_b64 v[34:35], v13 offset:37120
  v_mfma_f32_16x16x32_bf16 v[52:55], v[220:223], v[40:43], v[52:55]
  v_mfma_f32_16x16x32_bf16 v[56:59], v[216:219], v[44:47], v[56:59]
  ds_read_b64 v[36:37], v13 offset:36872
  ds_read_b64 v[38:39], v13 offset:37128
  v_mfma_f32_16x16x32_bf16 v[60:63], v[220:223], v[44:47], v[60:63]
  s_waitcnt lgkmcnt(8)
  v_mfma_f32_16x16x32_bf16 v[48:51], v[224:227], v[16:19], v[48:51]
  ds_read_b64 v[40:41], v13 offset:38912
  ds_read_b64 v[42:43], v13 offset:39168
  v_mfma_f32_16x16x32_bf16 v[52:55], v[228:231], v[16:19], v[52:55]
  v_mfma_f32_16x16x32_bf16 v[56:59], v[224:227], v[20:23], v[56:59]
  ds_read_b64 v[44:45], v13 offset:38920
  ds_read_b64 v[46:47], v13 offset:39176
  v_mfma_f32_16x16x32_bf16 v[60:63], v[228:231], v[20:23], v[60:63]
  s_waitcnt lgkmcnt(8)
  v_mfma_f32_16x16x32_bf16 v[48:51], v[232:235], v[24:27], v[48:51]
  v_mfma_f32_16x16x32_bf16 v[52:55], v[236:239], v[24:27], v[52:55]
  v_mfma_f32_16x16x32_bf16 v[56:59], v[232:235], v[28:31], v[56:59]
  v_mfma_f32_16x16x32_bf16 v[60:63], v[236:239], v[28:31], v[60:63]
  s_waitcnt lgkmcnt(4)
  v_mfma_f32_16x16x32_bf16 v[48:51], v[240:243], v[32:35], v[48:51]
  v_mfma_f32_16x16x32_bf16 v[52:55], v[244:247], v[32:35], v[52:55]
  v_mfma_f32_16x16x32_bf16 v[56:59], v[240:243], v[36:39], v[56:59]
  v_mfma_f32_16x16x32_bf16 v[60:63], v[244:247], v[36:39], v[60:63]
  s_waitcnt lgkmcnt(0)
  v_mfma_f32_16x16x32_bf16 v[48:51], v[248:251], v[40:43], v[48:51]
  v_mfma_f32_16x16x32_bf16 v[52:55], v[252:255], v[40:43], v[52:55]
  v_mfma_f32_16x16x32_bf16 v[56:59], v[248:251], v[44:47], v[56:59]
  v_mfma_f32_16x16x32_bf16 v[60:63], v[252:255], v[44:47], v[60:63]
  s_nop 6
  v_cmp_u_f32 vcc, v48, v56
  s_nop 0
  s_cbranch_vccnz mk_s2_re
  v_lshlrev_b32 v16, 16, v64
  v_and_b32 v17, s23, v64
  v_pk_add_f32 v[48:49], v[48:49], v[16:17]
  v_cvt_pk_bf16_f32 v72, v48, v49
  v_lshlrev_b32 v16, 16, v65
  v_and_b32 v17, s23, v65
  v_pk_add_f32 v[50:51], v[50:51], v[16:17]
  v_cvt_pk_bf16_f32 v73, v50, v51
  v_lshlrev_b32 v16, 16, v66
  v_and_b32 v17, s23, v66
  v_pk_add_f32 v[52:53], v[52:53], v[16:17]
  v_cvt_pk_bf16_f32 v74, v52, v53
  v_lshlrev_b32 v16, 16, v67
  v_and_b32 v17, s23, v67
  v_pk_add_f32 v[54:55], v[54:55], v[16:17]
  v_cvt_pk_bf16_f32 v75, v54, v55
  v_lshlrev_b32 v16, 16, v68
  v_and_b32 v17, s23, v68
  v_pk_add_f32 v[56:57], v[56:57], v[16:17]
  v_cvt_pk_bf16_f32 v76, v56, v57
  v_lshlrev_b32 v16, 16, v69
  v_and_b32 v17, s23, v69
  v_pk_add_f32 v[58:59], v[58:59], v[16:17]
  v_cvt_pk_bf16_f32 v77, v58, v59
  v_lshlrev_b32 v16, 16, v70
  v_and_b32 v17, s23, v70
  v_pk_add_f32 v[60:61], v[60:61], v[16:17]
  v_cvt_pk_bf16_f32 v78, v60, v61
  v_lshlrev_b32 v16, 16, v71
  v_and_b32 v17, s23, v71
  v_pk_add_f32 v[62:63], v[62:63], v[16:17]
  v_cvt_pk_bf16_f32 v79, v62, v63
  s_cmp_eq_u32 s66, 1
  s_cbranch_scc1 mk_s2_fin
  s_add_u32 s15, s19, 2621440
  buffer_store_dwordx4 v[72:75], v2, s[4:7], s15 offen sc1
  buffer_store_dwordx4 v[76:79], v9, s[4:7], s15 offen sc1
  s_branch mk_s2_nx
mk_s2_fin:
  s_add_u32 s15, s20, 20480
  buffer_store_dwordx4 v[72:75], v10, s[52:55], s20 offen
  buffer_store_dwordx4 v[76:79], v10, s[52:55], s15 offen
mk_s2_nx:
  s_add_u32 s19, s19, 491520
  s_add_u32 s20, s20, 491520
  s_mov_b32 s15, s24
  s_mov_b32 s24, s25
  s_mov_b32 s25, s26
  s_mov_b32 s26, s15
  s_cmp_lt_u32 s13, 64
  s_cbranch_scc1 mk_s2_loop
mk_s2_done:
  s_add_u32 s66, s66, 1
  s_cmp_ge_u32 s66, 2
  s_cbranch_scc1 mk_end
  s_waitcnt lgkmcnt(0)
  s_barrier
  s_cmp_eq_u32 s74, 2
  s_cbranch_scc1 mk_qrole
  s_branch mk_u_entry
int_sl6:
  s_lshr_b32 s68, s72, 1
  s_bitcmp1_b64 s[64:65], s68
  s_cselect_b32 s68, 0x2000, 0
  s_lshl_b32 s19, s72, 20
  s_add_u32 s19, s19, s68
  s_add_u32 s19, s19, s39
  s_add_u32 s19, s19, 970752
  s_cmp_ge_u32 s32, s29
  s_cbranch_scc1 int_wm7_ok
  s_mov_b32 s70, 0
int_wm7:
  buffer_load_dword v10, v9, s[4:7], s19 offen sc1
  s_waitcnt vmcnt(0)
  v_min_u32_dpp v10, v10, v10 quad_perm:[1,0,3,2] row_mask:0xf bank_mask:0xf
  s_nop 1
  v_min_u32_dpp v10, v10, v10 quad_perm:[2,3,0,1] row_mask:0xf bank_mask:0xf
  s_nop 1
  v_min_u32_dpp v10, v10, v10 row_half_mirror row_mask:0xf bank_mask:0xf
  s_nop 1
  v_min_u32_dpp v10, v10, v10 row_mirror row_mask:0xf bank_mask:0xf
  v_mov_b32 v11, v10
  s_nop 1
  v_permlane16_swap_b32 v10, v11
  v_min_u32 v10, v10, v11
  v_mov_b32 v11, v10
  s_nop 1
  v_permlane32_swap_b32 v10, v11
  v_min_u32 v10, v10, v11
  s_nop 0
  v_readfirstlane_b32 s32, v10
  s_nop 0
  s_cmp_ge_u32 s32, s29
  s_cbranch_scc1 int_wm7_ok
  s_sleep 8
  s_add_u32 s70, s70, 1
  s_cmp_lt_u32 s70, 262144
  s_cbranch_scc1 int_wm7
  s_branch mk_fail
int_wm7_ok:
  s_branch int_sl6_b
int_sl8:
  s_cmp_ge_u32 s26, 64
  s_cbranch_scc1 int_hn9_ok
  s_mov_b32 s70, 0
  s_branch int_hn9_a
int_hn9:
  s_lshl_b32 s29, s26, 7
  s_add_u32 s29, s29, 64909312
  buffer_load_dword v8, v7, s[4:7], s29 offen sc1
  s_waitcnt vmcnt(0)
int_hn9_a:
  v_cmp_gt_u32 vcc, s28, v8
  s_nop 0
  s_ff1_i32_b64 s29, vcc
  s_min_u32 s29, s29, 64
  s_lshr_b32 s29, s29, 3
  s_add_u32 s26, s26, s29
  s_min_u32 s29, s27, 63
  s_cmp_gt_u32 s26, s29
  s_cbranch_scc1 int_hn9_g
  s_sleep 1
  s_add_u32 s70, s70, 1
  s_cmp_lt_u32 s70, 262144
  s_cbranch_scc1 int_hn9
  s_branch mk_fail
int_hn9_g:
  s_lshl_b32 s29, s26, 7
  s_add_u32 s29, s29, 64909312
  buffer_load_dword v8, v7, s[4:7], s29 offen sc1
int_hn9_ok:
  s_branch int_sl8_b
int_sl12:
  s_cmp_ge_u32 s22, s23
  s_cbranch_scc1 int_wm13_ok
  s_mov_b32 s70, 0
int_wm13:
  buffer_load_dword v8, v7, s[4:7], s20 offen sc1
  s_waitcnt vmcnt(0)
  v_min_u32_dpp v8, v8, v8 quad_perm:[1,0,3,2] row_mask:0xf bank_mask:0xf
  s_nop 1
  v_min_u32_dpp v8, v8, v8 quad_perm:[2,3,0,1] row_mask:0xf bank_mask:0xf
  s_nop 0
  v_readfirstlane_b32 s22, v8
  s_nop 0
  s_cmp_ge_u32 s22, s23
  s_cbranch_scc1 int_wm13_ok
  s_sleep 1
  s_add_u32 s70, s70, 1
  s_cmp_lt_u32 s70, 262144
  s_cbranch_scc1 int_wm13
  s_branch mk_fail
int_wm13_ok:
  s_branch int_sl12_b
int_sl14:
  s_cmp_ge_u32 s22, s23
  s_cbranch_scc1 int_wm15_ok
  s_mov_b32 s70, 0
int_wm15:
  buffer_load_dword v8, v7, s[4:7], s20 offen sc1
  s_waitcnt vmcnt(0)
  v_min_u32_dpp v8, v8, v8 quad_perm:[1,0,3,2] row_mask:0xf bank_mask:0xf
  s_nop 1
  v_min_u32_dpp v8, v8, v8 quad_perm:[2,3,0,1] row_mask:0xf bank_mask:0xf
  s_nop 0
  v_readfirstlane_b32 s22, v8
  s_nop 0
  s_cmp_ge_u32 s22, s23
  s_cbranch_scc1 int_wm15_ok
  s_sleep 1
  s_add_u32 s70, s70, 1
  s_cmp_lt_u32 s70, 262144
  s_cbranch_scc1 int_wm15
  s_branch mk_fail
int_wm15_ok:
  s_branch int_sl14_b
int_sl16:
  s_cmp_ge_u32 s22, s23
  s_cbranch_scc1 int_wm17_ok
  s_mov_b32 s70, 0
int_wm17:
  buffer_load_dword v8, v7, s[4:7], s20 offen sc1
  s_waitcnt vmcnt(0)
  v_min_u32_dpp v8, v8, v8 quad_perm:[1,0,3,2] row_mask:0xf bank_mask:0xf
  s_nop 1
  v_min_u32_dpp v8, v8, v8 quad_perm:[2,3,0,1] row_mask:0xf bank_mask:0xf
  s_nop 0
  v_readfirstlane_b32 s22, v8
  s_nop 0
  s_cmp_ge_u32 s22, s23
  s_cbranch_scc1 int_wm17_ok
  s_sleep 1
  s_add_u32 s70, s70, 1
  s_cmp_lt_u32 s70, 262144
  s_cbranch_scc1 int_wm17
  s_branch mk_fail
int_wm17_ok:
  s_branch int_sl16_b
int_sl21:
  s_cmp_ge_u32 s32, s29
  s_cbranch_scc1 int_wm22_ok
  s_mov_b32 s70, 0
int_wm22:
  buffer_load_dword v10, v215, s[4:7], s25 offen sc1
  s_waitcnt vmcnt(0)
  v_min_u32_dpp v10, v10, v10 quad_perm:[1,0,3,2] row_mask:0xf bank_mask:0xf
  s_nop 1
  v_min_u32_dpp v10, v10, v10 quad_perm:[2,3,0,1] row_mask:0xf bank_mask:0xf
  s_nop 0
  v_readfirstlane_b32 s32, v10
  s_nop 0
  s_cmp_ge_u32 s32, s29
  s_cbranch_scc1 int_wm22_ok
  s_sleep 1
  s_add_u32 s70, s70, 1
  s_cmp_lt_u32 s70, 262144
  s_cbranch_scc1 int_wm22
  s_branch mk_fail
int_wm22_ok:
  s_branch int_sl21_b
int_sl23:
  s_cmp_ge_u32 s26, 64
  s_cbranch_scc1 int_hn24_ok
  s_mov_b32 s70, 0
  s_branch int_hn24_a
int_hn24:
  s_lshl_b32 s29, s26, 7
  s_add_u32 s29, s29, 64909312
  buffer_load_dword v8, v7, s[4:7], s29 offen sc1
  s_waitcnt vmcnt(0)
int_hn24_a:
  v_cmp_gt_u32 vcc, s28, v8
  s_nop 0
  s_ff1_i32_b64 s29, vcc
  s_min_u32 s29, s29, 64
  s_lshr_b32 s29, s29, 3
  s_add_u32 s26, s26, s29
  s_min_u32 s29, s27, 63
  s_cmp_gt_u32 s26, s29
  s_cbranch_scc1 int_hn24_g
  s_sleep 1
  s_add_u32 s70, s70, 1
  s_cmp_lt_u32 s70, 262144
  s_cbranch_scc1 int_hn24
  s_branch mk_fail
int_hn24_g:
  s_lshl_b32 s29, s26, 7
  s_add_u32 s29, s29, 64909312
  buffer_load_dword v8, v7, s[4:7], s29 offen sc1
int_hn24_ok:
  s_branch int_sl23_b
int_sl25:
  buffer_load_dwordx4 v[160:163], v209, s[4:7], s43 offen offset:0 sc1
  buffer_load_dwordx4 v[164:167], v209, s[4:7], s43 offen offset:512 sc1
  buffer_load_dwordx4 v[168:171], v209, s[4:7], s43 offen offset:1024 sc1
  buffer_load_dwordx4 v[172:175], v209, s[4:7], s43 offen offset:1536 sc1
  buffer_load_dwordx4 v[176:179], v209, s[4:7], s43 offen offset:2048 sc1
  buffer_load_dwordx4 v[180:183], v209, s[4:7], s43 offen offset:2560 sc1
  s_mov_b32 s19, 2
  s_branch int_sl25_b
int_sl26:
  s_cmp_ge_u32 s26, 64
  s_cbranch_scc1 int_hn27_ok
  s_mov_b32 s70, 0
  s_branch int_hn27_a
int_hn27:
  s_lshl_b32 s29, s26, 7
  s_add_u32 s29, s29, 64909312
  buffer_load_dword v8, v7, s[4:7], s29 offen sc1
  s_waitcnt vmcnt(0)
int_hn27_a:
  v_cmp_gt_u32 vcc, s28, v8
  s_nop 0
  s_ff1_i32_b64 s29, vcc
  s_min_u32 s29, s29, 64
  s_lshr_b32 s29, s29, 3
  s_add_u32 s26, s26, s29
  s_min_u32 s29, s27, 63
  s_cmp_gt_u32 s26, s29
  s_cbranch_scc1 int_hn27_g
  s_sleep 1
  s_add_u32 s70, s70, 1
  s_cmp_lt_u32 s70, 262144
  s_cbranch_scc1 int_hn27
  s_branch mk_fail
int_hn27_g:
  s_lshl_b32 s29, s26, 7
  s_add_u32 s29, s29, 64909312
  buffer_load_dword v8, v7, s[4:7], s29 offen sc1
int_hn27_ok:
  s_branch int_sl26_b
int_sl28:
  v_mov_b32 v197, 0
  buffer_atomic_or v197, v211, s[4:7], s43 offen sc0 sc1
  s_branch int_sl28_b
mk_redo:
  s_cmp_lg_u32 s67, 0
  s_cbranch_scc1 mk_fail
  s_waitcnt vmcnt(0) lgkmcnt(0)
  s_barrier
  v_mov_b32 v250, 0
  s_cmp_lg_u32 s3, 0
  s_cbranch_scc1 mk_redo1
  s_mov_b64 exec, 1
  ds_write_b32 v250, v255
  s_mov_b64 exec, -1
  s_waitcnt lgkmcnt(0)
mk_redo1:
  s_barrier
  ds_read_b32 v251, v250
  s_waitcnt lgkmcnt(0)
  v_readfirstlane_b32 s9, v251
  s_nop 0
  s_bfe_u32 s9, s9, 0x50008
  s_mov_b32 s67, 64
  s_barrier
  s_branch mk_start
mk_fail:
  s_mov_b64 exec, 1
  s_lshl_b32 s68, s8, 8
  s_add_u32 s68, s68, s9
  s_add_u32 s68, s68, 0x10000
  v_mov_b32 v24, s68
  buffer_store_dword v24, off, s[44:47], 0 offset:192
mk_end:
  s_endpgm
mk_rec:
  s_load_dwordx2 s[92:93], s[0:1], 16
  s_mov_b32 s94, 0x780000
  s_mov_b32 s95, 0x20000
  s_load_dwordx2 s[96:97], s[0:1], 24
  s_mov_b32 s98, 0x780000
  s_mov_b32 s99, 0x20000
  s_load_dwordx2 s[84:85], s[0:1], 32
  s_mov_b32 s86, 0x780000
  s_mov_b32 s87, 0x20000
  s_load_dwordx2 s[80:81], s[0:1], 40
  s_mov_b32 s82, 0x780000
  s_mov_b32 s83, 0x20000
  s_lshl_b32 s25, s8, 5
  s_add_u32 s25, s25, s9
  v_lshlrev_b32 v2, 4, v1
  s_cmp_lt_u32 s9, 16
  s_cselect_b32 s26, s3, 0
  s_cmp_lg_u32 s26, 3
  s_cbranch_scc1 mk_nopr
  s_lshl_b32 s26, s8, 4
  s_add_u32 s26, s26, s9
  s_lshl_b32 s27, s26, 21
  s_add_u32 s27, s27, s39
  s_add_u32 s27, s27, 1032192
  s_mov_b64 exec, 1
  s_mov_b32 s28, -1
  s_mov_b32 s29, -1
  s_mov_b32 s30, 0
mk_pr:
  s_memtime s[32:33]
  s_waitcnt lgkmcnt(0)
  buffer_store_dword v2, off, s[4:7], s27 sc1
  s_waitcnt vmcnt(0)
  s_memtime s[34:35]
  s_waitcnt lgkmcnt(0)
  s_sub_u32 s34, s34, s32
  s_min_u32 s28, s28, s34
  s_add_u32 s27, s27, 8192
  s_memtime s[32:33]
  s_waitcnt lgkmcnt(0)
  buffer_store_dword v2, off, s[4:7], s27 sc1
  s_waitcnt vmcnt(0)
  s_memtime s[34:35]
  s_waitcnt lgkmcnt(0)
  s_sub_u32 s34, s34, s32
  s_min_u32 s29, s29, s34
  s_sub_u32 s27, s27, 8192
  s_add_u32 s30, s30, 1
  s_cmp_lt_u32 s30, 3
  s_cbranch_scc1 mk_pr
  s_cmp_lt_u32 s29, s28
  s_cselect_b32 s28, 1, 0
  v_mov_b32 v3, s28
  s_lshl_b32 s26, s26, 2
  s_add_u32 s26, s26, 64946176
  buffer_store_dword v3, off, s[4:7], s26 sc1
  s_mov_b64 exec, -1
mk_nopr:
  s_cmp_lt_u32 s9, 16
  s_cbranch_scc0 mk_nopb
  s_barrier
mk_nopb:
  v_mov_b32 v8, -1
  v_mov_b32 v12, 0
  v_mov_b32 v9, -1
  v_mov_b32 v13, 0
  v_mov_b32 v10, -1
  v_mov_b32 v14, 0
  v_mov_b32 v11, -1
  v_mov_b32 v15, 0
  s_lshl_b32 s26, s25, 2
  s_add_u32 s26, s26, s3
  s_mul_i32 s26, s26, 5120
  s_add_u32 s26, s26, 31457280
  s_add_u32 s27, s26, 4096
  buffer_store_dwordx4 v[8:11], v2, s[4:7], s26 offen offset:0 sc1
  buffer_store_dwordx4 v[8:11], v2, s[4:7], s26 offen offset:1024 sc1
  buffer_store_dwordx4 v[8:11], v2, s[4:7], s26 offen offset:2048 sc1
  buffer_store_dwordx4 v[8:11], v2, s[4:7], s26 offen offset:3072 sc1
  buffer_store_dwordx4 v[8:11], v2, s[4:7], s27 offen offset:0 sc1
  s_mul_i32 s26, s25, 7168
  s_lshl_b32 s27, s3, 11
  s_add_u32 s26, s26, s27
  s_add_u32 s26, s26, 63963136
  buffer_store_dwordx4 v[8:11], v2, s[4:7], s26 offen sc1
  s_cmp_eq_u32 s3, 3
  s_cbranch_scc1 mk_in1
  buffer_store_dwordx4 v[8:11], v2, s[4:7], s26 offen offset:1024 sc1
  s_branch mk_in2
mk_in1:
  s_lshl_b32 s26, s25, 10
  s_cmp_lt_u32 s25, 28
  s_cselect_b32 s27, 0, 8192
  s_add_u32 s26, s26, s27
  s_add_u32 s26, s26, 64880640
  s_cmp_lt_u32 s25, 44
  s_cselect_b32 s26, s26, 1073741824
  buffer_store_dwordx4 v[12:15], v2, s[4:7], s26 offen sc1
  s_lshl_b32 s26, s8, 20
  s_lshl_b32 s27, s9, 7
  s_add_u32 s26, s26, s27
  s_add_u32 s26, s26, s39
  s_add_u32 s26, s26, 970752
  v_lshlrev_b32 v3, 13, v1
  s_mov_b64 exec, 3
  buffer_store_dword v12, v3, s[4:7], s26 offen sc1
  s_mov_b64 exec, -1
mk_in2:
  s_waitcnt lgkmcnt(0)
  s_and_b32 s12, s9, 3
  s_lshl_b32 s13, s8, 2
  s_add_u32 s13, s13, s12
  s_and_b32 s14, s9, 4
  s_add_u32 s14, s14, s3
  s_lshr_b32 s16, s9, 3
  s_mov_b32 s20, -1
  s_mov_b32 s21, 0x0fffffff
  s_mul_i32 s10, s13, 491520
  s_mul_i32 s11, s14, 160
  s_add_u32 s10, s10, s11
  s_mul_i32 s11, s3, 15360
  v_mul_u32_u24 v6, 6554, v1
  v_lshrrev_b32 v6, 16, v6
  v_mul_u32_u24 v4, 10, v6
  v_sub_u32 v4, v1, v4
  v_lshlrev_b32 v4, 4, v4
  v_mul_u32_u24 v6, 1280, v6
  v_add_u32 v4, v4, v6
  v_lshrrev_b32 v6, 4, v1
  v_mul_u32_u24 v6, 8, v6
  v_bfe_u32 v5, v1, 2, 2
  v_add_u32 v6, v6, v5
  v_mul_u32_u24 v6, 160, v6
  v_and_b32 v5, 3, v1
  v_lshl_add_u32 v5, v5, 3, v6
  v_add_u32 v5, s11, v5
  s_mov_b64 exec, s[20:21]
  s_add_u32 m0, s11, 0
  s_nop 0
  buffer_load_dwordx4 v4, s[80:83], s10 offen lds
  s_add_u32 s10, s10, 7680
  s_add_u32 m0, s11, 960
  s_nop 0
  buffer_load_dwordx4 v4, s[80:83], s10 offen lds
  s_add_u32 s10, s10, 7680
  s_add_u32 m0, s11, 1920
  s_nop 0
  buffer_load_dwordx4 v4, s[80:83], s10 offen lds
  s_add_u32 s10, s10, 7680
  s_add_u32 m0, s11, 2880
  s_nop 0
  buffer_load_dwordx4 v4, s[80:83], s10 offen lds
  s_add_u32 s10, s10, 7680
  s_add_u32 m0, s11, 3840
  s_nop 0
  buffer_load_dwordx4 v4, s[80:83], s10 offen lds
  s_add_u32 s10, s10, 7680
  s_add_u32 m0, s11, 4800
  s_nop 0
  buffer_load_dwordx4 v4, s[80:83], s10 offen lds
  s_add_u32 s10, s10, 7680
  s_add_u32 m0, s11, 5760
  s_nop 0
  buffer_load_dwordx4 v4, s[80:83], s10 offen lds
  s_add_u32 s10, s10, 7680
  s_add_u32 m0, s11, 6720
  s_nop 0
  buffer_load_dwordx4 v4, s[80:83], s10 offen lds
  s_add_u32 s10, s10, 7680
  s_add_u32 m0, s11, 7680
  s_nop 0
  buffer_load_dwordx4 v4, s[80:83], s10 offen lds
  s_add_u32 s10, s10, 7680
  s_add_u32 m0, s11, 8640
  s_nop 0
  buffer_load_dwordx4 v4, s[80:83], s10 offen lds
  s_add_u32 s10, s10, 7680
  s_add_u32 m0, s11, 9600
  s_nop 0
  buffer_load_dwordx4 v4, s[80:83], s10 offen lds
  s_add_u32 s10, s10, 7680
  s_add_u32 m0, s11, 10560
  s_nop 0
  buffer_load_dwordx4 v4, s[80:83], s10 offen lds
  s_add_u32 s10, s10, 7680
  s_add_u32 m0, s11, 11520
  s_nop 0
  buffer_load_dwordx4 v4, s[80:83], s10 offen lds
  s_add_u32 s10, s10, 7680
  s_add_u32 m0, s11, 12480
  s_nop 0
  buffer_load_dwordx4 v4, s[80:83], s10 offen lds
  s_add_u32 s10, s10, 7680
  s_add_u32 m0, s11, 13440
  s_nop 0
  buffer_load_dwordx4 v4, s[80:83], s10 offen lds
  s_add_u32 s10, s10, 7680
  s_add_u32 m0, s11, 14400
  s_nop 0
  buffer_load_dwordx4 v4, s[80:83], s10 offen lds
  s_add_u32 s10, s10, 7680
  s_mov_b64 exec, -1
  v_lshrrev_b32 v6, 2, v1
  v_mul_u32_u24 v6, 12288, v6
  v_lshrrev_b32 v7, 4, v1
  v_xor_b32 v7, v7, v1
  v_bfe_u32 v8, v7, 1, 1
  v_xor_b32 v7, v7, v8
  v_and_b32 v7, 1, v7
  v_lshl_add_u32 v6, v7, 5, v6
  v_lshl_add_u32 v6, v8, 4, v6
  s_mul_i32 s15, s16, 1966080
  s_mul_i32 s17, s13, 768
  s_add_u32 s15, s15, s17
  s_mul_i32 s17, s3, 192
  s_add_u32 s15, s15, s17
  s_mul_i32 s24, s3, 3072
  s_add_u32 m0, s24, 61440
  s_nop 0
  buffer_load_dwordx4 v6, s[84:87], s15 offen offset:0 lds
  s_add_u32 m0, s24, 62400
  s_nop 0
  buffer_load_dwordx4 v6, s[84:87], s15 offen offset:64 lds
  s_add_u32 m0, s24, 63360
  s_nop 0
  buffer_load_dwordx4 v6, s[84:87], s15 offen offset:128 lds
  s_add_u32 s15, s15, 196608
  s_add_u32 m0, s24, 73728
  s_nop 0
  buffer_load_dwordx4 v6, s[84:87], s15 offen offset:0 lds
  s_add_u32 m0, s24, 74688
  s_nop 0
  buffer_load_dwordx4 v6, s[84:87], s15 offen offset:64 lds
  s_add_u32 m0, s24, 75648
  s_nop 0
  buffer_load_dwordx4 v6, s[84:87], s15 offen offset:128 lds
  s_add_u32 s15, s15, 196608
  s_add_u32 m0, s24, 86016
  s_nop 0
  buffer_load_dwordx4 v6, s[84:87], s15 offen offset:0 lds
  s_add_u32 m0, s24, 86976
  s_nop 0
  buffer_load_dwordx4 v6, s[84:87], s15 offen offset:64 lds
  s_add_u32 m0, s24, 87936
  s_nop 0
  buffer_load_dwordx4 v6, s[84:87], s15 offen offset:128 lds
  s_add_u32 s15, s15, 196608
  s_add_u32 m0, s24, 98304
  s_nop 0
  buffer_load_dwordx4 v6, s[84:87], s15 offen offset:0 lds
  s_add_u32 m0, s24, 99264
  s_nop 0
  buffer_load_dwordx4 v6, s[84:87], s15 offen offset:64 lds
  s_add_u32 m0, s24, 100224
  s_nop 0
  buffer_load_dwordx4 v6, s[84:87], s15 offen offset:128 lds
  s_add_u32 s15, s15, 196608
  s_add_u32 m0, s24, 110592
  s_nop 0
  buffer_load_dwordx4 v6, s[84:87], s15 offen offset:0 lds
  s_add_u32 m0, s24, 111552
  s_nop 0
  buffer_load_dwordx4 v6, s[84:87], s15 offen offset:64 lds
  s_add_u32 m0, s24, 112512
  s_nop 0
  buffer_load_dwordx4 v6, s[84:87], s15 offen offset:128 lds
  s_add_u32 s15, s15, 196608
  s_add_u32 m0, s24, 122880
  s_nop 0
  buffer_load_dwordx4 v6, s[84:87], s15 offen offset:0 lds
  s_add_u32 m0, s24, 123840
  s_nop 0
  buffer_load_dwordx4 v6, s[84:87], s15 offen offset:64 lds
  s_add_u32 m0, s24, 124800
  s_nop 0
  buffer_load_dwordx4 v6, s[84:87], s15 offen offset:128 lds
  s_add_u32 s15, s15, 196608
  s_add_u32 m0, s24, 135168
  s_nop 0
  buffer_load_dwordx4 v6, s[84:87], s15 offen offset:0 lds
  s_add_u32 m0, s24, 136128
  s_nop 0
  buffer_load_dwordx4 v6, s[84:87], s15 offen offset:64 lds
  s_add_u32 m0, s24, 137088
  s_nop 0
  buffer_load_dwordx4 v6, s[84:87], s15 offen offset:128 lds
  s_add_u32 s15, s15, 196608
  s_add_u32 m0, s24, 147456
  s_nop 0
  buffer_load_dwordx4 v6, s[84:87], s15 offen offset:0 lds
  s_add_u32 m0, s24, 148416
  s_nop 0
  buffer_load_dwordx4 v6, s[84:87], s15 offen offset:64 lds
  s_add_u32 m0, s24, 149376
  s_nop 0
  buffer_load_dwordx4 v6, s[84:87], s15 offen offset:128 lds
  s_add_u32 s15, s15, 196608
  s_waitcnt vmcnt(0)
  s_barrier
  s_cmp_lg_u32 s3, 0
  s_cbranch_scc1 int_ar31
  s_lshl_b32 s68, 1, s9
  v_mov_b32 v254, s68
  v_mov_b32 v255, 0x100
  s_lshl_b32 s68, s8, 3
  s_add_u32 s68, s68, s67
  s_mov_b64 exec, 1
  buffer_atomic_add_x2 v[254:255], off, s[44:47], s68 sc0 sc1
  s_mov_b64 exec, -1
int_ar31:
  ds_read_b64_tr_b16 a[0:1], v5 offset:0
  ds_read_b64_tr_b16 a[2:3], v5 offset:640
  ds_read_b64_tr_b16 a[4:5], v5 offset:32
  ds_read_b64_tr_b16 a[6:7], v5 offset:672
  ds_read_b64_tr_b16 a[8:9], v5 offset:64
  ds_read_b64_tr_b16 a[10:11], v5 offset:704
  ds_read_b64_tr_b16 a[12:13], v5 offset:96
  ds_read_b64_tr_b16 a[14:15], v5 offset:736
  ds_read_b64_tr_b16 a[16:17], v5 offset:128
  ds_read_b64_tr_b16 a[18:19], v5 offset:768
  s_waitcnt lgkmcnt(0)
  s_mov_b64 exec, s[20:21]
  s_add_u32 m0, s11, 0
  s_nop 0
  buffer_load_dwordx4 v4, s[80:83], s10 offen lds
  s_add_u32 s10, s10, 7680
  s_add_u32 m0, s11, 960
  s_nop 0
  buffer_load_dwordx4 v4, s[80:83], s10 offen lds
  s_add_u32 s10, s10, 7680
  s_add_u32 m0, s11, 1920
  s_nop 0
  buffer_load_dwordx4 v4, s[80:83], s10 offen lds
  s_add_u32 s10, s10, 7680
  s_add_u32 m0, s11, 2880
  s_nop 0
  buffer_load_dwordx4 v4, s[80:83], s10 offen lds
  s_add_u32 s10, s10, 7680
  s_add_u32 m0, s11, 3840
  s_nop 0
  buffer_load_dwordx4 v4, s[80:83], s10 offen lds
  s_add_u32 s10, s10, 7680
  s_mov_b64 exec, -1
  ds_read_b64_tr_b16 a[20:21], v5 offset:5120
  ds_read_b64_tr_b16 a[22:23], v5 offset:5760
  ds_read_b64_tr_b16 a[24:25], v5 offset:5152
  ds_read_b64_tr_b16 a[26:27], v5 offset:5792
  ds_read_b64_tr_b16 a[28:29], v5 offset:5184
  ds_read_b64_tr_b16 a[30:31], v5 offset:5824
  ds_read_b64_tr_b16 a[32:33], v5 offset:5216
  ds_read_b64_tr_b16 a[34:35], v5 offset:5856
  ds_read_b64_tr_b16 a[36:37], v5 offset:5248
  ds_read_b64_tr_b16 a[38:39], v5 offset:5888
  s_waitcnt lgkmcnt(0)
  s_mov_b64 exec, s[20:21]
  s_add_u32 m0, s11, 4800
  s_nop 0
  buffer_load_dwordx4 v4, s[80:83], s10 offen lds
  s_add_u32 s10, s10, 7680
  s_add_u32 m0, s11, 5760
  s_nop 0
  buffer_load_dwordx4 v4, s[80:83], s10 offen lds
  s_add_u32 s10, s10, 7680
  s_add_u32 m0, s11, 6720
  s_nop 0
  buffer_load_dwordx4 v4, s[80:83], s10 offen lds
  s_add_u32 s10, s10, 7680
  s_add_u32 m0, s11, 7680
  s_nop 0
  buffer_load_dwordx4 v4, s[80:83], s10 offen lds
  s_add_u32 s10, s10, 7680
  s_add_u32 m0, s11, 8640
  s_nop 0
  buffer_load_dwordx4 v4, s[80:83], s10 offen lds
  s_add_u32 s10, s10, 7680
  s_mov_b64 exec, -1
  ds_read_b64_tr_b16 a[40:41], v5 offset:10240
  ds_read_b64_tr_b16 a[42:43], v5 offset:10880
  ds_read_b64_tr_b16 a[44:45], v5 offset:10272
  ds_read_b64_tr_b16 a[46:47], v5 offset:10912
  ds_read_b64_tr_b16 a[48:49], v5 offset:10304
  ds_read_b64_tr_b16 a[50:51], v5 offset:10944
  ds_read_b64_tr_b16 a[52:53], v5 offset:10336
  ds_read_b64_tr_b16 a[54:55], v5 offset:10976
  ds_read_b64_tr_b16 a[56:57], v5 offset:10368
  ds_read_b64_tr_b16 a[58:59], v5 offset:11008
  s_waitcnt lgkmcnt(0)
  s_mov_b64 exec, s[20:21]
  s_add_u32 m0, s11, 9600
  s_nop 0
  buffer_load_dwordx4 v4, s[80:83], s10 offen lds
  s_add_u32 s10, s10, 7680
  s_add_u32 m0, s11, 10560
  s_nop 0
  buffer_load_dwordx4 v4, s[80:83], s10 offen lds
  s_add_u32 s10, s10, 7680
  s_add_u32 m0, s11, 11520
  s_nop 0
  buffer_load_dwordx4 v4, s[80:83], s10 offen lds
  s_add_u32 s10, s10, 7680
  s_add_u32 m0, s11, 12480
  s_nop 0
  buffer_load_dwordx4 v4, s[80:83], s10 offen lds
  s_add_u32 s10, s10, 7680
  s_add_u32 m0, s11, 13440
  s_nop 0
  buffer_load_dwordx4 v4, s[80:83], s10 offen lds
  s_add_u32 s10, s10, 7680
  s_add_u32 m0, s11, 14400
  s_nop 0
  buffer_load_dwordx4 v4, s[80:83], s10 offen lds
  s_add_u32 s10, s10, 7680
  s_mov_b64 exec, -1
  s_waitcnt vmcnt(10)
  ds_read_b64_tr_b16 a[60:61], v5 offset:0
  ds_read_b64_tr_b16 a[62:63], v5 offset:640
  ds_read_b64_tr_b16 a[64:65], v5 offset:32
  ds_read_b64_tr_b16 a[66:67], v5 offset:672
  ds_read_b64_tr_b16 a[68:69], v5 offset:64
  ds_read_b64_tr_b16 a[70:71], v5 offset:704
  ds_read_b64_tr_b16 a[72:73], v5 offset:96
  ds_read_b64_tr_b16 a[74:75], v5 offset:736
  ds_read_b64_tr_b16 a[76:77], v5 offset:128
  ds_read_b64_tr_b16 a[78:79], v5 offset:768
  s_waitcnt lgkmcnt(0)
  s_mov_b64 exec, s[20:21]
  s_add_u32 m0, s11, 0
  s_nop 0
  buffer_load_dwordx4 v4, s[80:83], s10 offen lds
  s_add_u32 s10, s10, 7680
  s_add_u32 m0, s11, 960
  s_nop 0
  buffer_load_dwordx4 v4, s[80:83], s10 offen lds
  s_add_u32 s10, s10, 7680
  s_add_u32 m0, s11, 1920
  s_nop 0
  buffer_load_dwordx4 v4, s[80:83], s10 offen lds
  s_add_u32 s10, s10, 7680
  s_add_u32 m0, s11, 2880
  s_nop 0
  buffer_load_dwordx4 v4, s[80:83], s10 offen lds
  s_add_u32 s10, s10, 7680
  s_add_u32 m0, s11, 3840
  s_nop 0
  buffer_load_dwordx4 v4, s[80:83], s10 offen lds
  s_add_u32 s10, s10, 7680
  s_mov_b64 exec, -1
  s_waitcnt vmcnt(10)
  ds_read_b64_tr_b16 a[80:81], v5 offset:5120
  ds_read_b64_tr_b16 a[82:83], v5 offset:5760
  ds_read_b64_tr_b16 a[84:85], v5 offset:5152
  ds_read_b64_tr_b16 a[86:87], v5 offset:5792
  ds_read_b64_tr_b16 a[88:89], v5 offset:5184
  ds_read_b64_tr_b16 a[90:91], v5 offset:5824
  ds_read_b64_tr_b16 a[92:93], v5 offset:5216
  ds_read_b64_tr_b16 a[94:95], v5 offset:5856
  ds_read_b64_tr_b16 a[96:97], v5 offset:5248
  ds_read_b64_tr_b16 a[98:99], v5 offset:5888
  s_waitcnt lgkmcnt(0)
  s_mov_b64 exec, s[20:21]
  s_add_u32 m0, s11, 4800
  s_nop 0
  buffer_load_dwordx4 v4, s[80:83], s10 offen lds
  s_add_u32 s10, s10, 7680
  s_add_u32 m0, s11, 5760
  s_nop 0
  buffer_load_dwordx4 v4, s[80:83], s10 offen lds
  s_add_u32 s10, s10, 7680
  s_add_u32 m0, s11, 6720
  s_nop 0
  buffer_load_dwordx4 v4, s[80:83], s10 offen lds
  s_add_u32 s10, s10, 7680
  s_add_u32 m0, s11, 7680
  s_nop 0
  buffer_load_dwordx4 v4, s[80:83], s10 offen lds
  s_add_u32 s10, s10, 7680
  s_add_u32 m0, s11, 8640
  s_nop 0
  buffer_load_dwordx4 v4, s[80:83], s10 offen lds
  s_add_u32 s10, s10, 7680
  s_mov_b64 exec, -1
  s_waitcnt vmcnt(10)
  ds_read_b64_tr_b16 a[100:101], v5 offset:10240
  ds_read_b64_tr_b16 a[102:103], v5 offset:10880
  ds_read_b64_tr_b16 a[104:105], v5 offset:10272
  ds_read_b64_tr_b16 a[106:107], v5 offset:10912
  ds_read_b64_tr_b16 a[108:109], v5 offset:10304
  ds_read_b64_tr_b16 a[110:111], v5 offset:10944
  ds_read_b64_tr_b16 a[112:113], v5 offset:10336
  ds_read_b64_tr_b16 a[114:115], v5 offset:10976
  ds_read_b64_tr_b16 a[116:117], v5 offset:10368
  ds_read_b64_tr_b16 a[118:119], v5 offset:11008
  s_waitcnt lgkmcnt(0)
  s_mov_b64 exec, s[20:21]
  s_add_u32 m0, s11, 9600
  s_nop 0
  buffer_load_dwordx4 v4, s[80:83], s10 offen lds
  s_add_u32 s10, s10, 7680
  s_add_u32 m0, s11, 10560
  s_nop 0
  buffer_load_dwordx4 v4, s[80:83], s10 offen lds
  s_add_u32 s10, s10, 7680
  s_add_u32 m0, s11, 11520
  s_nop 0
  buffer_load_dwordx4 v4, s[80:83], s10 offen lds
  s_add_u32 s10, s10, 7680
  s_add_u32 m0, s11, 12480
  s_nop 0
  buffer_load_dwordx4 v4, s[80:83], s10 offen lds
  s_add_u32 s10, s10, 7680
  s_add_u32 m0, s11, 13440
  s_nop 0
  buffer_load_dwordx4 v4, s[80:83], s10 offen lds
  s_add_u32 s10, s10, 7680
  s_add_u32 m0, s11, 14400
  s_nop 0
  buffer_load_dwordx4 v4, s[80:83], s10 offen lds
  s_add_u32 s10, s10, 7680
  s_mov_b64 exec, -1
  s_waitcnt vmcnt(10)
  ds_read_b64_tr_b16 a[120:121], v5 offset:0
  ds_read_b64_tr_b16 a[122:123], v5 offset:640
  ds_read_b64_tr_b16 a[124:125], v5 offset:32
  ds_read_b64_tr_b16 a[126:127], v5 offset:672
  ds_read_b64_tr_b16 a[128:129], v5 offset:64
  ds_read_b64_tr_b16 a[130:131], v5 offset:704
  ds_read_b64_tr_b16 a[132:133], v5 offset:96
  ds_read_b64_tr_b16 a[134:135], v5 offset:736
  ds_read_b64_tr_b16 a[136:137], v5 offset:128
  ds_read_b64_tr_b16 a[138:139], v5 offset:768
  s_waitcnt lgkmcnt(0)
  s_mov_b64 exec, s[20:21]
  s_add_u32 m0, s11, 0
  s_nop 0
  buffer_load_dwordx4 v4, s[80:83], s10 offen lds
  s_add_u32 s10, s10, 7680
  s_add_u32 m0, s11, 960
  s_nop 0
  buffer_load_dwordx4 v4, s[80:83], s10 offen lds
  s_add_u32 s10, s10, 7680
  s_add_u32 m0, s11, 1920
  s_nop 0
  buffer_load_dwordx4 v4, s[80:83], s10 offen lds
  s_add_u32 s10, s10, 7680
  s_add_u32 m0, s11, 2880
  s_nop 0
  buffer_load_dwordx4 v4, s[80:83], s10 offen lds
  s_add_u32 s10, s10, 7680
  s_add_u32 m0, s11, 3840
  s_nop 0
  buffer_load_dwordx4 v4, s[80:83], s10 offen lds
  s_add_u32 s10, s10, 7680
  s_mov_b64 exec, -1
  s_waitcnt vmcnt(10)
  ds_read_b64_tr_b16 a[140:141], v5 offset:5120
  ds_read_b64_tr_b16 a[142:143], v5 offset:5760
  ds_read_b64_tr_b16 a[144:145], v5 offset:5152
  ds_read_b64_tr_b16 a[146:147], v5 offset:5792
  ds_read_b64_tr_b16 a[148:149], v5 offset:5184
  ds_read_b64_tr_b16 a[150:151], v5 offset:5824
  ds_read_b64_tr_b16 a[152:153], v5 offset:5216
  ds_read_b64_tr_b16 a[154:155], v5 offset:5856
  ds_read_b64_tr_b16 a[156:157], v5 offset:5248
  ds_read_b64_tr_b16 a[158:159], v5 offset:5888
  s_waitcnt lgkmcnt(0)
  s_mov_b64 exec, s[20:21]
  s_add_u32 m0, s11, 4800
  s_nop 0
  buffer_load_dwordx4 v4, s[80:83], s10 offen lds
  s_add_u32 s10, s10, 7680
  s_add_u32 m0, s11, 5760
  s_nop 0
  buffer_load_dwordx4 v4, s[80:83], s10 offen lds
  s_add_u32 s10, s10, 7680
  s_add_u32 m0, s11, 6720
  s_nop 0
  buffer_load_dwordx4 v4, s[80:83], s10 offen lds
  s_add_u32 s10, s10, 7680
  s_add_u32 m0, s11, 7680
  s_nop 0
  buffer_load_dwordx4 v4, s[80:83], s10 offen lds
  s_add_u32 s10, s10, 7680
  s_add_u32 m0, s11, 8640
  s_nop 0
  buffer_load_dwordx4 v4, s[80:83], s10 offen lds
  s_add_u32 s10, s10, 7680
  s_mov_b64 exec, -1
  s_waitcnt vmcnt(10)
  ds_read_b64_tr_b16 a[160:161], v5 offset:10240
  ds_read_b64_tr_b16 a[162:163], v5 offset:10880
  ds_read_b64_tr_b16 a[164:165], v5 offset:10272
  ds_read_b64_tr_b16 a[166:167], v5 offset:10912
  ds_read_b64_tr_b16 a[168:169], v5 offset:10304
  ds_read_b64_tr_b16 a[170:171], v5 offset:10944
  ds_read_b64_tr_b16 a[172:173], v5 offset:10336
  ds_read_b64_tr_b16 a[174:175], v5 offset:10976
  ds_read_b64_tr_b16 a[176:177], v5 offset:10368
  ds_read_b64_tr_b16 a[178:179], v5 offset:11008
  s_waitcnt lgkmcnt(0)
  s_mov_b64 exec, s[20:21]
  s_add_u32 m0, s11, 9600
  s_nop 0
  buffer_load_dwordx4 v4, s[80:83], s10 offen lds
  s_add_u32 s10, s10, 7680
  s_add_u32 m0, s11, 10560
  s_nop 0
  buffer_load_dwordx4 v4, s[80:83], s10 offen lds
  s_add_u32 s10, s10, 7680
  s_add_u32 m0, s11, 11520
  s_nop 0
  buffer_load_dwordx4 v4, s[80:83], s10 offen lds
  s_add_u32 s10, s10, 7680
  s_add_u32 m0, s11, 12480
  s_nop 0
  buffer_load_dwordx4 v4, s[80:83], s10 offen lds
  s_add_u32 s10, s10, 7680
  s_add_u32 m0, s11, 13440
  s_nop 0
  buffer_load_dwordx4 v4, s[80:83], s10 offen lds
  s_add_u32 s10, s10, 7680
  s_add_u32 m0, s11, 14400
  s_nop 0
  buffer_load_dwordx4 v4, s[80:83], s10 offen lds
  s_add_u32 s10, s10, 7680
  s_mov_b64 exec, -1
  s_waitcnt vmcnt(10)
  ds_read_b64_tr_b16 a[180:181], v5 offset:0
  ds_read_b64_tr_b16 a[182:183], v5 offset:640
  ds_read_b64_tr_b16 a[184:185], v5 offset:32
  ds_read_b64_tr_b16 a[186:187], v5 offset:672
  ds_read_b64_tr_b16 a[188:189], v5 offset:64
  ds_read_b64_tr_b16 a[190:191], v5 offset:704
  ds_read_b64_tr_b16 a[192:193], v5 offset:96
  ds_read_b64_tr_b16 a[194:195], v5 offset:736
  ds_read_b64_tr_b16 a[196:197], v5 offset:128
  ds_read_b64_tr_b16 a[198:199], v5 offset:768
  s_waitcnt vmcnt(5)
  ds_read_b64_tr_b16 a[200:201], v5 offset:5120
  ds_read_b64_tr_b16 a[202:203], v5 offset:5760
  ds_read_b64_tr_b16 a[204:205], v5 offset:5152
  ds_read_b64_tr_b16 a[206:207], v5 offset:5792
  ds_read_b64_tr_b16 a[208:209], v5 offset:5184
  ds_read_b64_tr_b16 a[210:211], v5 offset:5824
  ds_read_b64_tr_b16 a[212:213], v5 offset:5216
  ds_read_b64_tr_b16 a[214:215], v5 offset:5856
  ds_read_b64_tr_b16 a[216:217], v5 offset:5248
  ds_read_b64_tr_b16 a[218:219], v5 offset:5888
  s_waitcnt vmcnt(0)
  ds_read_b64_tr_b16 a[220:221], v5 offset:10240
  ds_read_b64_tr_b16 a[222:223], v5 offset:10880
  ds_read_b64_tr_b16 a[224:225], v5 offset:10272
  ds_read_b64_tr_b16 a[226:227], v5 offset:10912
  ds_read_b64_tr_b16 a[228:229], v5 offset:10304
  ds_read_b64_tr_b16 a[230:231], v5 offset:10944
  ds_read_b64_tr_b16 a[232:233], v5 offset:10336
  ds_read_b64_tr_b16 a[234:235], v5 offset:10976
  ds_read_b64_tr_b16 a[236:237], v5 offset:10368
  ds_read_b64_tr_b16 a[238:239], v5 offset:11008
  s_waitcnt lgkmcnt(0)
  s_barrier
  s_add_u32 m0, s24, 0
  s_nop 0
  buffer_load_dwordx4 v6, s[84:87], s15 offen offset:0 lds
  s_add_u32 m0, s24, 960
  s_nop 0
  buffer_load_dwordx4 v6, s[84:87], s15 offen offset:64 lds
  s_add_u32 m0, s24, 1920
  s_nop 0
  buffer_load_dwordx4 v6, s[84:87], s15 offen offset:128 lds
  s_add_u32 s15, s15, 196608
  s_add_u32 m0, s24, 12288
  s_nop 0
  buffer_load_dwordx4 v6, s[84:87], s15 offen offset:0 lds
  s_add_u32 m0, s24, 13248
  s_nop 0
  buffer_load_dwordx4 v6, s[84:87], s15 offen offset:64 lds
  s_add_u32 m0, s24, 14208
  s_nop 0
  buffer_load_dwordx4 v6, s[84:87], s15 offen offset:128 lds
  s_add_u32 s15, s15, 196608
  v_bfe_u32 v7, v1, 4, 1
  v_lshrrev_b32 v8, 5, v1
  v_xor_b32 v8, v8, v7
  v_lshl_add_u32 v7, v7, 1, v8
  v_bfe_u32 v8, v1, 2, 2
  v_xor_b32 v7, v7, v8
  v_and_b32 v8, 15, v1
  v_lshlrev_b32 v8, 6, v8
  v_lshl_add_u32 v7, v7, 4, v8
  v_add_u32 v3, 61440, v7
  v_lshlrev_b32 v2, 4, v1
  s_mul_i32 s22, s8, 40
  s_mul_i32 s23, s14, 5
  s_add_u32 s22, s22, s23
  s_lshl_b32 s22, s22, 2
  s_add_u32 s22, s22, s12
  s_mul_i32 s22, s22, 40
  s_mul_i32 s23, s16, 10
  s_add_u32 s22, s22, s23
  s_lshl_b32 s22, s22, 10
  s_add_u32 s22, s22, 0
  s_mov_b32 s23, 1073741824
  ds_read_b128 v[8:11], v3 offset:0
  ds_read_b128 v[12:15], v3 offset:1024
  ds_read_b128 v[16:19], v3 offset:2048
  ds_read_b128 v[20:23], v3 offset:3072
  ds_read_b128 v[24:27], v3 offset:4096
  ds_read_b128 v[28:31], v3 offset:5120
  ds_read_b128 v[32:35], v3 offset:6144
  ds_read_b128 v[36:39], v3 offset:7168
  ds_read_b128 v[40:43], v3 offset:8192
  ds_read_b128 v[44:47], v3 offset:9216
  ds_read_b128 v[48:51], v3 offset:10240
  ds_read_b128 v[52:55], v3 offset:11264
  s_mov_b32 s25, 0
mk_bm_loop:
  s_waitcnt lgkmcnt(0)
  v_mfma_f32_16x16x32_bf16 v[104:107], v[8:11], a[0:3], 0
  ds_read_b128 v[56:59], v3 offset:12288
  v_mfma_f32_16x16x32_bf16 v[108:111], v[32:35], a[120:123], 0
  ds_read_b128 v[60:63], v3 offset:13312
  v_mfma_f32_16x16x32_bf16 v[104:107], v[12:15], a[20:23], v[104:107]
  v_mfma_f32_16x16x32_bf16 v[108:111], v[36:39], a[140:143], v[108:111]
  v_mfma_f32_16x16x32_bf16 v[104:107], v[16:19], a[40:43], v[104:107]
  v_mfma_f32_16x16x32_bf16 v[108:111], v[40:43], a[160:163], v[108:111]
  v_mfma_f32_16x16x32_bf16 v[104:107], v[20:23], a[60:63], v[104:107]
  v_mfma_f32_16x16x32_bf16 v[108:111], v[44:47], a[180:183], v[108:111]
  v_cvt_pk_bf16_f32 v124, v112, v113
  v_cvt_pk_bf16_f32 v125, v116, v117
  v_cvt_pk_bf16_f32 v126, v114, v115
  v_cvt_pk_bf16_f32 v127, v118, v119
  buffer_store_dwordx4 v[124:127], v2, s[4:7], s23 offen
  s_add_u32 s23, s22, 0
  v_mfma_f32_16x16x32_bf16 v[104:107], v[24:27], a[80:83], v[104:107]
  v_mfma_f32_16x16x32_bf16 v[108:111], v[48:51], a[200:203], v[108:111]
  v_mfma_f32_16x16x32_bf16 v[104:107], v[28:31], a[100:103], v[104:107]
  ds_read_b128 v[64:67], v3 offset:14336
  v_mfma_f32_16x16x32_bf16 v[108:111], v[52:55], a[220:223], v[108:111]
  ds_read_b128 v[68:71], v3 offset:15360
  v_mfma_f32_16x16x32_bf16 v[112:115], v[8:11], a[4:7], 0
  ds_read_b128 v[72:75], v3 offset:16384
  v_mfma_f32_16x16x32_bf16 v[116:119], v[32:35], a[124:127], 0
  ds_read_b128 v[76:79], v3 offset:17408
  v_mfma_f32_16x16x32_bf16 v[112:115], v[12:15], a[24:27], v[112:115]
  v_mfma_f32_16x16x32_bf16 v[116:119], v[36:39], a[144:147], v[116:119]
  v_mfma_f32_16x16x32_bf16 v[112:115], v[16:19], a[44:47], v[112:115]
  v_mfma_f32_16x16x32_bf16 v[116:119], v[40:43], a[164:167], v[116:119]
  v_mfma_f32_16x16x32_bf16 v[112:115], v[20:23], a[64:67], v[112:115]
  v_mfma_f32_16x16x32_bf16 v[116:119], v[44:47], a[184:187], v[116:119]
  v_cvt_pk_bf16_f32 v120, v104, v105
  v_cvt_pk_bf16_f32 v121, v108, v109
  v_cvt_pk_bf16_f32 v122, v106, v107
  v_cvt_pk_bf16_f32 v123, v110, v111
  buffer_store_dwordx4 v[120:123], v2, s[4:7], s23 offen
  s_add_u32 s23, s22, 163840
  v_mfma_f32_16x16x32_bf16 v[112:115], v[24:27], a[84:87], v[112:115]
  v_mfma_f32_16x16x32_bf16 v[116:119], v[48:51], a[204:207], v[116:119]
  v_mfma_f32_16x16x32_bf16 v[112:115], v[28:31], a[104:107], v[112:115]
  ds_read_b128 v[80:83], v3 offset:18432
  v_mfma_f32_16x16x32_bf16 v[116:119], v[52:55], a[224:227], v[116:119]
  ds_read_b128 v[84:87], v3 offset:19456
  v_mfma_f32_16x16x32_bf16 v[104:107], v[8:11], a[8:11], 0
  ds_read_b128 v[88:91], v3 offset:20480
  v_mfma_f32_16x16x32_bf16 v[108:111], v[32:35], a[128:131], 0
  ds_read_b128 v[92:95], v3 offset:21504
  v_mfma_f32_16x16x32_bf16 v[104:107], v[12:15], a[28:31], v[104:107]
  v_mfma_f32_16x16x32_bf16 v[108:111], v[36:39], a[148:151], v[108:111]
  v_mfma_f32_16x16x32_bf16 v[104:107], v[16:19], a[48:51], v[104:107]
  v_mfma_f32_16x16x32_bf16 v[108:111], v[40:43], a[168:171], v[108:111]
  v_mfma_f32_16x16x32_bf16 v[104:107], v[20:23], a[68:71], v[104:107]
  v_mfma_f32_16x16x32_bf16 v[108:111], v[44:47], a[188:191], v[108:111]
  v_cvt_pk_bf16_f32 v124, v112, v113
  v_cvt_pk_bf16_f32 v125, v116, v117
  v_cvt_pk_bf16_f32 v126, v114, v115
  v_cvt_pk_bf16_f32 v127, v118, v119
  buffer_store_dwordx4 v[124:127], v2, s[4:7], s23 offen
  s_add_u32 s23, s22, 327680
  v_mfma_f32_16x16x32_bf16 v[104:107], v[24:27], a[88:91], v[104:107]
  v_mfma_f32_16x16x32_bf16 v[108:111], v[48:51], a[208:211], v[108:111]
  v_mfma_f32_16x16x32_bf16 v[104:107], v[28:31], a[108:111], v[104:107]
  ds_read_b128 v[96:99], v3 offset:22528
  v_mfma_f32_16x16x32_bf16 v[108:111], v[52:55], a[228:231], v[108:111]
  ds_read_b128 v[100:103], v3 offset:23552
  v_mfma_f32_16x16x32_bf16 v[112:115], v[8:11], a[12:15], 0
  v_mfma_f32_16x16x32_bf16 v[116:119], v[32:35], a[132:135], 0
  v_mfma_f32_16x16x32_bf16 v[112:115], v[12:15], a[32:35], v[112:115]
  v_mfma_f32_16x16x32_bf16 v[116:119], v[36:39], a[152:155], v[116:119]
  v_mfma_f32_16x16x32_bf16 v[112:115], v[16:19], a[52:55], v[112:115]
  v_mfma_f32_16x16x32_bf16 v[116:119], v[40:43], a[172:175], v[116:119]
  v_mfma_f32_16x16x32_bf16 v[112:115], v[20:23], a[72:75], v[112:115]
  v_mfma_f32_16x16x32_bf16 v[116:119], v[44:47], a[192:195], v[116:119]
  v_cvt_pk_bf16_f32 v120, v104, v105
  v_cvt_pk_bf16_f32 v121, v108, v109
  v_cvt_pk_bf16_f32 v122, v106, v107
  v_cvt_pk_bf16_f32 v123, v110, v111
  buffer_store_dwordx4 v[120:123], v2, s[4:7], s23 offen
  s_add_u32 s23, s22, 491520
  v_mfma_f32_16x16x32_bf16 v[112:115], v[24:27], a[92:95], v[112:115]
  v_mfma_f32_16x16x32_bf16 v[116:119], v[48:51], a[212:215], v[116:119]
  v_mfma_f32_16x16x32_bf16 v[112:115], v[28:31], a[112:115], v[112:115]
  v_mfma_f32_16x16x32_bf16 v[116:119], v[52:55], a[232:235], v[116:119]
  v_mfma_f32_16x16x32_bf16 v[104:107], v[8:11], a[16:19], 0
  v_mfma_f32_16x16x32_bf16 v[108:111], v[32:35], a[136:139], 0
  v_mfma_f32_16x16x32_bf16 v[104:107], v[12:15], a[36:39], v[104:107]
  v_mfma_f32_16x16x32_bf16 v[108:111], v[36:39], a[156:159], v[108:111]
  v_mfma_f32_16x16x32_bf16 v[104:107], v[16:19], a[56:59], v[104:107]
  v_mfma_f32_16x16x32_bf16 v[108:111], v[40:43], a[176:179], v[108:111]
  v_mfma_f32_16x16x32_bf16 v[104:107], v[20:23], a[76:79], v[104:107]
  v_mfma_f32_16x16x32_bf16 v[108:111], v[44:47], a[196:199], v[108:111]
  v_cvt_pk_bf16_f32 v124, v112, v113
  v_cvt_pk_bf16_f32 v125, v116, v117
  v_cvt_pk_bf16_f32 v126, v114, v115
  v_cvt_pk_bf16_f32 v127, v118, v119
  buffer_store_dwordx4 v[124:127], v2, s[4:7], s23 offen
  s_add_u32 s23, s22, 655360
  v_mfma_f32_16x16x32_bf16 v[104:107], v[24:27], a[96:99], v[104:107]
  v_mfma_f32_16x16x32_bf16 v[108:111], v[48:51], a[216:219], v[108:111]
  v_mfma_f32_16x16x32_bf16 v[104:107], v[28:31], a[116:119], v[104:107]
  v_mfma_f32_16x16x32_bf16 v[108:111], v[52:55], a[236:239], v[108:111]
  v_add_u32 v3, 24576, v3
  s_cmp_lg_u32 s25, 3
  s_cbranch_scc1 mk_bm_nw
  v_mov_b32 v3, v7
  s_waitcnt vmcnt(8)
  s_barrier
mk_bm_nw:
  s_waitcnt lgkmcnt(0)
  v_mfma_f32_16x16x32_bf16 v[112:115], v[56:59], a[0:3], 0
  ds_read_b128 v[8:11], v3 offset:0
  v_mfma_f32_16x16x32_bf16 v[116:119], v[80:83], a[120:123], 0
  ds_read_b128 v[12:15], v3 offset:1024
  v_mfma_f32_16x16x32_bf16 v[112:115], v[60:63], a[20:23], v[112:115]
  v_mfma_f32_16x16x32_bf16 v[116:119], v[84:87], a[140:143], v[116:119]
  v_mfma_f32_16x16x32_bf16 v[112:115], v[64:67], a[40:43], v[112:115]
  v_mfma_f32_16x16x32_bf16 v[116:119], v[88:91], a[160:163], v[116:119]
  v_mfma_f32_16x16x32_bf16 v[112:115], v[68:71], a[60:63], v[112:115]
  v_mfma_f32_16x16x32_bf16 v[116:119], v[92:95], a[180:183], v[116:119]
  v_cvt_pk_bf16_f32 v120, v104, v105
  v_cvt_pk_bf16_f32 v121, v108, v109
  v_cvt_pk_bf16_f32 v122, v106, v107
  v_cvt_pk_bf16_f32 v123, v110, v111
  buffer_store_dwordx4 v[120:123], v2, s[4:7], s23 offen
  s_add_u32 s23, s22, 1024
  v_mfma_f32_16x16x32_bf16 v[112:115], v[72:75], a[80:83], v[112:115]
  v_mfma_f32_16x16x32_bf16 v[116:119], v[96:99], a[200:203], v[116:119]
  v_mfma_f32_16x16x32_bf16 v[112:115], v[76:79], a[100:103], v[112:115]
  ds_read_b128 v[16:19], v3 offset:2048
  v_mfma_f32_16x16x32_bf16 v[116:119], v[100:103], a[220:223], v[116:119]
  ds_read_b128 v[20:23], v3 offset:3072
  v_mfma_f32_16x16x32_bf16 v[104:107], v[56:59], a[4:7], 0
  ds_read_b128 v[24:27], v3 offset:4096
  v_mfma_f32_16x16x32_bf16 v[108:111], v[80:83], a[124:127], 0
  ds_read_b128 v[28:31], v3 offset:5120
  v_mfma_f32_16x16x32_bf16 v[104:107], v[60:63], a[24:27], v[104:107]
  v_mfma_f32_16x16x32_bf16 v[108:111], v[84:87], a[144:147], v[108:111]
  v_mfma_f32_16x16x32_bf16 v[104:107], v[64:67], a[44:47], v[104:107]
  v_mfma_f32_16x16x32_bf16 v[108:111], v[88:91], a[164:167], v[108:111]
  v_mfma_f32_16x16x32_bf16 v[104:107], v[68:71], a[64:67], v[104:107]
  v_mfma_f32_16x16x32_bf16 v[108:111], v[92:95], a[184:187], v[108:111]
  v_cvt_pk_bf16_f32 v124, v112, v113
  v_cvt_pk_bf16_f32 v125, v116, v117
  v_cvt_pk_bf16_f32 v126, v114, v115
  v_cvt_pk_bf16_f32 v127, v118, v119
  buffer_store_dwordx4 v[124:127], v2, s[4:7], s23 offen
  s_add_u32 s23, s22, 164864
  v_mfma_f32_16x16x32_bf16 v[104:107], v[72:75], a[84:87], v[104:107]
  v_mfma_f32_16x16x32_bf16 v[108:111], v[96:99], a[204:207], v[108:111]
  v_mfma_f32_16x16x32_bf16 v[104:107], v[76:79], a[104:107], v[104:107]
  ds_read_b128 v[32:35], v3 offset:6144
  v_mfma_f32_16x16x32_bf16 v[108:111], v[100:103], a[224:227], v[108:111]
  ds_read_b128 v[36:39], v3 offset:7168
  v_mfma_f32_16x16x32_bf16 v[112:115], v[56:59], a[8:11], 0
  ds_read_b128 v[40:43], v3 offset:8192
  v_mfma_f32_16x16x32_bf16 v[116:119], v[80:83], a[128:131], 0
  ds_read_b128 v[44:47], v3 offset:9216
  v_mfma_f32_16x16x32_bf16 v[112:115], v[60:63], a[28:31], v[112:115]
  v_mfma_f32_16x16x32_bf16 v[116:119], v[84:87], a[148:151], v[116:119]
  v_mfma_f32_16x16x32_bf16 v[112:115], v[64:67], a[48:51], v[112:115]
  v_mfma_f32_16x16x32_bf16 v[116:119], v[88:91], a[168:171], v[116:119]
  v_mfma_f32_16x16x32_bf16 v[112:115], v[68:71], a[68:71], v[112:115]
  v_mfma_f32_16x16x32_bf16 v[116:119], v[92:95], a[188:191], v[116:119]
  v_cvt_pk_bf16_f32 v120, v104, v105
  v_cvt_pk_bf16_f32 v121, v108, v109
  v_cvt_pk_bf16_f32 v122, v106, v107
  v_cvt_pk_bf16_f32 v123, v110, v111
  buffer_store_dwordx4 v[120:123], v2, s[4:7], s23 offen
  s_add_u32 s23, s22, 328704
  v_mfma_f32_16x16x32_bf16 v[112:115], v[72:75], a[88:91], v[112:115]
  v_mfma_f32_16x16x32_bf16 v[116:119], v[96:99], a[208:211], v[116:119]
  v_mfma_f32_16x16x32_bf16 v[112:115], v[76:79], a[108:111], v[112:115]
  ds_read_b128 v[48:51], v3 offset:10240
  v_mfma_f32_16x16x32_bf16 v[116:119], v[100:103], a[228:231], v[116:119]
  ds_read_b128 v[52:55], v3 offset:11264
  v_mfma_f32_16x16x32_bf16 v[104:107], v[56:59], a[12:15], 0
  v_mfma_f32_16x16x32_bf16 v[108:111], v[80:83], a[132:135], 0
  v_mfma_f32_16x16x32_bf16 v[104:107], v[60:63], a[32:35], v[104:107]
  v_mfma_f32_16x16x32_bf16 v[108:111], v[84:87], a[152:155], v[108:111]
  v_mfma_f32_16x16x32_bf16 v[104:107], v[64:67], a[52:55], v[104:107]
  v_mfma_f32_16x16x32_bf16 v[108:111], v[88:91], a[172:175], v[108:111]
  v_mfma_f32_16x16x32_bf16 v[104:107], v[68:71], a[72:75], v[104:107]
  v_mfma_f32_16x16x32_bf16 v[108:111], v[92:95], a[192:195], v[108:111]
  v_cvt_pk_bf16_f32 v124, v112, v113
  v_cvt_pk_bf16_f32 v125, v116, v117
  v_cvt_pk_bf16_f32 v126, v114, v115
  v_cvt_pk_bf16_f32 v127, v118, v119
  buffer_store_dwordx4 v[124:127], v2, s[4:7], s23 offen
  s_add_u32 s23, s22, 492544
  v_mfma_f32_16x16x32_bf16 v[104:107], v[72:75], a[92:95], v[104:107]
  v_mfma_f32_16x16x32_bf16 v[108:111], v[96:99], a[212:215], v[108:111]
  v_mfma_f32_16x16x32_bf16 v[104:107], v[76:79], a[112:115], v[104:107]
  v_mfma_f32_16x16x32_bf16 v[108:111], v[100:103], a[232:235], v[108:111]
  v_mfma_f32_16x16x32_bf16 v[112:115], v[56:59], a[16:19], 0
  v_mfma_f32_16x16x32_bf16 v[116:119], v[80:83], a[136:139], 0
  v_mfma_f32_16x16x32_bf16 v[112:115], v[60:63], a[36:39], v[112:115]
  v_mfma_f32_16x16x32_bf16 v[116:119], v[84:87], a[156:159], v[116:119]
  v_mfma_f32_16x16x32_bf16 v[112:115], v[64:67], a[56:59], v[112:115]
  v_mfma_f32_16x16x32_bf16 v[116:119], v[88:91], a[176:179], v[116:119]
  v_mfma_f32_16x16x32_bf16 v[112:115], v[68:71], a[76:79], v[112:115]
  v_mfma_f32_16x16x32_bf16 v[116:119], v[92:95], a[196:199], v[116:119]
  v_cvt_pk_bf16_f32 v120, v104, v105
  v_cvt_pk_bf16_f32 v121, v108, v109
  v_cvt_pk_bf16_f32 v122, v106, v107
  v_cvt_pk_bf16_f32 v123, v110, v111
  buffer_store_dwordx4 v[120:123], v2, s[4:7], s23 offen
  s_add_u32 s23, s22, 656384
  v_mfma_f32_16x16x32_bf16 v[112:115], v[72:75], a[96:99], v[112:115]
  v_mfma_f32_16x16x32_bf16 v[116:119], v[96:99], a[216:219], v[116:119]
  v_mfma_f32_16x16x32_bf16 v[112:115], v[76:79], a[116:119], v[112:115]
  v_mfma_f32_16x16x32_bf16 v[116:119], v[100:103], a[236:239], v[116:119]
  s_add_u32 s22, s22, 2048
  s_add_u32 s25, s25, 1
  s_cmp_lt_u32 s25, 5
  s_cbranch_scc1 mk_bm_loop
  s_nop 2
  v_cvt_pk_bf16_f32 v124, v112, v113
  v_cvt_pk_bf16_f32 v125, v116, v117
  v_cvt_pk_bf16_f32 v126, v114, v115
  v_cvt_pk_bf16_f32 v127, v118, v119
  buffer_store_dwordx4 v[124:127], v2, s[4:7], s23 offen
  s_waitcnt vmcnt(0) lgkmcnt(0)
  s_barrier
  v_and_b32 v252, 7, v1
  v_lshlrev_b32 v252, 3, v252
  s_mov_b32 s70, 0
int_ce32:
  buffer_load_dwordx2 v[250:251], v252, s[44:47], s67 offen sc1
  s_waitcnt vmcnt(0)
  v_lshrrev_b32 v253, 8, v251
  v_cmp_ne_u32 vcc, 32, v253
  s_nop 0
  s_cbranch_vccz int_ce32_ok
  s_sleep 8
  s_add_u32 s70, s70, 1
  s_cmp_lt_u32 s70, 262144
  s_cbranch_scc1 int_ce32
  s_branch mk_fail
int_ce32_ok:
  v_not_b32 v250, v250
  v_and_b32 v251, 0xff, v251
  v_or_b32 v250, v250, v251
  v_cmp_ne_u32 vcc, 0, v250
  s_nop 0
  s_cbranch_vccnz mk_redo
  v_lshlrev_b32 v252, 2, v1
  s_mov_b32 s68, 64946176
  buffer_load_dword v250, v252, s[4:7], s68 offen sc1
  s_waitcnt vmcnt(0)
  v_cmp_eq_u32 s[64:65], 1, v250
  s_cmp_lg_u32 s3, 0
  s_cbranch_scc1 mk_na
  s_lshl_b32 s13, s8, 2
  v_mov_b32 v62, 1
  s_mov_b64 exec, 1
  buffer_atomic_add v62, off, s[44:47], s13 offset:128 sc1
  s_mov_b64 exec, -1
mk_na:
  v_and_b32 v60, 15, v1
  v_lshrrev_b32 v61, 4, v1
  v_lshlrev_b32 v5, 4, v1
  s_mul_hi_u32 s37, s9, 0x55555556
  s_mul_i32 s16, s37, 3
  s_sub_u32 s16, s9, s16
  s_lshl_b32 s13, s9, 1
  s_sub_u32 s13, s13, 24
  s_sub_u32 s14, s9, 24
  s_cmp_lt_u32 s9, 24
  s_cselect_b32 s38, s9, s13
  s_cselect_b32 s37, s37, s14
  s_cbranch_scc0 mk_smw
  s_lshr_b32 s13, s3, 1
  s_add_u32 s13, s13, s3
  s_mul_i32 s14, s16, 6
  s_add_u32 s13, s13, s14
  s_mul_i32 s14, s3, 3
  s_add_u32 s14, s14, 2
  s_cmp_eq_u32 s16, 2
  s_cselect_b32 s13, s14, s13
  s_lshl_b32 s13, s13, 5
  s_lshl_b32 s14, s8, 3
  s_add_u32 s14, s14, s37
  s_mul_i32 s14, s14, 384
  s_add_u32 s13, s13, s14
  v_lshrrev_b32 v62, 1, v1
  v_mul_u32_u24 v62, 12288, v62
  v_and_b32 v63, 1, v1
  v_lshl_add_u32 v62, v63, 4, v62
  s_mul_i32 s14, s3, 40960
  s_mov_b32 m0, s14
  s_mov_b32 s15, 0
mk_sq:
  buffer_load_dwordx4 v62, s[92:95], s13 offen lds
  s_add_u32 m0, m0, 1024
  s_nop 0
  buffer_load_dwordx4 v62, s[96:99], s13 offen lds
  s_add_u32 m0, m0, 1024
  s_add_u32 s13, s13, 393216
  s_add_u32 s15, s15, 1
  s_cmp_lt_u32 s15, 20
  s_cbranch_scc1 mk_sq
  v_bfe_u32 v62, v1, 3, 1
  v_lshlrev_b32 v62, 10, v62
  v_lshl_add_u32 v62, v61, 7, v62
  v_bfe_u32 v63, v1, 2, 1
  v_lshl_add_u32 v62, v63, 5, v62
  v_and_b32 v63, 3, v1
  v_lshl_add_u32 v62, v63, 3, v62
  v_add_u32 v62, s14, v62
  s_waitcnt vmcnt(32)
  ds_read_b64_tr_b16 a[0:1], v62 offset:0
  ds_read_b64_tr_b16 a[2:3], v62 offset:64
  ds_read_b64_tr_b16 a[4:5], v62 offset:512
  ds_read_b64_tr_b16 a[6:7], v62 offset:576
  ds_read_b64_tr_b16 a[8:9], v62 offset:2048
  ds_read_b64_tr_b16 a[10:11], v62 offset:2112
  ds_read_b64_tr_b16 a[12:13], v62 offset:2560
  ds_read_b64_tr_b16 a[14:15], v62 offset:2624
  ds_read_b64_tr_b16 a[16:17], v62 offset:4096
  ds_read_b64_tr_b16 a[18:19], v62 offset:4160
  ds_read_b64_tr_b16 a[20:21], v62 offset:4608
  ds_read_b64_tr_b16 a[22:23], v62 offset:4672
  ds_read_b64_tr_b16 a[24:25], v62 offset:6144
  ds_read_b64_tr_b16 a[26:27], v62 offset:6208
  ds_read_b64_tr_b16 a[28:29], v62 offset:6656
  ds_read_b64_tr_b16 a[30:31], v62 offset:6720
  s_waitcnt vmcnt(24)
  ds_read_b64_tr_b16 a[32:33], v62 offset:8192
  ds_read_b64_tr_b16 a[34:35], v62 offset:8256
  ds_read_b64_tr_b16 a[36:37], v62 offset:8704
  ds_read_b64_tr_b16 a[38:39], v62 offset:8768
  ds_read_b64_tr_b16 a[40:41], v62 offset:10240
  ds_read_b64_tr_b16 a[42:43], v62 offset:10304
  ds_read_b64_tr_b16 a[44:45], v62 offset:10752
  ds_read_b64_tr_b16 a[46:47], v62 offset:10816
  ds_read_b64_tr_b16 a[48:49], v62 offset:12288
  ds_read_b64_tr_b16 a[50:51], v62 offset:12352
  ds_read_b64_tr_b16 a[52:53], v62 offset:12800
  ds_read_b64_tr_b16 a[54:55], v62 offset:12864
  ds_read_b64_tr_b16 a[56:57], v62 offset:14336
  ds_read_b64_tr_b16 a[58:59], v62 offset:14400
  ds_read_b64_tr_b16 a[60:61], v62 offset:14848
  ds_read_b64_tr_b16 a[62:63], v62 offset:14912
  s_waitcnt vmcnt(16)
  ds_read_b64_tr_b16 a[64:65], v62 offset:16384
  ds_read_b64_tr_b16 a[66:67], v62 offset:16448
  ds_read_b64_tr_b16 a[68:69], v62 offset:16896
  ds_read_b64_tr_b16 a[70:71], v62 offset:16960
  ds_read_b64_tr_b16 a[72:73], v62 offset:18432
  ds_read_b64_tr_b16 a[74:75], v62 offset:18496
  ds_read_b64_tr_b16 a[76:77], v62 offset:18944
  ds_read_b64_tr_b16 a[78:79], v62 offset:19008
  ds_read_b64_tr_b16 a[80:81], v62 offset:20480
  ds_read_b64_tr_b16 a[82:83], v62 offset:20544
  ds_read_b64_tr_b16 a[84:85], v62 offset:20992
  ds_read_b64_tr_b16 a[86:87], v62 offset:21056
  ds_read_b64_tr_b16 a[88:89], v62 offset:22528
  ds_read_b64_tr_b16 a[90:91], v62 offset:22592
  ds_read_b64_tr_b16 a[92:93], v62 offset:23040
  ds_read_b64_tr_b16 a[94:95], v62 offset:23104
  s_waitcnt vmcnt(8)
  ds_read_b64_tr_b16 a[96:97], v62 offset:24576
  ds_read_b64_tr_b16 a[98:99], v62 offset:24640
  ds_read_b64_tr_b16 a[100:101], v62 offset:25088
  ds_read_b64_tr_b16 a[102:103], v62 offset:25152
  ds_read_b64_tr_b16 a[104:105], v62 offset:26624
  ds_read_b64_tr_b16 a[106:107], v62 offset:26688
  ds_read_b64_tr_b16 a[108:109], v62 offset:27136
  ds_read_b64_tr_b16 a[110:111], v62 offset:27200
  ds_read_b64_tr_b16 a[112:113], v62 offset:28672
  ds_read_b64_tr_b16 a[114:115], v62 offset:28736
  ds_read_b64_tr_b16 a[116:117], v62 offset:29184
  ds_read_b64_tr_b16 a[118:119], v62 offset:29248
  ds_read_b64_tr_b16 a[120:121], v62 offset:30720
  ds_read_b64_tr_b16 a[122:123], v62 offset:30784
  ds_read_b64_tr_b16 a[124:125], v62 offset:31232
  ds_read_b64_tr_b16 a[126:127], v62 offset:31296
  s_waitcnt vmcnt(0)
  ds_read_b64_tr_b16 a[128:129], v62 offset:32768
  ds_read_b64_tr_b16 a[130:131], v62 offset:32832
  ds_read_b64_tr_b16 a[132:133], v62 offset:33280
  ds_read_b64_tr_b16 a[134:135], v62 offset:33344
  ds_read_b64_tr_b16 a[136:137], v62 offset:34816
  ds_read_b64_tr_b16 a[138:139], v62 offset:34880
  ds_read_b64_tr_b16 a[140:141], v62 offset:35328
  ds_read_b64_tr_b16 a[142:143], v62 offset:35392
  ds_read_b64_tr_b16 a[144:145], v62 offset:36864
  ds_read_b64_tr_b16 a[146:147], v62 offset:36928
  ds_read_b64_tr_b16 a[148:149], v62 offset:37376
  ds_read_b64_tr_b16 a[150:151], v62 offset:37440
  ds_read_b64_tr_b16 a[152:153], v62 offset:38912
  ds_read_b64_tr_b16 a[154:155], v62 offset:38976
  ds_read_b64_tr_b16 a[156:157], v62 offset:39424
  ds_read_b64_tr_b16 a[158:159], v62 offset:39488
mk_smw:
  s_lshl_b32 s13, s8, 2
  s_mov_b32 s70, 0
mk_wb:
  buffer_load_dword v63, off, s[44:47], s13 offset:128 sc1
  s_waitcnt vmcnt(0)
  v_cmp_gt_u32 vcc, 32, v63
  s_nop 0
  s_cbranch_vccz mk_wbk
  s_sleep 4
  s_add_u32 s70, s70, 1
  s_cmp_lt_u32 s70, 262144
  s_cbranch_scc1 mk_wb
  s_branch mk_fail
mk_wbk:
  s_mul_i32 s26, s8, 40
  s_add_u32 s26, s26, s38
  s_lshl_b32 s26, s26, 2
  s_add_u32 s26, s26, s3
  s_mul_i32 s26, s26, 40960
  s_add_u32 s26, s26, 0
  s_cmp_lt_u32 s9, 24
  s_cbranch_scc1 mk_c1
  buffer_load_dwordx4 a[0:3], v5, s[4:7], s26 offen offset:0 sc1
  buffer_load_dwordx4 a[4:7], v5, s[4:7], s26 offen offset:1024 sc1
  buffer_load_dwordx4 a[8:11], v5, s[4:7], s26 offen offset:2048 sc1
  buffer_load_dwordx4 a[12:15], v5, s[4:7], s26 offen offset:3072 sc1
  s_add_u32 s26, s26, 4096
  buffer_load_dwordx4 a[16:19], v5, s[4:7], s26 offen offset:0 sc1
  buffer_load_dwordx4 a[20:23], v5, s[4:7], s26 offen offset:1024 sc1
  buffer_load_dwordx4 a[24:27], v5, s[4:7], s26 offen offset:2048 sc1
  buffer_load_dwordx4 a[28:31], v5, s[4:7], s26 offen offset:3072 sc1
  s_add_u32 s26, s26, 4096
  buffer_load_dwordx4 a[32:35], v5, s[4:7], s26 offen offset:0 sc1
  buffer_load_dwordx4 a[36:39], v5, s[4:7], s26 offen offset:1024 sc1
  buffer_load_dwordx4 a[40:43], v5, s[4:7], s26 offen offset:2048 sc1
  buffer_load_dwordx4 a[44:47], v5, s[4:7], s26 offen offset:3072 sc1
  s_add_u32 s26, s26, 4096
  buffer_load_dwordx4 a[48:51], v5, s[4:7], s26 offen offset:0 sc1
  buffer_load_dwordx4 a[52:55], v5, s[4:7], s26 offen offset:1024 sc1
  buffer_load_dwordx4 a[56:59], v5, s[4:7], s26 offen offset:2048 sc1
  buffer_load_dwordx4 a[60:63], v5, s[4:7], s26 offen offset:3072 sc1
  s_add_u32 s26, s26, 4096
  buffer_load_dwordx4 a[64:67], v5, s[4:7], s26 offen offset:0 sc1
  buffer_load_dwordx4 a[68:71], v5, s[4:7], s26 offen offset:1024 sc1
  buffer_load_dwordx4 a[72:75], v5, s[4:7], s26 offen offset:2048 sc1
  buffer_load_dwordx4 a[76:79], v5, s[4:7], s26 offen offset:3072 sc1
  s_add_u32 s26, s26, 4096
  buffer_load_dwordx4 a[80:83], v5, s[4:7], s26 offen offset:0 sc1
  buffer_load_dwordx4 a[84:87], v5, s[4:7], s26 offen offset:1024 sc1
  buffer_load_dwordx4 a[88:91], v5, s[4:7], s26 offen offset:2048 sc1
  buffer_load_dwordx4 a[92:95], v5, s[4:7], s26 offen offset:3072 sc1
  s_add_u32 s26, s26, 4096
  buffer_load_dwordx4 a[96:99], v5, s[4:7], s26 offen offset:0 sc1
  buffer_load_dwordx4 a[100:103], v5, s[4:7], s26 offen offset:1024 sc1
  buffer_load_dwordx4 a[104:107], v5, s[4:7], s26 offen offset:2048 sc1
  buffer_load_dwordx4 a[108:111], v5, s[4:7], s26 offen offset:3072 sc1
  s_add_u32 s26, s26, 4096
  buffer_load_dwordx4 a[112:115], v5, s[4:7], s26 offen offset:0 sc1
  buffer_load_dwordx4 a[116:119], v5, s[4:7], s26 offen offset:1024 sc1
  buffer_load_dwordx4 a[120:123], v5, s[4:7], s26 offen offset:2048 sc1
  buffer_load_dwordx4 a[124:127], v5, s[4:7], s26 offen offset:3072 sc1
  s_add_u32 s26, s26, 4096
  buffer_load_dwordx4 a[128:131], v5, s[4:7], s26 offen offset:0 sc1
  buffer_load_dwordx4 a[132:135], v5, s[4:7], s26 offen offset:1024 sc1
  buffer_load_dwordx4 a[136:139], v5, s[4:7], s26 offen offset:2048 sc1
  buffer_load_dwordx4 a[140:143], v5, s[4:7], s26 offen offset:3072 sc1
  s_add_u32 s26, s26, 4096
  buffer_load_dwordx4 a[144:147], v5, s[4:7], s26 offen offset:0 sc1
  buffer_load_dwordx4 a[148:151], v5, s[4:7], s26 offen offset:1024 sc1
  buffer_load_dwordx4 a[152:155], v5, s[4:7], s26 offen offset:2048 sc1
  buffer_load_dwordx4 a[156:159], v5, s[4:7], s26 offen offset:3072 sc1
  s_add_u32 s26, s26, 4096
  s_add_u32 s26, s26, 122880
  s_waitcnt vmcnt(20)
mk_c1:
  buffer_load_dwordx4 a[160:163], v5, s[4:7], s26 offen offset:0 sc1
  buffer_load_dwordx4 a[164:167], v5, s[4:7], s26 offen offset:1024 sc1
  buffer_load_dwordx4 a[168:171], v5, s[4:7], s26 offen offset:2048 sc1
  buffer_load_dwordx4 a[172:175], v5, s[4:7], s26 offen offset:3072 sc1
  s_add_u32 s26, s26, 4096
  buffer_load_dwordx4 a[176:179], v5, s[4:7], s26 offen offset:0 sc1
  buffer_load_dwordx4 a[180:183], v5, s[4:7], s26 offen offset:1024 sc1
  buffer_load_dwordx4 a[184:187], v5, s[4:7], s26 offen offset:2048 sc1
  buffer_load_dwordx4 a[188:191], v5, s[4:7], s26 offen offset:3072 sc1
  s_add_u32 s26, s26, 4096
  buffer_load_dwordx4 a[192:195], v5, s[4:7], s26 offen offset:0 sc1
  buffer_load_dwordx4 a[196:199], v5, s[4:7], s26 offen offset:1024 sc1
  buffer_load_dwordx4 a[200:203], v5, s[4:7], s26 offen offset:2048 sc1
  buffer_load_dwordx4 a[204:207], v5, s[4:7], s26 offen offset:3072 sc1
  s_add_u32 s26, s26, 4096
  buffer_load_dwordx4 a[208:211], v5, s[4:7], s26 offen offset:0 sc1
  buffer_load_dwordx4 a[212:215], v5, s[4:7], s26 offen offset:1024 sc1
  buffer_load_dwordx4 a[216:219], v5, s[4:7], s26 offen offset:2048 sc1
  buffer_load_dwordx4 a[220:223], v5, s[4:7], s26 offen offset:3072 sc1
  s_add_u32 s26, s26, 4096
  buffer_load_dwordx4 a[224:227], v5, s[4:7], s26 offen offset:0 sc1
  buffer_load_dwordx4 a[228:231], v5, s[4:7], s26 offen offset:1024 sc1
  buffer_load_dwordx4 a[232:235], v5, s[4:7], s26 offen offset:2048 sc1
  buffer_load_dwordx4 a[236:239], v5, s[4:7], s26 offen offset:3072 sc1
  s_add_u32 s26, s26, 4096
  buffer_load_dwordx4 a[240:243], v5, s[4:7], s26 offen offset:0 sc1
  buffer_load_dwordx4 a[244:247], v5, s[4:7], s26 offen offset:1024 sc1
  buffer_load_dwordx4 a[248:251], v5, s[4:7], s26 offen offset:2048 sc1
  buffer_load_dwordx4 a[252:255], v5, s[4:7], s26 offen offset:3072 sc1
  s_add_u32 s26, s26, 4096
  buffer_load_dwordx4 v[192:195], v5, s[4:7], s26 offen offset:0 sc1
  buffer_load_dwordx4 v[196:199], v5, s[4:7], s26 offen offset:1024 sc1
  buffer_load_dwordx4 v[200:203], v5, s[4:7], s26 offen offset:2048 sc1
  buffer_load_dwordx4 v[204:207], v5, s[4:7], s26 offen offset:3072 sc1
  s_add_u32 s26, s26, 4096
  buffer_load_dwordx4 v[208:211], v5, s[4:7], s26 offen offset:0 sc1
  buffer_load_dwordx4 v[212:215], v5, s[4:7], s26 offen offset:1024 sc1
  buffer_load_dwordx4 v[216:219], v5, s[4:7], s26 offen offset:2048 sc1
  buffer_load_dwordx4 v[220:223], v5, s[4:7], s26 offen offset:3072 sc1
  s_add_u32 s26, s26, 4096
  buffer_load_dwordx4 v[224:227], v5, s[4:7], s26 offen offset:0 sc1
  buffer_load_dwordx4 v[228:231], v5, s[4:7], s26 offen offset:1024 sc1
  buffer_load_dwordx4 v[232:235], v5, s[4:7], s26 offen offset:2048 sc1
  buffer_load_dwordx4 v[236:239], v5, s[4:7], s26 offen offset:3072 sc1
  s_add_u32 s26, s26, 4096
  buffer_load_dwordx4 v[240:243], v5, s[4:7], s26 offen offset:0 sc1
  buffer_load_dwordx4 v[244:247], v5, s[4:7], s26 offen offset:1024 sc1
  buffer_load_dwordx4 v[248:251], v5, s[4:7], s26 offen offset:2048 sc1
  buffer_load_dwordx4 v[252:255], v5, s[4:7], s26 offen offset:3072 sc1
  s_add_u32 s26, s26, 4096
  v_mov_b32 v2, 0x4444
  v_mov_b32 v15, 0x4444
  v_mov_b32 v3, 0xeeee
  v_cmp_lt_u32 vcc, 7, v60
  s_nop 1
  v_cndmask_b32 v2, v2, v3, vcc
  v_and_b32 v63, 2, v1
  v_cmp_ne_u32 vcc, 0, v63
  s_nop 1
  v_cndmask_b32 v15, v15, v3, vcc
  v_and_b32 v3, 1, v1
  v_lshlrev_b32 v3, 4, v3
  v_bfe_u32 v63, v1, 1, 2
  v_lshl_add_u32 v3, v63, 6, v3
  v_bfe_u32 v63, v1, 4, 1
  v_lshl_add_u32 v3, v63, 5, v3
  v_lshrrev_b32 v63, 5, v1
  v_lshl_add_u32 v3, v63, 8, v3
  v_mul_u32_u24 v6, 576, v61
  v_lshl_add_u32 v6, v60, 3, v6
  s_lshl_b32 s13, s3, 7
  v_add_u32 v6, s13, v6
  v_and_b32 v63, 3, v1
  v_mul_u32_u24 v7, 576, v63
  v_lshrrev_b32 v63, 2, v1
  v_lshl_add_u32 v7, v63, 3, v7
  s_lshl_b32 s13, s3, 9
  s_add_u32 s13, s13, 16384
  v_lshl_add_u32 v8, v1, 3, s13
  v_mov_b32 v16, -1
  v_mov_b32 v17, -1
  v_mov_b32 v18, -1
  v_mov_b32 v19, -1
  s_mov_b32 s36, 0x3dd53b95
  s_mov_b32 s10, 0
  s_mul_i32 s13, s3, 3
  s_min_u32 s13, s13, 8
  s_lshl_b32 s19, s13, 10
  s_lshl_b32 s17, s8, 16
  s_add_u32 s17, s17, 63963136
  s_lshl_b32 s40, s38, 14
  s_add_u32 s40, s40, s39
  v_add_u32 v4, s19, v5
  s_add_u32 s41, s39, 933888
  s_lshr_b32 s68, s8, 1
  s_bitcmp1_b64 s[64:65], s68
  s_cselect_b32 s68, 0x2000, 0
  s_lshl_b32 s43, s8, 20
  s_add_u32 s43, s43, s68
  s_add_u32 s43, s43, s39
  s_add_u32 s43, s43, 970752
  s_lshl_b32 s13, s9, 7
  s_add_u32 s43, s43, s13
  s_lshr_b32 s72, s38, 3
  s_lshl_b32 s72, s72, 14
  s_and_b32 s13, s38, 7
  s_lshl_b32 s13, s13, 10
  s_add_u32 s72, s72, s13
  s_cmp_lt_u32 s9, 24
  s_cselect_b32 s13, s39, s41
  s_add_u32 s72, s72, s13
  s_mov_b32 s24, 1073741824
  s_mov_b32 s12, 0
  s_waitcnt vmcnt(0) lgkmcnt(0)
  s_barrier
  s_cmp_ge_u32 s9, 24
  s_cselect_b32 s13, 4, 0
  s_add_u32 s13, s13, s3
  s_cmp_eq_u32 s13, 1
  s_cbranch_scc1 mk_Q1_init
  s_cmp_eq_u32 s13, 2
  s_cbranch_scc1 mk_Q2_init
  s_cmp_eq_u32 s13, 3
  s_cbranch_scc1 mk_Q3_init
  s_cmp_eq_u32 s13, 4
  s_cbranch_scc1 mk_S0_init
  s_cmp_eq_u32 s13, 5
  s_cbranch_scc1 mk_S1_init
  s_cmp_eq_u32 s13, 6
  s_cbranch_scc1 mk_S2_init
  s_cmp_eq_u32 s13, 7
  s_cbranch_scc1 mk_S3_init
mk_Q0_init:
  s_lshl_b32 s26, s8, 17
  s_lshl_b32 s13, s37, 12
  s_add_u32 s26, s26, s13
  s_add_u32 s26, s26, 64225280
  s_mul_i32 s13, s16, 1280
  s_add_u32 s26, s26, s13
  v_bfe_u32 v62, v1, 2, 3
  v_lshlrev_b32 v54, 7, v62
  v_add_u32 v54, 8192, v54
  s_lshl_b32 s13, s37, 7
  v_mov_b32 v62, s13
  v_cmp_lt_u32 vcc, 31, v1
  s_nop 1
  v_cndmask_b32 v54, v54, v62, vcc
  v_and_b32 v62, 3, v1
  v_lshl_add_u32 v54, v62, 2, v54
  s_lshl_b32 s21, s8, 10
  s_add_u32 s21, s21, 64880640
  s_mov_b32 s20, 0
  v_mov_b32 v55, 0
  v_lshrrev_b32 v9, 1, v60
  v_lshlrev_b32 v9, 8, v9
  v_lshl_add_u32 v9, v61, 5, v9
  v_and_b32 v62, 1, v60
  v_lshl_add_u32 v9, v62, 4, v9
  v_add_u32 v9, 0, v9
  v_lshrrev_b32 v62, 3, v60
  v_lshl_add_u32 v9, v62, 30, v9
  s_lshl_b32 s13, s37, 14
  s_lshl_b32 s14, s16, 11
  s_add_u32 s13, s13, s14
  s_add_u32 s13, s13, 655360
  s_lshr_b32 s14, s37, 1
  s_lshl_b32 s14, s14, 14
  s_and_b32 s15, s37, 1
  s_lshl_b32 s15, s15, 12
  s_add_u32 s14, s14, s15
  s_add_u32 s14, s14, 786432
  s_cmp_eq_u32 s16, 2
  s_cselect_b32 s32, s14, s13
  s_cselect_b32 s33, 1024, 0
  s_cselect_b32 s15, 1024, 8
  s_add_u32 s33, s33, 1024
  s_add_u32 s32, s32, s39
  v_mov_b32 v10, v5
  v_add_u32 v11, s15, v5
  v_min_u32 v53, 47, v1
  v_lshrrev_b32 v62, 1, v53
  v_and_b32 v62, 15, v62
  v_lshlrev_b32 v53, 6, v53
  v_lshl_add_u32 v53, v62, 2, v53
  v_add_u32 v53, s19, v53
mk_Q0_prime:
  v_mov_b32 v20, 0
  v_mov_b32 v21, 0
  v_mov_b32 v22, 0
  v_mov_b32 v23, 0
  v_mov_b32 v24, 0
  v_mov_b32 v25, 0
  v_mov_b32 v26, 0
  v_mov_b32 v27, 0
  s_and_b32 s18, s10, 3
  s_lshl_b32 s18, s18, 14
  s_add_u32 s18, s18, s17
  s_mov_b32 s11, 0
  s_mul_hi_u32 s68, s10, 0x2aaaaaab
  s_mul_i32 s68, s68, 6
  s_sub_u32 s13, s10, s68
  s_mul_i32 s13, s13, 20480
  s_add_u32 s13, s13, 33792
  v_add_u32 v0, s13, v8
  s_and_b32 s30, s10, 3
  s_lshl_b32 s30, s30, 15
  s_add_u32 s30, s30, s26
  s_add_u32 s31, s10, 3
  s_and_b32 s31, s31, 3
  s_lshl_b32 s31, s31, 15
  s_add_u32 s31, s31, s26
  s_add_u32 s13, s10, 1
  s_cmp_ge_u32 s20, s13
  s_cbranch_scc1 int_wm33_ok
  s_mov_b32 s70, 0
int_wm33:
  buffer_load_dword v28, v54, s[4:7], s21 offen sc1
  s_waitcnt vmcnt(0)
  v_min_u32_dpp v28, v28, v28 quad_perm:[1,0,3,2] row_mask:0xf bank_mask:0xf
  s_nop 1
  v_min_u32_dpp v28, v28, v28 quad_perm:[2,3,0,1] row_mask:0xf bank_mask:0xf
  s_nop 1
  v_min_u32_dpp v28, v28, v28 row_half_mirror row_mask:0xf bank_mask:0xf
  s_nop 1
  v_min_u32_dpp v28, v28, v28 row_mirror row_mask:0xf bank_mask:0xf
  v_mov_b32 v29, v28
  s_nop 1
  v_permlane16_swap_b32 v28, v29
  v_min_u32 v28, v28, v29
  v_mov_b32 v29, v28
  s_nop 1
  v_permlane32_swap_b32 v28, v29
  v_min_u32 v28, v28, v29
  s_nop 0
  v_readfirstlane_b32 s20, v28
  s_nop 0
  s_cmp_ge_u32 s20, s13
  s_cbranch_scc1 int_wm33_ok
  s_sleep 1
  s_add_u32 s70, s70, 1
  s_cmp_lt_u32 s70, 262144
  s_cbranch_scc1 int_wm33
  s_branch mk_fail
int_wm33_ok:
  s_and_b32 s28, s10, 31
  s_lshl_b32 s28, s28, 2
  s_add_u32 s28, s28, s8
  s_lshr_b32 s68, s28, 1
  s_bitcmp1_b64 s[64:65], s68
  s_cselect_b32 s68, 0x2000, 0
  s_lshl_b32 s28, s28, 20
  s_add_u32 s28, s28, s68
  s_add_u32 s28, s28, s32
  s_add_u32 s29, s28, s33
  buffer_load_dwordx2 v[44:45], v10, s[4:7], s28 offen sc1
  buffer_load_dwordx2 v[46:47], v11, s[4:7], s28 offen sc1
  buffer_load_dwordx2 v[48:49], v10, s[4:7], s29 offen sc1
  buffer_load_dwordx2 v[50:51], v11, s[4:7], s29 offen sc1
  s_or_b32 s13, s10, 63
  s_add_u32 s13, s13, 1
  s_add_u32 s14, s10, 2
  s_min_u32 s13, s13, s14
  s_cmp_ge_u32 s20, s13
  s_cbranch_scc1 int_wm34_ok
  s_mov_b32 s70, 0
int_wm34:
  buffer_load_dword v28, v54, s[4:7], s21 offen sc1
  s_waitcnt vmcnt(0)
  v_min_u32_dpp v28, v28, v28 quad_perm:[1,0,3,2] row_mask:0xf bank_mask:0xf
  s_nop 1
  v_min_u32_dpp v28, v28, v28 quad_perm:[2,3,0,1] row_mask:0xf bank_mask:0xf
  s_nop 1
  v_min_u32_dpp v28, v28, v28 row_half_mirror row_mask:0xf bank_mask:0xf
  s_nop 1
  v_min_u32_dpp v28, v28, v28 row_mirror row_mask:0xf bank_mask:0xf
  v_mov_b32 v29, v28
  s_nop 1
  v_permlane16_swap_b32 v28, v29
  v_min_u32 v28, v28, v29
  v_mov_b32 v29, v28
  s_nop 1
  v_permlane32_swap_b32 v28, v29
  v_min_u32 v28, v28, v29
  s_nop 0
  v_readfirstlane_b32 s20, v28
  s_nop 0
  s_cmp_ge_u32 s20, s13
  s_cbranch_scc1 int_wm34_ok
  s_sleep 1
  s_add_u32 s70, s70, 1
  s_cmp_lt_u32 s70, 262144
  s_cbranch_scc1 int_wm34
  s_branch mk_fail
int_wm34_ok:
  s_add_u32 s28, s10, 1
  s_and_b32 s28, s28, 31
  s_lshl_b32 s28, s28, 2
  s_add_u32 s28, s28, s8
  s_lshr_b32 s68, s28, 1
  s_bitcmp1_b64 s[64:65], s68
  s_cselect_b32 s68, 0x2000, 0
  s_lshl_b32 s28, s28, 20
  s_add_u32 s28, s28, s68
  s_add_u32 s28, s28, s32
  s_add_u32 s29, s28, s33
  s_mov_b32 m0, s19
  s_waitcnt vmcnt(0) lgkmcnt(0)
  s_branch mk_Q0_top
mk_Q0_last:
  s_branch mk_Q_drain
mk_Q0_rcv:
  s_add_u32 s11, s11, 1
  s_cmp_lt_u32 s11, 262144
  s_cbranch_scc0 mk_fail
  s_mov_b32 s13, s18
  s_mov_b32 m0, 0
  s_nop 0
  buffer_load_dwordx4 v5, s[4:7], s13 offen offset:0 sc1 lds
  buffer_load_dwordx4 v5, s[4:7], s13 offen offset:1024 sc1 lds
  buffer_load_dwordx4 v5, s[4:7], s13 offen offset:2048 sc1 lds
  buffer_load_dwordx4 v5, s[4:7], s13 offen offset:3072 sc1 lds
  s_mov_b32 m0, 4096
  s_add_u32 s13, s13, 4096
  buffer_load_dwordx4 v5, s[4:7], s13 offen offset:0 sc1 lds
  buffer_load_dwordx4 v5, s[4:7], s13 offen offset:1024 sc1 lds
  buffer_load_dwordx4 v5, s[4:7], s13 offen offset:2048 sc1 lds
  buffer_load_dwordx4 v5, s[4:7], s13 offen offset:3072 sc1 lds
  s_mov_b32 m0, 8192
  s_add_u32 s13, s13, 4096
  buffer_load_dwordx4 v5, s[4:7], s13 offen offset:0 sc1 lds
  buffer_load_dwordx4 v5, s[4:7], s13 offen offset:1024 sc1 lds
  s_waitcnt vmcnt(0) lgkmcnt(0)
  s_nop 7
  v_mov_b32 v20, 0
  v_mov_b32 v21, 0
  v_mov_b32 v22, 0
  v_mov_b32 v23, 0
  v_mov_b32 v24, 0
  v_mov_b32 v25, 0
  v_mov_b32 v26, 0
  v_mov_b32 v27, 0
  ds_read_b128 v[64:67], v3 offset:0
  ds_read_b128 v[68:71], v3 offset:512
  ds_read_b128 v[72:75], v3 offset:1024
  ds_read_b128 v[76:79], v3 offset:1536
  s_branch mk_Q0_chain
.p2alignl 4, 0xbf800000
mk_Q0_top:
  s_barrier
  s_nop 15
  s_nop 7
  buffer_load_dwordx4 v4, s[4:7], s18 offen offset:0 sc1 lds
  buffer_load_dwordx4 v4, s[4:7], s18 offen offset:1024 sc1 lds
  buffer_load_dwordx4 v4, s[4:7], s18 offen offset:2048 sc1 lds
  s_nop 15
  s_nop 13
  buffer_load_dwordx4 v4, s[4:7], s18 offen offset:0 sc1 lds
  buffer_load_dwordx4 v4, s[4:7], s18 offen offset:1024 sc1 lds
  buffer_load_dwordx4 v4, s[4:7], s18 offen offset:2048 sc1 lds
  s_branch mk_Q0_c1
.p2alignl 4, 0xbf800000
mk_Q0_c0:
  s_add_u32 s11, s11, 1
  s_cmp_lt_u32 s11, 262144
  s_cbranch_scc0 mk_fail
mk_Q0_c1:
  s_waitcnt vmcnt(3)
  ds_read_b32 v28, v53
  ds_read_b128 v[64:67], v3 offset:0
  ds_read_b128 v[68:71], v3 offset:512
  ds_read_b128 v[72:75], v3 offset:1024
  ds_read_b128 v[76:79], v3 offset:1536
  buffer_load_dwordx4 v4, s[4:7], s18 offen offset:0 sc1 lds
  buffer_load_dwordx4 v4, s[4:7], s18 offen offset:1024 sc1 lds
  buffer_load_dwordx4 v4, s[4:7], s18 offen offset:2048 sc1 lds
  s_waitcnt lgkmcnt(4)
  v_cmp_eq_u32 vcc, -1, v28
  s_nop 0
  s_cbranch_vccnz mk_Q0_c0
  s_barrier
mk_Q0_chain:
  s_waitcnt lgkmcnt(3)
  v_smfmac_f32_16x16x64_bf16 v[20:23], v[64:67], a[0:7], v2
  ds_read_b128 v[80:83], v3 offset:2048
  s_waitcnt lgkmcnt(3)
  v_smfmac_f32_16x16x64_bf16 v[20:23], v[68:71], a[8:15], v2
  ds_read_b128 v[84:87], v3 offset:2560
  s_waitcnt lgkmcnt(3)
  v_smfmac_f32_16x16x64_bf16 v[20:23], v[72:75], a[16:23], v2
  ds_read_b128 v[88:91], v3 offset:3072
  s_waitcnt lgkmcnt(3)
  v_smfmac_f32_16x16x64_bf16 v[20:23], v[76:79], a[24:31], v2
  ds_read_b128 v[92:95], v3 offset:3584
  s_waitcnt lgkmcnt(3)
  v_smfmac_f32_16x16x64_bf16 v[20:23], v[80:83], a[32:39], v2
  ds_read_b128 v[96:99], v3 offset:4096
  s_waitcnt lgkmcnt(3)
  v_smfmac_f32_16x16x64_bf16 v[20:23], v[84:87], a[40:47], v2
  ds_read_b128 v[100:103], v3 offset:4608
  s_waitcnt lgkmcnt(3)
  v_smfmac_f32_16x16x64_bf16 v[20:23], v[88:91], a[48:55], v2
  ds_read_b128 v[104:107], v3 offset:5120
  s_waitcnt lgkmcnt(3)
  v_smfmac_f32_16x16x64_bf16 v[20:23], v[92:95], a[56:63], v2
  ds_read_b128 v[108:111], v3 offset:5632
  s_waitcnt lgkmcnt(3)
  v_smfmac_f32_16x16x64_bf16 v[20:23], v[96:99], a[64:71], v2
  ds_read_b128 v[112:115], v3 offset:6144
  s_waitcnt lgkmcnt(3)
  v_smfmac_f32_16x16x64_bf16 v[20:23], v[100:103], a[72:79], v2
  ds_read_b128 v[116:119], v3 offset:6656
  s_waitcnt lgkmcnt(3)
  v_smfmac_f32_16x16x64_bf16 v[20:23], v[104:107], a[80:87], v2
  ds_read_b128 v[120:123], v3 offset:7168
  s_waitcnt lgkmcnt(3)
  v_smfmac_f32_16x16x64_bf16 v[20:23], v[108:111], a[88:95], v2
  ds_read_b128 v[124:127], v3 offset:7680
  s_waitcnt lgkmcnt(3)
  v_smfmac_f32_16x16x64_bf16 v[20:23], v[112:115], a[96:103], v2
  ds_read_b128 v[128:131], v3 offset:8192
  s_waitcnt lgkmcnt(3)
  v_smfmac_f32_16x16x64_bf16 v[20:23], v[116:119], a[104:111], v2
  ds_read_b128 v[132:135], v3 offset:8704
  s_waitcnt lgkmcnt(3)
  v_smfmac_f32_16x16x64_bf16 v[20:23], v[120:123], a[112:119], v2
  ds_read_b128 v[136:139], v3 offset:9216
  s_waitcnt lgkmcnt(3)
  v_smfmac_f32_16x16x64_bf16 v[20:23], v[124:127], a[120:127], v2
  ds_read_b128 v[140:143], v3 offset:9728
  s_waitcnt lgkmcnt(3)
  v_smfmac_f32_16x16x64_bf16 v[20:23], v[128:131], a[128:135], v2
  s_waitcnt lgkmcnt(2)
  v_smfmac_f32_16x16x64_bf16 v[20:23], v[132:135], a[136:143], v2
  s_waitcnt lgkmcnt(1)
  v_smfmac_f32_16x16x64_bf16 v[20:23], v[136:139], a[144:151], v2
  s_waitcnt lgkmcnt(0)
  v_smfmac_f32_16x16x64_bf16 v[20:23], v[140:143], a[152:159], v2
  v_smfmac_f32_16x16x64_bf16 v[24:27], v[64:67], a[160:167], v2
  v_smfmac_f32_16x16x64_bf16 v[24:27], v[68:71], a[168:175], v2
  v_cvt_pk_bf16_f32 v28, v20, v21
  v_cvt_pk_bf16_f32 v29, v22, v23
  ds_write_b64 v6, v[28:29] offset:10240
  v_maximum3_f32 v31, v20, v21, v22
  v_cmp_u_f32 vcc, v31, v23
  v_smfmac_f32_16x16x64_bf16 v[24:27], v[72:75], a[176:183], v2
  v_smfmac_f32_16x16x64_bf16 v[24:27], v[76:79], a[184:191], v2
  s_cbranch_vccnz mk_Q0_rcv
  s_waitcnt lgkmcnt(0)
  s_barrier
  ds_read_b64_tr_b16 v[36:37], v7 offset:10240
  ds_read_b64_tr_b16 v[38:39], v7 offset:10368
  ds_read_b64_tr_b16 v[40:41], v7 offset:10496
  ds_read_b64_tr_b16 v[42:43], v7 offset:10624
  v_smfmac_f32_16x16x64_bf16 v[24:27], v[80:83], a[192:199], v2
  v_smfmac_f32_16x16x64_bf16 v[24:27], v[84:87], a[200:207], v2
  s_waitcnt lgkmcnt(2)
  v_mfma_f32_16x16x32_bf16 v[32:35], v[44:47], v[36:39], 0
  s_waitcnt lgkmcnt(0)
  v_mfma_f32_16x16x32_bf16 v[32:35], v[48:51], v[40:43], v[32:35]
  v_smfmac_f32_16x16x64_bf16 v[24:27], v[88:91], a[208:215], v2
  v_smfmac_f32_16x16x64_bf16 v[24:27], v[92:95], a[216:223], v2
  buffer_store_dwordx4 v[32:35], v9, s[4:7], s30 offen
  v_smfmac_f32_16x16x64_bf16 v[24:27], v[96:99], a[224:231], v2
  v_smfmac_f32_16x16x64_bf16 v[24:27], v[100:103], a[232:239], v2
  v_smfmac_f32_16x16x64_bf16 v[24:27], v[104:107], a[240:247], v2
  v_smfmac_f32_16x16x64_bf16 v[24:27], v[108:111], a[248:255], v2
  s_andn2_b32 s13, 63, s10
  s_cbranch_scc0 int_w135
  buffer_load_dwordx2 v[44:45], v10, s[4:7], s28 offen sc1
  buffer_load_dwordx2 v[46:47], v11, s[4:7], s28 offen sc1
  buffer_load_dwordx2 v[48:49], v10, s[4:7], s29 offen sc1
  buffer_load_dwordx2 v[50:51], v11, s[4:7], s29 offen sc1
  s_add_u32 s13, s10, 5
  s_cmp_ge_u32 s20, s13
  s_cbranch_scc1 int_w135
  buffer_load_dword v55, v54, s[4:7], s21 offen sc1
int_w135:
  v_smfmac_f32_16x16x64_bf16 v[24:27], v[112:115], v[192:199], v2
  v_smfmac_f32_16x16x64_bf16 v[24:27], v[116:119], v[200:207], v2
  buffer_store_dwordx4 v[16:19], v9, s[4:7], s31 offen
  v_smfmac_f32_16x16x64_bf16 v[24:27], v[120:123], v[208:215], v2
  v_smfmac_f32_16x16x64_bf16 v[24:27], v[124:127], v[216:223], v2
  v_smfmac_f32_16x16x64_bf16 v[24:27], v[128:131], v[224:231], v2
  v_smfmac_f32_16x16x64_bf16 v[24:27], v[132:135], v[232:239], v2
  v_smfmac_f32_16x16x64_bf16 v[24:27], v[136:139], v[240:247], v2
  v_smfmac_f32_16x16x64_bf16 v[24:27], v[140:143], v[248:255], v2
  s_nop 7
  v_cvt_pk_bf16_f32 v32, v24, v25
  v_cvt_pk_bf16_f32 v33, v26, v27
  ds_write_b64 v0, v[32:33] offset:0
  s_waitcnt lgkmcnt(0)
  s_barrier
  s_andn2_b32 s13, 63, s10
  s_cbranch_scc0 mk_Q0_b4b
  s_barrier
mk_Q0_b4b:
mk_Q0_tok:
  s_add_u32 s10, s10, 1
  s_and_b32 s13, s10, 63
  s_cbranch_scc0 mk_Q0_last
  v_mov_b32 v20, 0
  v_mov_b32 v21, 0
  v_mov_b32 v22, 0
  v_mov_b32 v23, 0
  v_mov_b32 v24, 0
  v_mov_b32 v25, 0
  v_mov_b32 v26, 0
  v_mov_b32 v27, 0
  s_and_b32 s18, s10, 3
  s_lshl_b32 s18, s18, 14
  s_add_u32 s18, s18, s17
  s_mov_b32 s11, 0
  s_mul_hi_u32 s68, s10, 0x2aaaaaab
  s_mul_i32 s68, s68, 6
  s_sub_u32 s13, s10, s68
  s_mul_i32 s13, s13, 20480
  s_add_u32 s13, s13, 33792
  v_add_u32 v0, s13, v8
  s_and_b32 s30, s10, 3
  s_lshl_b32 s30, s30, 15
  s_add_u32 s30, s30, s26
  s_add_u32 s31, s10, 3
  s_and_b32 s31, s31, 3
  s_lshl_b32 s31, s31, 15
  s_add_u32 s31, s31, s26
  s_waitcnt vmcnt(0)
  v_min_u32_dpp v55, v55, v55 quad_perm:[1,0,3,2] row_mask:0xf bank_mask:0xf
  s_nop 1
  v_min_u32_dpp v55, v55, v55 quad_perm:[2,3,0,1] row_mask:0xf bank_mask:0xf
  s_nop 1
  v_min_u32_dpp v55, v55, v55 row_half_mirror row_mask:0xf bank_mask:0xf
  s_nop 1
  v_min_u32_dpp v55, v55, v55 row_mirror row_mask:0xf bank_mask:0xf
  v_mov_b32 v28, v55
  s_nop 1
  v_permlane16_swap_b32 v55, v28
  v_min_u32 v55, v55, v28
  v_mov_b32 v28, v55
  s_nop 1
  v_permlane32_swap_b32 v55, v28
  v_min_u32 v55, v55, v28
  s_nop 0
  v_readfirstlane_b32 s13, v55
  s_nop 0
  s_max_u32 s20, s20, s13
  s_or_b32 s13, s10, 63
  s_add_u32 s13, s13, 1
  s_add_u32 s14, s10, 2
  s_min_u32 s13, s13, s14
  s_cmp_ge_u32 s20, s13
  s_cbranch_scc1 int_wm36_ok
  s_mov_b32 s70, 0
int_wm36:
  buffer_load_dword v28, v54, s[4:7], s21 offen sc1
  s_waitcnt vmcnt(0)
  v_min_u32_dpp v28, v28, v28 quad_perm:[1,0,3,2] row_mask:0xf bank_mask:0xf
  s_nop 1
  v_min_u32_dpp v28, v28, v28 quad_perm:[2,3,0,1] row_mask:0xf bank_mask:0xf
  s_nop 1
  v_min_u32_dpp v28, v28, v28 row_half_mirror row_mask:0xf bank_mask:0xf
  s_nop 1
  v_min_u32_dpp v28, v28, v28 row_mirror row_mask:0xf bank_mask:0xf
  v_mov_b32 v29, v28
  s_nop 1
  v_permlane16_swap_b32 v28, v29
  v_min_u32 v28, v28, v29
  v_mov_b32 v29, v28
  s_nop 1
  v_permlane32_swap_b32 v28, v29
  v_min_u32 v28, v28, v29
  s_nop 0
  v_readfirstlane_b32 s20, v28
  s_nop 0
  s_cmp_ge_u32 s20, s13
  s_cbranch_scc1 int_wm36_ok
  s_sleep 1
  s_add_u32 s70, s70, 1
  s_cmp_lt_u32 s70, 262144
  s_cbranch_scc1 int_wm36
  s_branch mk_fail
int_wm36_ok:
  s_add_u32 s28, s10, 1
  s_and_b32 s28, s28, 31
  s_lshl_b32 s28, s28, 2
  s_add_u32 s28, s28, s8
  s_lshr_b32 s68, s28, 1
  s_bitcmp1_b64 s[64:65], s68
  s_cselect_b32 s68, 0x2000, 0
  s_lshl_b32 s28, s28, 20
  s_add_u32 s28, s28, s68
  s_add_u32 s28, s28, s32
  s_add_u32 s29, s28, s33
  s_mov_b32 m0, s19
  s_waitcnt lgkmcnt(0)
  s_branch mk_Q0_top
mk_Q1_init:
  s_lshl_b32 s26, s8, 17
  s_lshl_b32 s13, s37, 12
  s_add_u32 s26, s26, s13
  s_add_u32 s26, s26, 64225280
  s_mul_i32 s13, s16, 1280
  s_add_u32 s26, s26, s13
  v_bfe_u32 v62, v1, 2, 3
  v_lshlrev_b32 v54, 7, v62
  v_add_u32 v54, 8192, v54
  s_lshl_b32 s13, s37, 7
  v_mov_b32 v62, s13
  v_cmp_lt_u32 vcc, 31, v1
  s_nop 1
  v_cndmask_b32 v54, v54, v62, vcc
  v_and_b32 v62, 3, v1
  v_lshl_add_u32 v54, v62, 2, v54
  s_lshl_b32 s21, s8, 10
  s_add_u32 s21, s21, 64880640
  s_mov_b32 s20, 0
  v_mov_b32 v55, 0
  v_lshrrev_b32 v9, 1, v60
  v_lshlrev_b32 v9, 8, v9
  v_lshl_add_u32 v9, v61, 5, v9
  v_and_b32 v62, 1, v60
  v_lshl_add_u32 v9, v62, 4, v9
  v_add_u32 v9, 128, v9
  v_lshrrev_b32 v62, 3, v60
  v_lshl_add_u32 v9, v62, 30, v9
  s_lshl_b32 s13, s37, 14
  s_lshl_b32 s14, s16, 11
  s_add_u32 s13, s13, s14
  s_add_u32 s13, s13, 659456
  s_lshr_b32 s14, s37, 1
  s_lshl_b32 s14, s14, 14
  s_and_b32 s15, s37, 1
  s_lshl_b32 s15, s15, 12
  s_add_u32 s14, s14, s15
  s_add_u32 s14, s14, 786440
  s_cmp_eq_u32 s16, 2
  s_cselect_b32 s32, s14, s13
  s_cselect_b32 s33, 1024, 0
  s_cselect_b32 s15, 1024, 8
  s_add_u32 s33, s33, 1024
  s_add_u32 s32, s32, s39
  v_mov_b32 v10, v5
  v_add_u32 v11, s15, v5
  v_min_u32 v53, 47, v1
  v_lshrrev_b32 v62, 1, v53
  v_and_b32 v62, 15, v62
  v_lshlrev_b32 v53, 6, v53
  v_lshl_add_u32 v53, v62, 2, v53
  v_add_u32 v53, s19, v53
mk_Q1_prime:
  v_mov_b32 v20, 0
  v_mov_b32 v21, 0
  v_mov_b32 v22, 0
  v_mov_b32 v23, 0
  v_mov_b32 v24, 0
  v_mov_b32 v25, 0
  v_mov_b32 v26, 0
  v_mov_b32 v27, 0
  s_and_b32 s18, s10, 3
  s_lshl_b32 s18, s18, 14
  s_add_u32 s18, s18, s17
  s_mov_b32 s11, 0
  s_mul_hi_u32 s68, s10, 0x2aaaaaab
  s_mul_i32 s68, s68, 6
  s_sub_u32 s13, s10, s68
  s_mul_i32 s13, s13, 20480
  s_add_u32 s13, s13, 33792
  v_add_u32 v0, s13, v8
  s_and_b32 s30, s10, 3
  s_lshl_b32 s30, s30, 15
  s_add_u32 s30, s30, s26
  s_add_u32 s31, s10, 3
  s_and_b32 s31, s31, 3
  s_lshl_b32 s31, s31, 15
  s_add_u32 s31, s31, s26
  s_add_u32 s13, s10, 1
  s_cmp_ge_u32 s20, s13
  s_cbranch_scc1 int_wm37_ok
  s_mov_b32 s70, 0
int_wm37:
  buffer_load_dword v28, v54, s[4:7], s21 offen sc1
  s_waitcnt vmcnt(0)
  v_min_u32_dpp v28, v28, v28 quad_perm:[1,0,3,2] row_mask:0xf bank_mask:0xf
  s_nop 1
  v_min_u32_dpp v28, v28, v28 quad_perm:[2,3,0,1] row_mask:0xf bank_mask:0xf
  s_nop 1
  v_min_u32_dpp v28, v28, v28 row_half_mirror row_mask:0xf bank_mask:0xf
  s_nop 1
  v_min_u32_dpp v28, v28, v28 row_mirror row_mask:0xf bank_mask:0xf
  v_mov_b32 v29, v28
  s_nop 1
  v_permlane16_swap_b32 v28, v29
  v_min_u32 v28, v28, v29
  v_mov_b32 v29, v28
  s_nop 1
  v_permlane32_swap_b32 v28, v29
  v_min_u32 v28, v28, v29
  s_nop 0
  v_readfirstlane_b32 s20, v28
  s_nop 0
  s_cmp_ge_u32 s20, s13
  s_cbranch_scc1 int_wm37_ok
  s_sleep 1
  s_add_u32 s70, s70, 1
  s_cmp_lt_u32 s70, 262144
  s_cbranch_scc1 int_wm37
  s_branch mk_fail
int_wm37_ok:
  s_and_b32 s34, s10, 31
  s_lshl_b32 s34, s34, 2
  s_add_u32 s34, s34, s8
  s_lshr_b32 s68, s34, 1
  s_bitcmp1_b64 s[64:65], s68
  s_cselect_b32 s68, 0x2000, 0
  s_lshl_b32 s34, s34, 20
  s_add_u32 s34, s34, s68
  s_add_u32 s34, s34, s40
  s_mul_hi_u32 s68, s10, 0x2aaaaaab
  s_mul_i32 s68, s68, 6
  s_sub_u32 s35, s10, s68
  s_mul_i32 s35, s35, 20480
  s_add_u32 s35, s35, 33792
  s_and_b32 s28, s10, 31
  s_lshl_b32 s28, s28, 2
  s_add_u32 s28, s28, s8
  s_lshr_b32 s68, s28, 1
  s_bitcmp1_b64 s[64:65], s68
  s_cselect_b32 s68, 0x2000, 0
  s_lshl_b32 s28, s28, 20
  s_add_u32 s28, s28, s68
  s_add_u32 s28, s28, s32
  s_add_u32 s29, s28, s33
  s_add_u32 m0, s35, 0
  s_add_u32 s15, s34, 0
  buffer_load_dwordx4 v5, s[4:7], s15 offen offset:0 sc1 lds
  buffer_load_dwordx4 v5, s[4:7], s15 offen offset:1024 sc1 lds
  buffer_load_dwordx4 v5, s[4:7], s15 offen offset:2048 sc1 lds
  buffer_load_dwordx4 v5, s[4:7], s15 offen offset:3072 sc1 lds
  s_add_u32 m0, s35, 4096
  s_add_u32 s15, s34, 4096
  buffer_load_dwordx4 v5, s[4:7], s15 offen offset:0 sc1 lds
  buffer_load_dwordx4 v5, s[4:7], s15 offen offset:1024 sc1 lds
  buffer_load_dwordx4 v5, s[4:7], s15 offen offset:2048 sc1 lds
  buffer_load_dwordx4 v5, s[4:7], s15 offen offset:3072 sc1 lds
  buffer_load_dwordx2 v[44:45], v10, s[4:7], s28 offen sc1
  buffer_load_dwordx2 v[46:47], v11, s[4:7], s28 offen sc1
  buffer_load_dwordx2 v[48:49], v10, s[4:7], s29 offen sc1
  buffer_load_dwordx2 v[50:51], v11, s[4:7], s29 offen sc1
  s_or_b32 s13, s10, 63
  s_add_u32 s13, s13, 1
  s_add_u32 s14, s10, 2
  s_min_u32 s13, s13, s14
  s_cmp_ge_u32 s20, s13
  s_cbranch_scc1 int_wm38_ok
  s_mov_b32 s70, 0
int_wm38:
  buffer_load_dword v28, v54, s[4:7], s21 offen sc1
  s_waitcnt vmcnt(0)
  v_min_u32_dpp v28, v28, v28 quad_perm:[1,0,3,2] row_mask:0xf bank_mask:0xf
  s_nop 1
  v_min_u32_dpp v28, v28, v28 quad_perm:[2,3,0,1] row_mask:0xf bank_mask:0xf
  s_nop 1
  v_min_u32_dpp v28, v28, v28 row_half_mirror row_mask:0xf bank_mask:0xf
  s_nop 1
  v_min_u32_dpp v28, v28, v28 row_mirror row_mask:0xf bank_mask:0xf
  v_mov_b32 v29, v28
  s_nop 1
  v_permlane16_swap_b32 v28, v29
  v_min_u32 v28, v28, v29
  v_mov_b32 v29, v28
  s_nop 1
  v_permlane32_swap_b32 v28, v29
  v_min_u32 v28, v28, v29
  s_nop 0
  v_readfirstlane_b32 s20, v28
  s_nop 0
  s_cmp_ge_u32 s20, s13
  s_cbranch_scc1 int_wm38_ok
  s_sleep 1
  s_add_u32 s70, s70, 1
  s_cmp_lt_u32 s70, 262144
  s_cbranch_scc1 int_wm38
  s_branch mk_fail
int_wm38_ok:
  s_add_u32 s34, s10, 1
  s_and_b32 s34, s34, 31
  s_lshl_b32 s34, s34, 2
  s_add_u32 s34, s34, s8
  s_lshr_b32 s68, s34, 1
  s_bitcmp1_b64 s[64:65], s68
  s_cselect_b32 s68, 0x2000, 0
  s_lshl_b32 s34, s34, 20
  s_add_u32 s34, s34, s68
  s_add_u32 s34, s34, s40
  s_add_u32 s35, s10, 1
  s_mul_hi_u32 s68, s35, 0x2aaaaaab
  s_mul_i32 s68, s68, 6
  s_sub_u32 s35, s35, s68
  s_mul_i32 s35, s35, 20480
  s_add_u32 s35, s35, 33792
  s_add_u32 s28, s10, 1
  s_and_b32 s28, s28, 31
  s_lshl_b32 s28, s28, 2
  s_add_u32 s28, s28, s8
  s_lshr_b32 s68, s28, 1
  s_bitcmp1_b64 s[64:65], s68
  s_cselect_b32 s68, 0x2000, 0
  s_lshl_b32 s28, s28, 20
  s_add_u32 s28, s28, s68
  s_add_u32 s28, s28, s32
  s_add_u32 s29, s28, s33
  s_mov_b32 m0, s19
  s_waitcnt vmcnt(0) lgkmcnt(0)
  s_branch mk_Q1_top
mk_Q1_last:
  s_branch mk_Q_drain
mk_Q1_rcv:
  s_add_u32 s11, s11, 1
  s_cmp_lt_u32 s11, 262144
  s_cbranch_scc0 mk_fail
  s_mov_b32 s13, s18
  s_mov_b32 m0, 0
  s_nop 0
  buffer_load_dwordx4 v5, s[4:7], s13 offen offset:0 sc1 lds
  buffer_load_dwordx4 v5, s[4:7], s13 offen offset:1024 sc1 lds
  buffer_load_dwordx4 v5, s[4:7], s13 offen offset:2048 sc1 lds
  buffer_load_dwordx4 v5, s[4:7], s13 offen offset:3072 sc1 lds
  s_mov_b32 m0, 4096
  s_add_u32 s13, s13, 4096
  buffer_load_dwordx4 v5, s[4:7], s13 offen offset:0 sc1 lds
  buffer_load_dwordx4 v5, s[4:7], s13 offen offset:1024 sc1 lds
  buffer_load_dwordx4 v5, s[4:7], s13 offen offset:2048 sc1 lds
  buffer_load_dwordx4 v5, s[4:7], s13 offen offset:3072 sc1 lds
  s_mov_b32 m0, 8192
  s_add_u32 s13, s13, 4096
  buffer_load_dwordx4 v5, s[4:7], s13 offen offset:0 sc1 lds
  buffer_load_dwordx4 v5, s[4:7], s13 offen offset:1024 sc1 lds
  s_waitcnt vmcnt(0) lgkmcnt(0)
  s_nop 7
  v_mov_b32 v20, 0
  v_mov_b32 v21, 0
  v_mov_b32 v22, 0
  v_mov_b32 v23, 0
  v_mov_b32 v24, 0
  v_mov_b32 v25, 0
  v_mov_b32 v26, 0
  v_mov_b32 v27, 0
  ds_read_b128 v[88:91], v3 offset:3072
  ds_read_b128 v[92:95], v3 offset:3584
  ds_read_b128 v[96:99], v3 offset:4096
  ds_read_b128 v[100:103], v3 offset:4608
  s_branch mk_Q1_chain
.p2alignl 4, 0xbf800000
mk_Q1_top:
  s_barrier
  s_nop 15
  s_nop 7
  buffer_load_dwordx4 v4, s[4:7], s18 offen offset:0 sc1 lds
  buffer_load_dwordx4 v4, s[4:7], s18 offen offset:1024 sc1 lds
  buffer_load_dwordx4 v4, s[4:7], s18 offen offset:2048 sc1 lds
  s_nop 15
  s_nop 13
  buffer_load_dwordx4 v4, s[4:7], s18 offen offset:0 sc1 lds
  buffer_load_dwordx4 v4, s[4:7], s18 offen offset:1024 sc1 lds
  buffer_load_dwordx4 v4, s[4:7], s18 offen offset:2048 sc1 lds
  s_branch mk_Q1_c1
.p2alignl 4, 0xbf800000
mk_Q1_c0:
  s_add_u32 s11, s11, 1
  s_cmp_lt_u32 s11, 262144
  s_cbranch_scc0 mk_fail
mk_Q1_c1:
  s_waitcnt vmcnt(3)
  ds_read_b32 v28, v53
  ds_read_b128 v[88:91], v3 offset:3072
  ds_read_b128 v[92:95], v3 offset:3584
  ds_read_b128 v[96:99], v3 offset:4096
  ds_read_b128 v[100:103], v3 offset:4608
  buffer_load_dwordx4 v4, s[4:7], s18 offen offset:0 sc1 lds
  buffer_load_dwordx4 v4, s[4:7], s18 offen offset:1024 sc1 lds
  buffer_load_dwordx4 v4, s[4:7], s18 offen offset:2048 sc1 lds
  s_waitcnt lgkmcnt(4)
  v_cmp_eq_u32 vcc, -1, v28
  s_nop 0
  s_cbranch_vccnz mk_Q1_c0
  s_barrier
mk_Q1_chain:
  s_waitcnt lgkmcnt(3)
  v_smfmac_f32_16x16x64_bf16 v[20:23], v[88:91], a[48:55], v2
  ds_read_b128 v[104:107], v3 offset:5120
  s_waitcnt lgkmcnt(3)
  v_smfmac_f32_16x16x64_bf16 v[20:23], v[92:95], a[56:63], v2
  ds_read_b128 v[108:111], v3 offset:5632
  s_waitcnt lgkmcnt(3)
  v_smfmac_f32_16x16x64_bf16 v[20:23], v[96:99], a[64:71], v2
  ds_read_b128 v[112:115], v3 offset:6144
  s_waitcnt lgkmcnt(3)
  v_smfmac_f32_16x16x64_bf16 v[20:23], v[100:103], a[72:79], v2
  ds_read_b128 v[116:119], v3 offset:6656
  s_waitcnt lgkmcnt(3)
  v_smfmac_f32_16x16x64_bf16 v[20:23], v[104:107], a[80:87], v2
  ds_read_b128 v[120:123], v3 offset:7168
  s_waitcnt lgkmcnt(3)
  v_smfmac_f32_16x16x64_bf16 v[20:23], v[108:111], a[88:95], v2
  ds_read_b128 v[124:127], v3 offset:7680
  s_waitcnt lgkmcnt(3)
  v_smfmac_f32_16x16x64_bf16 v[20:23], v[112:115], a[96:103], v2
  ds_read_b128 v[128:131], v3 offset:8192
  s_waitcnt lgkmcnt(3)
  v_smfmac_f32_16x16x64_bf16 v[20:23], v[116:119], a[104:111], v2
  ds_read_b128 v[132:135], v3 offset:8704
  s_waitcnt lgkmcnt(3)
  v_smfmac_f32_16x16x64_bf16 v[20:23], v[120:123], a[112:119], v2
  ds_read_b128 v[136:139], v3 offset:9216
  s_waitcnt lgkmcnt(3)
  v_smfmac_f32_16x16x64_bf16 v[20:23], v[124:127], a[120:127], v2
  ds_read_b128 v[140:143], v3 offset:9728
  s_waitcnt lgkmcnt(3)
  v_smfmac_f32_16x16x64_bf16 v[20:23], v[128:131], a[128:135], v2
  ds_read_b128 v[64:67], v3 offset:0
  s_waitcnt lgkmcnt(3)
  v_smfmac_f32_16x16x64_bf16 v[20:23], v[132:135], a[136:143], v2
  ds_read_b128 v[68:71], v3 offset:512
  s_waitcnt lgkmcnt(3)
  v_smfmac_f32_16x16x64_bf16 v[20:23], v[136:139], a[144:151], v2
  ds_read_b128 v[72:75], v3 offset:1024
  s_waitcnt lgkmcnt(3)
  v_smfmac_f32_16x16x64_bf16 v[20:23], v[140:143], a[152:159], v2
  ds_read_b128 v[76:79], v3 offset:1536
  s_waitcnt lgkmcnt(3)
  v_smfmac_f32_16x16x64_bf16 v[20:23], v[64:67], a[0:7], v2
  ds_read_b128 v[80:83], v3 offset:2048
  s_waitcnt lgkmcnt(3)
  v_smfmac_f32_16x16x64_bf16 v[20:23], v[68:71], a[8:15], v2
  ds_read_b128 v[84:87], v3 offset:2560
  s_waitcnt lgkmcnt(3)
  v_smfmac_f32_16x16x64_bf16 v[20:23], v[72:75], a[16:23], v2
  s_waitcnt lgkmcnt(2)
  v_smfmac_f32_16x16x64_bf16 v[20:23], v[76:79], a[24:31], v2
  s_waitcnt lgkmcnt(1)
  v_smfmac_f32_16x16x64_bf16 v[20:23], v[80:83], a[32:39], v2
  s_waitcnt lgkmcnt(0)
  v_smfmac_f32_16x16x64_bf16 v[20:23], v[84:87], a[40:47], v2
  v_smfmac_f32_16x16x64_bf16 v[24:27], v[64:67], a[160:167], v2
  v_smfmac_f32_16x16x64_bf16 v[24:27], v[68:71], a[168:175], v2
  v_cvt_pk_bf16_f32 v28, v20, v21
  v_cvt_pk_bf16_f32 v29, v22, v23
  ds_write_b64 v6, v[28:29] offset:10240
  v_maximum3_f32 v31, v20, v21, v22
  v_cmp_u_f32 vcc, v31, v23
  v_smfmac_f32_16x16x64_bf16 v[24:27], v[72:75], a[176:183], v2
  v_smfmac_f32_16x16x64_bf16 v[24:27], v[76:79], a[184:191], v2
  s_cbranch_vccnz mk_Q1_rcv
  s_waitcnt lgkmcnt(0)
  s_barrier
  ds_read_b64_tr_b16 v[36:37], v7 offset:10240
  ds_read_b64_tr_b16 v[38:39], v7 offset:10368
  ds_read_b64_tr_b16 v[40:41], v7 offset:10496
  ds_read_b64_tr_b16 v[42:43], v7 offset:10624
  v_smfmac_f32_16x16x64_bf16 v[24:27], v[80:83], a[192:199], v2
  v_smfmac_f32_16x16x64_bf16 v[24:27], v[84:87], a[200:207], v2
  s_waitcnt lgkmcnt(2)
  v_mfma_f32_16x16x32_bf16 v[32:35], v[44:47], v[36:39], 0
  s_waitcnt lgkmcnt(0)
  v_mfma_f32_16x16x32_bf16 v[32:35], v[48:51], v[40:43], v[32:35]
  v_smfmac_f32_16x16x64_bf16 v[24:27], v[88:91], a[208:215], v2
  v_smfmac_f32_16x16x64_bf16 v[24:27], v[92:95], a[216:223], v2
  buffer_store_dwordx4 v[32:35], v9, s[4:7], s30 offen
  v_smfmac_f32_16x16x64_bf16 v[24:27], v[96:99], a[224:231], v2
  v_smfmac_f32_16x16x64_bf16 v[24:27], v[100:103], a[232:239], v2
  v_smfmac_f32_16x16x64_bf16 v[24:27], v[104:107], a[240:247], v2
  v_smfmac_f32_16x16x64_bf16 v[24:27], v[108:111], a[248:255], v2
  s_andn2_b32 s13, 63, s10
  s_cbranch_scc0 int_w139
  s_add_u32 m0, s35, 0
  s_add_u32 s15, s34, 0
  buffer_load_dwordx4 v5, s[4:7], s15 offen offset:0 sc1 lds
  buffer_load_dwordx4 v5, s[4:7], s15 offen offset:1024 sc1 lds
  buffer_load_dwordx4 v5, s[4:7], s15 offen offset:2048 sc1 lds
  buffer_load_dwordx4 v5, s[4:7], s15 offen offset:3072 sc1 lds
  s_add_u32 m0, s35, 4096
  s_add_u32 s15, s34, 4096
  buffer_load_dwordx4 v5, s[4:7], s15 offen offset:0 sc1 lds
  buffer_load_dwordx4 v5, s[4:7], s15 offen offset:1024 sc1 lds
  buffer_load_dwordx4 v5, s[4:7], s15 offen offset:2048 sc1 lds
  buffer_load_dwordx4 v5, s[4:7], s15 offen offset:3072 sc1 lds
  buffer_load_dwordx2 v[44:45], v10, s[4:7], s28 offen sc1
  buffer_load_dwordx2 v[46:47], v11, s[4:7], s28 offen sc1
  buffer_load_dwordx2 v[48:49], v10, s[4:7], s29 offen sc1
  buffer_load_dwordx2 v[50:51], v11, s[4:7], s29 offen sc1
  s_add_u32 s13, s10, 5
  s_cmp_ge_u32 s20, s13
  s_cbranch_scc1 int_w139
  buffer_load_dword v55, v54, s[4:7], s21 offen sc1
int_w139:
  v_smfmac_f32_16x16x64_bf16 v[24:27], v[112:115], v[192:199], v2
  v_smfmac_f32_16x16x64_bf16 v[24:27], v[116:119], v[200:207], v2
  buffer_store_dwordx4 v[16:19], v9, s[4:7], s31 offen
  v_smfmac_f32_16x16x64_bf16 v[24:27], v[120:123], v[208:215], v2
  v_smfmac_f32_16x16x64_bf16 v[24:27], v[124:127], v[216:223], v2
  v_smfmac_f32_16x16x64_bf16 v[24:27], v[128:131], v[224:231], v2
  v_smfmac_f32_16x16x64_bf16 v[24:27], v[132:135], v[232:239], v2
  v_smfmac_f32_16x16x64_bf16 v[24:27], v[136:139], v[240:247], v2
  v_smfmac_f32_16x16x64_bf16 v[24:27], v[140:143], v[248:255], v2
  s_nop 7
  v_cvt_pk_bf16_f32 v32, v24, v25
  v_cvt_pk_bf16_f32 v33, v26, v27
  ds_write_b64 v0, v[32:33] offset:0
  s_waitcnt lgkmcnt(0)
  s_barrier
  s_andn2_b32 s13, 63, s10
  s_cbranch_scc0 mk_Q1_b4b
  s_barrier
mk_Q1_b4b:
mk_Q1_tok:
  s_add_u32 s10, s10, 1
  s_and_b32 s13, s10, 63
  s_cbranch_scc0 mk_Q1_last
  v_mov_b32 v20, 0
  v_mov_b32 v21, 0
  v_mov_b32 v22, 0
  v_mov_b32 v23, 0
  v_mov_b32 v24, 0
  v_mov_b32 v25, 0
  v_mov_b32 v26, 0
  v_mov_b32 v27, 0
  s_and_b32 s18, s10, 3
  s_lshl_b32 s18, s18, 14
  s_add_u32 s18, s18, s17
  s_mov_b32 s11, 0
  s_mul_hi_u32 s68, s10, 0x2aaaaaab
  s_mul_i32 s68, s68, 6
  s_sub_u32 s13, s10, s68
  s_mul_i32 s13, s13, 20480
  s_add_u32 s13, s13, 33792
  v_add_u32 v0, s13, v8
  s_and_b32 s30, s10, 3
  s_lshl_b32 s30, s30, 15
  s_add_u32 s30, s30, s26
  s_add_u32 s31, s10, 3
  s_and_b32 s31, s31, 3
  s_lshl_b32 s31, s31, 15
  s_add_u32 s31, s31, s26
  s_waitcnt vmcnt(0)
  v_min_u32_dpp v55, v55, v55 quad_perm:[1,0,3,2] row_mask:0xf bank_mask:0xf
  s_nop 1
  v_min_u32_dpp v55, v55, v55 quad_perm:[2,3,0,1] row_mask:0xf bank_mask:0xf
  s_nop 1
  v_min_u32_dpp v55, v55, v55 row_half_mirror row_mask:0xf bank_mask:0xf
  s_nop 1
  v_min_u32_dpp v55, v55, v55 row_mirror row_mask:0xf bank_mask:0xf
  v_mov_b32 v28, v55
  s_nop 1
  v_permlane16_swap_b32 v55, v28
  v_min_u32 v55, v55, v28
  v_mov_b32 v28, v55
  s_nop 1
  v_permlane32_swap_b32 v55, v28
  v_min_u32 v55, v55, v28
  s_nop 0
  v_readfirstlane_b32 s13, v55
  s_nop 0
  s_max_u32 s20, s20, s13
  s_or_b32 s13, s10, 63
  s_add_u32 s13, s13, 1
  s_add_u32 s14, s10, 2
  s_min_u32 s13, s13, s14
  s_cmp_ge_u32 s20, s13
  s_cbranch_scc1 int_wm40_ok
  s_mov_b32 s70, 0
int_wm40:
  buffer_load_dword v28, v54, s[4:7], s21 offen sc1
  s_waitcnt vmcnt(0)
  v_min_u32_dpp v28, v28, v28 quad_perm:[1,0,3,2] row_mask:0xf bank_mask:0xf
  s_nop 1
  v_min_u32_dpp v28, v28, v28 quad_perm:[2,3,0,1] row_mask:0xf bank_mask:0xf
  s_nop 1
  v_min_u32_dpp v28, v28, v28 row_half_mirror row_mask:0xf bank_mask:0xf
  s_nop 1
  v_min_u32_dpp v28, v28, v28 row_mirror row_mask:0xf bank_mask:0xf
  v_mov_b32 v29, v28
  s_nop 1
  v_permlane16_swap_b32 v28, v29
  v_min_u32 v28, v28, v29
  v_mov_b32 v29, v28
  s_nop 1
  v_permlane32_swap_b32 v28, v29
  v_min_u32 v28, v28, v29
  s_nop 0
  v_readfirstlane_b32 s20, v28
  s_nop 0
  s_cmp_ge_u32 s20, s13
  s_cbranch_scc1 int_wm40_ok
  s_sleep 1
  s_add_u32 s70, s70, 1
  s_cmp_lt_u32 s70, 262144
  s_cbranch_scc1 int_wm40
  s_branch mk_fail
int_wm40_ok:
  s_add_u32 s34, s10, 1
  s_and_b32 s34, s34, 31
  s_lshl_b32 s34, s34, 2
  s_add_u32 s34, s34, s8
  s_lshr_b32 s68, s34, 1
  s_bitcmp1_b64 s[64:65], s68
  s_cselect_b32 s68, 0x2000, 0
  s_lshl_b32 s34, s34, 20
  s_add_u32 s34, s34, s68
  s_add_u32 s34, s34, s40
  s_add_u32 s35, s10, 1
  s_mul_hi_u32 s68, s35, 0x2aaaaaab
  s_mul_i32 s68, s68, 6
  s_sub_u32 s35, s35, s68
  s_mul_i32 s35, s35, 20480
  s_add_u32 s35, s35, 33792
  s_add_u32 s28, s10, 1
  s_and_b32 s28, s28, 31
  s_lshl_b32 s28, s28, 2
  s_add_u32 s28, s28, s8
  s_lshr_b32 s68, s28, 1
  s_bitcmp1_b64 s[64:65], s68
  s_cselect_b32 s68, 0x2000, 0
  s_lshl_b32 s28, s28, 20
  s_add_u32 s28, s28, s68
  s_add_u32 s28, s28, s32
  s_add_u32 s29, s28, s33
  s_mov_b32 m0, s19
  s_waitcnt lgkmcnt(0)
  s_branch mk_Q1_top
mk_Q2_init:
  s_lshl_b32 s26, s8, 17
  s_lshl_b32 s13, s37, 12
  s_add_u32 s26, s26, s13
  s_add_u32 s26, s26, 64225280
  s_mul_i32 s13, s16, 1280
  s_add_u32 s26, s26, s13
  v_lshlrev_b32 v9, 3, v60
  v_lshl_add_u32 v9, v61, 7, v9
  v_add_u32 v9, 960, v9
  v_and_b32 v14, 7, v1
  v_lshlrev_b32 v14, 4, v14
  v_lshl_add_u32 v14, v61, 7, v14
  v_lshrrev_b32 v62, 3, v60
  v_xor_b32 v62, 1, v62
  v_lshl_add_u32 v14, v62, 30, v14
  v_lshrrev_b32 v63, 1, v61
  v_or_b32 v62, v62, v63
  v_lshl_add_u32 v9, v62, 30, v9
  s_add_u32 s73, s37, 52
  s_lshl_b32 s73, s73, 14
  s_lshl_b32 s13, s16, 10
  s_add_u32 s73, s73, s13
  s_add_u32 s73, s73, s39
  s_lshl_b32 s27, s8, 15
  s_add_u32 s27, s27, 64749568
  s_sub_u32 s13, s17, 5120
  s_cmp_lt_u32 s9, 5
  s_cselect_b32 s27, s27, s13
  s_cselect_b32 s33, 13, 14
  s_min_u32 s13, s9, 15
  s_lshl_b32 s13, s13, 10
  s_add_u32 s27, s27, s13
  v_min_u32 v53, 31, v1
  v_lshrrev_b32 v62, 1, v53
  v_and_b32 v62, 15, v62
  v_lshlrev_b32 v53, 6, v53
  v_lshl_add_u32 v53, v62, 2, v53
  v_add_u32 v53, s19, v53
mk_Q2_prime:
  v_mov_b32 v20, 0
  v_mov_b32 v21, 0
  v_mov_b32 v22, 0
  v_mov_b32 v23, 0
  v_mov_b32 v24, 0
  v_mov_b32 v25, 0
  v_mov_b32 v26, 0
  v_mov_b32 v27, 0
  s_and_b32 s18, s10, 3
  s_lshl_b32 s18, s18, 14
  s_add_u32 s18, s18, s17
  s_mov_b32 s11, 0
  s_mul_hi_u32 s68, s10, 0x2aaaaaab
  s_mul_i32 s68, s68, 6
  s_sub_u32 s13, s10, s68
  s_mul_i32 s13, s13, 20480
  s_add_u32 s13, s13, 33792
  v_add_u32 v0, s13, v8
  s_and_b32 s30, s10, 3
  s_lshl_b32 s30, s30, 15
  s_add_u32 s30, s30, s26
  s_add_u32 s31, s10, 3
  s_and_b32 s31, s31, 3
  s_lshl_b32 s31, s31, 15
  s_add_u32 s31, s31, s26
  s_add_u32 s32, s10, 3
  s_and_b32 s32, s32, 3
  s_lshl_b32 s32, s32, s33
  s_add_u32 s32, s32, s27
  s_and_b32 s28, s10, 31
  s_lshl_b32 s28, s28, 2
  s_add_u32 s28, s28, s8
  s_lshr_b32 s68, s28, 1
  s_bitcmp0_b64 s[64:65], s68
  s_cselect_b32 s68, 0x2000, 0
  s_lshl_b32 s28, s28, 20
  s_add_u32 s28, s28, s68
  s_add_u32 s28, s28, s73
  s_add_u32 s13, s10, 1
  s_mov_b32 m0, s19
  s_waitcnt vmcnt(0) lgkmcnt(0)
  s_branch mk_Q2_top
mk_Q2_last:
  buffer_store_dwordx4 v[56:59], v5, s[4:7], s24 offen offset:0 sc1
  s_branch mk_Q_drain
mk_Q2_tre:
  s_add_u32 s11, s11, 1
  s_cmp_lt_u32 s11, 262144
  s_cbranch_scc0 mk_fail
  s_and_b32 s14, s22, 31
  s_lshl_b32 s14, s14, 2
  s_add_u32 s14, s14, s8
  s_lshr_b32 s68, s14, 1
  s_bitcmp1_b64 s[64:65], s68
  s_cselect_b32 s68, 0x2000, 0
  s_lshl_b32 s14, s14, 20
  s_add_u32 s14, s14, s68
  s_add_u32 s14, s14, s41
  buffer_load_dwordx4 v[64:67], v5, s[4:7], s14 offen offset:0 sc1
  buffer_load_dwordx4 v[68:71], v5, s[4:7], s14 offen offset:1024 sc1
  buffer_load_dwordx4 v[72:75], v5, s[4:7], s14 offen offset:2048 sc1
  buffer_load_dwordx4 v[76:79], v5, s[4:7], s14 offen offset:3072 sc1
  s_add_u32 s14, s14, 4096
  buffer_load_dwordx4 v[84:87], v5, s[4:7], s14 offen offset:0 sc1
  buffer_load_dwordx4 v[88:91], v5, s[4:7], s14 offen offset:1024 sc1
  buffer_load_dwordx4 v[92:95], v5, s[4:7], s14 offen offset:2048 sc1
  buffer_load_dwordx4 v[96:99], v5, s[4:7], s14 offen offset:3072 sc1
  s_add_u32 s14, s14, 12288
  buffer_load_dwordx4 v[104:107], v5, s[4:7], s14 offen offset:0 sc1
  buffer_load_dwordx4 v[108:111], v5, s[4:7], s14 offen offset:1024 sc1
  buffer_load_dwordx4 v[112:115], v5, s[4:7], s14 offen offset:2048 sc1
  buffer_load_dwordx4 v[116:119], v5, s[4:7], s14 offen offset:3072 sc1
  s_add_u32 s14, s14, 4096
  buffer_load_dwordx4 v[124:127], v5, s[4:7], s14 offen offset:0 sc1
  buffer_load_dwordx4 v[128:131], v5, s[4:7], s14 offen offset:1024 sc1
  buffer_load_dwordx4 v[132:135], v5, s[4:7], s14 offen offset:2048 sc1
  buffer_load_dwordx4 v[136:139], v5, s[4:7], s14 offen offset:3072 sc1
  s_add_u32 s14, s14, 12288
  buffer_load_dwordx4 v[80:83], v5, s[4:7], s14 offen offset:0 sc1
  buffer_load_dwordx4 v[100:103], v5, s[4:7], s14 offen offset:1024 sc1
  buffer_load_dwordx4 v[120:123], v5, s[4:7], s14 offen offset:2048 sc1
  buffer_load_dwordx4 v[140:143], v5, s[4:7], s14 offen offset:3072 sc1
  s_waitcnt vmcnt(0)
  v_mov_b32 v20, 0
  v_mov_b32 v21, 0
  v_mov_b32 v22, 0
  v_mov_b32 v23, 0
  v_mov_b32 v24, 0
  v_mov_b32 v25, 0
  v_mov_b32 v26, 0
  v_mov_b32 v27, 0
  v_mov_b32 v28, 0
  v_mov_b32 v29, 0
  v_mov_b32 v30, 0
  v_mov_b32 v31, 0
  v_mov_b32 v32, 0
  v_mov_b32 v33, 0
  v_mov_b32 v34, 0
  v_mov_b32 v35, 0
  v_smfmac_f32_16x16x64_bf16 v[20:23], v[64:67], v[144:151], v15
  v_smfmac_f32_16x16x64_bf16 v[20:23], v[68:71], v[152:159], v15
  v_smfmac_f32_16x16x64_bf16 v[20:23], v[72:75], v[160:167], v15
  v_smfmac_f32_16x16x64_bf16 v[20:23], v[76:79], v[168:175], v15
  v_smfmac_f32_16x16x64_bf16 v[20:23], v[80:83], v[176:183], v15
  v_smfmac_f32_16x16x64_bf16 v[24:27], v[84:87], v[144:151], v15
  v_smfmac_f32_16x16x64_bf16 v[24:27], v[88:91], v[152:159], v15
  v_smfmac_f32_16x16x64_bf16 v[24:27], v[92:95], v[160:167], v15
  v_smfmac_f32_16x16x64_bf16 v[24:27], v[96:99], v[168:175], v15
  v_smfmac_f32_16x16x64_bf16 v[24:27], v[100:103], v[176:183], v15
  v_smfmac_f32_16x16x64_bf16 v[28:31], v[104:107], v[144:151], v15
  v_smfmac_f32_16x16x64_bf16 v[28:31], v[108:111], v[152:159], v15
  v_smfmac_f32_16x16x64_bf16 v[28:31], v[112:115], v[160:167], v15
  v_smfmac_f32_16x16x64_bf16 v[28:31], v[116:119], v[168:175], v15
  v_smfmac_f32_16x16x64_bf16 v[28:31], v[120:123], v[176:183], v15
  v_smfmac_f32_16x16x64_bf16 v[32:35], v[124:127], v[144:151], v15
  v_smfmac_f32_16x16x64_bf16 v[32:35], v[128:131], v[152:159], v15
  v_smfmac_f32_16x16x64_bf16 v[32:35], v[132:135], v[160:167], v15
  v_smfmac_f32_16x16x64_bf16 v[32:35], v[136:139], v[168:175], v15
  v_smfmac_f32_16x16x64_bf16 v[32:35], v[140:143], v[176:183], v15
  v_pk_add_f32 v[20:21], v[20:21], v[22:23]
  v_cvt_pk_bf16_f32 v56, v20, v21
  v_maximum3_f32 v60, v20, v21, v20
  v_pk_add_f32 v[24:25], v[24:25], v[26:27]
  v_cvt_pk_bf16_f32 v57, v24, v25
  v_maximum3_f32 v60, v24, v25, v60
  v_pk_add_f32 v[28:29], v[28:29], v[30:31]
  v_cvt_pk_bf16_f32 v58, v28, v29
  v_maximum3_f32 v60, v28, v29, v60
  v_pk_add_f32 v[32:33], v[32:33], v[34:35]
  v_cvt_pk_bf16_f32 v59, v32, v33
  v_maximum3_f32 v60, v32, v33, v60
  v_cmp_u_f32 vcc, v60, v60
  s_nop 0
  s_cbranch_vccnz mk_Q2_tre
  s_branch mk_Q2_tok
mk_Q2_rcv:
  s_add_u32 s11, s11, 1
  s_cmp_lt_u32 s11, 262144
  s_cbranch_scc0 mk_fail
  s_mov_b32 s13, s18
  s_mov_b32 m0, 0
  s_nop 0
  buffer_load_dwordx4 v5, s[4:7], s13 offen offset:0 sc1 lds
  buffer_load_dwordx4 v5, s[4:7], s13 offen offset:1024 sc1 lds
  buffer_load_dwordx4 v5, s[4:7], s13 offen offset:2048 sc1 lds
  buffer_load_dwordx4 v5, s[4:7], s13 offen offset:3072 sc1 lds
  s_mov_b32 m0, 4096
  s_add_u32 s13, s13, 4096
  buffer_load_dwordx4 v5, s[4:7], s13 offen offset:0 sc1 lds
  buffer_load_dwordx4 v5, s[4:7], s13 offen offset:1024 sc1 lds
  buffer_load_dwordx4 v5, s[4:7], s13 offen offset:2048 sc1 lds
  buffer_load_dwordx4 v5, s[4:7], s13 offen offset:3072 sc1 lds
  s_mov_b32 m0, 8192
  s_add_u32 s13, s13, 4096
  buffer_load_dwordx4 v5, s[4:7], s13 offen offset:0 sc1 lds
  buffer_load_dwordx4 v5, s[4:7], s13 offen offset:1024 sc1 lds
  s_waitcnt vmcnt(0) lgkmcnt(0)
  s_nop 7
  v_mov_b32 v20, 0
  v_mov_b32 v21, 0
  v_mov_b32 v22, 0
  v_mov_b32 v23, 0
  v_mov_b32 v24, 0
  v_mov_b32 v25, 0
  v_mov_b32 v26, 0
  v_mov_b32 v27, 0
  ds_read_b128 v[112:115], v3 offset:6144
  ds_read_b128 v[116:119], v3 offset:6656
  ds_read_b128 v[120:123], v3 offset:7168
  ds_read_b128 v[124:127], v3 offset:7680
  s_branch mk_Q2_chain
.p2alignl 4, 0xbf800000
mk_Q2_top:
  s_barrier
  s_nop 15
  s_nop 7
  buffer_load_dwordx4 v4, s[4:7], s18 offen offset:0 sc1 lds
  buffer_load_dwordx4 v4, s[4:7], s18 offen offset:1024 sc1 lds
  s_nop 15
  s_nop 13
  buffer_load_dwordx4 v4, s[4:7], s18 offen offset:0 sc1 lds
  buffer_load_dwordx4 v4, s[4:7], s18 offen offset:1024 sc1 lds
  s_branch mk_Q2_c1
.p2alignl 4, 0xbf800000
mk_Q2_c0:
  s_add_u32 s11, s11, 1
  s_cmp_lt_u32 s11, 262144
  s_cbranch_scc0 mk_fail
mk_Q2_c1:
  s_waitcnt vmcnt(2)
  ds_read_b32 v28, v53
  ds_read_b128 v[112:115], v3 offset:6144
  ds_read_b128 v[116:119], v3 offset:6656
  ds_read_b128 v[120:123], v3 offset:7168
  ds_read_b128 v[124:127], v3 offset:7680
  buffer_load_dwordx4 v4, s[4:7], s18 offen offset:0 sc1 lds
  buffer_load_dwordx4 v4, s[4:7], s18 offen offset:1024 sc1 lds
  s_waitcnt lgkmcnt(4)
  v_cmp_eq_u32 vcc, -1, v28
  s_nop 0
  s_cbranch_vccnz mk_Q2_c0
  s_barrier
mk_Q2_chain:
  s_waitcnt lgkmcnt(3)
  v_smfmac_f32_16x16x64_bf16 v[20:23], v[112:115], a[96:103], v2
  ds_read_b128 v[128:131], v3 offset:8192
  s_waitcnt lgkmcnt(3)
  v_smfmac_f32_16x16x64_bf16 v[20:23], v[116:119], a[104:111], v2
  ds_read_b128 v[132:135], v3 offset:8704
  s_waitcnt lgkmcnt(3)
  v_smfmac_f32_16x16x64_bf16 v[20:23], v[120:123], a[112:119], v2
  ds_read_b128 v[136:139], v3 offset:9216
  s_waitcnt lgkmcnt(3)
  v_smfmac_f32_16x16x64_bf16 v[20:23], v[124:127], a[120:127], v2
  ds_read_b128 v[140:143], v3 offset:9728
  s_waitcnt lgkmcnt(3)
  v_smfmac_f32_16x16x64_bf16 v[20:23], v[128:131], a[128:135], v2
  ds_read_b128 v[64:67], v3 offset:0
  s_waitcnt lgkmcnt(3)
  v_smfmac_f32_16x16x64_bf16 v[20:23], v[132:135], a[136:143], v2
  ds_read_b128 v[68:71], v3 offset:512
  s_waitcnt lgkmcnt(3)
  v_smfmac_f32_16x16x64_bf16 v[20:23], v[136:139], a[144:151], v2
  ds_read_b128 v[72:75], v3 offset:1024
  s_waitcnt lgkmcnt(3)
  v_smfmac_f32_16x16x64_bf16 v[20:23], v[140:143], a[152:159], v2
  ds_read_b128 v[76:79], v3 offset:1536
  s_waitcnt lgkmcnt(3)
  v_smfmac_f32_16x16x64_bf16 v[20:23], v[64:67], a[0:7], v2
  ds_read_b128 v[80:83], v3 offset:2048
  s_waitcnt lgkmcnt(3)
  v_smfmac_f32_16x16x64_bf16 v[20:23], v[68:71], a[8:15], v2
  ds_read_b128 v[84:87], v3 offset:2560
  s_waitcnt lgkmcnt(3)
  v_smfmac_f32_16x16x64_bf16 v[20:23], v[72:75], a[16:23], v2
  ds_read_b128 v[88:91], v3 offset:3072
  s_waitcnt lgkmcnt(3)
  v_smfmac_f32_16x16x64_bf16 v[20:23], v[76:79], a[24:31], v2
  ds_read_b128 v[92:95], v3 offset:3584
  s_waitcnt lgkmcnt(3)
  v_smfmac_f32_16x16x64_bf16 v[20:23], v[80:83], a[32:39], v2
  ds_read_b128 v[96:99], v3 offset:4096
  s_waitcnt lgkmcnt(3)
  v_smfmac_f32_16x16x64_bf16 v[20:23], v[84:87], a[40:47], v2
  ds_read_b128 v[100:103], v3 offset:4608
  s_waitcnt lgkmcnt(3)
  v_smfmac_f32_16x16x64_bf16 v[20:23], v[88:91], a[48:55], v2
  ds_read_b128 v[104:107], v3 offset:5120
  s_waitcnt lgkmcnt(3)
  v_smfmac_f32_16x16x64_bf16 v[20:23], v[92:95], a[56:63], v2
  ds_read_b128 v[108:111], v3 offset:5632
  s_waitcnt lgkmcnt(3)
  v_smfmac_f32_16x16x64_bf16 v[20:23], v[96:99], a[64:71], v2
  s_waitcnt lgkmcnt(2)
  v_smfmac_f32_16x16x64_bf16 v[20:23], v[100:103], a[72:79], v2
  s_waitcnt lgkmcnt(1)
  v_smfmac_f32_16x16x64_bf16 v[20:23], v[104:107], a[80:87], v2
  s_waitcnt lgkmcnt(0)
  v_smfmac_f32_16x16x64_bf16 v[20:23], v[108:111], a[88:95], v2
  v_smfmac_f32_16x16x64_bf16 v[24:27], v[64:67], a[160:167], v2
  v_smfmac_f32_16x16x64_bf16 v[24:27], v[68:71], a[168:175], v2
  v_cvt_pk_bf16_f32 v28, v20, v21
  v_cvt_pk_bf16_f32 v29, v22, v23
  ds_write_b64 v6, v[28:29] offset:10240
  v_maximum3_f32 v31, v20, v21, v22
  v_cmp_u_f32 vcc, v31, v23
  v_smfmac_f32_16x16x64_bf16 v[24:27], v[72:75], a[176:183], v2
  v_smfmac_f32_16x16x64_bf16 v[24:27], v[76:79], a[184:191], v2
  s_cbranch_vccnz mk_Q2_rcv
  s_waitcnt lgkmcnt(0)
  s_barrier
  ds_read_b64_tr_b16 v[36:37], v7 offset:10240
  ds_read_b64_tr_b16 v[38:39], v7 offset:10368
  ds_read_b64_tr_b16 v[40:41], v7 offset:10496
  ds_read_b64_tr_b16 v[42:43], v7 offset:10624
  v_smfmac_f32_16x16x64_bf16 v[24:27], v[80:83], a[192:199], v2
  v_smfmac_f32_16x16x64_bf16 v[24:27], v[84:87], a[200:207], v2
  s_waitcnt lgkmcnt(2)
  v_mfma_f32_16x16x32_bf16 v[32:35], v[36:39], v[36:39], 0
  s_waitcnt lgkmcnt(0)
  v_mfma_f32_16x16x32_bf16 v[32:35], v[40:43], v[40:43], v[32:35]
  v_smfmac_f32_16x16x64_bf16 v[24:27], v[88:91], a[208:215], v2
  v_smfmac_f32_16x16x64_bf16 v[24:27], v[92:95], a[216:223], v2
  buffer_store_dwordx2 v[32:33], v9, s[4:7], s30 offen
  buffer_store_dwordx2 v[34:35], v9, s[4:7], s30 offen offset:64
  v_smfmac_f32_16x16x64_bf16 v[24:27], v[96:99], a[224:231], v2
  v_smfmac_f32_16x16x64_bf16 v[24:27], v[100:103], a[232:239], v2
  v_smfmac_f32_16x16x64_bf16 v[24:27], v[104:107], a[240:247], v2
  v_smfmac_f32_16x16x64_bf16 v[24:27], v[108:111], a[248:255], v2
  buffer_store_dwordx4 v[36:39], v14, s[4:7], s28 offen offset:0 sc1
  buffer_store_dwordx4 v[40:43], v14, s[4:7], s28 offen offset:512 sc1
  buffer_store_dwordx4 v[56:59], v5, s[4:7], s24 offen offset:0 sc1
  s_sub_u32 s13, s10, 5
  s_lshl_b32 s14, s66, 6
  s_max_i32 s13, s13, s14
  v_mov_b32 v30, s13
  s_mov_b64 exec, 1
  buffer_store_dword v30, off, s[4:7], s43 sc1
  s_mov_b64 exec, -1
  v_smfmac_f32_16x16x64_bf16 v[24:27], v[112:115], v[192:199], v2
  v_smfmac_f32_16x16x64_bf16 v[24:27], v[116:119], v[200:207], v2
  buffer_store_dwordx2 v[16:17], v9, s[4:7], s31 offen
  buffer_store_dwordx2 v[16:17], v9, s[4:7], s31 offen offset:64
  buffer_store_dwordx4 v[16:19], v5, s[4:7], s32 offen
  v_smfmac_f32_16x16x64_bf16 v[24:27], v[120:123], v[208:215], v2
  v_smfmac_f32_16x16x64_bf16 v[24:27], v[124:127], v[216:223], v2
  v_smfmac_f32_16x16x64_bf16 v[24:27], v[128:131], v[224:231], v2
  v_smfmac_f32_16x16x64_bf16 v[24:27], v[132:135], v[232:239], v2
  v_smfmac_f32_16x16x64_bf16 v[24:27], v[136:139], v[240:247], v2
  v_smfmac_f32_16x16x64_bf16 v[24:27], v[140:143], v[248:255], v2
  s_nop 7
  v_cvt_pk_bf16_f32 v32, v24, v25
  v_cvt_pk_bf16_f32 v33, v26, v27
  ds_write_b64 v0, v[32:33] offset:0
  s_waitcnt lgkmcnt(0)
  s_barrier
  s_and_b32 s13, s10, 63
  s_cmp_lt_u32 s13, 4
  s_cbranch_scc1 mk_Q2_nt
  s_sub_u32 s22, s10, 4
  s_mul_hi_u32 s68, s22, 0x2aaaaaab
  s_mul_i32 s68, s68, 6
  s_sub_u32 s13, s22, s68
  s_mul_i32 s13, s13, 20480
  s_add_u32 s13, s13, 33792
  v_add_u32 v60, s13, v5
  s_add_u32 s13, s13, 16384
  v_lshl_add_u32 v61, v1, 3, s13
  v_add_u32 v62, 1024, v61
  ds_read_b128 v[144:147], v60 offset:0
  ds_read_b128 v[148:151], v60 offset:1024
  ds_read_b128 v[152:155], v60 offset:2048
  ds_read_b128 v[156:159], v60 offset:3072
  ds_read_b128 v[160:163], v60 offset:4096
  ds_read_b128 v[164:167], v60 offset:5120
  ds_read_b128 v[168:171], v60 offset:6144
  ds_read_b128 v[172:175], v60 offset:7168
  ds_read2_b32 v[176:177], v61 offset0:0 offset1:128
  ds_read2_b32 v[178:179], v61 offset0:1 offset1:129
  ds_read2_b32 v[180:181], v62 offset0:0 offset1:128
  ds_read2_b32 v[182:183], v62 offset0:1 offset1:129
  ds_read_b128 v[64:67], v5 offset:13312
  ds_read_b128 v[68:71], v5 offset:14336
  ds_read_b128 v[72:75], v5 offset:15360
  ds_read_b128 v[76:79], v5 offset:16384
  ds_read_b128 v[80:83], v5 offset:29696
  ds_read_b128 v[84:87], v5 offset:17408
  ds_read_b128 v[88:91], v5 offset:18432
  ds_read_b128 v[92:95], v5 offset:19456
  ds_read_b128 v[96:99], v5 offset:20480
  ds_read_b128 v[100:103], v5 offset:30720
  ds_read_b128 v[104:107], v5 offset:21504
  ds_read_b128 v[108:111], v5 offset:22528
  ds_read_b128 v[112:115], v5 offset:23552
  ds_read_b128 v[116:119], v5 offset:24576
  ds_read_b128 v[120:123], v5 offset:31744
  ds_read_b128 v[124:127], v5 offset:25600
  ds_read_b128 v[128:131], v5 offset:26624
  ds_read_b128 v[132:135], v5 offset:27648
  ds_read_b128 v[136:139], v5 offset:28672
  ds_read_b128 v[140:143], v5 offset:32768
  s_and_b32 s24, s22, 31
  s_lshl_b32 s24, s24, 2
  s_add_u32 s24, s24, s8
  s_lshr_b32 s68, s24, 1
  s_bitcmp0_b64 s[64:65], s68
  s_cselect_b32 s68, 0x2000, 0
  s_lshl_b32 s24, s24, 20
  s_add_u32 s24, s24, s68
  s_add_u32 s24, s24, s72
  s_bitcmp1_b32 s22, 5
  s_cselect_b32 s13, 49152, 0
  s_add_u32 s24, s24, s13
  v_mov_b32 v20, 0
  v_mov_b32 v21, 0
  v_mov_b32 v22, 0
  v_mov_b32 v23, 0
  v_mov_b32 v24, 0
  v_mov_b32 v25, 0
  v_mov_b32 v26, 0
  v_mov_b32 v27, 0
  v_mov_b32 v28, 0
  v_mov_b32 v29, 0
  v_mov_b32 v30, 0
  v_mov_b32 v31, 0
  v_mov_b32 v32, 0
  v_mov_b32 v33, 0
  v_mov_b32 v34, 0
  v_mov_b32 v35, 0
  s_waitcnt lgkmcnt(15)
  v_smfmac_f32_16x16x64_bf16 v[20:23], v[64:67], v[144:151], v15
  v_smfmac_f32_16x16x64_bf16 v[20:23], v[68:71], v[152:159], v15
  v_smfmac_f32_16x16x64_bf16 v[20:23], v[72:75], v[160:167], v15
  v_smfmac_f32_16x16x64_bf16 v[20:23], v[76:79], v[168:175], v15
  v_smfmac_f32_16x16x64_bf16 v[20:23], v[80:83], v[176:183], v15
  s_waitcnt lgkmcnt(10)
  v_smfmac_f32_16x16x64_bf16 v[24:27], v[84:87], v[144:151], v15
  v_smfmac_f32_16x16x64_bf16 v[24:27], v[88:91], v[152:159], v15
  v_smfmac_f32_16x16x64_bf16 v[24:27], v[92:95], v[160:167], v15
  v_smfmac_f32_16x16x64_bf16 v[24:27], v[96:99], v[168:175], v15
  v_smfmac_f32_16x16x64_bf16 v[24:27], v[100:103], v[176:183], v15
  s_waitcnt lgkmcnt(0)
  s_andn2_b32 s13, 63, s10
  s_cbranch_scc0 mk_Q2_b4a
  s_barrier
mk_Q2_b4a:
  v_smfmac_f32_16x16x64_bf16 v[28:31], v[104:107], v[144:151], v15
  v_smfmac_f32_16x16x64_bf16 v[28:31], v[108:111], v[152:159], v15
  v_smfmac_f32_16x16x64_bf16 v[28:31], v[112:115], v[160:167], v15
  v_smfmac_f32_16x16x64_bf16 v[28:31], v[116:119], v[168:175], v15
  v_smfmac_f32_16x16x64_bf16 v[28:31], v[120:123], v[176:183], v15
  s_waitcnt lgkmcnt(0)
  v_smfmac_f32_16x16x64_bf16 v[32:35], v[124:127], v[144:151], v15
  v_smfmac_f32_16x16x64_bf16 v[32:35], v[128:131], v[152:159], v15
  v_smfmac_f32_16x16x64_bf16 v[32:35], v[132:135], v[160:167], v15
  v_smfmac_f32_16x16x64_bf16 v[32:35], v[136:139], v[168:175], v15
  v_smfmac_f32_16x16x64_bf16 v[32:35], v[140:143], v[176:183], v15
  v_pk_add_f32 v[20:21], v[20:21], v[22:23]
  v_cvt_pk_bf16_f32 v56, v20, v21
  v_maximum3_f32 v60, v20, v21, v20
  v_pk_add_f32 v[24:25], v[24:25], v[26:27]
  v_cvt_pk_bf16_f32 v57, v24, v25
  v_maximum3_f32 v60, v24, v25, v60
  v_pk_add_f32 v[28:29], v[28:29], v[30:31]
  v_cvt_pk_bf16_f32 v58, v28, v29
  v_maximum3_f32 v60, v28, v29, v60
  v_pk_add_f32 v[32:33], v[32:33], v[34:35]
  v_cvt_pk_bf16_f32 v59, v32, v33
  v_maximum3_f32 v60, v32, v33, v60
  v_cmp_u_f32 vcc, v60, v60
  s_nop 0
  s_cbranch_vccnz mk_Q2_tre
  s_branch mk_Q2_tok
mk_Q2_nt:
  s_andn2_b32 s13, 63, s10
  s_cbranch_scc0 mk_Q2_b4b
  s_barrier
mk_Q2_b4b:
mk_Q2_tok:
  s_add_u32 s10, s10, 1
  s_and_b32 s13, s10, 63
  s_cbranch_scc0 mk_Q2_last
  v_mov_b32 v20, 0
  v_mov_b32 v21, 0
  v_mov_b32 v22, 0
  v_mov_b32 v23, 0
  v_mov_b32 v24, 0
  v_mov_b32 v25, 0
  v_mov_b32 v26, 0
  v_mov_b32 v27, 0
  s_and_b32 s18, s10, 3
  s_lshl_b32 s18, s18, 14
  s_add_u32 s18, s18, s17
  s_mov_b32 s11, 0
  s_mul_hi_u32 s68, s10, 0x2aaaaaab
  s_mul_i32 s68, s68, 6
  s_sub_u32 s13, s10, s68
  s_mul_i32 s13, s13, 20480
  s_add_u32 s13, s13, 33792
  v_add_u32 v0, s13, v8
  s_and_b32 s30, s10, 3
  s_lshl_b32 s30, s30, 15
  s_add_u32 s30, s30, s26
  s_add_u32 s31, s10, 3
  s_and_b32 s31, s31, 3
  s_lshl_b32 s31, s31, 15
  s_add_u32 s31, s31, s26
  s_add_u32 s32, s10, 3
  s_and_b32 s32, s32, 3
  s_lshl_b32 s32, s32, s33
  s_add_u32 s32, s32, s27
  s_and_b32 s28, s10, 31
  s_lshl_b32 s28, s28, 2
  s_add_u32 s28, s28, s8
  s_lshr_b32 s68, s28, 1
  s_bitcmp0_b64 s[64:65], s68
  s_cselect_b32 s68, 0x2000, 0
  s_lshl_b32 s28, s28, 20
  s_add_u32 s28, s28, s68
  s_add_u32 s28, s28, s73
  s_waitcnt vmcnt(0)
  s_mov_b32 m0, s19
  s_waitcnt lgkmcnt(0)
  s_branch mk_Q2_top
mk_Q3_init:
  s_lshl_b32 s27, s8, 15
  s_add_u32 s27, s27, 64749568
  s_load_dwordx2 s[80:81], s[0:1], 8
  s_mov_b32 s82, 0x2800
  s_mov_b32 s83, 0x20000
  v_lshrrev_b32 v62, 1, v61
  v_lshlrev_b32 v7, 9, v62
  v_and_b32 v62, 1, v61
  v_lshl_add_u32 v7, v62, 6, v7
  v_lshrrev_b32 v62, 2, v60
  v_lshl_add_u32 v7, v62, 7, v7
  v_and_b32 v62, 3, v60
  v_lshl_add_u32 v7, v62, 4, v7
  v_lshlrev_b32 v12, 6, v61
  v_and_b32 v62, 1, v60
  v_lshl_add_u32 v12, v62, 4, v12
  v_cmp_eq_u32 vcc, 1, v62
  v_mov_b32 v13, 0x05040100
  v_mov_b32 v63, 0x03020706
  v_cndmask_b32 v13, v13, v63, vcc
  v_lshl_add_u32 v62, v61, 1, v62
  v_mul_u32_u24 v62, 1280, v62
  v_and_b32 v63, 14, v60
  v_lshl_add_u32 v62, v63, 1, v62
  s_lshl_b32 s13, s38, 5
  s_waitcnt lgkmcnt(0)
  buffer_load_dword v54, v62, s[80:83], s13 offen
  v_lshrrev_b32 v63, 3, v60
  v_lshl_add_u32 v12, v63, 5, v12
  v_bfe_u32 v63, v60, 1, 2
  v_lshl_add_u32 v12, v63, 2, v12
  s_lshl_b32 s13, s38, 8
  v_add_u32 v12, s13, v12
  s_mul_hi_u32 s33, s38, 0x1999999a
  s_mul_i32 s13, s33, 10
  s_sub_u32 s13, s38, s13
  s_lshr_b32 s14, s13, 1
  s_lshl_b32 s14, s14, 14
  s_and_b32 s13, s13, 1
  s_lshl_b32 s13, s13, 12
  s_add_u32 s26, s13, s14
  s_add_u32 s26, s26, s39
  s_add_u32 s26, s26, 851968
  s_xor_b32 s13, s8, 0
  s_lshl_b32 s13, s13, 8
  v_lshl_add_u32 v36, v1, 2, s13
  s_xor_b32 s13, s8, 1
  s_lshl_b32 s13, s13, 8
  v_lshl_add_u32 v37, v1, 2, s13
  s_xor_b32 s13, s8, 2
  s_lshl_b32 s13, s13, 8
  v_lshl_add_u32 v38, v1, 2, s13
  s_xor_b32 s13, s8, 3
  s_lshl_b32 s13, s13, 8
  v_lshl_add_u32 v39, v1, 2, s13
  v_bfe_u32 v62, v1, 2, 3
  v_lshlrev_b32 v9, 7, v62
  v_and_b32 v62, 3, v1
  v_lshl_add_u32 v9, v62, 2, v9
  s_lshl_b32 s21, s33, 10
  s_add_u32 s21, s21, 64888832
  v_min_u32 v53, 31, v1
  v_lshrrev_b32 v62, 1, v53
  v_and_b32 v62, 15, v62
  v_lshlrev_b32 v53, 6, v53
  v_lshl_add_u32 v53, v62, 2, v53
  v_add_u32 v53, s19, v53
mk_Q3_prime:
  v_mov_b32 v20, 0
  v_mov_b32 v21, 0
  v_mov_b32 v22, 0
  v_mov_b32 v23, 0
  v_mov_b32 v24, 0
  v_mov_b32 v25, 0
  v_mov_b32 v26, 0
  v_mov_b32 v27, 0
  s_and_b32 s18, s10, 3
  s_lshl_b32 s18, s18, 14
  s_add_u32 s18, s18, s17
  s_mov_b32 s11, 0
  s_mul_hi_u32 s68, s10, 0x2aaaaaab
  s_mul_i32 s68, s68, 6
  s_sub_u32 s13, s10, s68
  s_mul_i32 s13, s13, 20480
  s_add_u32 s13, s13, 33792
  v_add_u32 v0, s13, v8
  v_add_u32 v11, s13, v5
  s_add_u32 s13, s10, 1
  s_waitcnt vmcnt(0)
  buffer_store_dword v54, v12, s[4:7], s18 offen
  s_mov_b32 s70, 0
int_wg41:
  buffer_load_dword v28, v9, s[4:7], s21 offen offset:0 sc1
  s_waitcnt vmcnt(0)
  v_cmp_gt_u32 vcc, s13, v28
  s_nop 0
  s_cbranch_vccz int_wg41_ok
  s_sleep 1
  s_add_u32 s70, s70, 1
  s_cmp_lt_u32 s70, 262144
  s_cbranch_scc1 int_wg41
  s_branch mk_fail
int_wg41_ok:
  s_mov_b32 m0, s19
  s_waitcnt vmcnt(0) lgkmcnt(0)
  s_branch mk_Q3_top
mk_Q3_last:
  s_branch mk_Q_drain
mk_Q3_rcv:
  s_add_u32 s11, s11, 1
  s_cmp_lt_u32 s11, 262144
  s_cbranch_scc0 mk_fail
  s_mov_b32 s13, s18
  s_mov_b32 m0, 0
  s_nop 0
  buffer_load_dwordx4 v5, s[4:7], s13 offen offset:0 sc1 lds
  buffer_load_dwordx4 v5, s[4:7], s13 offen offset:1024 sc1 lds
  buffer_load_dwordx4 v5, s[4:7], s13 offen offset:2048 sc1 lds
  buffer_load_dwordx4 v5, s[4:7], s13 offen offset:3072 sc1 lds
  s_mov_b32 m0, 4096
  s_add_u32 s13, s13, 4096
  buffer_load_dwordx4 v5, s[4:7], s13 offen offset:0 sc1 lds
  buffer_load_dwordx4 v5, s[4:7], s13 offen offset:1024 sc1 lds
  buffer_load_dwordx4 v5, s[4:7], s13 offen offset:2048 sc1 lds
  buffer_load_dwordx4 v5, s[4:7], s13 offen offset:3072 sc1 lds
  s_mov_b32 m0, 8192
  s_add_u32 s13, s13, 4096
  buffer_load_dwordx4 v5, s[4:7], s13 offen offset:0 sc1 lds
  buffer_load_dwordx4 v5, s[4:7], s13 offen offset:1024 sc1 lds
  s_waitcnt vmcnt(0) lgkmcnt(0)
  s_nop 7
  v_mov_b32 v20, 0
  v_mov_b32 v21, 0
  v_mov_b32 v22, 0
  v_mov_b32 v23, 0
  v_mov_b32 v24, 0
  v_mov_b32 v25, 0
  v_mov_b32 v26, 0
  v_mov_b32 v27, 0
  ds_read_b128 v[128:131], v3 offset:8192
  ds_read_b128 v[132:135], v3 offset:8704
  ds_read_b128 v[136:139], v3 offset:9216
  ds_read_b128 v[140:143], v3 offset:9728
  s_branch mk_Q3_chain
.p2alignl 4, 0xbf800000
mk_Q3_top:
  s_barrier
  s_nop 15
  s_nop 7
  buffer_load_dwordx4 v4, s[4:7], s18 offen offset:0 sc1 lds
  buffer_load_dwordx4 v4, s[4:7], s18 offen offset:1024 sc1 lds
  s_nop 15
  s_nop 13
  buffer_load_dwordx4 v4, s[4:7], s18 offen offset:0 sc1 lds
  buffer_load_dwordx4 v4, s[4:7], s18 offen offset:1024 sc1 lds
  s_branch mk_Q3_c1
.p2alignl 4, 0xbf800000
mk_Q3_c0:
  s_add_u32 s11, s11, 1
  s_cmp_lt_u32 s11, 262144
  s_cbranch_scc0 mk_fail
mk_Q3_c1:
  s_waitcnt vmcnt(2)
  ds_read_b32 v28, v53
  ds_read_b128 v[128:131], v3 offset:8192
  ds_read_b128 v[132:135], v3 offset:8704
  ds_read_b128 v[136:139], v3 offset:9216
  ds_read_b128 v[140:143], v3 offset:9728
  buffer_load_dwordx4 v4, s[4:7], s18 offen offset:0 sc1 lds
  buffer_load_dwordx4 v4, s[4:7], s18 offen offset:1024 sc1 lds
  s_waitcnt lgkmcnt(4)
  v_cmp_eq_u32 vcc, -1, v28
  s_nop 0
  s_cbranch_vccnz mk_Q3_c0
  s_barrier
mk_Q3_chain:
  s_waitcnt lgkmcnt(3)
  v_smfmac_f32_16x16x64_bf16 v[20:23], v[128:131], a[128:135], v2
  ds_read_b128 v[64:67], v3 offset:0
  s_waitcnt lgkmcnt(3)
  v_smfmac_f32_16x16x64_bf16 v[20:23], v[132:135], a[136:143], v2
  ds_read_b128 v[68:71], v3 offset:512
  s_waitcnt lgkmcnt(3)
  v_smfmac_f32_16x16x64_bf16 v[20:23], v[136:139], a[144:151], v2
  ds_read_b128 v[72:75], v3 offset:1024
  s_waitcnt lgkmcnt(3)
  v_smfmac_f32_16x16x64_bf16 v[20:23], v[140:143], a[152:159], v2
  ds_read_b128 v[76:79], v3 offset:1536
  s_waitcnt lgkmcnt(3)
  v_smfmac_f32_16x16x64_bf16 v[20:23], v[64:67], a[0:7], v2
  ds_read_b128 v[80:83], v3 offset:2048
  s_waitcnt lgkmcnt(3)
  v_smfmac_f32_16x16x64_bf16 v[20:23], v[68:71], a[8:15], v2
  ds_read_b128 v[84:87], v3 offset:2560
  s_waitcnt lgkmcnt(3)
  v_smfmac_f32_16x16x64_bf16 v[20:23], v[72:75], a[16:23], v2
  ds_read_b128 v[88:91], v3 offset:3072
  s_waitcnt lgkmcnt(3)
  v_smfmac_f32_16x16x64_bf16 v[20:23], v[76:79], a[24:31], v2
  ds_read_b128 v[92:95], v3 offset:3584
  s_waitcnt lgkmcnt(3)
  v_smfmac_f32_16x16x64_bf16 v[20:23], v[80:83], a[32:39], v2
  ds_read_b128 v[96:99], v3 offset:4096
  s_waitcnt lgkmcnt(3)
  v_smfmac_f32_16x16x64_bf16 v[20:23], v[84:87], a[40:47], v2
  ds_read_b128 v[100:103], v3 offset:4608
  s_waitcnt lgkmcnt(3)
  v_smfmac_f32_16x16x64_bf16 v[20:23], v[88:91], a[48:55], v2
  ds_read_b128 v[104:107], v3 offset:5120
  s_waitcnt lgkmcnt(3)
  v_smfmac_f32_16x16x64_bf16 v[20:23], v[92:95], a[56:63], v2
  ds_read_b128 v[108:111], v3 offset:5632
  s_waitcnt lgkmcnt(3)
  v_smfmac_f32_16x16x64_bf16 v[20:23], v[96:99], a[64:71], v2
  ds_read_b128 v[112:115], v3 offset:6144
  s_waitcnt lgkmcnt(3)
  v_smfmac_f32_16x16x64_bf16 v[20:23], v[100:103], a[72:79], v2
  ds_read_b128 v[116:119], v3 offset:6656
  s_waitcnt lgkmcnt(3)
  v_smfmac_f32_16x16x64_bf16 v[20:23], v[104:107], a[80:87], v2
  ds_read_b128 v[120:123], v3 offset:7168
  s_waitcnt lgkmcnt(3)
  v_smfmac_f32_16x16x64_bf16 v[20:23], v[108:111], a[88:95], v2
  ds_read_b128 v[124:127], v3 offset:7680
  s_waitcnt lgkmcnt(3)
  v_smfmac_f32_16x16x64_bf16 v[20:23], v[112:115], a[96:103], v2
  s_waitcnt lgkmcnt(2)
  v_smfmac_f32_16x16x64_bf16 v[20:23], v[116:119], a[104:111], v2
  s_waitcnt lgkmcnt(1)
  v_smfmac_f32_16x16x64_bf16 v[20:23], v[120:123], a[112:119], v2
  s_waitcnt lgkmcnt(0)
  v_smfmac_f32_16x16x64_bf16 v[20:23], v[124:127], a[120:127], v2
  v_smfmac_f32_16x16x64_bf16 v[24:27], v[64:67], a[160:167], v2
  v_smfmac_f32_16x16x64_bf16 v[24:27], v[68:71], a[168:175], v2
  v_cvt_pk_bf16_f32 v28, v20, v21
  v_cvt_pk_bf16_f32 v29, v22, v23
  ds_write_b64 v6, v[28:29] offset:10240
  v_maximum3_f32 v31, v20, v21, v22
  v_cmp_u_f32 vcc, v31, v23
  v_smfmac_f32_16x16x64_bf16 v[24:27], v[72:75], a[176:183], v2
  v_smfmac_f32_16x16x64_bf16 v[24:27], v[76:79], a[184:191], v2
  s_cbranch_vccnz mk_Q3_rcv
  s_waitcnt lgkmcnt(0)
  s_barrier
  v_smfmac_f32_16x16x64_bf16 v[24:27], v[80:83], a[192:199], v2
  v_smfmac_f32_16x16x64_bf16 v[24:27], v[84:87], a[200:207], v2
  v_smfmac_f32_16x16x64_bf16 v[24:27], v[88:91], a[208:215], v2
  v_smfmac_f32_16x16x64_bf16 v[24:27], v[92:95], a[216:223], v2
  v_smfmac_f32_16x16x64_bf16 v[24:27], v[96:99], a[224:231], v2
  v_smfmac_f32_16x16x64_bf16 v[24:27], v[100:103], a[232:239], v2
  v_smfmac_f32_16x16x64_bf16 v[24:27], v[104:107], a[240:247], v2
  v_smfmac_f32_16x16x64_bf16 v[24:27], v[108:111], a[248:255], v2
  v_smfmac_f32_16x16x64_bf16 v[24:27], v[112:115], v[192:199], v2
  v_smfmac_f32_16x16x64_bf16 v[24:27], v[116:119], v[200:207], v2
  v_smfmac_f32_16x16x64_bf16 v[24:27], v[120:123], v[208:215], v2
  v_smfmac_f32_16x16x64_bf16 v[24:27], v[124:127], v[216:223], v2
  v_smfmac_f32_16x16x64_bf16 v[24:27], v[128:131], v[224:231], v2
  v_smfmac_f32_16x16x64_bf16 v[24:27], v[132:135], v[232:239], v2
  v_smfmac_f32_16x16x64_bf16 v[24:27], v[136:139], v[240:247], v2
  v_smfmac_f32_16x16x64_bf16 v[24:27], v[140:143], v[248:255], v2
  s_nop 7
  v_cvt_pk_bf16_f32 v32, v24, v25
  v_cvt_pk_bf16_f32 v33, v26, v27
  ds_write_b64 v0, v[32:33] offset:0
  ds_read_b128 v[64:67], v11 offset:0
  ds_read_b128 v[68:71], v11 offset:1024
  ds_read_b128 v[72:75], v11 offset:2048
  ds_read_b128 v[76:79], v11 offset:3072
  ds_read_b128 v[80:83], v11 offset:4096
  ds_read_b128 v[84:87], v11 offset:5120
  ds_read_b128 v[88:91], v11 offset:6144
  ds_read_b128 v[92:95], v11 offset:7168
  v_add_u32 v10, -1536, v0
  v_add_u32 v52, 1024, v10
  s_and_b32 s28, s10, 3
  s_lshl_b32 s28, s28, 13
  s_add_u32 s28, s28, s27
  s_add_u32 s32, s28, 4096
  s_and_b32 s29, s10, 31
  s_lshl_b32 s29, s29, 2
  s_add_u32 s29, s29, s33
  s_lshr_b32 s68, s29, 1
  s_bitcmp1_b64 s[64:65], s68
  s_cselect_b32 s68, 0x2000, 0
  s_lshl_b32 s29, s29, 20
  s_add_u32 s29, s29, s68
  s_add_u32 s29, s29, s26
  s_add_u32 s23, s10, 29
  s_and_b32 s23, s23, 31
  s_lshl_b32 s23, s23, 2
  s_add_u32 s23, s23, s8
  s_lshr_b32 s68, s23, 1
  s_bitcmp1_b64 s[64:65], s68
  s_cselect_b32 s68, 0x2000, 0
  s_lshl_b32 s23, s23, 20
  s_add_u32 s23, s23, s68
  s_add_u32 s23, s23, s41
  s_and_b32 s13, s10, 63
  s_cmp_lt_u32 s13, 3
  s_cselect_b32 s23, 1073741824, s23
  v_mov_b32 v56, 0
  v_mov_b32 v57, 0
  v_mov_b32 v58, 0
  v_mov_b32 v59, 0
  v_mov_b32 v60, 0
  v_mov_b32 v61, 0
  v_mov_b32 v62, 0
  v_mov_b32 v63, 0
  v_mov_b32 v48, 0
  v_mov_b32 v49, 0
  v_mov_b32 v50, 0
  v_mov_b32 v51, 0
  s_add_u32 s10, s10, 1
  v_mov_b32 v20, 0
  v_mov_b32 v21, 0
  v_mov_b32 v22, 0
  v_mov_b32 v23, 0
  v_mov_b32 v24, 0
  v_mov_b32 v25, 0
  v_mov_b32 v26, 0
  v_mov_b32 v27, 0
  s_and_b32 s18, s10, 3
  s_lshl_b32 s18, s18, 14
  s_add_u32 s18, s18, s17
  s_mov_b32 s11, 0
  s_mul_hi_u32 s68, s10, 0x2aaaaaab
  s_mul_i32 s68, s68, 6
  s_sub_u32 s13, s10, s68
  s_mul_i32 s13, s13, 20480
  s_add_u32 s13, s13, 33792
  v_add_u32 v0, s13, v8
  v_add_u32 v11, s13, v5
  s_mov_b32 m0, s19
  s_and_b32 s13, s10, 63
  s_waitcnt lgkmcnt(0)
  s_barrier
  s_cbranch_scc0 mk_Q3_last
  s_sleep 6
  s_nop 15
  s_nop 15
  s_nop 1
mk_Q3_ps:
  buffer_load_dwordx4 v[120:123], v5, s[4:7], s32 offen offset:0 sc1
  buffer_load_dwordx4 v[104:107], v7, s[4:7], s28 offen offset:0 sc1
  buffer_load_dwordx4 v[108:111], v7, s[4:7], s28 offen offset:1024 sc1
  buffer_load_dwordx4 v[112:115], v7, s[4:7], s28 offen offset:2048 sc1
  buffer_load_dwordx4 v[116:119], v7, s[4:7], s28 offen offset:3072 sc1
  ds_read2_b32 v[96:97], v10 offset0:0 offset1:128
  ds_read2_b32 v[98:99], v10 offset0:1 offset1:129
  ds_read2_b32 v[100:101], v52 offset0:0 offset1:128
  ds_read2_b32 v[102:103], v52 offset0:1 offset1:129
  s_nop 15
  buffer_load_dwordx4 v[140:143], v5, s[4:7], s32 offen offset:0 sc1
  buffer_load_dwordx4 v[124:127], v7, s[4:7], s28 offen offset:0 sc1
  buffer_load_dwordx4 v[128:131], v7, s[4:7], s28 offen offset:1024 sc1
  buffer_load_dwordx4 v[132:135], v7, s[4:7], s28 offen offset:2048 sc1
  buffer_load_dwordx4 v[136:139], v7, s[4:7], s28 offen offset:3072 sc1
  s_nop 15
  s_nop 3
  buffer_load_dwordx4 v[160:163], v5, s[4:7], s32 offen offset:0 sc1
  buffer_load_dwordx4 v[144:147], v7, s[4:7], s28 offen offset:0 sc1
  buffer_load_dwordx4 v[148:151], v7, s[4:7], s28 offen offset:1024 sc1
  buffer_load_dwordx4 v[152:155], v7, s[4:7], s28 offen offset:2048 sc1
  buffer_load_dwordx4 v[156:159], v7, s[4:7], s28 offen offset:3072 sc1
  s_waitcnt lgkmcnt(0)
mk_Q3_p0:
  s_waitcnt vmcnt(14)
  v_cmp_eq_u32 vcc, -1, v120
  v_smfmac_f32_16x16x64_bf16 v[56:59], v[120:123], v[96:103], v15
  s_waitcnt vmcnt(13)
  v_smfmac_f32_16x16x64_bf16 v[56:59], v[104:107], v[64:71], v15
  s_cbranch_vccnz mk_Q3_pf0
  s_waitcnt vmcnt(12)
  v_smfmac_f32_16x16x64_bf16 v[56:59], v[108:111], v[72:79], v15
  s_waitcnt vmcnt(11)
  v_smfmac_f32_16x16x64_bf16 v[56:59], v[112:115], v[80:87], v15
  v_maximum3_f32 v28, v104, v108, v112
  s_waitcnt vmcnt(10)
  v_smfmac_f32_16x16x64_bf16 v[56:59], v[116:119], v[88:95], v15
  v_cmp_u_f32 vcc, v28, v116
  s_nop 0
  s_cbranch_vccnz mk_Q3_pf0
  v_pk_add_f32 v[32:33], v[56:57], v[58:59]
  v_cvt_pk_bf16_f32 v34, v32, v33
  buffer_store_dword v34, v36, s[4:7], s29 offen offset:0 sc1
  buffer_store_dword v34, v36, s[4:7], s29 offen offset:1024 sc1
  buffer_store_dword v34, v36, s[4:7], s29 offen offset:2048 sc1
  s_branch mk_Q3_pok
.p2alignl 4, 0xbf800000
mk_Q3_pf0:
  buffer_load_dwordx4 v[120:123], v5, s[4:7], s32 offen offset:0 sc1
  buffer_load_dwordx4 v[104:107], v7, s[4:7], s28 offen offset:0 sc1
  buffer_load_dwordx4 v[108:111], v7, s[4:7], s28 offen offset:1024 sc1
  buffer_load_dwordx4 v[112:115], v7, s[4:7], s28 offen offset:2048 sc1
  buffer_load_dwordx4 v[116:119], v7, s[4:7], s28 offen offset:3072 sc1
  v_mov_b32 v48, 0
  v_mov_b32 v49, 0
  v_mov_b32 v50, 0
  v_mov_b32 v51, 0
mk_Q3_p1:
  s_waitcnt vmcnt(14)
  v_cmp_eq_u32 vcc, -1, v140
  v_smfmac_f32_16x16x64_bf16 v[60:63], v[140:143], v[96:103], v15
  s_waitcnt vmcnt(13)
  v_smfmac_f32_16x16x64_bf16 v[60:63], v[124:127], v[64:71], v15
  s_cbranch_vccnz mk_Q3_pf1
  s_waitcnt vmcnt(12)
  v_smfmac_f32_16x16x64_bf16 v[60:63], v[128:131], v[72:79], v15
  s_waitcnt vmcnt(11)
  v_smfmac_f32_16x16x64_bf16 v[60:63], v[132:135], v[80:87], v15
  v_maximum3_f32 v28, v124, v128, v132
  s_waitcnt vmcnt(10)
  v_smfmac_f32_16x16x64_bf16 v[60:63], v[136:139], v[88:95], v15
  v_cmp_u_f32 vcc, v28, v136
  s_nop 0
  s_cbranch_vccnz mk_Q3_pf1
  v_pk_add_f32 v[32:33], v[60:61], v[62:63]
  v_cvt_pk_bf16_f32 v34, v32, v33
  buffer_store_dword v34, v36, s[4:7], s29 offen offset:0 sc1
  buffer_store_dword v34, v36, s[4:7], s29 offen offset:1024 sc1
  buffer_store_dword v34, v36, s[4:7], s29 offen offset:2048 sc1
  s_branch mk_Q3_pok
.p2alignl 4, 0xbf800000
mk_Q3_pf1:
  buffer_load_dwordx4 v[140:143], v5, s[4:7], s32 offen offset:0 sc1
  buffer_load_dwordx4 v[124:127], v7, s[4:7], s28 offen offset:0 sc1
  buffer_load_dwordx4 v[128:131], v7, s[4:7], s28 offen offset:1024 sc1
  buffer_load_dwordx4 v[132:135], v7, s[4:7], s28 offen offset:2048 sc1
  buffer_load_dwordx4 v[136:139], v7, s[4:7], s28 offen offset:3072 sc1
  v_mov_b32 v56, 0
  v_mov_b32 v57, 0
  v_mov_b32 v58, 0
  v_mov_b32 v59, 0
mk_Q3_p2:
  s_waitcnt vmcnt(14)
  v_cmp_eq_u32 vcc, -1, v160
  v_smfmac_f32_16x16x64_bf16 v[48:51], v[160:163], v[96:103], v15
  s_waitcnt vmcnt(13)
  v_smfmac_f32_16x16x64_bf16 v[48:51], v[144:147], v[64:71], v15
  s_cbranch_vccnz mk_Q3_pf2
  s_waitcnt vmcnt(12)
  v_smfmac_f32_16x16x64_bf16 v[48:51], v[148:151], v[72:79], v15
  s_waitcnt vmcnt(11)
  v_smfmac_f32_16x16x64_bf16 v[48:51], v[152:155], v[80:87], v15
  v_maximum3_f32 v28, v144, v148, v152
  s_waitcnt vmcnt(10)
  v_smfmac_f32_16x16x64_bf16 v[48:51], v[156:159], v[88:95], v15
  v_cmp_u_f32 vcc, v28, v156
  s_nop 0
  s_cbranch_vccnz mk_Q3_pf2
  v_pk_add_f32 v[32:33], v[48:49], v[50:51]
  v_cvt_pk_bf16_f32 v34, v32, v33
  buffer_store_dword v34, v36, s[4:7], s29 offen offset:0 sc1
  buffer_store_dword v34, v36, s[4:7], s29 offen offset:1024 sc1
  buffer_store_dword v34, v36, s[4:7], s29 offen offset:2048 sc1
  s_branch mk_Q3_pok
.p2alignl 4, 0xbf800000
mk_Q3_pf2:
  buffer_load_dwordx4 v[160:163], v5, s[4:7], s32 offen offset:0 sc1
  buffer_load_dwordx4 v[144:147], v7, s[4:7], s28 offen offset:0 sc1
  buffer_load_dwordx4 v[148:151], v7, s[4:7], s28 offen offset:1024 sc1
  buffer_load_dwordx4 v[152:155], v7, s[4:7], s28 offen offset:2048 sc1
  buffer_load_dwordx4 v[156:159], v7, s[4:7], s28 offen offset:3072 sc1
  v_mov_b32 v60, 0
  v_mov_b32 v61, 0
  v_mov_b32 v62, 0
  v_mov_b32 v63, 0
  s_add_u32 s11, s11, 1
  s_cmp_lt_u32 s11, 262144
  s_cbranch_scc0 mk_fail
  s_branch mk_Q3_p0
mk_Q3_ptorn:
  s_add_u32 s11, s11, 1
  s_cmp_lt_u32 s11, 262144
  s_cbranch_scc0 mk_fail
  s_waitcnt vmcnt(0)
  v_mov_b32 v48, 0
  v_mov_b32 v49, 0
  v_mov_b32 v50, 0
  v_mov_b32 v51, 0
  v_mov_b32 v56, 0
  v_mov_b32 v57, 0
  v_mov_b32 v58, 0
  v_mov_b32 v59, 0
  v_mov_b32 v60, 0
  v_mov_b32 v61, 0
  v_mov_b32 v62, 0
  v_mov_b32 v63, 0
  s_branch mk_Q3_ps
.p2alignl 4, 0xbf800000
mk_Q3_pok:
  v_cmp_u_f32 vcc, v32, v33
  s_nop 0
  s_cbranch_vccnz mk_Q3_ptorn
  v_lshlrev_b32 v32, 16, v34
  v_and_b32 v33, 0xffff0000, v34
  s_barrier
  s_mov_b32 m0, 13312
  s_add_u32 s13, s23, 0
  buffer_load_dwordx4 v5, s[4:7], s13 offen offset:0 sc1 lds
  buffer_load_dwordx4 v5, s[4:7], s13 offen offset:1024 sc1 lds
  buffer_load_dwordx4 v5, s[4:7], s13 offen offset:2048 sc1 lds
  buffer_load_dwordx4 v5, s[4:7], s13 offen offset:3072 sc1 lds
  s_mov_b32 m0, 17408
  s_add_u32 s13, s23, 4096
  buffer_load_dwordx4 v5, s[4:7], s13 offen offset:0 sc1 lds
  buffer_load_dwordx4 v5, s[4:7], s13 offen offset:1024 sc1 lds
  buffer_load_dwordx4 v5, s[4:7], s13 offen offset:2048 sc1 lds
  buffer_load_dwordx4 v5, s[4:7], s13 offen offset:3072 sc1 lds
  s_mov_b32 m0, 21504
  s_add_u32 s13, s23, 16384
  buffer_load_dwordx4 v5, s[4:7], s13 offen offset:0 sc1 lds
  buffer_load_dwordx4 v5, s[4:7], s13 offen offset:1024 sc1 lds
  s_nop 15
  s_nop 4
  buffer_load_dword v65, v37, s[4:7], s29 offen offset:0 sc1
  buffer_load_dword v67, v38, s[4:7], s29 offen offset:0 sc1
  buffer_load_dword v69, v39, s[4:7], s29 offen offset:0 sc1
  buffer_load_dwordx4 v5, s[4:7], s13 offen offset:2048 sc1 lds
  buffer_load_dwordx4 v5, s[4:7], s13 offen offset:3072 sc1 lds
  s_mov_b32 m0, 25600
  s_add_u32 s13, s23, 20480
  buffer_load_dwordx4 v5, s[4:7], s13 offen offset:0 sc1 lds
  buffer_load_dwordx4 v5, s[4:7], s13 offen offset:1024 sc1 lds
  buffer_load_dwordx4 v5, s[4:7], s13 offen offset:2048 sc1 lds
  s_nop 14
  buffer_load_dword v71, v37, s[4:7], s29 offen offset:1024 sc1
  buffer_load_dword v73, v38, s[4:7], s29 offen offset:1024 sc1
  buffer_load_dword v75, v39, s[4:7], s29 offen offset:1024 sc1
  buffer_load_dwordx4 v5, s[4:7], s13 offen offset:3072 sc1 lds
  s_mov_b32 m0, 29696
  s_add_u32 s13, s23, 32768
  buffer_load_dwordx4 v5, s[4:7], s13 offen offset:0 sc1 lds
  buffer_load_dwordx4 v5, s[4:7], s13 offen offset:1024 sc1 lds
  buffer_load_dwordx4 v5, s[4:7], s13 offen offset:2048 sc1 lds
  buffer_load_dwordx4 v5, s[4:7], s13 offen offset:3072 sc1 lds
  s_nop 14
  buffer_load_dword v77, v37, s[4:7], s29 offen offset:2048 sc1
  buffer_load_dword v79, v38, s[4:7], s29 offen offset:2048 sc1
  buffer_load_dword v81, v39, s[4:7], s29 offen offset:2048 sc1
  s_mov_b32 m0, s19
  s_waitcnt vmcnt(18)
  v_lshlrev_b32 v64, 16, v65
  v_and_b32 v65, 0xffff0000, v65
  v_pk_add_f32 v[44:45], v[32:33], v[64:65]
  s_waitcnt vmcnt(16)
  v_lshlrev_b32 v66, 16, v67
  v_and_b32 v67, 0xffff0000, v67
  v_lshlrev_b32 v68, 16, v69
  v_and_b32 v69, 0xffff0000, v69
  v_pk_add_f32 v[48:49], v[66:67], v[68:69]
  v_pk_add_f32 v[44:45], v[44:45], v[48:49]
  v_cmp_u_f32 vcc, v44, v45
  v_cvt_pk_bf16_f32 v46, v44, v45
  s_nop 1
  v_mov_b32_dpp v47, v46 quad_perm:[1,0,3,2] row_mask:0xf bank_mask:0xf
  v_perm_b32 v46, v47, v46, v13
  s_cbranch_vccnz mk_Q3_bg0
  buffer_store_dword v46, v12, s[4:7], s18 offen
  s_branch mk_Q3_top
.p2alignl 4, 0xbf800000
mk_Q3_bg0:
  buffer_load_dword v65, v37, s[4:7], s29 offen offset:0 sc1
  buffer_load_dword v67, v38, s[4:7], s29 offen offset:0 sc1
  buffer_load_dword v69, v39, s[4:7], s29 offen offset:0 sc1
  s_waitcnt vmcnt(13)
  v_lshlrev_b32 v70, 16, v71
  v_and_b32 v71, 0xffff0000, v71
  v_pk_add_f32 v[44:45], v[32:33], v[70:71]
  s_waitcnt vmcnt(11)
  v_lshlrev_b32 v72, 16, v73
  v_and_b32 v73, 0xffff0000, v73
  v_lshlrev_b32 v74, 16, v75
  v_and_b32 v75, 0xffff0000, v75
  v_pk_add_f32 v[48:49], v[72:73], v[74:75]
  v_pk_add_f32 v[44:45], v[44:45], v[48:49]
  v_cmp_u_f32 vcc, v44, v45
  v_cvt_pk_bf16_f32 v46, v44, v45
  s_nop 1
  v_mov_b32_dpp v47, v46 quad_perm:[1,0,3,2] row_mask:0xf bank_mask:0xf
  v_perm_b32 v46, v47, v46, v13
  s_cbranch_vccnz mk_Q3_bg1
  buffer_store_dword v46, v12, s[4:7], s18 offen
  s_branch mk_Q3_top
.p2alignl 4, 0xbf800000
mk_Q3_bg1:
  buffer_load_dword v71, v37, s[4:7], s29 offen offset:1024 sc1
  buffer_load_dword v73, v38, s[4:7], s29 offen offset:1024 sc1
  buffer_load_dword v75, v39, s[4:7], s29 offen offset:1024 sc1
  s_waitcnt vmcnt(8)
  v_lshlrev_b32 v76, 16, v77
  v_and_b32 v77, 0xffff0000, v77
  v_pk_add_f32 v[44:45], v[32:33], v[76:77]
  s_waitcnt vmcnt(6)
  v_lshlrev_b32 v78, 16, v79
  v_and_b32 v79, 0xffff0000, v79
  v_lshlrev_b32 v80, 16, v81
  v_and_b32 v81, 0xffff0000, v81
  v_pk_add_f32 v[48:49], v[78:79], v[80:81]
  v_pk_add_f32 v[44:45], v[44:45], v[48:49]
  v_cmp_u_f32 vcc, v44, v45
  v_cvt_pk_bf16_f32 v46, v44, v45
  s_nop 1
  v_mov_b32_dpp v47, v46 quad_perm:[1,0,3,2] row_mask:0xf bank_mask:0xf
  v_perm_b32 v46, v47, v46, v13
  s_cbranch_vccnz mk_Q3_bg2
  buffer_store_dword v46, v12, s[4:7], s18 offen
  s_branch mk_Q3_top
.p2alignl 4, 0xbf800000
mk_Q3_bg2:
  buffer_load_dword v77, v37, s[4:7], s29 offen offset:2048 sc1
  buffer_load_dword v79, v38, s[4:7], s29 offen offset:2048 sc1
  buffer_load_dword v81, v39, s[4:7], s29 offen offset:2048 sc1
mk_Q3_b0:
  s_waitcnt vmcnt(8)
  v_lshlrev_b32 v64, 16, v65
  v_and_b32 v65, 0xffff0000, v65
  v_pk_add_f32 v[44:45], v[32:33], v[64:65]
  s_waitcnt vmcnt(6)
  v_lshlrev_b32 v66, 16, v67
  v_and_b32 v67, 0xffff0000, v67
  v_lshlrev_b32 v68, 16, v69
  v_and_b32 v69, 0xffff0000, v69
  v_pk_add_f32 v[48:49], v[66:67], v[68:69]
  v_pk_add_f32 v[44:45], v[44:45], v[48:49]
  v_cmp_u_f32 vcc, v44, v45
  v_cvt_pk_bf16_f32 v46, v44, v45
  s_nop 1
  v_mov_b32_dpp v47, v46 quad_perm:[1,0,3,2] row_mask:0xf bank_mask:0xf
  v_perm_b32 v46, v47, v46, v13
  s_cbranch_vccnz mk_Q3_bf0
  buffer_store_dword v46, v12, s[4:7], s18 offen
  s_branch mk_Q3_top
.p2alignl 4, 0xbf800000
mk_Q3_bf0:
  buffer_load_dword v65, v37, s[4:7], s29 offen offset:0 sc1
  buffer_load_dword v67, v38, s[4:7], s29 offen offset:0 sc1
  buffer_load_dword v69, v39, s[4:7], s29 offen offset:0 sc1
mk_Q3_b1:
  s_waitcnt vmcnt(8)
  v_lshlrev_b32 v70, 16, v71
  v_and_b32 v71, 0xffff0000, v71
  v_pk_add_f32 v[44:45], v[32:33], v[70:71]
  s_waitcnt vmcnt(6)
  v_lshlrev_b32 v72, 16, v73
  v_and_b32 v73, 0xffff0000, v73
  v_lshlrev_b32 v74, 16, v75
  v_and_b32 v75, 0xffff0000, v75
  v_pk_add_f32 v[48:49], v[72:73], v[74:75]
  v_pk_add_f32 v[44:45], v[44:45], v[48:49]
  v_cmp_u_f32 vcc, v44, v45
  v_cvt_pk_bf16_f32 v46, v44, v45
  s_nop 1
  v_mov_b32_dpp v47, v46 quad_perm:[1,0,3,2] row_mask:0xf bank_mask:0xf
  v_perm_b32 v46, v47, v46, v13
  s_cbranch_vccnz mk_Q3_bf1
  buffer_store_dword v46, v12, s[4:7], s18 offen
  s_branch mk_Q3_top
.p2alignl 4, 0xbf800000
mk_Q3_bf1:
  buffer_load_dword v71, v37, s[4:7], s29 offen offset:1024 sc1
  buffer_load_dword v73, v38, s[4:7], s29 offen offset:1024 sc1
  buffer_load_dword v75, v39, s[4:7], s29 offen offset:1024 sc1
mk_Q3_b2:
  s_waitcnt vmcnt(8)
  v_lshlrev_b32 v76, 16, v77
  v_and_b32 v77, 0xffff0000, v77
  v_pk_add_f32 v[44:45], v[32:33], v[76:77]
  s_waitcnt vmcnt(6)
  v_lshlrev_b32 v78, 16, v79
  v_and_b32 v79, 0xffff0000, v79
  v_lshlrev_b32 v80, 16, v81
  v_and_b32 v81, 0xffff0000, v81
  v_pk_add_f32 v[48:49], v[78:79], v[80:81]
  v_pk_add_f32 v[44:45], v[44:45], v[48:49]
  v_cmp_u_f32 vcc, v44, v45
  v_cvt_pk_bf16_f32 v46, v44, v45
  s_nop 1
  v_mov_b32_dpp v47, v46 quad_perm:[1,0,3,2] row_mask:0xf bank_mask:0xf
  v_perm_b32 v46, v47, v46, v13
  s_cbranch_vccnz mk_Q3_bf2
  buffer_store_dword v46, v12, s[4:7], s18 offen
  s_branch mk_Q3_top
.p2alignl 4, 0xbf800000
mk_Q3_bf2:
  buffer_load_dword v77, v37, s[4:7], s29 offen offset:2048 sc1
  buffer_load_dword v79, v38, s[4:7], s29 offen offset:2048 sc1
  buffer_load_dword v81, v39, s[4:7], s29 offen offset:2048 sc1
  s_add_u32 s11, s11, 1
  s_cmp_lt_u32 s11, 262144
  s_cbranch_scc0 mk_fail
  s_branch mk_Q3_b0
mk_S0_init:
  s_lshl_b32 s26, s8, 17
  s_lshl_b32 s13, s37, 12
  s_add_u32 s26, s26, s13
  s_add_u32 s26, s26, 64225280
  v_and_b32 v62, 1, v1
  v_bfe_u32 v63, v1, 1, 3
  v_lshlrev_b32 v9, 2, v1
  v_lshlrev_b32 v11, 6, v61
  v_lshl_add_u32 v11, v62, 4, v11
  v_lshl_add_u32 v11, v63, 1, v11
  v_lshlrev_b32 v10, 7, v61
  v_lshl_add_u32 v10, v62, 4, v10
  v_bfe_u32 v63, v1, 1, 1
  v_lshl_add_u32 v10, v63, 3, v10
  v_bfe_u32 v63, v1, 2, 1
  v_lshl_add_u32 v10, v63, 6, v10
  v_bfe_u32 v63, v1, 3, 1
  v_lshl_add_u32 v10, v63, 5, v10
  s_lshl_b32 s13, s37, 9
  v_add_u32 v10, s13, v10
  s_and_b32 s13, s37, 1
  s_lshl_b32 s13, s13, 8
  s_lshr_b32 s14, s37, 2
  s_lshl_b32 s14, s14, 9
  s_add_u32 s13, s13, s14
  s_and_b32 s14, s37, 2
  s_lshl_b32 s14, s14, 4
  s_add_u32 s13, s13, s14
  s_add_u32 s13, s13, 4096
  v_add_u32 v11, s13, v11
  s_lshl_b32 s27, s8, 15
  s_add_u32 s27, s27, 64749568
  v_min_u32 v53, 47, v1
  v_lshrrev_b32 v62, 1, v53
  v_and_b32 v62, 15, v62
  v_lshlrev_b32 v53, 6, v53
  v_lshl_add_u32 v53, v62, 2, v53
  v_add_u32 v53, s19, v53
mk_S0_prime:
  v_mov_b32 v20, 0
  v_mov_b32 v21, 0
  v_mov_b32 v22, 0
  v_mov_b32 v23, 0
  v_mov_b32 v24, 0
  v_mov_b32 v25, 0
  v_mov_b32 v26, 0
  v_mov_b32 v27, 0
  s_and_b32 s18, s10, 3
  s_lshl_b32 s18, s18, 14
  s_add_u32 s18, s18, s17
  s_mov_b32 s11, 0
  s_mul_hi_u32 s68, s10, 0x2aaaaaab
  s_mul_i32 s68, s68, 6
  s_sub_u32 s13, s10, s68
  s_mul_i32 s13, s13, 20480
  s_add_u32 s13, s13, 33792
  v_add_u32 v0, s13, v8
  s_and_b32 s28, s10, 3
  s_lshl_b32 s28, s28, 15
  s_add_u32 s28, s28, s26
  s_and_b32 s29, s10, 3
  s_lshl_b32 s29, s29, 13
  s_add_u32 s29, s29, s27
  s_add_u32 s13, s10, 1
  s_mov_b32 m0, s19
  s_waitcnt vmcnt(0) lgkmcnt(0)
  s_branch mk_S0_top
mk_S0_last:
  buffer_store_dwordx4 v[56:59], v5, s[4:7], s24 offen offset:0 sc1
  s_branch mk_S_drain
mk_S0_tre:
  s_add_u32 s11, s11, 1
  s_cmp_lt_u32 s11, 262144
  s_cbranch_scc0 mk_fail
  s_and_b32 s14, s22, 31
  s_lshl_b32 s14, s14, 2
  s_add_u32 s14, s14, s8
  s_lshr_b32 s68, s14, 1
  s_bitcmp1_b64 s[64:65], s68
  s_cselect_b32 s68, 0x2000, 0
  s_lshl_b32 s14, s14, 20
  s_add_u32 s14, s14, s68
  s_add_u32 s14, s14, s41
  buffer_load_dwordx4 v[64:67], v5, s[4:7], s14 offen offset:0 sc1
  buffer_load_dwordx4 v[68:71], v5, s[4:7], s14 offen offset:1024 sc1
  buffer_load_dwordx4 v[72:75], v5, s[4:7], s14 offen offset:2048 sc1
  buffer_load_dwordx4 v[76:79], v5, s[4:7], s14 offen offset:3072 sc1
  s_add_u32 s14, s14, 4096
  buffer_load_dwordx4 v[84:87], v5, s[4:7], s14 offen offset:0 sc1
  buffer_load_dwordx4 v[88:91], v5, s[4:7], s14 offen offset:1024 sc1
  buffer_load_dwordx4 v[92:95], v5, s[4:7], s14 offen offset:2048 sc1
  buffer_load_dwordx4 v[96:99], v5, s[4:7], s14 offen offset:3072 sc1
  s_add_u32 s14, s14, 12288
  buffer_load_dwordx4 v[104:107], v5, s[4:7], s14 offen offset:0 sc1
  buffer_load_dwordx4 v[108:111], v5, s[4:7], s14 offen offset:1024 sc1
  buffer_load_dwordx4 v[112:115], v5, s[4:7], s14 offen offset:2048 sc1
  buffer_load_dwordx4 v[116:119], v5, s[4:7], s14 offen offset:3072 sc1
  s_add_u32 s14, s14, 4096
  buffer_load_dwordx4 v[124:127], v5, s[4:7], s14 offen offset:0 sc1
  buffer_load_dwordx4 v[128:131], v5, s[4:7], s14 offen offset:1024 sc1
  buffer_load_dwordx4 v[132:135], v5, s[4:7], s14 offen offset:2048 sc1
  buffer_load_dwordx4 v[136:139], v5, s[4:7], s14 offen offset:3072 sc1
  s_add_u32 s14, s14, 12288
  buffer_load_dwordx4 v[80:83], v5, s[4:7], s14 offen offset:0 sc1
  buffer_load_dwordx4 v[100:103], v5, s[4:7], s14 offen offset:1024 sc1
  buffer_load_dwordx4 v[120:123], v5, s[4:7], s14 offen offset:2048 sc1
  buffer_load_dwordx4 v[140:143], v5, s[4:7], s14 offen offset:3072 sc1
  s_waitcnt vmcnt(0)
  v_mov_b32 v20, 0
  v_mov_b32 v21, 0
  v_mov_b32 v22, 0
  v_mov_b32 v23, 0
  v_mov_b32 v24, 0
  v_mov_b32 v25, 0
  v_mov_b32 v26, 0
  v_mov_b32 v27, 0
  v_mov_b32 v28, 0
  v_mov_b32 v29, 0
  v_mov_b32 v30, 0
  v_mov_b32 v31, 0
  v_mov_b32 v32, 0
  v_mov_b32 v33, 0
  v_mov_b32 v34, 0
  v_mov_b32 v35, 0
  v_smfmac_f32_16x16x64_bf16 v[20:23], v[64:67], v[144:151], v15
  v_smfmac_f32_16x16x64_bf16 v[20:23], v[68:71], v[152:159], v15
  v_smfmac_f32_16x16x64_bf16 v[20:23], v[72:75], v[160:167], v15
  v_smfmac_f32_16x16x64_bf16 v[20:23], v[76:79], v[168:175], v15
  v_smfmac_f32_16x16x64_bf16 v[20:23], v[80:83], v[176:183], v15
  v_smfmac_f32_16x16x64_bf16 v[24:27], v[84:87], v[144:151], v15
  v_smfmac_f32_16x16x64_bf16 v[24:27], v[88:91], v[152:159], v15
  v_smfmac_f32_16x16x64_bf16 v[24:27], v[92:95], v[160:167], v15
  v_smfmac_f32_16x16x64_bf16 v[24:27], v[96:99], v[168:175], v15
  v_smfmac_f32_16x16x64_bf16 v[24:27], v[100:103], v[176:183], v15
  v_smfmac_f32_16x16x64_bf16 v[28:31], v[104:107], v[144:151], v15
  v_smfmac_f32_16x16x64_bf16 v[28:31], v[108:111], v[152:159], v15
  v_smfmac_f32_16x16x64_bf16 v[28:31], v[112:115], v[160:167], v15
  v_smfmac_f32_16x16x64_bf16 v[28:31], v[116:119], v[168:175], v15
  v_smfmac_f32_16x16x64_bf16 v[28:31], v[120:123], v[176:183], v15
  v_smfmac_f32_16x16x64_bf16 v[32:35], v[124:127], v[144:151], v15
  v_smfmac_f32_16x16x64_bf16 v[32:35], v[128:131], v[152:159], v15
  v_smfmac_f32_16x16x64_bf16 v[32:35], v[132:135], v[160:167], v15
  v_smfmac_f32_16x16x64_bf16 v[32:35], v[136:139], v[168:175], v15
  v_smfmac_f32_16x16x64_bf16 v[32:35], v[140:143], v[176:183], v15
  v_pk_add_f32 v[20:21], v[20:21], v[22:23]
  v_cvt_pk_bf16_f32 v56, v20, v21
  v_maximum3_f32 v60, v20, v21, v20
  v_pk_add_f32 v[24:25], v[24:25], v[26:27]
  v_cvt_pk_bf16_f32 v57, v24, v25
  v_maximum3_f32 v60, v24, v25, v60
  v_pk_add_f32 v[28:29], v[28:29], v[30:31]
  v_cvt_pk_bf16_f32 v58, v28, v29
  v_maximum3_f32 v60, v28, v29, v60
  v_pk_add_f32 v[32:33], v[32:33], v[34:35]
  v_cvt_pk_bf16_f32 v59, v32, v33
  v_maximum3_f32 v60, v32, v33, v60
  v_cmp_u_f32 vcc, v60, v60
  s_nop 0
  s_cbranch_vccnz mk_S0_tre
  s_branch mk_S0_tok
mk_S0_rcv:
  s_add_u32 s11, s11, 1
  s_cmp_lt_u32 s11, 262144
  s_cbranch_scc0 mk_fail
  s_mov_b32 s13, s18
  s_mov_b32 m0, 0
  s_nop 0
  buffer_load_dwordx4 v5, s[4:7], s13 offen offset:0 sc1 lds
  buffer_load_dwordx4 v5, s[4:7], s13 offen offset:1024 sc1 lds
  buffer_load_dwordx4 v5, s[4:7], s13 offen offset:2048 sc1 lds
  buffer_load_dwordx4 v5, s[4:7], s13 offen offset:3072 sc1 lds
  s_mov_b32 m0, 4096
  s_add_u32 s13, s13, 4096
  buffer_load_dwordx4 v5, s[4:7], s13 offen offset:0 sc1 lds
  buffer_load_dwordx4 v5, s[4:7], s13 offen offset:1024 sc1 lds
  buffer_load_dwordx4 v5, s[4:7], s13 offen offset:2048 sc1 lds
  buffer_load_dwordx4 v5, s[4:7], s13 offen offset:3072 sc1 lds
  s_mov_b32 m0, 8192
  s_add_u32 s13, s13, 4096
  buffer_load_dwordx4 v5, s[4:7], s13 offen offset:0 sc1 lds
  buffer_load_dwordx4 v5, s[4:7], s13 offen offset:1024 sc1 lds
  s_waitcnt vmcnt(0) lgkmcnt(0)
  s_nop 7
  v_mov_b32 v20, 0
  v_mov_b32 v21, 0
  v_mov_b32 v22, 0
  v_mov_b32 v23, 0
  v_mov_b32 v24, 0
  v_mov_b32 v25, 0
  v_mov_b32 v26, 0
  v_mov_b32 v27, 0
  ds_read_b128 v[64:67], v3 offset:0
  ds_read_b128 v[68:71], v3 offset:512
  ds_read_b128 v[72:75], v3 offset:1024
  ds_read_b128 v[76:79], v3 offset:1536
  s_branch mk_S0_chain
.p2alignl 4, 0xbf800000
mk_S0_top:
  s_barrier
  s_nop 15
  s_nop 7
  buffer_load_dwordx4 v4, s[4:7], s18 offen offset:0 sc1 lds
  buffer_load_dwordx4 v4, s[4:7], s18 offen offset:1024 sc1 lds
  buffer_load_dwordx4 v4, s[4:7], s18 offen offset:2048 sc1 lds
  s_nop 15
  s_nop 13
  buffer_load_dwordx4 v4, s[4:7], s18 offen offset:0 sc1 lds
  buffer_load_dwordx4 v4, s[4:7], s18 offen offset:1024 sc1 lds
  buffer_load_dwordx4 v4, s[4:7], s18 offen offset:2048 sc1 lds
  s_branch mk_S0_c1
.p2alignl 4, 0xbf800000
mk_S0_c0:
  s_add_u32 s11, s11, 1
  s_cmp_lt_u32 s11, 262144
  s_cbranch_scc0 mk_fail
mk_S0_c1:
  s_waitcnt vmcnt(3)
  ds_read_b32 v28, v53
  ds_read_b128 v[64:67], v3 offset:0
  ds_read_b128 v[68:71], v3 offset:512
  ds_read_b128 v[72:75], v3 offset:1024
  ds_read_b128 v[76:79], v3 offset:1536
  buffer_load_dwordx4 v4, s[4:7], s18 offen offset:0 sc1 lds
  buffer_load_dwordx4 v4, s[4:7], s18 offen offset:1024 sc1 lds
  buffer_load_dwordx4 v4, s[4:7], s18 offen offset:2048 sc1 lds
  s_waitcnt lgkmcnt(4)
  v_cmp_eq_u32 vcc, -1, v28
  s_nop 0
  s_cbranch_vccnz mk_S0_c0
  s_barrier
mk_S0_chain:
  buffer_store_dwordx4 v[56:59], v5, s[4:7], s24 offen offset:0 sc1
  s_waitcnt lgkmcnt(3)
  v_smfmac_f32_16x16x64_bf16 v[20:23], v[64:67], a[0:7], v2
  ds_read_b128 v[80:83], v3 offset:2048
  v_smfmac_f32_16x16x64_bf16 v[24:27], v[64:67], a[160:167], v2
  s_waitcnt lgkmcnt(3)
  v_smfmac_f32_16x16x64_bf16 v[20:23], v[68:71], a[8:15], v2
  ds_read_b128 v[84:87], v3 offset:2560
  v_smfmac_f32_16x16x64_bf16 v[24:27], v[68:71], a[168:175], v2
  s_waitcnt lgkmcnt(3)
  v_smfmac_f32_16x16x64_bf16 v[20:23], v[72:75], a[16:23], v2
  ds_read_b128 v[88:91], v3 offset:3072
  v_smfmac_f32_16x16x64_bf16 v[24:27], v[72:75], a[176:183], v2
  s_waitcnt lgkmcnt(3)
  v_smfmac_f32_16x16x64_bf16 v[20:23], v[76:79], a[24:31], v2
  ds_read_b128 v[92:95], v3 offset:3584
  v_smfmac_f32_16x16x64_bf16 v[24:27], v[76:79], a[184:191], v2
  s_waitcnt lgkmcnt(3)
  v_smfmac_f32_16x16x64_bf16 v[20:23], v[80:83], a[32:39], v2
  ds_read_b128 v[96:99], v3 offset:4096
  v_smfmac_f32_16x16x64_bf16 v[24:27], v[80:83], a[192:199], v2
  s_waitcnt lgkmcnt(3)
  v_smfmac_f32_16x16x64_bf16 v[20:23], v[84:87], a[40:47], v2
  ds_read_b128 v[100:103], v3 offset:4608
  v_smfmac_f32_16x16x64_bf16 v[24:27], v[84:87], a[200:207], v2
  s_waitcnt lgkmcnt(3)
  v_smfmac_f32_16x16x64_bf16 v[20:23], v[88:91], a[48:55], v2
  ds_read_b128 v[104:107], v3 offset:5120
  v_smfmac_f32_16x16x64_bf16 v[24:27], v[88:91], a[208:215], v2
  s_waitcnt lgkmcnt(3)
  v_smfmac_f32_16x16x64_bf16 v[20:23], v[92:95], a[56:63], v2
  ds_read_b128 v[108:111], v3 offset:5632
  v_smfmac_f32_16x16x64_bf16 v[24:27], v[92:95], a[216:223], v2
  s_waitcnt lgkmcnt(3)
  v_smfmac_f32_16x16x64_bf16 v[20:23], v[96:99], a[64:71], v2
  ds_read_b128 v[112:115], v3 offset:6144
  v_smfmac_f32_16x16x64_bf16 v[24:27], v[96:99], a[224:231], v2
  s_waitcnt lgkmcnt(3)
  v_smfmac_f32_16x16x64_bf16 v[20:23], v[100:103], a[72:79], v2
  ds_read_b128 v[116:119], v3 offset:6656
  v_smfmac_f32_16x16x64_bf16 v[24:27], v[100:103], a[232:239], v2
  s_waitcnt lgkmcnt(3)
  v_smfmac_f32_16x16x64_bf16 v[20:23], v[104:107], a[80:87], v2
  ds_read_b128 v[120:123], v3 offset:7168
  v_smfmac_f32_16x16x64_bf16 v[24:27], v[104:107], a[240:247], v2
  s_waitcnt lgkmcnt(3)
  v_smfmac_f32_16x16x64_bf16 v[20:23], v[108:111], a[88:95], v2
  ds_read_b128 v[124:127], v3 offset:7680
  v_smfmac_f32_16x16x64_bf16 v[24:27], v[108:111], a[248:255], v2
  s_waitcnt lgkmcnt(3)
  v_smfmac_f32_16x16x64_bf16 v[20:23], v[112:115], a[96:103], v2
  ds_read_b128 v[128:131], v3 offset:8192
  v_smfmac_f32_16x16x64_bf16 v[24:27], v[112:115], v[192:199], v2
  s_waitcnt lgkmcnt(3)
  v_smfmac_f32_16x16x64_bf16 v[20:23], v[116:119], a[104:111], v2
  ds_read_b128 v[132:135], v3 offset:8704
  v_smfmac_f32_16x16x64_bf16 v[24:27], v[116:119], v[200:207], v2
  s_waitcnt lgkmcnt(3)
  v_smfmac_f32_16x16x64_bf16 v[20:23], v[120:123], a[112:119], v2
  ds_read_b128 v[136:139], v3 offset:9216
  v_smfmac_f32_16x16x64_bf16 v[24:27], v[120:123], v[208:215], v2
  s_waitcnt lgkmcnt(3)
  v_smfmac_f32_16x16x64_bf16 v[20:23], v[124:127], a[120:127], v2
  ds_read_b128 v[140:143], v3 offset:9728
  v_smfmac_f32_16x16x64_bf16 v[24:27], v[124:127], v[216:223], v2
  s_waitcnt lgkmcnt(3)
  v_smfmac_f32_16x16x64_bf16 v[20:23], v[128:131], a[128:135], v2
  v_smfmac_f32_16x16x64_bf16 v[24:27], v[128:131], v[224:231], v2
  buffer_load_dword v156, v9, s[4:7], s28 offen offset:1024 sc1
  buffer_load_dword v157, v9, s[4:7], s28 offen offset:2304 sc1
  buffer_load_dword v158, v9, s[4:7], s28 offen offset:3584 sc1
  buffer_load_dwordx4 v[144:147], v5, s[4:7], s28 offen offset:0 sc1
  buffer_load_dwordx4 v[148:151], v5, s[4:7], s28 offen offset:1280 sc1
  buffer_load_dwordx4 v[152:155], v5, s[4:7], s28 offen offset:2560 sc1
  s_waitcnt lgkmcnt(2)
  v_smfmac_f32_16x16x64_bf16 v[20:23], v[132:135], a[136:143], v2
  v_smfmac_f32_16x16x64_bf16 v[24:27], v[132:135], v[232:239], v2
  s_waitcnt lgkmcnt(1)
  v_smfmac_f32_16x16x64_bf16 v[20:23], v[136:139], a[144:151], v2
  v_smfmac_f32_16x16x64_bf16 v[24:27], v[136:139], v[240:247], v2
  s_waitcnt lgkmcnt(0)
  v_smfmac_f32_16x16x64_bf16 v[20:23], v[140:143], a[152:159], v2
  v_smfmac_f32_16x16x64_bf16 v[24:27], v[140:143], v[248:255], v2
  buffer_load_dword v172, v9, s[4:7], s28 offen offset:1024 sc1
  buffer_load_dword v173, v9, s[4:7], s28 offen offset:2304 sc1
  buffer_load_dword v174, v9, s[4:7], s28 offen offset:3584 sc1
  buffer_load_dwordx4 v[160:163], v5, s[4:7], s28 offen offset:0 sc1
  buffer_load_dwordx4 v[164:167], v5, s[4:7], s28 offen offset:1280 sc1
  buffer_load_dwordx4 v[168:171], v5, s[4:7], s28 offen offset:2560 sc1
  s_nop 0
  v_maximum3_f32 v31, v20, v21, v22
  v_cmp_u_f32 vcc, v31, v23
  v_cvt_pk_bf16_f32 v32, v20, v21
  v_cvt_pk_bf16_f32 v33, v22, v23
  v_cvt_pk_bf16_f32 v34, v24, v25
  v_cvt_pk_bf16_f32 v35, v26, v27
  s_cbranch_vccnz mk_S0_rcv
  ds_write_b64 v0, v[32:33] offset:0
  ds_write_b64 v0, v[34:35] offset:2048
  buffer_load_dword v188, v9, s[4:7], s28 offen offset:1024 sc1
  buffer_load_dword v189, v9, s[4:7], s28 offen offset:2304 sc1
  buffer_load_dword v190, v9, s[4:7], s28 offen offset:3584 sc1
  buffer_load_dwordx4 v[176:179], v5, s[4:7], s28 offen offset:0 sc1
  buffer_load_dwordx4 v[180:183], v5, s[4:7], s28 offen offset:1280 sc1
  buffer_load_dwordx4 v[184:187], v5, s[4:7], s28 offen offset:2560 sc1
mk_S0_a0:
  s_waitcnt vmcnt(15)
  v_add_f32 v40, v156, v157
  v_add_f32 v40, v40, v158
  v_cmp_u_f32 vcc, v40, v40
  s_waitcnt vmcnt(13)
  v_pk_add_f32 v[36:37], v[144:145], v[148:149]
  v_pk_add_f32 v[38:39], v[146:147], v[150:151]
  s_cbranch_vccnz mk_S0_af0
  s_waitcnt vmcnt(12)
  v_pk_add_f32 v[36:37], v[36:37], v[152:153]
  v_pk_add_f32 v[38:39], v[38:39], v[154:155]
  v_maximum3_f32 v42, v36, v37, v40
  v_maximum3_f32 v42, v42, v38, v39
  v_cmp_u_f32 vcc, v42, v42
  s_nop 0
  v_max_f32_dpp v42, v42, v42 quad_perm:[2,3,0,1] row_mask:0xf bank_mask:0xf
  s_nop 1
  v_max_f32_dpp v42, v42, v42 row_ror:4 row_mask:0xf bank_mask:0xf
  s_cbranch_vccnz mk_S0_af0
  s_nop 0
  v_max_f32_dpp v42, v42, v42 row_ror:8 row_mask:0xf bank_mask:0xf
  v_mul_f32 v42, s36, v42
  v_fma_f32 v36, v36, s36, -v42
  v_fma_f32 v37, v37, s36, -v42
  v_fma_f32 v38, v38, s36, -v42
  v_fma_f32 v39, v39, s36, -v42
  v_fma_f32 v40, v40, s36, -v42
  v_exp_f32 v36, v36
  v_exp_f32 v37, v37
  v_exp_f32 v38, v38
  v_exp_f32 v39, v39
  v_exp_f32 v40, v40
  v_pk_add_f32 v[44:45], v[36:37], v[38:39]
  v_add_f32 v44, v44, v45
  v_add_f32 v44, v44, v40
  s_nop 1
  v_add_f32_dpp v44, v44, v44 quad_perm:[2,3,0,1] row_mask:0xf bank_mask:0xf
  s_nop 1
  v_add_f32_dpp v44, v44, v44 row_ror:4 row_mask:0xf bank_mask:0xf
  s_nop 1
  v_add_f32_dpp v44, v44, v44 row_ror:8 row_mask:0xf bank_mask:0xf
  v_rcp_f32 v44, v44
  s_nop 0
  v_pk_mul_f32 v[36:37], v[36:37], v[44:45] op_sel_hi:[1,0]
  v_pk_mul_f32 v[38:39], v[38:39], v[44:45] op_sel_hi:[1,0]
  v_mul_f32 v40, v40, v44
  v_cvt_pk_bf16_f32 v36, v36, v37
  v_cvt_pk_bf16_f32 v37, v38, v39
  v_cvt_pk_bf16_f32 v40, v40, v40
  buffer_store_dwordx2 v[36:37], v10, s[4:7], s29 offen
  buffer_store_short v40, v11, s[4:7], s29 offen
  s_branch mk_S0_aok
.p2alignl 4, 0xbf800000
mk_S0_af0:
  buffer_load_dword v156, v9, s[4:7], s28 offen offset:1024 sc1
  buffer_load_dword v157, v9, s[4:7], s28 offen offset:2304 sc1
  buffer_load_dword v158, v9, s[4:7], s28 offen offset:3584 sc1
  buffer_load_dwordx4 v[144:147], v5, s[4:7], s28 offen offset:0 sc1
  buffer_load_dwordx4 v[148:151], v5, s[4:7], s28 offen offset:1280 sc1
  buffer_load_dwordx4 v[152:155], v5, s[4:7], s28 offen offset:2560 sc1
mk_S0_a1:
  s_waitcnt vmcnt(15)
  v_add_f32 v40, v172, v173
  v_add_f32 v40, v40, v174
  v_cmp_u_f32 vcc, v40, v40
  s_waitcnt vmcnt(13)
  v_pk_add_f32 v[36:37], v[160:161], v[164:165]
  v_pk_add_f32 v[38:39], v[162:163], v[166:167]
  s_cbranch_vccnz mk_S0_af1
  s_waitcnt vmcnt(12)
  v_pk_add_f32 v[36:37], v[36:37], v[168:169]
  v_pk_add_f32 v[38:39], v[38:39], v[170:171]
  v_maximum3_f32 v42, v36, v37, v40
  v_maximum3_f32 v42, v42, v38, v39
  v_cmp_u_f32 vcc, v42, v42
  s_nop 0
  v_max_f32_dpp v42, v42, v42 quad_perm:[2,3,0,1] row_mask:0xf bank_mask:0xf
  s_nop 1
  v_max_f32_dpp v42, v42, v42 row_ror:4 row_mask:0xf bank_mask:0xf
  s_cbranch_vccnz mk_S0_af1
  s_nop 0
  v_max_f32_dpp v42, v42, v42 row_ror:8 row_mask:0xf bank_mask:0xf
  v_mul_f32 v42, s36, v42
  v_fma_f32 v36, v36, s36, -v42
  v_fma_f32 v37, v37, s36, -v42
  v_fma_f32 v38, v38, s36, -v42
  v_fma_f32 v39, v39, s36, -v42
  v_fma_f32 v40, v40, s36, -v42
  v_exp_f32 v36, v36
  v_exp_f32 v37, v37
  v_exp_f32 v38, v38
  v_exp_f32 v39, v39
  v_exp_f32 v40, v40
  v_pk_add_f32 v[44:45], v[36:37], v[38:39]
  v_add_f32 v44, v44, v45
  v_add_f32 v44, v44, v40
  s_nop 1
  v_add_f32_dpp v44, v44, v44 quad_perm:[2,3,0,1] row_mask:0xf bank_mask:0xf
  s_nop 1
  v_add_f32_dpp v44, v44, v44 row_ror:4 row_mask:0xf bank_mask:0xf
  s_nop 1
  v_add_f32_dpp v44, v44, v44 row_ror:8 row_mask:0xf bank_mask:0xf
  v_rcp_f32 v44, v44
  s_nop 0
  v_pk_mul_f32 v[36:37], v[36:37], v[44:45] op_sel_hi:[1,0]
  v_pk_mul_f32 v[38:39], v[38:39], v[44:45] op_sel_hi:[1,0]
  v_mul_f32 v40, v40, v44
  v_cvt_pk_bf16_f32 v36, v36, v37
  v_cvt_pk_bf16_f32 v37, v38, v39
  v_cvt_pk_bf16_f32 v40, v40, v40
  buffer_store_dwordx2 v[36:37], v10, s[4:7], s29 offen
  buffer_store_short v40, v11, s[4:7], s29 offen
  s_branch mk_S0_aok
.p2alignl 4, 0xbf800000
mk_S0_af1:
  buffer_load_dword v172, v9, s[4:7], s28 offen offset:1024 sc1
  buffer_load_dword v173, v9, s[4:7], s28 offen offset:2304 sc1
  buffer_load_dword v174, v9, s[4:7], s28 offen offset:3584 sc1
  buffer_load_dwordx4 v[160:163], v5, s[4:7], s28 offen offset:0 sc1
  buffer_load_dwordx4 v[164:167], v5, s[4:7], s28 offen offset:1280 sc1
  buffer_load_dwordx4 v[168:171], v5, s[4:7], s28 offen offset:2560 sc1
mk_S0_a2:
  s_waitcnt vmcnt(15)
  v_add_f32 v40, v188, v189
  v_add_f32 v40, v40, v190
  v_cmp_u_f32 vcc, v40, v40
  s_waitcnt vmcnt(13)
  v_pk_add_f32 v[36:37], v[176:177], v[180:181]
  v_pk_add_f32 v[38:39], v[178:179], v[182:183]
  s_cbranch_vccnz mk_S0_af2
  s_waitcnt vmcnt(12)
  v_pk_add_f32 v[36:37], v[36:37], v[184:185]
  v_pk_add_f32 v[38:39], v[38:39], v[186:187]
  v_maximum3_f32 v42, v36, v37, v40
  v_maximum3_f32 v42, v42, v38, v39
  v_cmp_u_f32 vcc, v42, v42
  s_nop 0
  v_max_f32_dpp v42, v42, v42 quad_perm:[2,3,0,1] row_mask:0xf bank_mask:0xf
  s_nop 1
  v_max_f32_dpp v42, v42, v42 row_ror:4 row_mask:0xf bank_mask:0xf
  s_cbranch_vccnz mk_S0_af2
  s_nop 0
  v_max_f32_dpp v42, v42, v42 row_ror:8 row_mask:0xf bank_mask:0xf
  v_mul_f32 v42, s36, v42
  v_fma_f32 v36, v36, s36, -v42
  v_fma_f32 v37, v37, s36, -v42
  v_fma_f32 v38, v38, s36, -v42
  v_fma_f32 v39, v39, s36, -v42
  v_fma_f32 v40, v40, s36, -v42
  v_exp_f32 v36, v36
  v_exp_f32 v37, v37
  v_exp_f32 v38, v38
  v_exp_f32 v39, v39
  v_exp_f32 v40, v40
  v_pk_add_f32 v[44:45], v[36:37], v[38:39]
  v_add_f32 v44, v44, v45
  v_add_f32 v44, v44, v40
  s_nop 1
  v_add_f32_dpp v44, v44, v44 quad_perm:[2,3,0,1] row_mask:0xf bank_mask:0xf
  s_nop 1
  v_add_f32_dpp v44, v44, v44 row_ror:4 row_mask:0xf bank_mask:0xf
  s_nop 1
  v_add_f32_dpp v44, v44, v44 row_ror:8 row_mask:0xf bank_mask:0xf
  v_rcp_f32 v44, v44
  s_nop 0
  v_pk_mul_f32 v[36:37], v[36:37], v[44:45] op_sel_hi:[1,0]
  v_pk_mul_f32 v[38:39], v[38:39], v[44:45] op_sel_hi:[1,0]
  v_mul_f32 v40, v40, v44
  v_cvt_pk_bf16_f32 v36, v36, v37
  v_cvt_pk_bf16_f32 v37, v38, v39
  v_cvt_pk_bf16_f32 v40, v40, v40
  buffer_store_dwordx2 v[36:37], v10, s[4:7], s29 offen
  buffer_store_short v40, v11, s[4:7], s29 offen
  s_branch mk_S0_aok
.p2alignl 4, 0xbf800000
mk_S0_af2:
  buffer_load_dword v188, v9, s[4:7], s28 offen offset:1024 sc1
  buffer_load_dword v189, v9, s[4:7], s28 offen offset:2304 sc1
  buffer_load_dword v190, v9, s[4:7], s28 offen offset:3584 sc1
  buffer_load_dwordx4 v[176:179], v5, s[4:7], s28 offen offset:0 sc1
  buffer_load_dwordx4 v[180:183], v5, s[4:7], s28 offen offset:1280 sc1
  buffer_load_dwordx4 v[184:187], v5, s[4:7], s28 offen offset:2560 sc1
  s_add_u32 s11, s11, 1
  s_cmp_lt_u32 s11, 262144
  s_cbranch_scc0 mk_fail
  s_branch mk_S0_a0
.p2alignl 4, 0xbf800000
mk_S0_aok:
  s_waitcnt lgkmcnt(0)
  s_barrier
  s_and_b32 s13, s10, 63
  s_cmp_lt_u32 s13, 4
  s_cbranch_scc1 mk_S0_nt
  s_sub_u32 s22, s10, 4
  s_waitcnt vmcnt(2)
  s_mul_hi_u32 s68, s22, 0x2aaaaaab
  s_mul_i32 s68, s68, 6
  s_sub_u32 s13, s22, s68
  s_mul_i32 s13, s13, 20480
  s_add_u32 s13, s13, 33792
  v_add_u32 v60, s13, v5
  s_add_u32 s13, s13, 16384
  v_lshl_add_u32 v61, v1, 3, s13
  v_add_u32 v62, 1024, v61
  ds_read_b128 v[144:147], v60 offset:0
  ds_read_b128 v[148:151], v60 offset:1024
  ds_read_b128 v[152:155], v60 offset:2048
  ds_read_b128 v[156:159], v60 offset:3072
  ds_read_b128 v[160:163], v60 offset:4096
  ds_read_b128 v[164:167], v60 offset:5120
  ds_read_b128 v[168:171], v60 offset:6144
  ds_read_b128 v[172:175], v60 offset:7168
  ds_read2_b32 v[176:177], v61 offset0:0 offset1:128
  ds_read2_b32 v[178:179], v61 offset0:1 offset1:129
  ds_read2_b32 v[180:181], v62 offset0:0 offset1:128
  ds_read2_b32 v[182:183], v62 offset0:1 offset1:129
  ds_read_b128 v[64:67], v5 offset:13312
  ds_read_b128 v[68:71], v5 offset:14336
  ds_read_b128 v[72:75], v5 offset:15360
  ds_read_b128 v[76:79], v5 offset:16384
  ds_read_b128 v[80:83], v5 offset:29696
  ds_read_b128 v[84:87], v5 offset:17408
  ds_read_b128 v[88:91], v5 offset:18432
  ds_read_b128 v[92:95], v5 offset:19456
  ds_read_b128 v[96:99], v5 offset:20480
  ds_read_b128 v[100:103], v5 offset:30720
  ds_read_b128 v[104:107], v5 offset:21504
  ds_read_b128 v[108:111], v5 offset:22528
  ds_read_b128 v[112:115], v5 offset:23552
  ds_read_b128 v[116:119], v5 offset:24576
  ds_read_b128 v[120:123], v5 offset:31744
  ds_read_b128 v[124:127], v5 offset:25600
  ds_read_b128 v[128:131], v5 offset:26624
  ds_read_b128 v[132:135], v5 offset:27648
  ds_read_b128 v[136:139], v5 offset:28672
  ds_read_b128 v[140:143], v5 offset:32768
  s_and_b32 s24, s22, 31
  s_lshl_b32 s24, s24, 2
  s_add_u32 s24, s24, s8
  s_lshr_b32 s68, s24, 1
  s_bitcmp1_b64 s[64:65], s68
  s_cselect_b32 s68, 0x2000, 0
  s_lshl_b32 s24, s24, 20
  s_add_u32 s24, s24, s68
  s_add_u32 s24, s24, s72
  s_bitcmp1_b32 s22, 5
  s_cselect_b32 s13, 32768, 0
  s_add_u32 s24, s24, s13
  v_mov_b32 v20, 0
  v_mov_b32 v21, 0
  v_mov_b32 v22, 0
  v_mov_b32 v23, 0
  v_mov_b32 v24, 0
  v_mov_b32 v25, 0
  v_mov_b32 v26, 0
  v_mov_b32 v27, 0
  v_mov_b32 v28, 0
  v_mov_b32 v29, 0
  v_mov_b32 v30, 0
  v_mov_b32 v31, 0
  v_mov_b32 v32, 0
  v_mov_b32 v33, 0
  v_mov_b32 v34, 0
  v_mov_b32 v35, 0
  s_waitcnt lgkmcnt(15)
  v_smfmac_f32_16x16x64_bf16 v[20:23], v[64:67], v[144:151], v15
  v_smfmac_f32_16x16x64_bf16 v[20:23], v[68:71], v[152:159], v15
  v_smfmac_f32_16x16x64_bf16 v[20:23], v[72:75], v[160:167], v15
  v_smfmac_f32_16x16x64_bf16 v[20:23], v[76:79], v[168:175], v15
  v_smfmac_f32_16x16x64_bf16 v[20:23], v[80:83], v[176:183], v15
  s_waitcnt lgkmcnt(10)
  v_smfmac_f32_16x16x64_bf16 v[24:27], v[84:87], v[144:151], v15
  v_smfmac_f32_16x16x64_bf16 v[24:27], v[88:91], v[152:159], v15
  v_smfmac_f32_16x16x64_bf16 v[24:27], v[92:95], v[160:167], v15
  v_smfmac_f32_16x16x64_bf16 v[24:27], v[96:99], v[168:175], v15
  v_smfmac_f32_16x16x64_bf16 v[24:27], v[100:103], v[176:183], v15
  s_waitcnt lgkmcnt(0)
  s_andn2_b32 s13, 63, s10
  s_cbranch_scc0 mk_S0_b4a
  s_barrier
mk_S0_b4a:
  v_smfmac_f32_16x16x64_bf16 v[28:31], v[104:107], v[144:151], v15
  v_smfmac_f32_16x16x64_bf16 v[28:31], v[108:111], v[152:159], v15
  v_smfmac_f32_16x16x64_bf16 v[28:31], v[112:115], v[160:167], v15
  v_smfmac_f32_16x16x64_bf16 v[28:31], v[116:119], v[168:175], v15
  v_smfmac_f32_16x16x64_bf16 v[28:31], v[120:123], v[176:183], v15
  s_waitcnt lgkmcnt(0)
  v_smfmac_f32_16x16x64_bf16 v[32:35], v[124:127], v[144:151], v15
  v_smfmac_f32_16x16x64_bf16 v[32:35], v[128:131], v[152:159], v15
  v_smfmac_f32_16x16x64_bf16 v[32:35], v[132:135], v[160:167], v15
  v_smfmac_f32_16x16x64_bf16 v[32:35], v[136:139], v[168:175], v15
  v_smfmac_f32_16x16x64_bf16 v[32:35], v[140:143], v[176:183], v15
  v_pk_add_f32 v[20:21], v[20:21], v[22:23]
  v_cvt_pk_bf16_f32 v56, v20, v21
  v_maximum3_f32 v60, v20, v21, v20
  v_pk_add_f32 v[24:25], v[24:25], v[26:27]
  v_cvt_pk_bf16_f32 v57, v24, v25
  v_maximum3_f32 v60, v24, v25, v60
  v_pk_add_f32 v[28:29], v[28:29], v[30:31]
  v_cvt_pk_bf16_f32 v58, v28, v29
  v_maximum3_f32 v60, v28, v29, v60
  v_pk_add_f32 v[32:33], v[32:33], v[34:35]
  v_cvt_pk_bf16_f32 v59, v32, v33
  v_maximum3_f32 v60, v32, v33, v60
  v_cmp_u_f32 vcc, v60, v60
  s_nop 0
  s_cbranch_vccnz mk_S0_tre
  s_branch mk_S0_tok
mk_S0_nt:
  s_andn2_b32 s13, 63, s10
  s_cbranch_scc0 mk_S0_b4b
  s_barrier
mk_S0_b4b:
mk_S0_tok:
  s_add_u32 s10, s10, 1
  s_and_b32 s13, s10, 63
  s_cbranch_scc0 mk_S0_last
  v_mov_b32 v20, 0
  v_mov_b32 v21, 0
  v_mov_b32 v22, 0
  v_mov_b32 v23, 0
  v_mov_b32 v24, 0
  v_mov_b32 v25, 0
  v_mov_b32 v26, 0
  v_mov_b32 v27, 0
  s_and_b32 s18, s10, 3
  s_lshl_b32 s18, s18, 14
  s_add_u32 s18, s18, s17
  s_mov_b32 s11, 0
  s_mul_hi_u32 s68, s10, 0x2aaaaaab
  s_mul_i32 s68, s68, 6
  s_sub_u32 s13, s10, s68
  s_mul_i32 s13, s13, 20480
  s_add_u32 s13, s13, 33792
  v_add_u32 v0, s13, v8
  s_and_b32 s28, s10, 3
  s_lshl_b32 s28, s28, 15
  s_add_u32 s28, s28, s26
  s_and_b32 s29, s10, 3
  s_lshl_b32 s29, s29, 13
  s_add_u32 s29, s29, s27
  s_waitcnt vmcnt(0)
  s_mov_b32 m0, s19
  s_waitcnt lgkmcnt(0)
  s_branch mk_S0_top
mk_S1_init:
  v_bfe_u32 v62, v1, 2, 3
  v_lshlrev_b32 v54, 7, v62
  v_add_u32 v54, 8192, v54
  v_and_b32 v62, 3, v1
  v_lshl_add_u32 v54, v62, 2, v54
  s_lshl_b32 s21, s8, 10
  s_add_u32 s21, s21, 64880640
  s_mov_b32 s20, 0
  v_mov_b32 v55, 0
  v_min_u32 v53, 47, v1
  v_lshrrev_b32 v62, 1, v53
  v_and_b32 v62, 15, v62
  v_lshlrev_b32 v53, 6, v53
  v_lshl_add_u32 v53, v62, 2, v53
  v_add_u32 v53, s19, v53
mk_S1_prime:
  v_mov_b32 v20, 0
  v_mov_b32 v21, 0
  v_mov_b32 v22, 0
  v_mov_b32 v23, 0
  v_mov_b32 v24, 0
  v_mov_b32 v25, 0
  v_mov_b32 v26, 0
  v_mov_b32 v27, 0
  s_and_b32 s18, s10, 3
  s_lshl_b32 s18, s18, 14
  s_add_u32 s18, s18, s17
  s_mov_b32 s11, 0
  s_mul_hi_u32 s68, s10, 0x2aaaaaab
  s_mul_i32 s68, s68, 6
  s_sub_u32 s13, s10, s68
  s_mul_i32 s13, s13, 20480
  s_add_u32 s13, s13, 33792
  v_add_u32 v0, s13, v8
  s_add_u32 s13, s10, 1
  s_cmp_ge_u32 s20, s13
  s_cbranch_scc1 int_wm42_ok
  s_mov_b32 s70, 0
int_wm42:
  buffer_load_dword v28, v54, s[4:7], s21 offen sc1
  s_waitcnt vmcnt(0)
  v_min_u32_dpp v28, v28, v28 quad_perm:[1,0,3,2] row_mask:0xf bank_mask:0xf
  s_nop 1
  v_min_u32_dpp v28, v28, v28 quad_perm:[2,3,0,1] row_mask:0xf bank_mask:0xf
  s_nop 1
  v_min_u32_dpp v28, v28, v28 row_half_mirror row_mask:0xf bank_mask:0xf
  s_nop 1
  v_min_u32_dpp v28, v28, v28 row_mirror row_mask:0xf bank_mask:0xf
  v_mov_b32 v29, v28
  s_nop 1
  v_permlane16_swap_b32 v28, v29
  v_min_u32 v28, v28, v29
  v_mov_b32 v29, v28
  s_nop 1
  v_permlane32_swap_b32 v28, v29
  v_min_u32 v28, v28, v29
  s_nop 0
  v_readfirstlane_b32 s20, v28
  s_nop 0
  s_cmp_ge_u32 s20, s13
  s_cbranch_scc1 int_wm42_ok
  s_sleep 1
  s_add_u32 s70, s70, 1
  s_cmp_lt_u32 s70, 262144
  s_cbranch_scc1 int_wm42
  s_branch mk_fail
int_wm42_ok:
  s_and_b32 s34, s10, 31
  s_lshl_b32 s34, s34, 2
  s_add_u32 s34, s34, s8
  s_lshr_b32 s68, s34, 1
  s_bitcmp1_b64 s[64:65], s68
  s_cselect_b32 s68, 0x2000, 0
  s_lshl_b32 s34, s34, 20
  s_add_u32 s34, s34, s68
  s_add_u32 s34, s34, s40
  s_mul_hi_u32 s68, s10, 0x2aaaaaab
  s_mul_i32 s68, s68, 6
  s_sub_u32 s35, s10, s68
  s_mul_i32 s35, s35, 20480
  s_add_u32 s35, s35, 33792
  s_add_u32 m0, s35, 0
  s_add_u32 s15, s34, 0
  buffer_load_dwordx4 v5, s[4:7], s15 offen offset:0 sc1 lds
  buffer_load_dwordx4 v5, s[4:7], s15 offen offset:1024 sc1 lds
  buffer_load_dwordx4 v5, s[4:7], s15 offen offset:2048 sc1 lds
  buffer_load_dwordx4 v5, s[4:7], s15 offen offset:3072 sc1 lds
  s_add_u32 m0, s35, 4096
  s_add_u32 s15, s34, 4096
  buffer_load_dwordx4 v5, s[4:7], s15 offen offset:0 sc1 lds
  buffer_load_dwordx4 v5, s[4:7], s15 offen offset:1024 sc1 lds
  buffer_load_dwordx4 v5, s[4:7], s15 offen offset:2048 sc1 lds
  buffer_load_dwordx4 v5, s[4:7], s15 offen offset:3072 sc1 lds
  s_add_u32 m0, s35, 8192
  s_add_u32 s15, s34, 16384
  buffer_load_dwordx4 v5, s[4:7], s15 offen offset:0 sc1 lds
  buffer_load_dwordx4 v5, s[4:7], s15 offen offset:1024 sc1 lds
  buffer_load_dwordx4 v5, s[4:7], s15 offen offset:2048 sc1 lds
  buffer_load_dwordx4 v5, s[4:7], s15 offen offset:3072 sc1 lds
  s_add_u32 m0, s35, 12288
  s_add_u32 s15, s34, 20480
  buffer_load_dwordx4 v5, s[4:7], s15 offen offset:0 sc1 lds
  buffer_load_dwordx4 v5, s[4:7], s15 offen offset:1024 sc1 lds
  buffer_load_dwordx4 v5, s[4:7], s15 offen offset:2048 sc1 lds
  buffer_load_dwordx4 v5, s[4:7], s15 offen offset:3072 sc1 lds
  s_or_b32 s13, s10, 63
  s_add_u32 s13, s13, 1
  s_add_u32 s14, s10, 2
  s_min_u32 s13, s13, s14
  s_cmp_ge_u32 s20, s13
  s_cbranch_scc1 int_wm43_ok
  s_mov_b32 s70, 0
int_wm43:
  buffer_load_dword v28, v54, s[4:7], s21 offen sc1
  s_waitcnt vmcnt(0)
  v_min_u32_dpp v28, v28, v28 quad_perm:[1,0,3,2] row_mask:0xf bank_mask:0xf
  s_nop 1
  v_min_u32_dpp v28, v28, v28 quad_perm:[2,3,0,1] row_mask:0xf bank_mask:0xf
  s_nop 1
  v_min_u32_dpp v28, v28, v28 row_half_mirror row_mask:0xf bank_mask:0xf
  s_nop 1
  v_min_u32_dpp v28, v28, v28 row_mirror row_mask:0xf bank_mask:0xf
  v_mov_b32 v29, v28
  s_nop 1
  v_permlane16_swap_b32 v28, v29
  v_min_u32 v28, v28, v29
  v_mov_b32 v29, v28
  s_nop 1
  v_permlane32_swap_b32 v28, v29
  v_min_u32 v28, v28, v29
  s_nop 0
  v_readfirstlane_b32 s20, v28
  s_nop 0
  s_cmp_ge_u32 s20, s13
  s_cbranch_scc1 int_wm43_ok
  s_sleep 1
  s_add_u32 s70, s70, 1
  s_cmp_lt_u32 s70, 262144
  s_cbranch_scc1 int_wm43
  s_branch mk_fail
int_wm43_ok:
  s_add_u32 s34, s10, 1
  s_and_b32 s34, s34, 31
  s_lshl_b32 s34, s34, 2
  s_add_u32 s34, s34, s8
  s_lshr_b32 s68, s34, 1
  s_bitcmp1_b64 s[64:65], s68
  s_cselect_b32 s68, 0x2000, 0
  s_lshl_b32 s34, s34, 20
  s_add_u32 s34, s34, s68
  s_add_u32 s34, s34, s40
  s_add_u32 s35, s10, 1
  s_mul_hi_u32 s68, s35, 0x2aaaaaab
  s_mul_i32 s68, s68, 6
  s_sub_u32 s35, s35, s68
  s_mul_i32 s35, s35, 20480
  s_add_u32 s35, s35, 33792
  s_mov_b32 m0, s19
  s_waitcnt vmcnt(0) lgkmcnt(0)
  s_branch mk_S1_top
mk_S1_last:
  buffer_store_dwordx4 v[56:59], v5, s[4:7], s24 offen offset:1024 sc1
  s_branch mk_S_drain
mk_S1_tre:
  s_add_u32 s11, s11, 1
  s_cmp_lt_u32 s11, 262144
  s_cbranch_scc0 mk_fail
  s_and_b32 s14, s22, 31
  s_lshl_b32 s14, s14, 2
  s_add_u32 s14, s14, s8
  s_lshr_b32 s68, s14, 1
  s_bitcmp1_b64 s[64:65], s68
  s_cselect_b32 s68, 0x2000, 0
  s_lshl_b32 s14, s14, 20
  s_add_u32 s14, s14, s68
  s_add_u32 s14, s14, s41
  buffer_load_dwordx4 v[64:67], v5, s[4:7], s14 offen offset:0 sc1
  buffer_load_dwordx4 v[68:71], v5, s[4:7], s14 offen offset:1024 sc1
  buffer_load_dwordx4 v[72:75], v5, s[4:7], s14 offen offset:2048 sc1
  buffer_load_dwordx4 v[76:79], v5, s[4:7], s14 offen offset:3072 sc1
  s_add_u32 s14, s14, 4096
  buffer_load_dwordx4 v[84:87], v5, s[4:7], s14 offen offset:0 sc1
  buffer_load_dwordx4 v[88:91], v5, s[4:7], s14 offen offset:1024 sc1
  buffer_load_dwordx4 v[92:95], v5, s[4:7], s14 offen offset:2048 sc1
  buffer_load_dwordx4 v[96:99], v5, s[4:7], s14 offen offset:3072 sc1
  s_add_u32 s14, s14, 12288
  buffer_load_dwordx4 v[104:107], v5, s[4:7], s14 offen offset:0 sc1
  buffer_load_dwordx4 v[108:111], v5, s[4:7], s14 offen offset:1024 sc1
  buffer_load_dwordx4 v[112:115], v5, s[4:7], s14 offen offset:2048 sc1
  buffer_load_dwordx4 v[116:119], v5, s[4:7], s14 offen offset:3072 sc1
  s_add_u32 s14, s14, 4096
  buffer_load_dwordx4 v[124:127], v5, s[4:7], s14 offen offset:0 sc1
  buffer_load_dwordx4 v[128:131], v5, s[4:7], s14 offen offset:1024 sc1
  buffer_load_dwordx4 v[132:135], v5, s[4:7], s14 offen offset:2048 sc1
  buffer_load_dwordx4 v[136:139], v5, s[4:7], s14 offen offset:3072 sc1
  s_add_u32 s14, s14, 12288
  buffer_load_dwordx4 v[80:83], v5, s[4:7], s14 offen offset:0 sc1
  buffer_load_dwordx4 v[100:103], v5, s[4:7], s14 offen offset:1024 sc1
  buffer_load_dwordx4 v[120:123], v5, s[4:7], s14 offen offset:2048 sc1
  buffer_load_dwordx4 v[140:143], v5, s[4:7], s14 offen offset:3072 sc1
  s_waitcnt vmcnt(0)
  v_mov_b32 v20, 0
  v_mov_b32 v21, 0
  v_mov_b32 v22, 0
  v_mov_b32 v23, 0
  v_mov_b32 v24, 0
  v_mov_b32 v25, 0
  v_mov_b32 v26, 0
  v_mov_b32 v27, 0
  v_mov_b32 v28, 0
  v_mov_b32 v29, 0
  v_mov_b32 v30, 0
  v_mov_b32 v31, 0
  v_mov_b32 v32, 0
  v_mov_b32 v33, 0
  v_mov_b32 v34, 0
  v_mov_b32 v35, 0
  v_smfmac_f32_16x16x64_bf16 v[20:23], v[64:67], v[144:151], v15
  v_smfmac_f32_16x16x64_bf16 v[20:23], v[68:71], v[152:159], v15
  v_smfmac_f32_16x16x64_bf16 v[20:23], v[72:75], v[160:167], v15
  v_smfmac_f32_16x16x64_bf16 v[20:23], v[76:79], v[168:175], v15
  v_smfmac_f32_16x16x64_bf16 v[20:23], v[80:83], v[176:183], v15
  v_smfmac_f32_16x16x64_bf16 v[24:27], v[84:87], v[144:151], v15
  v_smfmac_f32_16x16x64_bf16 v[24:27], v[88:91], v[152:159], v15
  v_smfmac_f32_16x16x64_bf16 v[24:27], v[92:95], v[160:167], v15
  v_smfmac_f32_16x16x64_bf16 v[24:27], v[96:99], v[168:175], v15
  v_smfmac_f32_16x16x64_bf16 v[24:27], v[100:103], v[176:183], v15
  v_smfmac_f32_16x16x64_bf16 v[28:31], v[104:107], v[144:151], v15
  v_smfmac_f32_16x16x64_bf16 v[28:31], v[108:111], v[152:159], v15
  v_smfmac_f32_16x16x64_bf16 v[28:31], v[112:115], v[160:167], v15
  v_smfmac_f32_16x16x64_bf16 v[28:31], v[116:119], v[168:175], v15
  v_smfmac_f32_16x16x64_bf16 v[28:31], v[120:123], v[176:183], v15
  v_smfmac_f32_16x16x64_bf16 v[32:35], v[124:127], v[144:151], v15
  v_smfmac_f32_16x16x64_bf16 v[32:35], v[128:131], v[152:159], v15
  v_smfmac_f32_16x16x64_bf16 v[32:35], v[132:135], v[160:167], v15
  v_smfmac_f32_16x16x64_bf16 v[32:35], v[136:139], v[168:175], v15
  v_smfmac_f32_16x16x64_bf16 v[32:35], v[140:143], v[176:183], v15
  v_pk_add_f32 v[20:21], v[20:21], v[22:23]
  v_cvt_pk_bf16_f32 v56, v20, v21
  v_maximum3_f32 v60, v20, v21, v20
  v_pk_add_f32 v[24:25], v[24:25], v[26:27]
  v_cvt_pk_bf16_f32 v57, v24, v25
  v_maximum3_f32 v60, v24, v25, v60
  v_pk_add_f32 v[28:29], v[28:29], v[30:31]
  v_cvt_pk_bf16_f32 v58, v28, v29
  v_maximum3_f32 v60, v28, v29, v60
  v_pk_add_f32 v[32:33], v[32:33], v[34:35]
  v_cvt_pk_bf16_f32 v59, v32, v33
  v_maximum3_f32 v60, v32, v33, v60
  v_cmp_u_f32 vcc, v60, v60
  s_nop 0
  s_cbranch_vccnz mk_S1_tre
  s_branch mk_S1_tok
mk_S1_rcv:
  s_add_u32 s11, s11, 1
  s_cmp_lt_u32 s11, 262144
  s_cbranch_scc0 mk_fail
  s_mov_b32 s13, s18
  s_mov_b32 m0, 0
  s_nop 0
  buffer_load_dwordx4 v5, s[4:7], s13 offen offset:0 sc1 lds
  buffer_load_dwordx4 v5, s[4:7], s13 offen offset:1024 sc1 lds
  buffer_load_dwordx4 v5, s[4:7], s13 offen offset:2048 sc1 lds
  buffer_load_dwordx4 v5, s[4:7], s13 offen offset:3072 sc1 lds
  s_mov_b32 m0, 4096
  s_add_u32 s13, s13, 4096
  buffer_load_dwordx4 v5, s[4:7], s13 offen offset:0 sc1 lds
  buffer_load_dwordx4 v5, s[4:7], s13 offen offset:1024 sc1 lds
  buffer_load_dwordx4 v5, s[4:7], s13 offen offset:2048 sc1 lds
  buffer_load_dwordx4 v5, s[4:7], s13 offen offset:3072 sc1 lds
  s_mov_b32 m0, 8192
  s_add_u32 s13, s13, 4096
  buffer_load_dwordx4 v5, s[4:7], s13 offen offset:0 sc1 lds
  buffer_load_dwordx4 v5, s[4:7], s13 offen offset:1024 sc1 lds
  s_waitcnt vmcnt(0) lgkmcnt(0)
  s_nop 7
  v_mov_b32 v20, 0
  v_mov_b32 v21, 0
  v_mov_b32 v22, 0
  v_mov_b32 v23, 0
  v_mov_b32 v24, 0
  v_mov_b32 v25, 0
  v_mov_b32 v26, 0
  v_mov_b32 v27, 0
  ds_read_b128 v[88:91], v3 offset:3072
  ds_read_b128 v[92:95], v3 offset:3584
  ds_read_b128 v[96:99], v3 offset:4096
  ds_read_b128 v[100:103], v3 offset:4608
  s_branch mk_S1_chain
.p2alignl 4, 0xbf800000
mk_S1_top:
  s_barrier
  s_nop 15
  s_nop 7
  buffer_load_dwordx4 v4, s[4:7], s18 offen offset:0 sc1 lds
  buffer_load_dwordx4 v4, s[4:7], s18 offen offset:1024 sc1 lds
  buffer_load_dwordx4 v4, s[4:7], s18 offen offset:2048 sc1 lds
  s_nop 15
  s_nop 13
  buffer_load_dwordx4 v4, s[4:7], s18 offen offset:0 sc1 lds
  buffer_load_dwordx4 v4, s[4:7], s18 offen offset:1024 sc1 lds
  buffer_load_dwordx4 v4, s[4:7], s18 offen offset:2048 sc1 lds
  s_branch mk_S1_c1
.p2alignl 4, 0xbf800000
mk_S1_c0:
  s_add_u32 s11, s11, 1
  s_cmp_lt_u32 s11, 262144
  s_cbranch_scc0 mk_fail
mk_S1_c1:
  s_waitcnt vmcnt(3)
  ds_read_b32 v28, v53
  ds_read_b128 v[88:91], v3 offset:3072
  ds_read_b128 v[92:95], v3 offset:3584
  ds_read_b128 v[96:99], v3 offset:4096
  ds_read_b128 v[100:103], v3 offset:4608
  buffer_load_dwordx4 v4, s[4:7], s18 offen offset:0 sc1 lds
  buffer_load_dwordx4 v4, s[4:7], s18 offen offset:1024 sc1 lds
  buffer_load_dwordx4 v4, s[4:7], s18 offen offset:2048 sc1 lds
  s_waitcnt lgkmcnt(4)
  v_cmp_eq_u32 vcc, -1, v28
  s_nop 0
  s_cbranch_vccnz mk_S1_c0
  s_barrier
mk_S1_chain:
  buffer_store_dwordx4 v[56:59], v5, s[4:7], s24 offen offset:1024 sc1
  s_sub_u32 s13, s10, 5
  s_lshl_b32 s14, s66, 6
  s_max_i32 s13, s13, s14
  v_mov_b32 v30, s13
  s_mov_b64 exec, 1
  buffer_store_dword v30, off, s[4:7], s43 sc1
  s_mov_b64 exec, -1
  s_andn2_b32 s13, 63, s10
  s_cbranch_scc0 int_w144
  s_add_u32 m0, s35, 0
  s_add_u32 s15, s34, 0
  buffer_load_dwordx4 v5, s[4:7], s15 offen offset:0 sc1 lds
  buffer_load_dwordx4 v5, s[4:7], s15 offen offset:1024 sc1 lds
  buffer_load_dwordx4 v5, s[4:7], s15 offen offset:2048 sc1 lds
  buffer_load_dwordx4 v5, s[4:7], s15 offen offset:3072 sc1 lds
  s_add_u32 m0, s35, 4096
  s_add_u32 s15, s34, 4096
  buffer_load_dwordx4 v5, s[4:7], s15 offen offset:0 sc1 lds
  buffer_load_dwordx4 v5, s[4:7], s15 offen offset:1024 sc1 lds
  buffer_load_dwordx4 v5, s[4:7], s15 offen offset:2048 sc1 lds
  buffer_load_dwordx4 v5, s[4:7], s15 offen offset:3072 sc1 lds
  s_add_u32 m0, s35, 8192
  s_add_u32 s15, s34, 16384
  buffer_load_dwordx4 v5, s[4:7], s15 offen offset:0 sc1 lds
  buffer_load_dwordx4 v5, s[4:7], s15 offen offset:1024 sc1 lds
  buffer_load_dwordx4 v5, s[4:7], s15 offen offset:2048 sc1 lds
  buffer_load_dwordx4 v5, s[4:7], s15 offen offset:3072 sc1 lds
  s_add_u32 m0, s35, 12288
  s_add_u32 s15, s34, 20480
  buffer_load_dwordx4 v5, s[4:7], s15 offen offset:0 sc1 lds
  buffer_load_dwordx4 v5, s[4:7], s15 offen offset:1024 sc1 lds
  buffer_load_dwordx4 v5, s[4:7], s15 offen offset:2048 sc1 lds
  buffer_load_dwordx4 v5, s[4:7], s15 offen offset:3072 sc1 lds
  s_add_u32 s13, s10, 5
  s_cmp_ge_u32 s20, s13
  s_cbranch_scc1 int_w144
  buffer_load_dword v55, v54, s[4:7], s21 offen sc1
int_w144:
  s_waitcnt lgkmcnt(3)
  v_smfmac_f32_16x16x64_bf16 v[20:23], v[88:91], a[48:55], v2
  ds_read_b128 v[104:107], v3 offset:5120
  v_smfmac_f32_16x16x64_bf16 v[24:27], v[88:91], a[208:215], v2
  s_waitcnt lgkmcnt(3)
  v_smfmac_f32_16x16x64_bf16 v[20:23], v[92:95], a[56:63], v2
  ds_read_b128 v[108:111], v3 offset:5632
  v_smfmac_f32_16x16x64_bf16 v[24:27], v[92:95], a[216:223], v2
  s_waitcnt lgkmcnt(3)
  v_smfmac_f32_16x16x64_bf16 v[20:23], v[96:99], a[64:71], v2
  ds_read_b128 v[112:115], v3 offset:6144
  v_smfmac_f32_16x16x64_bf16 v[24:27], v[96:99], a[224:231], v2
  s_waitcnt lgkmcnt(3)
  v_smfmac_f32_16x16x64_bf16 v[20:23], v[100:103], a[72:79], v2
  ds_read_b128 v[116:119], v3 offset:6656
  v_smfmac_f32_16x16x64_bf16 v[24:27], v[100:103], a[232:239], v2
  s_waitcnt lgkmcnt(3)
  v_smfmac_f32_16x16x64_bf16 v[20:23], v[104:107], a[80:87], v2
  ds_read_b128 v[120:123], v3 offset:7168
  v_smfmac_f32_16x16x64_bf16 v[24:27], v[104:107], a[240:247], v2
  s_waitcnt lgkmcnt(3)
  v_smfmac_f32_16x16x64_bf16 v[20:23], v[108:111], a[88:95], v2
  ds_read_b128 v[124:127], v3 offset:7680
  v_smfmac_f32_16x16x64_bf16 v[24:27], v[108:111], a[248:255], v2
  s_waitcnt lgkmcnt(3)
  v_smfmac_f32_16x16x64_bf16 v[20:23], v[112:115], a[96:103], v2
  ds_read_b128 v[128:131], v3 offset:8192
  v_smfmac_f32_16x16x64_bf16 v[24:27], v[112:115], v[192:199], v2
  s_waitcnt lgkmcnt(3)
  v_smfmac_f32_16x16x64_bf16 v[20:23], v[116:119], a[104:111], v2
  ds_read_b128 v[132:135], v3 offset:8704
  v_smfmac_f32_16x16x64_bf16 v[24:27], v[116:119], v[200:207], v2
  s_waitcnt lgkmcnt(3)
  v_smfmac_f32_16x16x64_bf16 v[20:23], v[120:123], a[112:119], v2
  ds_read_b128 v[136:139], v3 offset:9216
  v_smfmac_f32_16x16x64_bf16 v[24:27], v[120:123], v[208:215], v2
  s_waitcnt lgkmcnt(3)
  v_smfmac_f32_16x16x64_bf16 v[20:23], v[124:127], a[120:127], v2
  ds_read_b128 v[140:143], v3 offset:9728
  v_smfmac_f32_16x16x64_bf16 v[24:27], v[124:127], v[216:223], v2
  s_waitcnt lgkmcnt(3)
  v_smfmac_f32_16x16x64_bf16 v[20:23], v[128:131], a[128:135], v2
  ds_read_b128 v[64:67], v3 offset:0
  v_smfmac_f32_16x16x64_bf16 v[24:27], v[128:131], v[224:231], v2
  s_waitcnt lgkmcnt(3)
  v_smfmac_f32_16x16x64_bf16 v[20:23], v[132:135], a[136:143], v2
  ds_read_b128 v[68:71], v3 offset:512
  v_smfmac_f32_16x16x64_bf16 v[24:27], v[132:135], v[232:239], v2
  s_waitcnt lgkmcnt(3)
  v_smfmac_f32_16x16x64_bf16 v[20:23], v[136:139], a[144:151], v2
  ds_read_b128 v[72:75], v3 offset:1024
  v_smfmac_f32_16x16x64_bf16 v[24:27], v[136:139], v[240:247], v2
  s_waitcnt lgkmcnt(3)
  v_smfmac_f32_16x16x64_bf16 v[20:23], v[140:143], a[152:159], v2
  ds_read_b128 v[76:79], v3 offset:1536
  v_smfmac_f32_16x16x64_bf16 v[24:27], v[140:143], v[248:255], v2
  s_waitcnt lgkmcnt(3)
  v_smfmac_f32_16x16x64_bf16 v[20:23], v[64:67], a[0:7], v2
  ds_read_b128 v[80:83], v3 offset:2048
  v_smfmac_f32_16x16x64_bf16 v[24:27], v[64:67], a[160:167], v2
  s_waitcnt lgkmcnt(3)
  v_smfmac_f32_16x16x64_bf16 v[20:23], v[68:71], a[8:15], v2
  ds_read_b128 v[84:87], v3 offset:2560
  v_smfmac_f32_16x16x64_bf16 v[24:27], v[68:71], a[168:175], v2
  s_waitcnt lgkmcnt(3)
  v_smfmac_f32_16x16x64_bf16 v[20:23], v[72:75], a[16:23], v2
  v_smfmac_f32_16x16x64_bf16 v[24:27], v[72:75], a[176:183], v2
  s_waitcnt lgkmcnt(2)
  v_smfmac_f32_16x16x64_bf16 v[20:23], v[76:79], a[24:31], v2
  v_smfmac_f32_16x16x64_bf16 v[24:27], v[76:79], a[184:191], v2
  s_waitcnt lgkmcnt(1)
  v_smfmac_f32_16x16x64_bf16 v[20:23], v[80:83], a[32:39], v2
  v_smfmac_f32_16x16x64_bf16 v[24:27], v[80:83], a[192:199], v2
  s_waitcnt lgkmcnt(0)
  v_smfmac_f32_16x16x64_bf16 v[20:23], v[84:87], a[40:47], v2
  v_smfmac_f32_16x16x64_bf16 v[24:27], v[84:87], a[200:207], v2
  s_nop 6
  v_maximum3_f32 v31, v20, v21, v22
  v_cmp_u_f32 vcc, v31, v23
  v_cvt_pk_bf16_f32 v32, v20, v21
  v_cvt_pk_bf16_f32 v33, v22, v23
  v_cvt_pk_bf16_f32 v34, v24, v25
  v_cvt_pk_bf16_f32 v35, v26, v27
  s_cbranch_vccnz mk_S1_rcv
  ds_write_b64 v0, v[32:33] offset:0
  ds_write_b64 v0, v[34:35] offset:2048
  s_waitcnt lgkmcnt(0)
  s_barrier
  s_and_b32 s13, s10, 63
  s_cmp_lt_u32 s13, 4
  s_cbranch_scc1 mk_S1_nt
  s_sub_u32 s22, s10, 4
  s_mul_hi_u32 s68, s22, 0x2aaaaaab
  s_mul_i32 s68, s68, 6
  s_sub_u32 s13, s22, s68
  s_mul_i32 s13, s13, 20480
  s_add_u32 s13, s13, 33792
  v_add_u32 v60, s13, v5
  s_add_u32 s13, s13, 18432
  v_lshl_add_u32 v61, v1, 3, s13
  v_add_u32 v62, 1024, v61
  ds_read_b128 v[144:147], v60 offset:8192
  ds_read_b128 v[148:151], v60 offset:9216
  ds_read_b128 v[152:155], v60 offset:10240
  ds_read_b128 v[156:159], v60 offset:11264
  ds_read_b128 v[160:163], v60 offset:12288
  ds_read_b128 v[164:167], v60 offset:13312
  ds_read_b128 v[168:171], v60 offset:14336
  ds_read_b128 v[172:175], v60 offset:15360
  ds_read2_b32 v[176:177], v61 offset0:0 offset1:128
  ds_read2_b32 v[178:179], v61 offset0:1 offset1:129
  ds_read2_b32 v[180:181], v62 offset0:0 offset1:128
  ds_read2_b32 v[182:183], v62 offset0:1 offset1:129
  ds_read_b128 v[64:67], v5 offset:13312
  ds_read_b128 v[68:71], v5 offset:14336
  ds_read_b128 v[72:75], v5 offset:15360
  ds_read_b128 v[76:79], v5 offset:16384
  ds_read_b128 v[80:83], v5 offset:29696
  ds_read_b128 v[84:87], v5 offset:17408
  ds_read_b128 v[88:91], v5 offset:18432
  ds_read_b128 v[92:95], v5 offset:19456
  ds_read_b128 v[96:99], v5 offset:20480
  ds_read_b128 v[100:103], v5 offset:30720
  ds_read_b128 v[104:107], v5 offset:21504
  ds_read_b128 v[108:111], v5 offset:22528
  ds_read_b128 v[112:115], v5 offset:23552
  ds_read_b128 v[116:119], v5 offset:24576
  ds_read_b128 v[120:123], v5 offset:31744
  ds_read_b128 v[124:127], v5 offset:25600
  ds_read_b128 v[128:131], v5 offset:26624
  ds_read_b128 v[132:135], v5 offset:27648
  ds_read_b128 v[136:139], v5 offset:28672
  ds_read_b128 v[140:143], v5 offset:32768
  s_and_b32 s24, s22, 31
  s_lshl_b32 s24, s24, 2
  s_add_u32 s24, s24, s8
  s_lshr_b32 s68, s24, 1
  s_bitcmp1_b64 s[64:65], s68
  s_cselect_b32 s68, 0x2000, 0
  s_lshl_b32 s24, s24, 20
  s_add_u32 s24, s24, s68
  s_add_u32 s24, s24, s72
  s_bitcmp1_b32 s22, 5
  s_cselect_b32 s13, 32768, 0
  s_add_u32 s24, s24, s13
  v_mov_b32 v20, 0
  v_mov_b32 v21, 0
  v_mov_b32 v22, 0
  v_mov_b32 v23, 0
  v_mov_b32 v24, 0
  v_mov_b32 v25, 0
  v_mov_b32 v26, 0
  v_mov_b32 v27, 0
  v_mov_b32 v28, 0
  v_mov_b32 v29, 0
  v_mov_b32 v30, 0
  v_mov_b32 v31, 0
  v_mov_b32 v32, 0
  v_mov_b32 v33, 0
  v_mov_b32 v34, 0
  v_mov_b32 v35, 0
  s_waitcnt lgkmcnt(15)
  v_smfmac_f32_16x16x64_bf16 v[20:23], v[64:67], v[144:151], v15
  v_smfmac_f32_16x16x64_bf16 v[20:23], v[68:71], v[152:159], v15
  v_smfmac_f32_16x16x64_bf16 v[20:23], v[72:75], v[160:167], v15
  v_smfmac_f32_16x16x64_bf16 v[20:23], v[76:79], v[168:175], v15
  v_smfmac_f32_16x16x64_bf16 v[20:23], v[80:83], v[176:183], v15
  s_waitcnt lgkmcnt(10)
  v_smfmac_f32_16x16x64_bf16 v[24:27], v[84:87], v[144:151], v15
  v_smfmac_f32_16x16x64_bf16 v[24:27], v[88:91], v[152:159], v15
  v_smfmac_f32_16x16x64_bf16 v[24:27], v[92:95], v[160:167], v15
  v_smfmac_f32_16x16x64_bf16 v[24:27], v[96:99], v[168:175], v15
  v_smfmac_f32_16x16x64_bf16 v[24:27], v[100:103], v[176:183], v15
  s_waitcnt lgkmcnt(0)
  s_andn2_b32 s13, 63, s10
  s_cbranch_scc0 mk_S1_b4a
  s_barrier
mk_S1_b4a:
  v_smfmac_f32_16x16x64_bf16 v[28:31], v[104:107], v[144:151], v15
  v_smfmac_f32_16x16x64_bf16 v[28:31], v[108:111], v[152:159], v15
  v_smfmac_f32_16x16x64_bf16 v[28:31], v[112:115], v[160:167], v15
  v_smfmac_f32_16x16x64_bf16 v[28:31], v[116:119], v[168:175], v15
  v_smfmac_f32_16x16x64_bf16 v[28:31], v[120:123], v[176:183], v15
  s_waitcnt lgkmcnt(0)
  v_smfmac_f32_16x16x64_bf16 v[32:35], v[124:127], v[144:151], v15
  v_smfmac_f32_16x16x64_bf16 v[32:35], v[128:131], v[152:159], v15
  v_smfmac_f32_16x16x64_bf16 v[32:35], v[132:135], v[160:167], v15
  v_smfmac_f32_16x16x64_bf16 v[32:35], v[136:139], v[168:175], v15
  v_smfmac_f32_16x16x64_bf16 v[32:35], v[140:143], v[176:183], v15
  v_pk_add_f32 v[20:21], v[20:21], v[22:23]
  v_cvt_pk_bf16_f32 v56, v20, v21
  v_maximum3_f32 v60, v20, v21, v20
  v_pk_add_f32 v[24:25], v[24:25], v[26:27]
  v_cvt_pk_bf16_f32 v57, v24, v25
  v_maximum3_f32 v60, v24, v25, v60
  v_pk_add_f32 v[28:29], v[28:29], v[30:31]
  v_cvt_pk_bf16_f32 v58, v28, v29
  v_maximum3_f32 v60, v28, v29, v60
  v_pk_add_f32 v[32:33], v[32:33], v[34:35]
  v_cvt_pk_bf16_f32 v59, v32, v33
  v_maximum3_f32 v60, v32, v33, v60
  v_cmp_u_f32 vcc, v60, v60
  s_nop 0
  s_cbranch_vccnz mk_S1_tre
  s_branch mk_S1_tok
mk_S1_nt:
  s_andn2_b32 s13, 63, s10
  s_cbranch_scc0 mk_S1_b4b
  s_barrier
mk_S1_b4b:
mk_S1_tok:
  s_add_u32 s10, s10, 1
  s_and_b32 s13, s10, 63
  s_cbranch_scc0 mk_S1_last
  v_mov_b32 v20, 0
  v_mov_b32 v21, 0
  v_mov_b32 v22, 0
  v_mov_b32 v23, 0
  v_mov_b32 v24, 0
  v_mov_b32 v25, 0
  v_mov_b32 v26, 0
  v_mov_b32 v27, 0
  s_and_b32 s18, s10, 3
  s_lshl_b32 s18, s18, 14
  s_add_u32 s18, s18, s17
  s_mov_b32 s11, 0
  s_mul_hi_u32 s68, s10, 0x2aaaaaab
  s_mul_i32 s68, s68, 6
  s_sub_u32 s13, s10, s68
  s_mul_i32 s13, s13, 20480
  s_add_u32 s13, s13, 33792
  v_add_u32 v0, s13, v8
  s_waitcnt vmcnt(0)
  v_min_u32_dpp v55, v55, v55 quad_perm:[1,0,3,2] row_mask:0xf bank_mask:0xf
  s_nop 1
  v_min_u32_dpp v55, v55, v55 quad_perm:[2,3,0,1] row_mask:0xf bank_mask:0xf
  s_nop 1
  v_min_u32_dpp v55, v55, v55 row_half_mirror row_mask:0xf bank_mask:0xf
  s_nop 1
  v_min_u32_dpp v55, v55, v55 row_mirror row_mask:0xf bank_mask:0xf
  v_mov_b32 v28, v55
  s_nop 1
  v_permlane16_swap_b32 v55, v28
  v_min_u32 v55, v55, v28
  v_mov_b32 v28, v55
  s_nop 1
  v_permlane32_swap_b32 v55, v28
  v_min_u32 v55, v55, v28
  s_nop 0
  v_readfirstlane_b32 s13, v55
  s_nop 0
  s_max_u32 s20, s20, s13
  s_or_b32 s13, s10, 63
  s_add_u32 s13, s13, 1
  s_add_u32 s14, s10, 2
  s_min_u32 s13, s13, s14
  s_cmp_ge_u32 s20, s13
  s_cbranch_scc1 int_wm45_ok
  s_mov_b32 s70, 0
int_wm45:
  buffer_load_dword v28, v54, s[4:7], s21 offen sc1
  s_waitcnt vmcnt(0)
  v_min_u32_dpp v28, v28, v28 quad_perm:[1,0,3,2] row_mask:0xf bank_mask:0xf
  s_nop 1
  v_min_u32_dpp v28, v28, v28 quad_perm:[2,3,0,1] row_mask:0xf bank_mask:0xf
  s_nop 1
  v_min_u32_dpp v28, v28, v28 row_half_mirror row_mask:0xf bank_mask:0xf
  s_nop 1
  v_min_u32_dpp v28, v28, v28 row_mirror row_mask:0xf bank_mask:0xf
  v_mov_b32 v29, v28
  s_nop 1
  v_permlane16_swap_b32 v28, v29
  v_min_u32 v28, v28, v29
  v_mov_b32 v29, v28
  s_nop 1
  v_permlane32_swap_b32 v28, v29
  v_min_u32 v28, v28, v29
  s_nop 0
  v_readfirstlane_b32 s20, v28
  s_nop 0
  s_cmp_ge_u32 s20, s13
  s_cbranch_scc1 int_wm45_ok
  s_sleep 1
  s_add_u32 s70, s70, 1
  s_cmp_lt_u32 s70, 262144
  s_cbranch_scc1 int_wm45
  s_branch mk_fail
int_wm45_ok:
  s_add_u32 s34, s10, 1
  s_and_b32 s34, s34, 31
  s_lshl_b32 s34, s34, 2
  s_add_u32 s34, s34, s8
  s_lshr_b32 s68, s34, 1
  s_bitcmp1_b64 s[64:65], s68
  s_cselect_b32 s68, 0x2000, 0
  s_lshl_b32 s34, s34, 20
  s_add_u32 s34, s34, s68
  s_add_u32 s34, s34, s40
  s_add_u32 s35, s10, 1
  s_mul_hi_u32 s68, s35, 0x2aaaaaab
  s_mul_i32 s68, s68, 6
  s_sub_u32 s35, s35, s68
  s_mul_i32 s35, s35, 20480
  s_add_u32 s35, s35, 33792
  s_mov_b32 m0, s19
  s_waitcnt lgkmcnt(0)
  s_branch mk_S1_top
mk_S2_init:
  s_lshl_b32 s27, s8, 15
  s_add_u32 s27, s27, 64749568
  s_load_dwordx2 s[80:81], s[0:1], 8
  s_mov_b32 s82, 0x2800
  s_mov_b32 s83, 0x20000
  v_lshrrev_b32 v62, 1, v61
  v_lshlrev_b32 v7, 9, v62
  v_and_b32 v62, 1, v61
  v_lshl_add_u32 v7, v62, 6, v7
  v_lshrrev_b32 v62, 2, v60
  v_lshl_add_u32 v7, v62, 7, v7
  v_and_b32 v62, 3, v60
  v_lshl_add_u32 v7, v62, 4, v7
  v_lshlrev_b32 v12, 6, v61
  v_and_b32 v62, 1, v60
  v_lshl_add_u32 v12, v62, 4, v12
  v_cmp_eq_u32 vcc, 1, v62
  v_mov_b32 v13, 0x05040100
  v_mov_b32 v63, 0x03020706
  v_cndmask_b32 v13, v13, v63, vcc
  v_lshl_add_u32 v62, v61, 1, v62
  v_mul_u32_u24 v62, 1280, v62
  v_and_b32 v63, 14, v60
  v_lshl_add_u32 v62, v63, 1, v62
  s_lshl_b32 s13, s38, 5
  s_waitcnt lgkmcnt(0)
  buffer_load_dword v54, v62, s[80:83], s13 offen
  v_lshrrev_b32 v63, 3, v60
  v_lshl_add_u32 v12, v63, 5, v12
  v_bfe_u32 v63, v60, 1, 2
  v_lshl_add_u32 v12, v63, 2, v12
  s_lshl_b32 s13, s38, 8
  v_add_u32 v12, s13, v12
  s_mul_hi_u32 s33, s38, 0x1999999a
  s_mul_i32 s13, s33, 10
  s_sub_u32 s13, s38, s13
  s_lshr_b32 s14, s13, 1
  s_lshl_b32 s14, s14, 14
  s_and_b32 s13, s13, 1
  s_lshl_b32 s13, s13, 12
  s_add_u32 s26, s13, s14
  s_add_u32 s26, s26, s39
  s_add_u32 s26, s26, 851968
  s_xor_b32 s13, s8, 0
  s_lshl_b32 s13, s13, 8
  v_lshl_add_u32 v36, v1, 2, s13
  s_xor_b32 s13, s8, 1
  s_lshl_b32 s13, s13, 8
  v_lshl_add_u32 v37, v1, 2, s13
  s_xor_b32 s13, s8, 2
  s_lshl_b32 s13, s13, 8
  v_lshl_add_u32 v38, v1, 2, s13
  s_xor_b32 s13, s8, 3
  s_lshl_b32 s13, s13, 8
  v_lshl_add_u32 v39, v1, 2, s13
  v_bfe_u32 v62, v1, 2, 3
  v_lshlrev_b32 v9, 7, v62
  v_and_b32 v62, 3, v1
  v_lshl_add_u32 v9, v62, 2, v9
  s_lshl_b32 s21, s33, 10
  s_add_u32 s21, s21, 64888832
  v_min_u32 v53, 31, v1
  v_lshrrev_b32 v62, 1, v53
  v_and_b32 v62, 15, v62
  v_lshlrev_b32 v53, 6, v53
  v_lshl_add_u32 v53, v62, 2, v53
  v_add_u32 v53, s19, v53
mk_S2_prime:
  v_mov_b32 v20, 0
  v_mov_b32 v21, 0
  v_mov_b32 v22, 0
  v_mov_b32 v23, 0
  v_mov_b32 v24, 0
  v_mov_b32 v25, 0
  v_mov_b32 v26, 0
  v_mov_b32 v27, 0
  s_and_b32 s18, s10, 3
  s_lshl_b32 s18, s18, 14
  s_add_u32 s18, s18, s17
  s_mov_b32 s11, 0
  s_mul_hi_u32 s68, s10, 0x2aaaaaab
  s_mul_i32 s68, s68, 6
  s_sub_u32 s13, s10, s68
  s_mul_i32 s13, s13, 20480
  s_add_u32 s13, s13, 33792
  v_add_u32 v0, s13, v8
  v_add_u32 v11, s13, v5
  s_add_u32 s13, s10, 1
  s_waitcnt vmcnt(0)
  buffer_store_dword v54, v12, s[4:7], s18 offen
  s_mov_b32 s70, 0
int_wg46:
  buffer_load_dword v28, v9, s[4:7], s21 offen offset:0 sc1
  s_waitcnt vmcnt(0)
  v_cmp_gt_u32 vcc, s13, v28
  s_nop 0
  s_cbranch_vccz int_wg46_ok
  s_sleep 1
  s_add_u32 s70, s70, 1
  s_cmp_lt_u32 s70, 262144
  s_cbranch_scc1 int_wg46
  s_branch mk_fail
int_wg46_ok:
  s_mov_b32 m0, s19
  s_waitcnt vmcnt(0) lgkmcnt(0)
  s_branch mk_S2_top
mk_S2_last:
  s_branch mk_S_drain
mk_S2_rcv:
  s_add_u32 s11, s11, 1
  s_cmp_lt_u32 s11, 262144
  s_cbranch_scc0 mk_fail
  s_mov_b32 s13, s18
  s_mov_b32 m0, 0
  s_nop 0
  buffer_load_dwordx4 v5, s[4:7], s13 offen offset:0 sc1 lds
  buffer_load_dwordx4 v5, s[4:7], s13 offen offset:1024 sc1 lds
  buffer_load_dwordx4 v5, s[4:7], s13 offen offset:2048 sc1 lds
  buffer_load_dwordx4 v5, s[4:7], s13 offen offset:3072 sc1 lds
  s_mov_b32 m0, 4096
  s_add_u32 s13, s13, 4096
  buffer_load_dwordx4 v5, s[4:7], s13 offen offset:0 sc1 lds
  buffer_load_dwordx4 v5, s[4:7], s13 offen offset:1024 sc1 lds
  buffer_load_dwordx4 v5, s[4:7], s13 offen offset:2048 sc1 lds
  buffer_load_dwordx4 v5, s[4:7], s13 offen offset:3072 sc1 lds
  s_mov_b32 m0, 8192
  s_add_u32 s13, s13, 4096
  buffer_load_dwordx4 v5, s[4:7], s13 offen offset:0 sc1 lds
  buffer_load_dwordx4 v5, s[4:7], s13 offen offset:1024 sc1 lds
  s_waitcnt vmcnt(0) lgkmcnt(0)
  s_nop 7
  v_mov_b32 v20, 0
  v_mov_b32 v21, 0
  v_mov_b32 v22, 0
  v_mov_b32 v23, 0
  v_mov_b32 v24, 0
  v_mov_b32 v25, 0
  v_mov_b32 v26, 0
  v_mov_b32 v27, 0
  ds_read_b128 v[112:115], v3 offset:6144
  ds_read_b128 v[116:119], v3 offset:6656
  ds_read_b128 v[120:123], v3 offset:7168
  ds_read_b128 v[124:127], v3 offset:7680
  s_branch mk_S2_chain
.p2alignl 4, 0xbf800000
mk_S2_top:
  s_barrier
  s_nop 15
  s_nop 7
  buffer_load_dwordx4 v4, s[4:7], s18 offen offset:0 sc1 lds
  buffer_load_dwordx4 v4, s[4:7], s18 offen offset:1024 sc1 lds
  s_nop 15
  s_nop 13
  buffer_load_dwordx4 v4, s[4:7], s18 offen offset:0 sc1 lds
  buffer_load_dwordx4 v4, s[4:7], s18 offen offset:1024 sc1 lds
  s_branch mk_S2_c1
.p2alignl 4, 0xbf800000
mk_S2_c0:
  s_add_u32 s11, s11, 1
  s_cmp_lt_u32 s11, 262144
  s_cbranch_scc0 mk_fail
mk_S2_c1:
  s_waitcnt vmcnt(2)
  ds_read_b32 v28, v53
  ds_read_b128 v[112:115], v3 offset:6144
  ds_read_b128 v[116:119], v3 offset:6656
  ds_read_b128 v[120:123], v3 offset:7168
  ds_read_b128 v[124:127], v3 offset:7680
  buffer_load_dwordx4 v4, s[4:7], s18 offen offset:0 sc1 lds
  buffer_load_dwordx4 v4, s[4:7], s18 offen offset:1024 sc1 lds
  s_waitcnt lgkmcnt(4)
  v_cmp_eq_u32 vcc, -1, v28
  s_nop 0
  s_cbranch_vccnz mk_S2_c0
  s_barrier
mk_S2_chain:
  s_waitcnt lgkmcnt(3)
  v_smfmac_f32_16x16x64_bf16 v[20:23], v[112:115], a[96:103], v2
  ds_read_b128 v[128:131], v3 offset:8192
  v_smfmac_f32_16x16x64_bf16 v[24:27], v[112:115], v[192:199], v2
  s_waitcnt lgkmcnt(3)
  v_smfmac_f32_16x16x64_bf16 v[20:23], v[116:119], a[104:111], v2
  ds_read_b128 v[132:135], v3 offset:8704
  v_smfmac_f32_16x16x64_bf16 v[24:27], v[116:119], v[200:207], v2
  s_waitcnt lgkmcnt(3)
  v_smfmac_f32_16x16x64_bf16 v[20:23], v[120:123], a[112:119], v2
  ds_read_b128 v[136:139], v3 offset:9216
  v_smfmac_f32_16x16x64_bf16 v[24:27], v[120:123], v[208:215], v2
  s_waitcnt lgkmcnt(3)
  v_smfmac_f32_16x16x64_bf16 v[20:23], v[124:127], a[120:127], v2
  ds_read_b128 v[140:143], v3 offset:9728
  v_smfmac_f32_16x16x64_bf16 v[24:27], v[124:127], v[216:223], v2
  s_waitcnt lgkmcnt(3)
  v_smfmac_f32_16x16x64_bf16 v[20:23], v[128:131], a[128:135], v2
  ds_read_b128 v[64:67], v3 offset:0
  v_smfmac_f32_16x16x64_bf16 v[24:27], v[128:131], v[224:231], v2
  s_waitcnt lgkmcnt(3)
  v_smfmac_f32_16x16x64_bf16 v[20:23], v[132:135], a[136:143], v2
  ds_read_b128 v[68:71], v3 offset:512
  v_smfmac_f32_16x16x64_bf16 v[24:27], v[132:135], v[232:239], v2
  s_waitcnt lgkmcnt(3)
  v_smfmac_f32_16x16x64_bf16 v[20:23], v[136:139], a[144:151], v2
  ds_read_b128 v[72:75], v3 offset:1024
  v_smfmac_f32_16x16x64_bf16 v[24:27], v[136:139], v[240:247], v2
  s_waitcnt lgkmcnt(3)
  v_smfmac_f32_16x16x64_bf16 v[20:23], v[140:143], a[152:159], v2
  ds_read_b128 v[76:79], v3 offset:1536
  v_smfmac_f32_16x16x64_bf16 v[24:27], v[140:143], v[248:255], v2
  s_waitcnt lgkmcnt(3)
  v_smfmac_f32_16x16x64_bf16 v[20:23], v[64:67], a[0:7], v2
  ds_read_b128 v[80:83], v3 offset:2048
  v_smfmac_f32_16x16x64_bf16 v[24:27], v[64:67], a[160:167], v2
  s_waitcnt lgkmcnt(3)
  v_smfmac_f32_16x16x64_bf16 v[20:23], v[68:71], a[8:15], v2
  ds_read_b128 v[84:87], v3 offset:2560
  v_smfmac_f32_16x16x64_bf16 v[24:27], v[68:71], a[168:175], v2
  s_waitcnt lgkmcnt(3)
  v_smfmac_f32_16x16x64_bf16 v[20:23], v[72:75], a[16:23], v2
  ds_read_b128 v[88:91], v3 offset:3072
  v_smfmac_f32_16x16x64_bf16 v[24:27], v[72:75], a[176:183], v2
  s_waitcnt lgkmcnt(3)
  v_smfmac_f32_16x16x64_bf16 v[20:23], v[76:79], a[24:31], v2
  ds_read_b128 v[92:95], v3 offset:3584
  v_smfmac_f32_16x16x64_bf16 v[24:27], v[76:79], a[184:191], v2
  s_waitcnt lgkmcnt(3)
  v_smfmac_f32_16x16x64_bf16 v[20:23], v[80:83], a[32:39], v2
  ds_read_b128 v[96:99], v3 offset:4096
  v_smfmac_f32_16x16x64_bf16 v[24:27], v[80:83], a[192:199], v2
  s_waitcnt lgkmcnt(3)
  v_smfmac_f32_16x16x64_bf16 v[20:23], v[84:87], a[40:47], v2
  ds_read_b128 v[100:103], v3 offset:4608
  v_smfmac_f32_16x16x64_bf16 v[24:27], v[84:87], a[200:207], v2
  s_waitcnt lgkmcnt(3)
  v_smfmac_f32_16x16x64_bf16 v[20:23], v[88:91], a[48:55], v2
  ds_read_b128 v[104:107], v3 offset:5120
  v_smfmac_f32_16x16x64_bf16 v[24:27], v[88:91], a[208:215], v2
  s_waitcnt lgkmcnt(3)
  v_smfmac_f32_16x16x64_bf16 v[20:23], v[92:95], a[56:63], v2
  ds_read_b128 v[108:111], v3 offset:5632
  v_smfmac_f32_16x16x64_bf16 v[24:27], v[92:95], a[216:223], v2
  s_waitcnt lgkmcnt(3)
  v_smfmac_f32_16x16x64_bf16 v[20:23], v[96:99], a[64:71], v2
  v_smfmac_f32_16x16x64_bf16 v[24:27], v[96:99], a[224:231], v2
  s_waitcnt lgkmcnt(2)
  v_smfmac_f32_16x16x64_bf16 v[20:23], v[100:103], a[72:79], v2
  v_smfmac_f32_16x16x64_bf16 v[24:27], v[100:103], a[232:239], v2
  s_waitcnt lgkmcnt(1)
  v_smfmac_f32_16x16x64_bf16 v[20:23], v[104:107], a[80:87], v2
  v_smfmac_f32_16x16x64_bf16 v[24:27], v[104:107], a[240:247], v2
  s_waitcnt lgkmcnt(0)
  v_smfmac_f32_16x16x64_bf16 v[20:23], v[108:111], a[88:95], v2
  v_smfmac_f32_16x16x64_bf16 v[24:27], v[108:111], a[248:255], v2
  s_nop 6
  v_maximum3_f32 v31, v20, v21, v22
  v_cmp_u_f32 vcc, v31, v23
  v_cvt_pk_bf16_f32 v32, v20, v21
  v_cvt_pk_bf16_f32 v33, v22, v23
  v_cvt_pk_bf16_f32 v34, v24, v25
  v_cvt_pk_bf16_f32 v35, v26, v27
  s_cbranch_vccnz mk_S2_rcv
  ds_write_b64 v0, v[32:33] offset:0
  ds_write_b64 v0, v[34:35] offset:2048
  ds_read_b128 v[64:67], v11 offset:0
  ds_read_b128 v[68:71], v11 offset:1024
  ds_read_b128 v[72:75], v11 offset:2048
  ds_read_b128 v[76:79], v11 offset:3072
  ds_read_b128 v[80:83], v11 offset:4096
  ds_read_b128 v[84:87], v11 offset:5120
  ds_read_b128 v[88:91], v11 offset:6144
  ds_read_b128 v[92:95], v11 offset:7168
  v_add_u32 v10, -1024, v0
  v_add_u32 v52, 1024, v10
  s_and_b32 s28, s10, 3
  s_lshl_b32 s28, s28, 13
  s_add_u32 s28, s28, s27
  s_add_u32 s32, s28, 4096
  s_and_b32 s29, s10, 31
  s_lshl_b32 s29, s29, 2
  s_add_u32 s29, s29, s33
  s_lshr_b32 s68, s29, 1
  s_bitcmp1_b64 s[64:65], s68
  s_cselect_b32 s68, 0x2000, 0
  s_lshl_b32 s29, s29, 20
  s_add_u32 s29, s29, s68
  s_add_u32 s29, s29, s26
  s_add_u32 s23, s10, 29
  s_and_b32 s23, s23, 31
  s_lshl_b32 s23, s23, 2
  s_add_u32 s23, s23, s8
  s_lshr_b32 s68, s23, 1
  s_bitcmp1_b64 s[64:65], s68
  s_cselect_b32 s68, 0x2000, 0
  s_lshl_b32 s23, s23, 20
  s_add_u32 s23, s23, s68
  s_add_u32 s23, s23, s41
  s_and_b32 s13, s10, 63
  s_cmp_lt_u32 s13, 3
  s_cselect_b32 s23, 1073741824, s23
  v_mov_b32 v56, 0
  v_mov_b32 v57, 0
  v_mov_b32 v58, 0
  v_mov_b32 v59, 0
  v_mov_b32 v60, 0
  v_mov_b32 v61, 0
  v_mov_b32 v62, 0
  v_mov_b32 v63, 0
  s_add_u32 s10, s10, 1
  v_mov_b32 v20, 0
  v_mov_b32 v21, 0
  v_mov_b32 v22, 0
  v_mov_b32 v23, 0
  v_mov_b32 v24, 0
  v_mov_b32 v25, 0
  v_mov_b32 v26, 0
  v_mov_b32 v27, 0
  s_and_b32 s18, s10, 3
  s_lshl_b32 s18, s18, 14
  s_add_u32 s18, s18, s17
  s_mov_b32 s11, 0
  s_mul_hi_u32 s68, s10, 0x2aaaaaab
  s_mul_i32 s68, s68, 6
  s_sub_u32 s13, s10, s68
  s_mul_i32 s13, s13, 20480
  s_add_u32 s13, s13, 33792
  v_add_u32 v0, s13, v8
  v_add_u32 v11, s13, v5
  s_mov_b32 m0, s19
  s_and_b32 s13, s10, 63
  s_waitcnt lgkmcnt(0)
  s_barrier
  s_cbranch_scc0 mk_S2_last
  s_nop 15
  s_nop 3
mk_S2_ps:
  buffer_load_dwordx4 v[120:123], v5, s[4:7], s32 offen offset:0 sc1
  buffer_load_dwordx4 v[104:107], v7, s[4:7], s28 offen offset:0 sc1
  buffer_load_dwordx4 v[108:111], v7, s[4:7], s28 offen offset:1024 sc1
  buffer_load_dwordx4 v[112:115], v7, s[4:7], s28 offen offset:2048 sc1
  buffer_load_dwordx4 v[116:119], v7, s[4:7], s28 offen offset:3072 sc1
  ds_read2_b32 v[96:97], v10 offset0:0 offset1:128
  ds_read2_b32 v[98:99], v10 offset0:1 offset1:129
  ds_read2_b32 v[100:101], v52 offset0:0 offset1:128
  ds_read2_b32 v[102:103], v52 offset0:1 offset1:129
  s_nop 15
  s_nop 9
  buffer_load_dwordx4 v[140:143], v5, s[4:7], s32 offen offset:0 sc1
  buffer_load_dwordx4 v[124:127], v7, s[4:7], s28 offen offset:0 sc1
  buffer_load_dwordx4 v[128:131], v7, s[4:7], s28 offen offset:1024 sc1
  buffer_load_dwordx4 v[132:135], v7, s[4:7], s28 offen offset:2048 sc1
  buffer_load_dwordx4 v[136:139], v7, s[4:7], s28 offen offset:3072 sc1
  s_waitcnt lgkmcnt(0)
mk_S2_p0:
  s_waitcnt vmcnt(9)
  v_cmp_eq_u32 vcc, -1, v120
  v_smfmac_f32_16x16x64_bf16 v[56:59], v[120:123], v[96:103], v15
  s_waitcnt vmcnt(8)
  v_smfmac_f32_16x16x64_bf16 v[56:59], v[104:107], v[64:71], v15
  s_cbranch_vccnz mk_S2_pf0
  s_waitcnt vmcnt(7)
  v_smfmac_f32_16x16x64_bf16 v[56:59], v[108:111], v[72:79], v15
  s_waitcnt vmcnt(6)
  v_smfmac_f32_16x16x64_bf16 v[56:59], v[112:115], v[80:87], v15
  v_maximum3_f32 v28, v104, v108, v112
  s_waitcnt vmcnt(5)
  v_smfmac_f32_16x16x64_bf16 v[56:59], v[116:119], v[88:95], v15
  v_cmp_u_f32 vcc, v28, v116
  s_nop 0
  s_cbranch_vccnz mk_S2_pf0
  v_pk_add_f32 v[32:33], v[56:57], v[58:59]
  v_cvt_pk_bf16_f32 v34, v32, v33
  buffer_store_dword v34, v36, s[4:7], s29 offen offset:0 sc1
  buffer_store_dword v34, v36, s[4:7], s29 offen offset:1024 sc1
  buffer_store_dword v34, v36, s[4:7], s29 offen offset:2048 sc1
  s_branch mk_S2_pok
.p2alignl 4, 0xbf800000
mk_S2_pf0:
  buffer_load_dwordx4 v[120:123], v5, s[4:7], s32 offen offset:0 sc1
  buffer_load_dwordx4 v[104:107], v7, s[4:7], s28 offen offset:0 sc1
  buffer_load_dwordx4 v[108:111], v7, s[4:7], s28 offen offset:1024 sc1
  buffer_load_dwordx4 v[112:115], v7, s[4:7], s28 offen offset:2048 sc1
  buffer_load_dwordx4 v[116:119], v7, s[4:7], s28 offen offset:3072 sc1
  v_mov_b32 v60, 0
  v_mov_b32 v61, 0
  v_mov_b32 v62, 0
  v_mov_b32 v63, 0
mk_S2_p1:
  s_waitcnt vmcnt(9)
  v_cmp_eq_u32 vcc, -1, v140
  v_smfmac_f32_16x16x64_bf16 v[60:63], v[140:143], v[96:103], v15
  s_waitcnt vmcnt(8)
  v_smfmac_f32_16x16x64_bf16 v[60:63], v[124:127], v[64:71], v15
  s_cbranch_vccnz mk_S2_pf1
  s_waitcnt vmcnt(7)
  v_smfmac_f32_16x16x64_bf16 v[60:63], v[128:131], v[72:79], v15
  s_waitcnt vmcnt(6)
  v_smfmac_f32_16x16x64_bf16 v[60:63], v[132:135], v[80:87], v15
  v_maximum3_f32 v28, v124, v128, v132
  s_waitcnt vmcnt(5)
  v_smfmac_f32_16x16x64_bf16 v[60:63], v[136:139], v[88:95], v15
  v_cmp_u_f32 vcc, v28, v136
  s_nop 0
  s_cbranch_vccnz mk_S2_pf1
  v_pk_add_f32 v[32:33], v[60:61], v[62:63]
  v_cvt_pk_bf16_f32 v34, v32, v33
  buffer_store_dword v34, v36, s[4:7], s29 offen offset:0 sc1
  buffer_store_dword v34, v36, s[4:7], s29 offen offset:1024 sc1
  buffer_store_dword v34, v36, s[4:7], s29 offen offset:2048 sc1
  s_branch mk_S2_pok
.p2alignl 4, 0xbf800000
mk_S2_pf1:
  buffer_load_dwordx4 v[140:143], v5, s[4:7], s32 offen offset:0 sc1
  buffer_load_dwordx4 v[124:127], v7, s[4:7], s28 offen offset:0 sc1
  buffer_load_dwordx4 v[128:131], v7, s[4:7], s28 offen offset:1024 sc1
  buffer_load_dwordx4 v[132:135], v7, s[4:7], s28 offen offset:2048 sc1
  buffer_load_dwordx4 v[136:139], v7, s[4:7], s28 offen offset:3072 sc1
  v_mov_b32 v56, 0
  v_mov_b32 v57, 0
  v_mov_b32 v58, 0
  v_mov_b32 v59, 0
  s_add_u32 s11, s11, 1
  s_cmp_lt_u32 s11, 262144
  s_cbranch_scc0 mk_fail
  s_branch mk_S2_p0
mk_S2_ptorn:
  s_add_u32 s11, s11, 1
  s_cmp_lt_u32 s11, 262144
  s_cbranch_scc0 mk_fail
  s_waitcnt vmcnt(0)
  v_mov_b32 v60, 0
  v_mov_b32 v61, 0
  v_mov_b32 v62, 0
  v_mov_b32 v63, 0
  v_mov_b32 v56, 0
  v_mov_b32 v57, 0
  v_mov_b32 v58, 0
  v_mov_b32 v59, 0
  s_branch mk_S2_ps
.p2alignl 4, 0xbf800000
mk_S2_pok:
  v_cmp_u_f32 vcc, v32, v33
  s_nop 0
  s_cbranch_vccnz mk_S2_ptorn
  v_lshlrev_b32 v32, 16, v34
  v_and_b32 v33, 0xffff0000, v34
  s_barrier
  s_mov_b32 m0, 13312
  s_add_u32 s13, s23, 0
  buffer_load_dwordx4 v5, s[4:7], s13 offen offset:0 sc1 lds
  buffer_load_dwordx4 v5, s[4:7], s13 offen offset:1024 sc1 lds
  buffer_load_dwordx4 v5, s[4:7], s13 offen offset:2048 sc1 lds
  buffer_load_dwordx4 v5, s[4:7], s13 offen offset:3072 sc1 lds
  s_mov_b32 m0, 17408
  s_add_u32 s13, s23, 4096
  buffer_load_dwordx4 v5, s[4:7], s13 offen offset:0 sc1 lds
  s_nop 15
  s_nop 11
  buffer_load_dword v65, v37, s[4:7], s29 offen offset:0 sc1
  buffer_load_dword v67, v38, s[4:7], s29 offen offset:0 sc1
  buffer_load_dword v69, v39, s[4:7], s29 offen offset:0 sc1
  buffer_load_dwordx4 v5, s[4:7], s13 offen offset:1024 sc1 lds
  buffer_load_dwordx4 v5, s[4:7], s13 offen offset:2048 sc1 lds
  buffer_load_dwordx4 v5, s[4:7], s13 offen offset:3072 sc1 lds
  s_nop 15
  s_nop 2
  buffer_load_dword v71, v37, s[4:7], s29 offen offset:1024 sc1
  buffer_load_dword v73, v38, s[4:7], s29 offen offset:1024 sc1
  buffer_load_dword v75, v39, s[4:7], s29 offen offset:1024 sc1
  s_mov_b32 m0, 21504
  s_add_u32 s13, s23, 16384
  buffer_load_dwordx4 v5, s[4:7], s13 offen offset:0 sc1 lds
  buffer_load_dwordx4 v5, s[4:7], s13 offen offset:1024 sc1 lds
  s_nop 15
  s_nop 1
  buffer_load_dword v77, v37, s[4:7], s29 offen offset:2048 sc1
  buffer_load_dword v79, v38, s[4:7], s29 offen offset:2048 sc1
  buffer_load_dword v81, v39, s[4:7], s29 offen offset:2048 sc1
  s_mov_b32 m0, s19
  s_waitcnt vmcnt(13)
  v_lshlrev_b32 v64, 16, v65
  v_and_b32 v65, 0xffff0000, v65
  v_pk_add_f32 v[44:45], v[32:33], v[64:65]
  s_waitcnt vmcnt(11)
  v_lshlrev_b32 v66, 16, v67
  v_and_b32 v67, 0xffff0000, v67
  v_lshlrev_b32 v68, 16, v69
  v_and_b32 v69, 0xffff0000, v69
  v_pk_add_f32 v[48:49], v[66:67], v[68:69]
  v_pk_add_f32 v[44:45], v[44:45], v[48:49]
  v_cmp_u_f32 vcc, v44, v45
  v_cvt_pk_bf16_f32 v46, v44, v45
  s_nop 1
  v_mov_b32_dpp v47, v46 quad_perm:[1,0,3,2] row_mask:0xf bank_mask:0xf
  v_perm_b32 v46, v47, v46, v13
  s_cbranch_vccnz mk_S2_bg0
  buffer_store_dword v46, v12, s[4:7], s18 offen
  s_branch mk_S2_top
.p2alignl 4, 0xbf800000
mk_S2_bg0:
  buffer_load_dword v65, v37, s[4:7], s29 offen offset:0 sc1
  buffer_load_dword v67, v38, s[4:7], s29 offen offset:0 sc1
  buffer_load_dword v69, v39, s[4:7], s29 offen offset:0 sc1
  s_waitcnt vmcnt(10)
  v_lshlrev_b32 v70, 16, v71
  v_and_b32 v71, 0xffff0000, v71
  v_pk_add_f32 v[44:45], v[32:33], v[70:71]
  s_waitcnt vmcnt(8)
  v_lshlrev_b32 v72, 16, v73
  v_and_b32 v73, 0xffff0000, v73
  v_lshlrev_b32 v74, 16, v75
  v_and_b32 v75, 0xffff0000, v75
  v_pk_add_f32 v[48:49], v[72:73], v[74:75]
  v_pk_add_f32 v[44:45], v[44:45], v[48:49]
  v_cmp_u_f32 vcc, v44, v45
  v_cvt_pk_bf16_f32 v46, v44, v45
  s_nop 1
  v_mov_b32_dpp v47, v46 quad_perm:[1,0,3,2] row_mask:0xf bank_mask:0xf
  v_perm_b32 v46, v47, v46, v13
  s_cbranch_vccnz mk_S2_bg1
  buffer_store_dword v46, v12, s[4:7], s18 offen
  s_branch mk_S2_top
.p2alignl 4, 0xbf800000
mk_S2_bg1:
  buffer_load_dword v71, v37, s[4:7], s29 offen offset:1024 sc1
  buffer_load_dword v73, v38, s[4:7], s29 offen offset:1024 sc1
  buffer_load_dword v75, v39, s[4:7], s29 offen offset:1024 sc1
  s_waitcnt vmcnt(8)
  v_lshlrev_b32 v76, 16, v77
  v_and_b32 v77, 0xffff0000, v77
  v_pk_add_f32 v[44:45], v[32:33], v[76:77]
  s_waitcnt vmcnt(6)
  v_lshlrev_b32 v78, 16, v79
  v_and_b32 v79, 0xffff0000, v79
  v_lshlrev_b32 v80, 16, v81
  v_and_b32 v81, 0xffff0000, v81
  v_pk_add_f32 v[48:49], v[78:79], v[80:81]
  v_pk_add_f32 v[44:45], v[44:45], v[48:49]
  v_cmp_u_f32 vcc, v44, v45
  v_cvt_pk_bf16_f32 v46, v44, v45
  s_nop 1
  v_mov_b32_dpp v47, v46 quad_perm:[1,0,3,2] row_mask:0xf bank_mask:0xf
  v_perm_b32 v46, v47, v46, v13
  s_cbranch_vccnz mk_S2_bg2
  buffer_store_dword v46, v12, s[4:7], s18 offen
  s_branch mk_S2_top
.p2alignl 4, 0xbf800000
mk_S2_bg2:
  buffer_load_dword v77, v37, s[4:7], s29 offen offset:2048 sc1
  buffer_load_dword v79, v38, s[4:7], s29 offen offset:2048 sc1
  buffer_load_dword v81, v39, s[4:7], s29 offen offset:2048 sc1
mk_S2_b0:
  s_waitcnt vmcnt(8)
  v_lshlrev_b32 v64, 16, v65
  v_and_b32 v65, 0xffff0000, v65
  v_pk_add_f32 v[44:45], v[32:33], v[64:65]
  s_waitcnt vmcnt(6)
  v_lshlrev_b32 v66, 16, v67
  v_and_b32 v67, 0xffff0000, v67
  v_lshlrev_b32 v68, 16, v69
  v_and_b32 v69, 0xffff0000, v69
  v_pk_add_f32 v[48:49], v[66:67], v[68:69]
  v_pk_add_f32 v[44:45], v[44:45], v[48:49]
  v_cmp_u_f32 vcc, v44, v45
  v_cvt_pk_bf16_f32 v46, v44, v45
  s_nop 1
  v_mov_b32_dpp v47, v46 quad_perm:[1,0,3,2] row_mask:0xf bank_mask:0xf
  v_perm_b32 v46, v47, v46, v13
  s_cbranch_vccnz mk_S2_bf0
  buffer_store_dword v46, v12, s[4:7], s18 offen
  s_branch mk_S2_top
.p2alignl 4, 0xbf800000
mk_S2_bf0:
  buffer_load_dword v65, v37, s[4:7], s29 offen offset:0 sc1
  buffer_load_dword v67, v38, s[4:7], s29 offen offset:0 sc1
  buffer_load_dword v69, v39, s[4:7], s29 offen offset:0 sc1
mk_S2_b1:
  s_waitcnt vmcnt(8)
  v_lshlrev_b32 v70, 16, v71
  v_and_b32 v71, 0xffff0000, v71
  v_pk_add_f32 v[44:45], v[32:33], v[70:71]
  s_waitcnt vmcnt(6)
  v_lshlrev_b32 v72, 16, v73
  v_and_b32 v73, 0xffff0000, v73
  v_lshlrev_b32 v74, 16, v75
  v_and_b32 v75, 0xffff0000, v75
  v_pk_add_f32 v[48:49], v[72:73], v[74:75]
  v_pk_add_f32 v[44:45], v[44:45], v[48:49]
  v_cmp_u_f32 vcc, v44, v45
  v_cvt_pk_bf16_f32 v46, v44, v45
  s_nop 1
  v_mov_b32_dpp v47, v46 quad_perm:[1,0,3,2] row_mask:0xf bank_mask:0xf
  v_perm_b32 v46, v47, v46, v13
  s_cbranch_vccnz mk_S2_bf1
  buffer_store_dword v46, v12, s[4:7], s18 offen
  s_branch mk_S2_top
.p2alignl 4, 0xbf800000
mk_S2_bf1:
  buffer_load_dword v71, v37, s[4:7], s29 offen offset:1024 sc1
  buffer_load_dword v73, v38, s[4:7], s29 offen offset:1024 sc1
  buffer_load_dword v75, v39, s[4:7], s29 offen offset:1024 sc1
mk_S2_b2:
  s_waitcnt vmcnt(8)
  v_lshlrev_b32 v76, 16, v77
  v_and_b32 v77, 0xffff0000, v77
  v_pk_add_f32 v[44:45], v[32:33], v[76:77]
  s_waitcnt vmcnt(6)
  v_lshlrev_b32 v78, 16, v79
  v_and_b32 v79, 0xffff0000, v79
  v_lshlrev_b32 v80, 16, v81
  v_and_b32 v81, 0xffff0000, v81
  v_pk_add_f32 v[48:49], v[78:79], v[80:81]
  v_pk_add_f32 v[44:45], v[44:45], v[48:49]
  v_cmp_u_f32 vcc, v44, v45
  v_cvt_pk_bf16_f32 v46, v44, v45
  s_nop 1
  v_mov_b32_dpp v47, v46 quad_perm:[1,0,3,2] row_mask:0xf bank_mask:0xf
  v_perm_b32 v46, v47, v46, v13
  s_cbranch_vccnz mk_S2_bf2
  buffer_store_dword v46, v12, s[4:7], s18 offen
  s_branch mk_S2_top
.p2alignl 4, 0xbf800000
mk_S2_bf2:
  buffer_load_dword v77, v37, s[4:7], s29 offen offset:2048 sc1
  buffer_load_dword v79, v38, s[4:7], s29 offen offset:2048 sc1
  buffer_load_dword v81, v39, s[4:7], s29 offen offset:2048 sc1
  s_add_u32 s11, s11, 1
  s_cmp_lt_u32 s11, 262144
  s_cbranch_scc0 mk_fail
  s_branch mk_S2_b0
mk_S3_init:
  s_lshl_b32 s27, s8, 15
  s_add_u32 s27, s27, 64749568
  s_add_u32 s38, s38, 1
  s_load_dwordx2 s[80:81], s[0:1], 8
  s_mov_b32 s82, 0x2800
  s_mov_b32 s83, 0x20000
  v_lshrrev_b32 v62, 1, v61
  v_lshlrev_b32 v7, 9, v62
  v_and_b32 v62, 1, v61
  v_lshl_add_u32 v7, v62, 6, v7
  v_lshrrev_b32 v62, 2, v60
  v_lshl_add_u32 v7, v62, 7, v7
  v_and_b32 v62, 3, v60
  v_lshl_add_u32 v7, v62, 4, v7
  v_lshlrev_b32 v12, 6, v61
  v_and_b32 v62, 1, v60
  v_lshl_add_u32 v12, v62, 4, v12
  v_cmp_eq_u32 vcc, 1, v62
  v_mov_b32 v13, 0x05040100
  v_mov_b32 v63, 0x03020706
  v_cndmask_b32 v13, v13, v63, vcc
  v_lshl_add_u32 v62, v61, 1, v62
  v_mul_u32_u24 v62, 1280, v62
  v_and_b32 v63, 14, v60
  v_lshl_add_u32 v62, v63, 1, v62
  s_lshl_b32 s13, s38, 5
  s_waitcnt lgkmcnt(0)
  buffer_load_dword v54, v62, s[80:83], s13 offen
  v_lshrrev_b32 v63, 3, v60
  v_lshl_add_u32 v12, v63, 5, v12
  v_bfe_u32 v63, v60, 1, 2
  v_lshl_add_u32 v12, v63, 2, v12
  s_lshl_b32 s13, s38, 8
  v_add_u32 v12, s13, v12
  s_mul_hi_u32 s33, s38, 0x1999999a
  s_mul_i32 s13, s33, 10
  s_sub_u32 s13, s38, s13
  s_lshr_b32 s14, s13, 1
  s_lshl_b32 s14, s14, 14
  s_and_b32 s13, s13, 1
  s_lshl_b32 s13, s13, 12
  s_add_u32 s26, s13, s14
  s_add_u32 s26, s26, s39
  s_add_u32 s26, s26, 851968
  s_xor_b32 s13, s8, 0
  s_lshl_b32 s13, s13, 8
  v_lshl_add_u32 v36, v1, 2, s13
  s_xor_b32 s13, s8, 1
  s_lshl_b32 s13, s13, 8
  v_lshl_add_u32 v37, v1, 2, s13
  s_xor_b32 s13, s8, 2
  s_lshl_b32 s13, s13, 8
  v_lshl_add_u32 v38, v1, 2, s13
  s_xor_b32 s13, s8, 3
  s_lshl_b32 s13, s13, 8
  v_lshl_add_u32 v39, v1, 2, s13
  v_bfe_u32 v62, v1, 2, 3
  v_lshlrev_b32 v9, 7, v62
  v_and_b32 v62, 3, v1
  v_lshl_add_u32 v9, v62, 2, v9
  s_lshl_b32 s21, s33, 10
  s_add_u32 s21, s21, 64888832
  v_min_u32 v53, 31, v1
  v_lshrrev_b32 v62, 1, v53
  v_and_b32 v62, 15, v62
  v_lshlrev_b32 v53, 6, v53
  v_lshl_add_u32 v53, v62, 2, v53
  v_add_u32 v53, s19, v53
mk_S3_prime:
  v_mov_b32 v20, 0
  v_mov_b32 v21, 0
  v_mov_b32 v22, 0
  v_mov_b32 v23, 0
  v_mov_b32 v24, 0
  v_mov_b32 v25, 0
  v_mov_b32 v26, 0
  v_mov_b32 v27, 0
  s_and_b32 s18, s10, 3
  s_lshl_b32 s18, s18, 14
  s_add_u32 s18, s18, s17
  s_mov_b32 s11, 0
  s_mul_hi_u32 s68, s10, 0x2aaaaaab
  s_mul_i32 s68, s68, 6
  s_sub_u32 s13, s10, s68
  s_mul_i32 s13, s13, 20480
  s_add_u32 s13, s13, 33792
  v_add_u32 v0, s13, v8
  v_add_u32 v11, s13, v5
  s_add_u32 s13, s10, 1
  s_waitcnt vmcnt(0)
  buffer_store_dword v54, v12, s[4:7], s18 offen
  s_mov_b32 s70, 0
int_wg47:
  buffer_load_dword v28, v9, s[4:7], s21 offen offset:0 sc1
  s_waitcnt vmcnt(0)
  v_cmp_gt_u32 vcc, s13, v28
  s_nop 0
  s_cbranch_vccz int_wg47_ok
  s_sleep 1
  s_add_u32 s70, s70, 1
  s_cmp_lt_u32 s70, 262144
  s_cbranch_scc1 int_wg47
  s_branch mk_fail
int_wg47_ok:
  s_mov_b32 m0, s19
  s_waitcnt vmcnt(0) lgkmcnt(0)
  s_branch mk_S3_top
mk_S3_last:
  s_branch mk_S_drain
mk_S3_rcv:
  s_add_u32 s11, s11, 1
  s_cmp_lt_u32 s11, 262144
  s_cbranch_scc0 mk_fail
  s_mov_b32 s13, s18
  s_mov_b32 m0, 0
  s_nop 0
  buffer_load_dwordx4 v5, s[4:7], s13 offen offset:0 sc1 lds
  buffer_load_dwordx4 v5, s[4:7], s13 offen offset:1024 sc1 lds
  buffer_load_dwordx4 v5, s[4:7], s13 offen offset:2048 sc1 lds
  buffer_load_dwordx4 v5, s[4:7], s13 offen offset:3072 sc1 lds
  s_mov_b32 m0, 4096
  s_add_u32 s13, s13, 4096
  buffer_load_dwordx4 v5, s[4:7], s13 offen offset:0 sc1 lds
  buffer_load_dwordx4 v5, s[4:7], s13 offen offset:1024 sc1 lds
  buffer_load_dwordx4 v5, s[4:7], s13 offen offset:2048 sc1 lds
  buffer_load_dwordx4 v5, s[4:7], s13 offen offset:3072 sc1 lds
  s_mov_b32 m0, 8192
  s_add_u32 s13, s13, 4096
  buffer_load_dwordx4 v5, s[4:7], s13 offen offset:0 sc1 lds
  buffer_load_dwordx4 v5, s[4:7], s13 offen offset:1024 sc1 lds
  s_waitcnt vmcnt(0) lgkmcnt(0)
  s_nop 7
  v_mov_b32 v20, 0
  v_mov_b32 v21, 0
  v_mov_b32 v22, 0
  v_mov_b32 v23, 0
  v_mov_b32 v24, 0
  v_mov_b32 v25, 0
  v_mov_b32 v26, 0
  v_mov_b32 v27, 0
  ds_read_b128 v[128:131], v3 offset:8192
  ds_read_b128 v[132:135], v3 offset:8704
  ds_read_b128 v[136:139], v3 offset:9216
  ds_read_b128 v[140:143], v3 offset:9728
  s_branch mk_S3_chain
.p2alignl 4, 0xbf800000
mk_S3_top:
  s_barrier
  s_nop 15
  s_nop 7
  buffer_load_dwordx4 v4, s[4:7], s18 offen offset:0 sc1 lds
  buffer_load_dwordx4 v4, s[4:7], s18 offen offset:1024 sc1 lds
  s_nop 15
  s_nop 13
  buffer_load_dwordx4 v4, s[4:7], s18 offen offset:0 sc1 lds
  buffer_load_dwordx4 v4, s[4:7], s18 offen offset:1024 sc1 lds
  s_branch mk_S3_c1
.p2alignl 4, 0xbf800000
mk_S3_c0:
  s_add_u32 s11, s11, 1
  s_cmp_lt_u32 s11, 262144
  s_cbranch_scc0 mk_fail
mk_S3_c1:
  s_waitcnt vmcnt(2)
  ds_read_b32 v28, v53
  ds_read_b128 v[128:131], v3 offset:8192
  ds_read_b128 v[132:135], v3 offset:8704
  ds_read_b128 v[136:139], v3 offset:9216
  ds_read_b128 v[140:143], v3 offset:9728
  buffer_load_dwordx4 v4, s[4:7], s18 offen offset:0 sc1 lds
  buffer_load_dwordx4 v4, s[4:7], s18 offen offset:1024 sc1 lds
  s_waitcnt lgkmcnt(4)
  v_cmp_eq_u32 vcc, -1, v28
  s_nop 0
  s_cbranch_vccnz mk_S3_c0
  s_barrier
mk_S3_chain:
  s_waitcnt lgkmcnt(3)
  v_smfmac_f32_16x16x64_bf16 v[20:23], v[128:131], a[128:135], v2
  ds_read_b128 v[64:67], v3 offset:0
  v_smfmac_f32_16x16x64_bf16 v[24:27], v[128:131], v[224:231], v2
  s_waitcnt lgkmcnt(3)
  v_smfmac_f32_16x16x64_bf16 v[20:23], v[132:135], a[136:143], v2
  ds_read_b128 v[68:71], v3 offset:512
  v_smfmac_f32_16x16x64_bf16 v[24:27], v[132:135], v[232:239], v2
  s_waitcnt lgkmcnt(3)
  v_smfmac_f32_16x16x64_bf16 v[20:23], v[136:139], a[144:151], v2
  ds_read_b128 v[72:75], v3 offset:1024
  v_smfmac_f32_16x16x64_bf16 v[24:27], v[136:139], v[240:247], v2
  s_waitcnt lgkmcnt(3)
  v_smfmac_f32_16x16x64_bf16 v[20:23], v[140:143], a[152:159], v2
  ds_read_b128 v[76:79], v3 offset:1536
  v_smfmac_f32_16x16x64_bf16 v[24:27], v[140:143], v[248:255], v2
  s_waitcnt lgkmcnt(3)
  v_smfmac_f32_16x16x64_bf16 v[20:23], v[64:67], a[0:7], v2
  ds_read_b128 v[80:83], v3 offset:2048
  v_smfmac_f32_16x16x64_bf16 v[24:27], v[64:67], a[160:167], v2
  s_waitcnt lgkmcnt(3)
  v_smfmac_f32_16x16x64_bf16 v[20:23], v[68:71], a[8:15], v2
  ds_read_b128 v[84:87], v3 offset:2560
  v_smfmac_f32_16x16x64_bf16 v[24:27], v[68:71], a[168:175], v2
  s_waitcnt lgkmcnt(3)
  v_smfmac_f32_16x16x64_bf16 v[20:23], v[72:75], a[16:23], v2
  ds_read_b128 v[88:91], v3 offset:3072
  v_smfmac_f32_16x16x64_bf16 v[24:27], v[72:75], a[176:183], v2
  s_waitcnt lgkmcnt(3)
  v_smfmac_f32_16x16x64_bf16 v[20:23], v[76:79], a[24:31], v2
  ds_read_b128 v[92:95], v3 offset:3584
  v_smfmac_f32_16x16x64_bf16 v[24:27], v[76:79], a[184:191], v2
  s_waitcnt lgkmcnt(3)
  v_smfmac_f32_16x16x64_bf16 v[20:23], v[80:83], a[32:39], v2
  ds_read_b128 v[96:99], v3 offset:4096
  v_smfmac_f32_16x16x64_bf16 v[24:27], v[80:83], a[192:199], v2
  s_waitcnt lgkmcnt(3)
  v_smfmac_f32_16x16x64_bf16 v[20:23], v[84:87], a[40:47], v2
  ds_read_b128 v[100:103], v3 offset:4608
  v_smfmac_f32_16x16x64_bf16 v[24:27], v[84:87], a[200:207], v2
  s_waitcnt lgkmcnt(3)
  v_smfmac_f32_16x16x64_bf16 v[20:23], v[88:91], a[48:55], v2
  ds_read_b128 v[104:107], v3 offset:5120
  v_smfmac_f32_16x16x64_bf16 v[24:27], v[88:91], a[208:215], v2
  s_waitcnt lgkmcnt(3)
  v_smfmac_f32_16x16x64_bf16 v[20:23], v[92:95], a[56:63], v2
  ds_read_b128 v[108:111], v3 offset:5632
  v_smfmac_f32_16x16x64_bf16 v[24:27], v[92:95], a[216:223], v2
  s_waitcnt lgkmcnt(3)
  v_smfmac_f32_16x16x64_bf16 v[20:23], v[96:99], a[64:71], v2
  ds_read_b128 v[112:115], v3 offset:6144
  v_smfmac_f32_16x16x64_bf16 v[24:27], v[96:99], a[224:231], v2
  s_waitcnt lgkmcnt(3)
  v_smfmac_f32_16x16x64_bf16 v[20:23], v[100:103], a[72:79], v2
  ds_read_b128 v[116:119], v3 offset:6656
  v_smfmac_f32_16x16x64_bf16 v[24:27], v[100:103], a[232:239], v2
  s_waitcnt lgkmcnt(3)
  v_smfmac_f32_16x16x64_bf16 v[20:23], v[104:107], a[80:87], v2
  ds_read_b128 v[120:123], v3 offset:7168
  v_smfmac_f32_16x16x64_bf16 v[24:27], v[104:107], a[240:247], v2
  s_waitcnt lgkmcnt(3)
  v_smfmac_f32_16x16x64_bf16 v[20:23], v[108:111], a[88:95], v2
  ds_read_b128 v[124:127], v3 offset:7680
  v_smfmac_f32_16x16x64_bf16 v[24:27], v[108:111], a[248:255], v2
  s_waitcnt lgkmcnt(3)
  v_smfmac_f32_16x16x64_bf16 v[20:23], v[112:115], a[96:103], v2
  v_smfmac_f32_16x16x64_bf16 v[24:27], v[112:115], v[192:199], v2
  s_waitcnt lgkmcnt(2)
  v_smfmac_f32_16x16x64_bf16 v[20:23], v[116:119], a[104:111], v2
  v_smfmac_f32_16x16x64_bf16 v[24:27], v[116:119], v[200:207], v2
  s_waitcnt lgkmcnt(1)
  v_smfmac_f32_16x16x64_bf16 v[20:23], v[120:123], a[112:119], v2
  v_smfmac_f32_16x16x64_bf16 v[24:27], v[120:123], v[208:215], v2
  s_waitcnt lgkmcnt(0)
  v_smfmac_f32_16x16x64_bf16 v[20:23], v[124:127], a[120:127], v2
  v_smfmac_f32_16x16x64_bf16 v[24:27], v[124:127], v[216:223], v2
  s_nop 6
  v_maximum3_f32 v31, v20, v21, v22
  v_cmp_u_f32 vcc, v31, v23
  v_cvt_pk_bf16_f32 v32, v20, v21
  v_cvt_pk_bf16_f32 v33, v22, v23
  v_cvt_pk_bf16_f32 v34, v24, v25
  v_cvt_pk_bf16_f32 v35, v26, v27
  s_cbranch_vccnz mk_S3_rcv
  ds_write_b64 v0, v[32:33] offset:0
  ds_write_b64 v0, v[34:35] offset:2048
  ds_read_b128 v[64:67], v11 offset:8192
  ds_read_b128 v[68:71], v11 offset:9216
  ds_read_b128 v[72:75], v11 offset:10240
  ds_read_b128 v[76:79], v11 offset:11264
  ds_read_b128 v[80:83], v11 offset:12288
  ds_read_b128 v[84:87], v11 offset:13312
  ds_read_b128 v[88:91], v11 offset:14336
  ds_read_b128 v[92:95], v11 offset:15360
  v_add_u32 v10, 512, v0
  v_add_u32 v52, 1024, v10
  s_and_b32 s28, s10, 3
  s_lshl_b32 s28, s28, 13
  s_add_u32 s28, s28, s27
  s_add_u32 s32, s28, 4096
  s_and_b32 s29, s10, 31
  s_lshl_b32 s29, s29, 2
  s_add_u32 s29, s29, s33
  s_lshr_b32 s68, s29, 1
  s_bitcmp1_b64 s[64:65], s68
  s_cselect_b32 s68, 0x2000, 0
  s_lshl_b32 s29, s29, 20
  s_add_u32 s29, s29, s68
  s_add_u32 s29, s29, s26
  s_add_u32 s23, s10, 29
  s_and_b32 s23, s23, 31
  s_lshl_b32 s23, s23, 2
  s_add_u32 s23, s23, s8
  s_lshr_b32 s68, s23, 1
  s_bitcmp1_b64 s[64:65], s68
  s_cselect_b32 s68, 0x2000, 0
  s_lshl_b32 s23, s23, 20
  s_add_u32 s23, s23, s68
  s_add_u32 s23, s23, s41
  s_and_b32 s13, s10, 63
  s_cmp_lt_u32 s13, 3
  s_cselect_b32 s23, 1073741824, s23
  v_mov_b32 v56, 0
  v_mov_b32 v57, 0
  v_mov_b32 v58, 0
  v_mov_b32 v59, 0
  v_mov_b32 v60, 0
  v_mov_b32 v61, 0
  v_mov_b32 v62, 0
  v_mov_b32 v63, 0
  s_add_u32 s10, s10, 1
  v_mov_b32 v20, 0
  v_mov_b32 v21, 0
  v_mov_b32 v22, 0
  v_mov_b32 v23, 0
  v_mov_b32 v24, 0
  v_mov_b32 v25, 0
  v_mov_b32 v26, 0
  v_mov_b32 v27, 0
  s_and_b32 s18, s10, 3
  s_lshl_b32 s18, s18, 14
  s_add_u32 s18, s18, s17
  s_mov_b32 s11, 0
  s_mul_hi_u32 s68, s10, 0x2aaaaaab
  s_mul_i32 s68, s68, 6
  s_sub_u32 s13, s10, s68
  s_mul_i32 s13, s13, 20480
  s_add_u32 s13, s13, 33792
  v_add_u32 v0, s13, v8
  v_add_u32 v11, s13, v5
  s_mov_b32 m0, s19
  s_and_b32 s13, s10, 63
  s_waitcnt lgkmcnt(0)
  s_barrier
  s_cbranch_scc0 mk_S3_last
  s_nop 15
  s_nop 3
mk_S3_ps:
  buffer_load_dwordx4 v[120:123], v5, s[4:7], s32 offen offset:0 sc1
  buffer_load_dwordx4 v[104:107], v7, s[4:7], s28 offen offset:0 sc1
  buffer_load_dwordx4 v[108:111], v7, s[4:7], s28 offen offset:1024 sc1
  buffer_load_dwordx4 v[112:115], v7, s[4:7], s28 offen offset:2048 sc1
  buffer_load_dwordx4 v[116:119], v7, s[4:7], s28 offen offset:3072 sc1
  ds_read2_b32 v[96:97], v10 offset0:0 offset1:128
  ds_read2_b32 v[98:99], v10 offset0:1 offset1:129
  ds_read2_b32 v[100:101], v52 offset0:0 offset1:128
  ds_read2_b32 v[102:103], v52 offset0:1 offset1:129
  s_nop 15
  s_nop 9
  buffer_load_dwordx4 v[140:143], v5, s[4:7], s32 offen offset:0 sc1
  buffer_load_dwordx4 v[124:127], v7, s[4:7], s28 offen offset:0 sc1
  buffer_load_dwordx4 v[128:131], v7, s[4:7], s28 offen offset:1024 sc1
  buffer_load_dwordx4 v[132:135], v7, s[4:7], s28 offen offset:2048 sc1
  buffer_load_dwordx4 v[136:139], v7, s[4:7], s28 offen offset:3072 sc1
  s_waitcnt lgkmcnt(0)
mk_S3_p0:
  s_waitcnt vmcnt(9)
  v_cmp_eq_u32 vcc, -1, v120
  v_smfmac_f32_16x16x64_bf16 v[56:59], v[120:123], v[96:103], v15
  s_waitcnt vmcnt(8)
  v_smfmac_f32_16x16x64_bf16 v[56:59], v[104:107], v[64:71], v15
  s_cbranch_vccnz mk_S3_pf0
  s_waitcnt vmcnt(7)
  v_smfmac_f32_16x16x64_bf16 v[56:59], v[108:111], v[72:79], v15
  s_waitcnt vmcnt(6)
  v_smfmac_f32_16x16x64_bf16 v[56:59], v[112:115], v[80:87], v15
  v_maximum3_f32 v28, v104, v108, v112
  s_waitcnt vmcnt(5)
  v_smfmac_f32_16x16x64_bf16 v[56:59], v[116:119], v[88:95], v15
  v_cmp_u_f32 vcc, v28, v116
  s_nop 0
  s_cbranch_vccnz mk_S3_pf0
  v_pk_add_f32 v[32:33], v[56:57], v[58:59]
  v_cvt_pk_bf16_f32 v34, v32, v33
  buffer_store_dword v34, v36, s[4:7], s29 offen offset:0 sc1
  buffer_store_dword v34, v36, s[4:7], s29 offen offset:1024 sc1
  buffer_store_dword v34, v36, s[4:7], s29 offen offset:2048 sc1
  s_branch mk_S3_pok
.p2alignl 4, 0xbf800000
mk_S3_pf0:
  buffer_load_dwordx4 v[120:123], v5, s[4:7], s32 offen offset:0 sc1
  buffer_load_dwordx4 v[104:107], v7, s[4:7], s28 offen offset:0 sc1
  buffer_load_dwordx4 v[108:111], v7, s[4:7], s28 offen offset:1024 sc1
  buffer_load_dwordx4 v[112:115], v7, s[4:7], s28 offen offset:2048 sc1
  buffer_load_dwordx4 v[116:119], v7, s[4:7], s28 offen offset:3072 sc1
  v_mov_b32 v60, 0
  v_mov_b32 v61, 0
  v_mov_b32 v62, 0
  v_mov_b32 v63, 0
mk_S3_p1:
  s_waitcnt vmcnt(9)
  v_cmp_eq_u32 vcc, -1, v140
  v_smfmac_f32_16x16x64_bf16 v[60:63], v[140:143], v[96:103], v15
  s_waitcnt vmcnt(8)
  v_smfmac_f32_16x16x64_bf16 v[60:63], v[124:127], v[64:71], v15
  s_cbranch_vccnz mk_S3_pf1
  s_waitcnt vmcnt(7)
  v_smfmac_f32_16x16x64_bf16 v[60:63], v[128:131], v[72:79], v15
  s_waitcnt vmcnt(6)
  v_smfmac_f32_16x16x64_bf16 v[60:63], v[132:135], v[80:87], v15
  v_maximum3_f32 v28, v124, v128, v132
  s_waitcnt vmcnt(5)
  v_smfmac_f32_16x16x64_bf16 v[60:63], v[136:139], v[88:95], v15
  v_cmp_u_f32 vcc, v28, v136
  s_nop 0
  s_cbranch_vccnz mk_S3_pf1
  v_pk_add_f32 v[32:33], v[60:61], v[62:63]
  v_cvt_pk_bf16_f32 v34, v32, v33
  buffer_store_dword v34, v36, s[4:7], s29 offen offset:0 sc1
  buffer_store_dword v34, v36, s[4:7], s29 offen offset:1024 sc1
  buffer_store_dword v34, v36, s[4:7], s29 offen offset:2048 sc1
  s_branch mk_S3_pok
.p2alignl 4, 0xbf800000
mk_S3_pf1:
  buffer_load_dwordx4 v[140:143], v5, s[4:7], s32 offen offset:0 sc1
  buffer_load_dwordx4 v[124:127], v7, s[4:7], s28 offen offset:0 sc1
  buffer_load_dwordx4 v[128:131], v7, s[4:7], s28 offen offset:1024 sc1
  buffer_load_dwordx4 v[132:135], v7, s[4:7], s28 offen offset:2048 sc1
  buffer_load_dwordx4 v[136:139], v7, s[4:7], s28 offen offset:3072 sc1
  v_mov_b32 v56, 0
  v_mov_b32 v57, 0
  v_mov_b32 v58, 0
  v_mov_b32 v59, 0
  s_add_u32 s11, s11, 1
  s_cmp_lt_u32 s11, 262144
  s_cbranch_scc0 mk_fail
  s_branch mk_S3_p0
mk_S3_ptorn:
  s_add_u32 s11, s11, 1
  s_cmp_lt_u32 s11, 262144
  s_cbranch_scc0 mk_fail
  s_waitcnt vmcnt(0)
  v_mov_b32 v60, 0
  v_mov_b32 v61, 0
  v_mov_b32 v62, 0
  v_mov_b32 v63, 0
  v_mov_b32 v56, 0
  v_mov_b32 v57, 0
  v_mov_b32 v58, 0
  v_mov_b32 v59, 0
  s_branch mk_S3_ps
.p2alignl 4, 0xbf800000
mk_S3_pok:
  v_cmp_u_f32 vcc, v32, v33
  s_nop 0
  s_cbranch_vccnz mk_S3_ptorn
  v_lshlrev_b32 v32, 16, v34
  v_and_b32 v33, 0xffff0000, v34
  s_barrier
  s_mov_b32 m0, 21504
  s_add_u32 s13, s23, 16384
  buffer_load_dwordx4 v5, s[4:7], s13 offen offset:2048 sc1 lds
  buffer_load_dwordx4 v5, s[4:7], s13 offen offset:3072 sc1 lds
  s_mov_b32 m0, 25600
  s_add_u32 s13, s23, 20480
  buffer_load_dwordx4 v5, s[4:7], s13 offen offset:0 sc1 lds
  buffer_load_dwordx4 v5, s[4:7], s13 offen offset:1024 sc1 lds
  buffer_load_dwordx4 v5, s[4:7], s13 offen offset:2048 sc1 lds
  s_nop 15
  s_nop 11
  buffer_load_dword v65, v37, s[4:7], s29 offen offset:0 sc1
  buffer_load_dword v67, v38, s[4:7], s29 offen offset:0 sc1
  buffer_load_dword v69, v39, s[4:7], s29 offen offset:0 sc1
  buffer_load_dwordx4 v5, s[4:7], s13 offen offset:3072 sc1 lds
  s_mov_b32 m0, 29696
  s_add_u32 s13, s23, 32768
  buffer_load_dwordx4 v5, s[4:7], s13 offen offset:0 sc1 lds
  buffer_load_dwordx4 v5, s[4:7], s13 offen offset:1024 sc1 lds
  s_nop 15
  s_nop 0
  buffer_load_dword v71, v37, s[4:7], s29 offen offset:1024 sc1
  buffer_load_dword v73, v38, s[4:7], s29 offen offset:1024 sc1
  buffer_load_dword v75, v39, s[4:7], s29 offen offset:1024 sc1
  buffer_load_dwordx4 v5, s[4:7], s13 offen offset:2048 sc1 lds
  buffer_load_dwordx4 v5, s[4:7], s13 offen offset:3072 sc1 lds
  s_nop 15
  s_nop 3
  buffer_load_dword v77, v37, s[4:7], s29 offen offset:2048 sc1
  buffer_load_dword v79, v38, s[4:7], s29 offen offset:2048 sc1
  buffer_load_dword v81, v39, s[4:7], s29 offen offset:2048 sc1
  s_mov_b32 m0, s19
  s_waitcnt vmcnt(13)
  v_lshlrev_b32 v64, 16, v65
  v_and_b32 v65, 0xffff0000, v65
  v_pk_add_f32 v[44:45], v[32:33], v[64:65]
  s_waitcnt vmcnt(11)
  v_lshlrev_b32 v66, 16, v67
  v_and_b32 v67, 0xffff0000, v67
  v_lshlrev_b32 v68, 16, v69
  v_and_b32 v69, 0xffff0000, v69
  v_pk_add_f32 v[48:49], v[66:67], v[68:69]
  v_pk_add_f32 v[44:45], v[44:45], v[48:49]
  v_cmp_u_f32 vcc, v44, v45
  v_cvt_pk_bf16_f32 v46, v44, v45
  s_nop 1
  v_mov_b32_dpp v47, v46 quad_perm:[1,0,3,2] row_mask:0xf bank_mask:0xf
  v_perm_b32 v46, v47, v46, v13
  s_cbranch_vccnz mk_S3_bg0
  buffer_store_dword v46, v12, s[4:7], s18 offen
  s_branch mk_S3_top
.p2alignl 4, 0xbf800000
mk_S3_bg0:
  buffer_load_dword v65, v37, s[4:7], s29 offen offset:0 sc1
  buffer_load_dword v67, v38, s[4:7], s29 offen offset:0 sc1
  buffer_load_dword v69, v39, s[4:7], s29 offen offset:0 sc1
  s_waitcnt vmcnt(10)
  v_lshlrev_b32 v70, 16, v71
  v_and_b32 v71, 0xffff0000, v71
  v_pk_add_f32 v[44:45], v[32:33], v[70:71]
  s_waitcnt vmcnt(8)
  v_lshlrev_b32 v72, 16, v73
  v_and_b32 v73, 0xffff0000, v73
  v_lshlrev_b32 v74, 16, v75
  v_and_b32 v75, 0xffff0000, v75
  v_pk_add_f32 v[48:49], v[72:73], v[74:75]
  v_pk_add_f32 v[44:45], v[44:45], v[48:49]
  v_cmp_u_f32 vcc, v44, v45
  v_cvt_pk_bf16_f32 v46, v44, v45
  s_nop 1
  v_mov_b32_dpp v47, v46 quad_perm:[1,0,3,2] row_mask:0xf bank_mask:0xf
  v_perm_b32 v46, v47, v46, v13
  s_cbranch_vccnz mk_S3_bg1
  buffer_store_dword v46, v12, s[4:7], s18 offen
  s_branch mk_S3_top
.p2alignl 4, 0xbf800000
mk_S3_bg1:
  buffer_load_dword v71, v37, s[4:7], s29 offen offset:1024 sc1
  buffer_load_dword v73, v38, s[4:7], s29 offen offset:1024 sc1
  buffer_load_dword v75, v39, s[4:7], s29 offen offset:1024 sc1
  s_waitcnt vmcnt(8)
  v_lshlrev_b32 v76, 16, v77
  v_and_b32 v77, 0xffff0000, v77
  v_pk_add_f32 v[44:45], v[32:33], v[76:77]
  s_waitcnt vmcnt(6)
  v_lshlrev_b32 v78, 16, v79
  v_and_b32 v79, 0xffff0000, v79
  v_lshlrev_b32 v80, 16, v81
  v_and_b32 v81, 0xffff0000, v81
  v_pk_add_f32 v[48:49], v[78:79], v[80:81]
  v_pk_add_f32 v[44:45], v[44:45], v[48:49]
  v_cmp_u_f32 vcc, v44, v45
  v_cvt_pk_bf16_f32 v46, v44, v45
  s_nop 1
  v_mov_b32_dpp v47, v46 quad_perm:[1,0,3,2] row_mask:0xf bank_mask:0xf
  v_perm_b32 v46, v47, v46, v13
  s_cbranch_vccnz mk_S3_bg2
  buffer_store_dword v46, v12, s[4:7], s18 offen
  s_branch mk_S3_top
.p2alignl 4, 0xbf800000
mk_S3_bg2:
  buffer_load_dword v77, v37, s[4:7], s29 offen offset:2048 sc1
  buffer_load_dword v79, v38, s[4:7], s29 offen offset:2048 sc1
  buffer_load_dword v81, v39, s[4:7], s29 offen offset:2048 sc1
mk_S3_b0:
  s_waitcnt vmcnt(8)
  v_lshlrev_b32 v64, 16, v65
  v_and_b32 v65, 0xffff0000, v65
  v_pk_add_f32 v[44:45], v[32:33], v[64:65]
  s_waitcnt vmcnt(6)
  v_lshlrev_b32 v66, 16, v67
  v_and_b32 v67, 0xffff0000, v67
  v_lshlrev_b32 v68, 16, v69
  v_and_b32 v69, 0xffff0000, v69
  v_pk_add_f32 v[48:49], v[66:67], v[68:69]
  v_pk_add_f32 v[44:45], v[44:45], v[48:49]
  v_cmp_u_f32 vcc, v44, v45
  v_cvt_pk_bf16_f32 v46, v44, v45
  s_nop 1
  v_mov_b32_dpp v47, v46 quad_perm:[1,0,3,2] row_mask:0xf bank_mask:0xf
  v_perm_b32 v46, v47, v46, v13
  s_cbranch_vccnz mk_S3_bf0
  buffer_store_dword v46, v12, s[4:7], s18 offen
  s_branch mk_S3_top
.p2alignl 4, 0xbf800000
mk_S3_bf0:
  buffer_load_dword v65, v37, s[4:7], s29 offen offset:0 sc1
  buffer_load_dword v67, v38, s[4:7], s29 offen offset:0 sc1
  buffer_load_dword v69, v39, s[4:7], s29 offen offset:0 sc1
mk_S3_b1:
  s_waitcnt vmcnt(8)
  v_lshlrev_b32 v70, 16, v71
  v_and_b32 v71, 0xffff0000, v71
  v_pk_add_f32 v[44:45], v[32:33], v[70:71]
  s_waitcnt vmcnt(6)
  v_lshlrev_b32 v72, 16, v73
  v_and_b32 v73, 0xffff0000, v73
  v_lshlrev_b32 v74, 16, v75
  v_and_b32 v75, 0xffff0000, v75
  v_pk_add_f32 v[48:49], v[72:73], v[74:75]
  v_pk_add_f32 v[44:45], v[44:45], v[48:49]
  v_cmp_u_f32 vcc, v44, v45
  v_cvt_pk_bf16_f32 v46, v44, v45
  s_nop 1
  v_mov_b32_dpp v47, v46 quad_perm:[1,0,3,2] row_mask:0xf bank_mask:0xf
  v_perm_b32 v46, v47, v46, v13
  s_cbranch_vccnz mk_S3_bf1
  buffer_store_dword v46, v12, s[4:7], s18 offen
  s_branch mk_S3_top
.p2alignl 4, 0xbf800000
mk_S3_bf1:
  buffer_load_dword v71, v37, s[4:7], s29 offen offset:1024 sc1
  buffer_load_dword v73, v38, s[4:7], s29 offen offset:1024 sc1
  buffer_load_dword v75, v39, s[4:7], s29 offen offset:1024 sc1
mk_S3_b2:
  s_waitcnt vmcnt(8)
  v_lshlrev_b32 v76, 16, v77
  v_and_b32 v77, 0xffff0000, v77
  v_pk_add_f32 v[44:45], v[32:33], v[76:77]
  s_waitcnt vmcnt(6)
  v_lshlrev_b32 v78, 16, v79
  v_and_b32 v79, 0xffff0000, v79
  v_lshlrev_b32 v80, 16, v81
  v_and_b32 v81, 0xffff0000, v81
  v_pk_add_f32 v[48:49], v[78:79], v[80:81]
  v_pk_add_f32 v[44:45], v[44:45], v[48:49]
  v_cmp_u_f32 vcc, v44, v45
  v_cvt_pk_bf16_f32 v46, v44, v45
  s_nop 1
  v_mov_b32_dpp v47, v46 quad_perm:[1,0,3,2] row_mask:0xf bank_mask:0xf
  v_perm_b32 v46, v47, v46, v13
  s_cbranch_vccnz mk_S3_bf2
  buffer_store_dword v46, v12, s[4:7], s18 offen
  s_branch mk_S3_top
.p2alignl 4, 0xbf800000
mk_S3_bf2:
  buffer_load_dword v77, v37, s[4:7], s29 offen offset:2048 sc1
  buffer_load_dword v79, v38, s[4:7], s29 offen offset:2048 sc1
  buffer_load_dword v81, v39, s[4:7], s29 offen offset:2048 sc1
  s_add_u32 s11, s11, 1
  s_cmp_lt_u32 s11, 262144
  s_cbranch_scc0 mk_fail
  s_branch mk_S3_b0
mk_Q_drain:
  s_sub_u32 s22, s10, 4
  s_add_u32 s22, s22, s3
  s_mov_b32 s11, 0
  s_waitcnt vmcnt(0)
  s_mul_hi_u32 s68, s22, 0x2aaaaaab
  s_mul_i32 s68, s68, 6
  s_sub_u32 s13, s22, s68
  s_mul_i32 s13, s13, 20480
  s_add_u32 s13, s13, 33792
  v_add_u32 v60, s13, v5
  s_add_u32 s13, s13, 16384
  v_lshl_add_u32 v61, v1, 3, s13
  v_add_u32 v62, 1024, v61
  ds_read_b128 v[144:147], v60 offset:0
  ds_read_b128 v[148:151], v60 offset:1024
  ds_read_b128 v[152:155], v60 offset:2048
  ds_read_b128 v[156:159], v60 offset:3072
  ds_read_b128 v[160:163], v60 offset:4096
  ds_read_b128 v[164:167], v60 offset:5120
  ds_read_b128 v[168:171], v60 offset:6144
  ds_read_b128 v[172:175], v60 offset:7168
  ds_read2_b32 v[176:177], v61 offset0:0 offset1:128
  ds_read2_b32 v[178:179], v61 offset0:1 offset1:129
  ds_read2_b32 v[180:181], v62 offset0:0 offset1:128
  ds_read2_b32 v[182:183], v62 offset0:1 offset1:129
  s_and_b32 s24, s22, 31
  s_lshl_b32 s24, s24, 2
  s_add_u32 s24, s24, s8
  s_lshr_b32 s68, s24, 1
  s_bitcmp0_b64 s[64:65], s68
  s_cselect_b32 s68, 0x2000, 0
  s_lshl_b32 s24, s24, 20
  s_add_u32 s24, s24, s68
  s_add_u32 s24, s24, s72
  s_bitcmp1_b32 s22, 5
  s_cselect_b32 s13, 49152, 0
  s_add_u32 s24, s24, s13
mk_Q_dr1:
  s_add_u32 s11, s11, 1
  s_cmp_lt_u32 s11, 262144
  s_cbranch_scc0 mk_fail
  s_and_b32 s14, s22, 31
  s_lshl_b32 s14, s14, 2
  s_add_u32 s14, s14, s8
  s_lshr_b32 s68, s14, 1
  s_bitcmp1_b64 s[64:65], s68
  s_cselect_b32 s68, 0x2000, 0
  s_lshl_b32 s14, s14, 20
  s_add_u32 s14, s14, s68
  s_add_u32 s14, s14, s41
  buffer_load_dwordx4 v[64:67], v5, s[4:7], s14 offen offset:0 sc1
  buffer_load_dwordx4 v[68:71], v5, s[4:7], s14 offen offset:1024 sc1
  buffer_load_dwordx4 v[72:75], v5, s[4:7], s14 offen offset:2048 sc1
  buffer_load_dwordx4 v[76:79], v5, s[4:7], s14 offen offset:3072 sc1
  s_add_u32 s14, s14, 4096
  buffer_load_dwordx4 v[84:87], v5, s[4:7], s14 offen offset:0 sc1
  buffer_load_dwordx4 v[88:91], v5, s[4:7], s14 offen offset:1024 sc1
  buffer_load_dwordx4 v[92:95], v5, s[4:7], s14 offen offset:2048 sc1
  buffer_load_dwordx4 v[96:99], v5, s[4:7], s14 offen offset:3072 sc1
  s_add_u32 s14, s14, 12288
  buffer_load_dwordx4 v[104:107], v5, s[4:7], s14 offen offset:0 sc1
  buffer_load_dwordx4 v[108:111], v5, s[4:7], s14 offen offset:1024 sc1
  buffer_load_dwordx4 v[112:115], v5, s[4:7], s14 offen offset:2048 sc1
  buffer_load_dwordx4 v[116:119], v5, s[4:7], s14 offen offset:3072 sc1
  s_add_u32 s14, s14, 4096
  buffer_load_dwordx4 v[124:127], v5, s[4:7], s14 offen offset:0 sc1
  buffer_load_dwordx4 v[128:131], v5, s[4:7], s14 offen offset:1024 sc1
  buffer_load_dwordx4 v[132:135], v5, s[4:7], s14 offen offset:2048 sc1
  buffer_load_dwordx4 v[136:139], v5, s[4:7], s14 offen offset:3072 sc1
  s_add_u32 s14, s14, 12288
  buffer_load_dwordx4 v[80:83], v5, s[4:7], s14 offen offset:0 sc1
  buffer_load_dwordx4 v[100:103], v5, s[4:7], s14 offen offset:1024 sc1
  buffer_load_dwordx4 v[120:123], v5, s[4:7], s14 offen offset:2048 sc1
  buffer_load_dwordx4 v[140:143], v5, s[4:7], s14 offen offset:3072 sc1
  s_waitcnt vmcnt(0) lgkmcnt(0)
  v_mov_b32 v20, 0
  v_mov_b32 v21, 0
  v_mov_b32 v22, 0
  v_mov_b32 v23, 0
  v_mov_b32 v24, 0
  v_mov_b32 v25, 0
  v_mov_b32 v26, 0
  v_mov_b32 v27, 0
  v_mov_b32 v28, 0
  v_mov_b32 v29, 0
  v_mov_b32 v30, 0
  v_mov_b32 v31, 0
  v_mov_b32 v32, 0
  v_mov_b32 v33, 0
  v_mov_b32 v34, 0
  v_mov_b32 v35, 0
  v_smfmac_f32_16x16x64_bf16 v[20:23], v[64:67], v[144:151], v15
  v_smfmac_f32_16x16x64_bf16 v[20:23], v[68:71], v[152:159], v15
  v_smfmac_f32_16x16x64_bf16 v[20:23], v[72:75], v[160:167], v15
  v_smfmac_f32_16x16x64_bf16 v[20:23], v[76:79], v[168:175], v15
  v_smfmac_f32_16x16x64_bf16 v[20:23], v[80:83], v[176:183], v15
  v_smfmac_f32_16x16x64_bf16 v[24:27], v[84:87], v[144:151], v15
  v_smfmac_f32_16x16x64_bf16 v[24:27], v[88:91], v[152:159], v15
  v_smfmac_f32_16x16x64_bf16 v[24:27], v[92:95], v[160:167], v15
  v_smfmac_f32_16x16x64_bf16 v[24:27], v[96:99], v[168:175], v15
  v_smfmac_f32_16x16x64_bf16 v[24:27], v[100:103], v[176:183], v15
  v_smfmac_f32_16x16x64_bf16 v[28:31], v[104:107], v[144:151], v15
  v_smfmac_f32_16x16x64_bf16 v[28:31], v[108:111], v[152:159], v15
  v_smfmac_f32_16x16x64_bf16 v[28:31], v[112:115], v[160:167], v15
  v_smfmac_f32_16x16x64_bf16 v[28:31], v[116:119], v[168:175], v15
  v_smfmac_f32_16x16x64_bf16 v[28:31], v[120:123], v[176:183], v15
  v_smfmac_f32_16x16x64_bf16 v[32:35], v[124:127], v[144:151], v15
  v_smfmac_f32_16x16x64_bf16 v[32:35], v[128:131], v[152:159], v15
  v_smfmac_f32_16x16x64_bf16 v[32:35], v[132:135], v[160:167], v15
  v_smfmac_f32_16x16x64_bf16 v[32:35], v[136:139], v[168:175], v15
  v_smfmac_f32_16x16x64_bf16 v[32:35], v[140:143], v[176:183], v15
  v_pk_add_f32 v[20:21], v[20:21], v[22:23]
  v_cvt_pk_bf16_f32 v56, v20, v21
  v_maximum3_f32 v60, v20, v21, v20
  v_pk_add_f32 v[24:25], v[24:25], v[26:27]
  v_cvt_pk_bf16_f32 v57, v24, v25
  v_maximum3_f32 v60, v24, v25, v60
  v_pk_add_f32 v[28:29], v[28:29], v[30:31]
  v_cvt_pk_bf16_f32 v58, v28, v29
  v_maximum3_f32 v60, v28, v29, v60
  v_pk_add_f32 v[32:33], v[32:33], v[34:35]
  v_cvt_pk_bf16_f32 v59, v32, v33
  v_maximum3_f32 v60, v32, v33, v60
  v_cmp_u_f32 vcc, v60, v60
  s_nop 0
  s_cbranch_vccnz mk_Q_dr1
  buffer_store_dwordx4 v[56:59], v5, s[4:7], s24 offen offset:0 sc1
  s_mov_b32 s24, 1073741824
  s_waitcnt vmcnt(0)
  s_barrier
  s_cmp_lg_u32 s3, 0
  s_cbranch_scc1 mk_Q_dr2
  v_mov_b32 v60, s10
  s_mov_b64 exec, 1
  buffer_store_dword v60, off, s[4:7], s43 sc1
  s_mov_b64 exec, -1
mk_Q_dr2:
  s_cmp_eq_u32 s66, 1
  s_cbranch_scc1 mk_end
  s_branch mk_ln
mk_S_drain:
  s_sub_u32 s22, s10, 4
  s_add_u32 s22, s22, s3
  s_mov_b32 s11, 0
  s_waitcnt vmcnt(0)
  s_mul_hi_u32 s68, s22, 0x2aaaaaab
  s_mul_i32 s68, s68, 6
  s_sub_u32 s13, s22, s68
  s_mul_i32 s13, s13, 20480
  s_add_u32 s13, s13, 33792
  v_add_u32 v60, s13, v5
  s_add_u32 s13, s13, 16384
  v_lshl_add_u32 v61, v1, 3, s13
  v_add_u32 v62, 1024, v61
  ds_read_b128 v[144:147], v60 offset:0
  ds_read_b128 v[148:151], v60 offset:1024
  ds_read_b128 v[152:155], v60 offset:2048
  ds_read_b128 v[156:159], v60 offset:3072
  ds_read_b128 v[160:163], v60 offset:4096
  ds_read_b128 v[164:167], v60 offset:5120
  ds_read_b128 v[168:171], v60 offset:6144
  ds_read_b128 v[172:175], v60 offset:7168
  ds_read2_b32 v[176:177], v61 offset0:0 offset1:128
  ds_read2_b32 v[178:179], v61 offset0:1 offset1:129
  ds_read2_b32 v[180:181], v62 offset0:0 offset1:128
  ds_read2_b32 v[182:183], v62 offset0:1 offset1:129
  s_and_b32 s24, s22, 31
  s_lshl_b32 s24, s24, 2
  s_add_u32 s24, s24, s8
  s_lshr_b32 s68, s24, 1
  s_bitcmp1_b64 s[64:65], s68
  s_cselect_b32 s68, 0x2000, 0
  s_lshl_b32 s24, s24, 20
  s_add_u32 s24, s24, s68
  s_add_u32 s24, s24, s72
  s_bitcmp1_b32 s22, 5
  s_cselect_b32 s13, 32768, 0
  s_add_u32 s24, s24, s13
mk_S_dr1:
  s_add_u32 s11, s11, 1
  s_cmp_lt_u32 s11, 262144
  s_cbranch_scc0 mk_fail
  s_and_b32 s14, s22, 31
  s_lshl_b32 s14, s14, 2
  s_add_u32 s14, s14, s8
  s_lshr_b32 s68, s14, 1
  s_bitcmp1_b64 s[64:65], s68
  s_cselect_b32 s68, 0x2000, 0
  s_lshl_b32 s14, s14, 20
  s_add_u32 s14, s14, s68
  s_add_u32 s14, s14, s41
  buffer_load_dwordx4 v[64:67], v5, s[4:7], s14 offen offset:0 sc1
  buffer_load_dwordx4 v[68:71], v5, s[4:7], s14 offen offset:1024 sc1
  buffer_load_dwordx4 v[72:75], v5, s[4:7], s14 offen offset:2048 sc1
  buffer_load_dwordx4 v[76:79], v5, s[4:7], s14 offen offset:3072 sc1
  s_add_u32 s14, s14, 4096
  buffer_load_dwordx4 v[84:87], v5, s[4:7], s14 offen offset:0 sc1
  buffer_load_dwordx4 v[88:91], v5, s[4:7], s14 offen offset:1024 sc1
  buffer_load_dwordx4 v[92:95], v5, s[4:7], s14 offen offset:2048 sc1
  buffer_load_dwordx4 v[96:99], v5, s[4:7], s14 offen offset:3072 sc1
  s_add_u32 s14, s14, 12288
  buffer_load_dwordx4 v[104:107], v5, s[4:7], s14 offen offset:0 sc1
  buffer_load_dwordx4 v[108:111], v5, s[4:7], s14 offen offset:1024 sc1
  buffer_load_dwordx4 v[112:115], v5, s[4:7], s14 offen offset:2048 sc1
  buffer_load_dwordx4 v[116:119], v5, s[4:7], s14 offen offset:3072 sc1
  s_add_u32 s14, s14, 4096
  buffer_load_dwordx4 v[124:127], v5, s[4:7], s14 offen offset:0 sc1
  buffer_load_dwordx4 v[128:131], v5, s[4:7], s14 offen offset:1024 sc1
  buffer_load_dwordx4 v[132:135], v5, s[4:7], s14 offen offset:2048 sc1
  buffer_load_dwordx4 v[136:139], v5, s[4:7], s14 offen offset:3072 sc1
  s_add_u32 s14, s14, 12288
  buffer_load_dwordx4 v[80:83], v5, s[4:7], s14 offen offset:0 sc1
  buffer_load_dwordx4 v[100:103], v5, s[4:7], s14 offen offset:1024 sc1
  buffer_load_dwordx4 v[120:123], v5, s[4:7], s14 offen offset:2048 sc1
  buffer_load_dwordx4 v[140:143], v5, s[4:7], s14 offen offset:3072 sc1
  s_waitcnt vmcnt(0) lgkmcnt(0)
  v_mov_b32 v20, 0
  v_mov_b32 v21, 0
  v_mov_b32 v22, 0
  v_mov_b32 v23, 0
  v_mov_b32 v24, 0
  v_mov_b32 v25, 0
  v_mov_b32 v26, 0
  v_mov_b32 v27, 0
  v_mov_b32 v28, 0
  v_mov_b32 v29, 0
  v_mov_b32 v30, 0
  v_mov_b32 v31, 0
  v_mov_b32 v32, 0
  v_mov_b32 v33, 0
  v_mov_b32 v34, 0
  v_mov_b32 v35, 0
  v_smfmac_f32_16x16x64_bf16 v[20:23], v[64:67], v[144:151], v15
  v_smfmac_f32_16x16x64_bf16 v[20:23], v[68:71], v[152:159], v15
  v_smfmac_f32_16x16x64_bf16 v[20:23], v[72:75], v[160:167], v15
  v_smfmac_f32_16x16x64_bf16 v[20:23], v[76:79], v[168:175], v15
  v_smfmac_f32_16x16x64_bf16 v[20:23], v[80:83], v[176:183], v15
  v_smfmac_f32_16x16x64_bf16 v[24:27], v[84:87], v[144:151], v15
  v_smfmac_f32_16x16x64_bf16 v[24:27], v[88:91], v[152:159], v15
  v_smfmac_f32_16x16x64_bf16 v[24:27], v[92:95], v[160:167], v15
  v_smfmac_f32_16x16x64_bf16 v[24:27], v[96:99], v[168:175], v15
  v_smfmac_f32_16x16x64_bf16 v[24:27], v[100:103], v[176:183], v15
  v_smfmac_f32_16x16x64_bf16 v[28:31], v[104:107], v[144:151], v15
  v_smfmac_f32_16x16x64_bf16 v[28:31], v[108:111], v[152:159], v15
  v_smfmac_f32_16x16x64_bf16 v[28:31], v[112:115], v[160:167], v15
  v_smfmac_f32_16x16x64_bf16 v[28:31], v[116:119], v[168:175], v15
  v_smfmac_f32_16x16x64_bf16 v[28:31], v[120:123], v[176:183], v15
  v_smfmac_f32_16x16x64_bf16 v[32:35], v[124:127], v[144:151], v15
  v_smfmac_f32_16x16x64_bf16 v[32:35], v[128:131], v[152:159], v15
  v_smfmac_f32_16x16x64_bf16 v[32:35], v[132:135], v[160:167], v15
  v_smfmac_f32_16x16x64_bf16 v[32:35], v[136:139], v[168:175], v15
  v_smfmac_f32_16x16x64_bf16 v[32:35], v[140:143], v[176:183], v15
  v_pk_add_f32 v[20:21], v[20:21], v[22:23]
  v_cvt_pk_bf16_f32 v56, v20, v21
  v_maximum3_f32 v60, v20, v21, v20
  v_pk_add_f32 v[24:25], v[24:25], v[26:27]
  v_cvt_pk_bf16_f32 v57, v24, v25
  v_maximum3_f32 v60, v24, v25, v60
  v_pk_add_f32 v[28:29], v[28:29], v[30:31]
  v_cvt_pk_bf16_f32 v58, v28, v29
  v_maximum3_f32 v60, v28, v29, v60
  v_pk_add_f32 v[32:33], v[32:33], v[34:35]
  v_cvt_pk_bf16_f32 v59, v32, v33
  v_maximum3_f32 v60, v32, v33, v60
  v_cmp_u_f32 vcc, v60, v60
  s_nop 0
  s_cbranch_vccnz mk_S_dr1
  buffer_store_dwordx4 v[56:59], v5, s[4:7], s24 offen offset:0 sc1
  s_mul_hi_u32 s68, s22, 0x2aaaaaab
  s_mul_i32 s68, s68, 6
  s_sub_u32 s13, s22, s68
  s_mul_i32 s13, s13, 20480
  s_add_u32 s13, s13, 33792
  v_add_u32 v60, s13, v5
  s_add_u32 s13, s13, 18432
  v_lshl_add_u32 v61, v1, 3, s13
  v_add_u32 v62, 1024, v61
  ds_read_b128 v[144:147], v60 offset:8192
  ds_read_b128 v[148:151], v60 offset:9216
  ds_read_b128 v[152:155], v60 offset:10240
  ds_read_b128 v[156:159], v60 offset:11264
  ds_read_b128 v[160:163], v60 offset:12288
  ds_read_b128 v[164:167], v60 offset:13312
  ds_read_b128 v[168:171], v60 offset:14336
  ds_read_b128 v[172:175], v60 offset:15360
  ds_read2_b32 v[176:177], v61 offset0:0 offset1:128
  ds_read2_b32 v[178:179], v61 offset0:1 offset1:129
  ds_read2_b32 v[180:181], v62 offset0:0 offset1:128
  ds_read2_b32 v[182:183], v62 offset0:1 offset1:129
  s_waitcnt lgkmcnt(0)
  v_mov_b32 v20, 0
  v_mov_b32 v21, 0
  v_mov_b32 v22, 0
  v_mov_b32 v23, 0
  v_mov_b32 v24, 0
  v_mov_b32 v25, 0
  v_mov_b32 v26, 0
  v_mov_b32 v27, 0
  v_mov_b32 v28, 0
  v_mov_b32 v29, 0
  v_mov_b32 v30, 0
  v_mov_b32 v31, 0
  v_mov_b32 v32, 0
  v_mov_b32 v33, 0
  v_mov_b32 v34, 0
  v_mov_b32 v35, 0
  v_smfmac_f32_16x16x64_bf16 v[20:23], v[64:67], v[144:151], v15
  v_smfmac_f32_16x16x64_bf16 v[20:23], v[68:71], v[152:159], v15
  v_smfmac_f32_16x16x64_bf16 v[20:23], v[72:75], v[160:167], v15
  v_smfmac_f32_16x16x64_bf16 v[20:23], v[76:79], v[168:175], v15
  v_smfmac_f32_16x16x64_bf16 v[20:23], v[80:83], v[176:183], v15
  v_smfmac_f32_16x16x64_bf16 v[24:27], v[84:87], v[144:151], v15
  v_smfmac_f32_16x16x64_bf16 v[24:27], v[88:91], v[152:159], v15
  v_smfmac_f32_16x16x64_bf16 v[24:27], v[92:95], v[160:167], v15
  v_smfmac_f32_16x16x64_bf16 v[24:27], v[96:99], v[168:175], v15
  v_smfmac_f32_16x16x64_bf16 v[24:27], v[100:103], v[176:183], v15
  v_smfmac_f32_16x16x64_bf16 v[28:31], v[104:107], v[144:151], v15
  v_smfmac_f32_16x16x64_bf16 v[28:31], v[108:111], v[152:159], v15
  v_smfmac_f32_16x16x64_bf16 v[28:31], v[112:115], v[160:167], v15
  v_smfmac_f32_16x16x64_bf16 v[28:31], v[116:119], v[168:175], v15
  v_smfmac_f32_16x16x64_bf16 v[28:31], v[120:123], v[176:183], v15
  v_smfmac_f32_16x16x64_bf16 v[32:35], v[124:127], v[144:151], v15
  v_smfmac_f32_16x16x64_bf16 v[32:35], v[128:131], v[152:159], v15
  v_smfmac_f32_16x16x64_bf16 v[32:35], v[132:135], v[160:167], v15
  v_smfmac_f32_16x16x64_bf16 v[32:35], v[136:139], v[168:175], v15
  v_smfmac_f32_16x16x64_bf16 v[32:35], v[140:143], v[176:183], v15
  v_pk_add_f32 v[20:21], v[20:21], v[22:23]
  v_cvt_pk_bf16_f32 v56, v20, v21
  v_maximum3_f32 v60, v20, v21, v20
  v_pk_add_f32 v[24:25], v[24:25], v[26:27]
  v_cvt_pk_bf16_f32 v57, v24, v25
  v_maximum3_f32 v60, v24, v25, v60
  v_pk_add_f32 v[28:29], v[28:29], v[30:31]
  v_cvt_pk_bf16_f32 v58, v28, v29
  v_maximum3_f32 v60, v28, v29, v60
  v_pk_add_f32 v[32:33], v[32:33], v[34:35]
  v_cvt_pk_bf16_f32 v59, v32, v33
  v_maximum3_f32 v60, v32, v33, v60
  v_cmp_u_f32 vcc, v60, v60
  buffer_store_dwordx4 v[56:59], v5, s[4:7], s24 offen offset:1024 sc1
  s_mov_b32 s24, 1073741824
  s_waitcnt vmcnt(0)
  s_barrier
  s_cmp_lg_u32 s3, 0
  s_cbranch_scc1 mk_S_dr2
  v_mov_b32 v60, s10
  s_mov_b64 exec, 1
  buffer_store_dword v60, off, s[4:7], s43 sc1
  s_mov_b64 exec, -1
mk_S_dr2:
  s_cmp_eq_u32 s66, 1
  s_cbranch_scc1 mk_end
mk_ln:
  s_lshl_b32 s76, s9, 2
  s_add_u32 s76, s76, s8
  s_mov_b32 s77, 2
  s_mov_b32 s78, 0
  v_lshlrev_b32 v64, 4, v1
  s_mul_i32 s79, s76, 20480
  s_mul_i32 s80, s3, 5120
  s_add_u32 s79, s79, s80
  s_mul_i32 s80, s77, 2621440
  s_add_u32 s79, s79, s80
  s_add_u32 s80, s79, 26214400
  s_add_u32 s81, s80, 4096
  s_mov_b32 s70, 0
int_xp48:
  buffer_load_dwordx4 v[80:83], v64, s[4:7], s80 offen offset:0 sc1
  buffer_load_dwordx4 v[84:87], v64, s[4:7], s80 offen offset:1024 sc1
  buffer_load_dwordx4 v[88:91], v64, s[4:7], s80 offen offset:2048 sc1
  buffer_load_dwordx4 v[92:95], v64, s[4:7], s80 offen offset:3072 sc1
  buffer_load_dwordx4 v[96:99], v64, s[4:7], s81 offen offset:0 sc1
  s_waitcnt vmcnt(0)
  v_max_u32 v66, v80, v81
  v_max3_u32 v66, v66, v82, v83
  v_max3_u32 v66, v66, v84, v85
  v_max3_u32 v66, v66, v86, v87
  v_max3_u32 v66, v66, v88, v89
  v_max3_u32 v66, v66, v90, v91
  v_max3_u32 v66, v66, v92, v93
  v_max3_u32 v66, v66, v94, v95
  v_max3_u32 v66, v66, v96, v97
  v_max3_u32 v66, v66, v98, v99
  v_cmp_eq_u32 vcc, -1, v66
  s_nop 0
  s_cbranch_vccz int_xp48_ok
  s_sleep 2
  s_add_u32 s70, s70, 1
  s_cmp_lt_u32 s70, 262144
  s_cbranch_scc1 int_xp48
  s_branch mk_fail
int_xp48_ok:
  s_mov_b32 s83, 0xffff0000
  s_add_u32 s80, s79, 26214400
  s_add_u32 s81, s80, 4096
  s_waitcnt vmcnt(0)
  v_lshlrev_b32 v100, 16, v80
  v_and_b32 v101, s83, v80
  v_lshlrev_b32 v102, 16, v81
  v_and_b32 v103, s83, v81
  v_lshlrev_b32 v104, 16, v82
  v_and_b32 v105, s83, v82
  v_lshlrev_b32 v106, 16, v83
  v_and_b32 v107, s83, v83
  v_lshlrev_b32 v108, 16, v84
  v_and_b32 v109, s83, v84
  v_lshlrev_b32 v110, 16, v85
  v_and_b32 v111, s83, v85
  v_lshlrev_b32 v112, 16, v86
  v_and_b32 v113, s83, v86
  v_lshlrev_b32 v114, 16, v87
  v_and_b32 v115, s83, v87
  v_lshlrev_b32 v116, 16, v88
  v_and_b32 v117, s83, v88
  v_lshlrev_b32 v118, 16, v89
  v_and_b32 v119, s83, v89
  v_lshlrev_b32 v120, 16, v90
  v_and_b32 v121, s83, v90
  v_lshlrev_b32 v122, 16, v91
  v_and_b32 v123, s83, v91
  v_lshlrev_b32 v124, 16, v92
  v_and_b32 v125, s83, v92
  v_lshlrev_b32 v126, 16, v93
  v_and_b32 v127, s83, v93
  v_lshlrev_b32 v128, 16, v94
  v_and_b32 v129, s83, v94
  v_lshlrev_b32 v130, 16, v95
  v_and_b32 v131, s83, v95
  v_lshlrev_b32 v132, 16, v96
  v_and_b32 v133, s83, v96
  v_lshlrev_b32 v134, 16, v97
  v_and_b32 v135, s83, v97
  v_lshlrev_b32 v136, 16, v98
  v_and_b32 v137, s83, v98
  v_lshlrev_b32 v138, 16, v99
  v_and_b32 v139, s83, v99
  v_pk_add_f32 v[68:69], v[100:101], v[102:103]
  v_pk_add_f32 v[68:69], v[68:69], v[104:105]
  v_pk_add_f32 v[68:69], v[68:69], v[106:107]
  v_pk_add_f32 v[68:69], v[68:69], v[108:109]
  v_pk_add_f32 v[68:69], v[68:69], v[110:111]
  v_pk_add_f32 v[68:69], v[68:69], v[112:113]
  v_pk_add_f32 v[68:69], v[68:69], v[114:115]
  v_pk_add_f32 v[68:69], v[68:69], v[116:117]
  v_pk_add_f32 v[68:69], v[68:69], v[118:119]
  v_pk_add_f32 v[68:69], v[68:69], v[120:121]
  v_pk_add_f32 v[68:69], v[68:69], v[122:123]
  v_pk_add_f32 v[68:69], v[68:69], v[124:125]
  v_pk_add_f32 v[68:69], v[68:69], v[126:127]
  v_pk_add_f32 v[68:69], v[68:69], v[128:129]
  v_pk_add_f32 v[68:69], v[68:69], v[130:131]
  v_pk_add_f32 v[68:69], v[68:69], v[132:133]
  v_pk_add_f32 v[68:69], v[68:69], v[134:135]
  v_pk_add_f32 v[68:69], v[68:69], v[136:137]
  v_pk_add_f32 v[68:69], v[68:69], v[138:139]
  v_add_f32 v68, v68, v69
  v_mov_b32 v66, v68
  s_nop 1
  v_permlane16_swap_b32 v68, v66
  v_add_f32 v68, v68, v66
  v_mov_b32 v66, v68
  s_nop 1
  v_permlane32_swap_b32 v68, v66
  v_add_f32 v68, v68, v66
  v_mul_f32 v68, 0x3bcccccd, v68
  v_pk_add_f32 v[100:101], v[100:101], v[68:69] op_sel_hi:[1,0] neg_lo:[0,1] neg_hi:[0,1]
  v_pk_mul_f32 v[70:71], v[100:101], v[100:101]
  v_pk_add_f32 v[102:103], v[102:103], v[68:69] op_sel_hi:[1,0] neg_lo:[0,1] neg_hi:[0,1]
  v_pk_fma_f32 v[70:71], v[102:103], v[102:103], v[70:71]
  v_pk_add_f32 v[104:105], v[104:105], v[68:69] op_sel_hi:[1,0] neg_lo:[0,1] neg_hi:[0,1]
  v_pk_fma_f32 v[70:71], v[104:105], v[104:105], v[70:71]
  v_pk_add_f32 v[106:107], v[106:107], v[68:69] op_sel_hi:[1,0] neg_lo:[0,1] neg_hi:[0,1]
  v_pk_fma_f32 v[70:71], v[106:107], v[106:107], v[70:71]
  v_pk_add_f32 v[108:109], v[108:109], v[68:69] op_sel_hi:[1,0] neg_lo:[0,1] neg_hi:[0,1]
  v_pk_fma_f32 v[70:71], v[108:109], v[108:109], v[70:71]
  v_pk_add_f32 v[110:111], v[110:111], v[68:69] op_sel_hi:[1,0] neg_lo:[0,1] neg_hi:[0,1]
  v_pk_fma_f32 v[70:71], v[110:111], v[110:111], v[70:71]
  v_pk_add_f32 v[112:113], v[112:113], v[68:69] op_sel_hi:[1,0] neg_lo:[0,1] neg_hi:[0,1]
  v_pk_fma_f32 v[70:71], v[112:113], v[112:113], v[70:71]
  v_pk_add_f32 v[114:115], v[114:115], v[68:69] op_sel_hi:[1,0] neg_lo:[0,1] neg_hi:[0,1]
  v_pk_fma_f32 v[70:71], v[114:115], v[114:115], v[70:71]
  v_pk_add_f32 v[116:117], v[116:117], v[68:69] op_sel_hi:[1,0] neg_lo:[0,1] neg_hi:[0,1]
  v_pk_fma_f32 v[70:71], v[116:117], v[116:117], v[70:71]
  v_pk_add_f32 v[118:119], v[118:119], v[68:69] op_sel_hi:[1,0] neg_lo:[0,1] neg_hi:[0,1]
  v_pk_fma_f32 v[70:71], v[118:119], v[118:119], v[70:71]
  v_pk_add_f32 v[120:121], v[120:121], v[68:69] op_sel_hi:[1,0] neg_lo:[0,1] neg_hi:[0,1]
  v_pk_fma_f32 v[70:71], v[120:121], v[120:121], v[70:71]
  v_pk_add_f32 v[122:123], v[122:123], v[68:69] op_sel_hi:[1,0] neg_lo:[0,1] neg_hi:[0,1]
  v_pk_fma_f32 v[70:71], v[122:123], v[122:123], v[70:71]
  v_pk_add_f32 v[124:125], v[124:125], v[68:69] op_sel_hi:[1,0] neg_lo:[0,1] neg_hi:[0,1]
  v_pk_fma_f32 v[70:71], v[124:125], v[124:125], v[70:71]
  v_pk_add_f32 v[126:127], v[126:127], v[68:69] op_sel_hi:[1,0] neg_lo:[0,1] neg_hi:[0,1]
  v_pk_fma_f32 v[70:71], v[126:127], v[126:127], v[70:71]
  v_pk_add_f32 v[128:129], v[128:129], v[68:69] op_sel_hi:[1,0] neg_lo:[0,1] neg_hi:[0,1]
  v_pk_fma_f32 v[70:71], v[128:129], v[128:129], v[70:71]
  v_pk_add_f32 v[130:131], v[130:131], v[68:69] op_sel_hi:[1,0] neg_lo:[0,1] neg_hi:[0,1]
  v_pk_fma_f32 v[70:71], v[130:131], v[130:131], v[70:71]
  v_pk_add_f32 v[132:133], v[132:133], v[68:69] op_sel_hi:[1,0] neg_lo:[0,1] neg_hi:[0,1]
  v_pk_fma_f32 v[70:71], v[132:133], v[132:133], v[70:71]
  v_pk_add_f32 v[134:135], v[134:135], v[68:69] op_sel_hi:[1,0] neg_lo:[0,1] neg_hi:[0,1]
  v_pk_fma_f32 v[70:71], v[134:135], v[134:135], v[70:71]
  v_pk_add_f32 v[136:137], v[136:137], v[68:69] op_sel_hi:[1,0] neg_lo:[0,1] neg_hi:[0,1]
  v_pk_fma_f32 v[70:71], v[136:137], v[136:137], v[70:71]
  v_pk_add_f32 v[138:139], v[138:139], v[68:69] op_sel_hi:[1,0] neg_lo:[0,1] neg_hi:[0,1]
  v_pk_fma_f32 v[70:71], v[138:139], v[138:139], v[70:71]
  v_add_f32 v69, v70, v71
  v_mov_b32 v66, v69
  s_nop 1
  v_permlane16_swap_b32 v69, v66
  v_add_f32 v69, v69, v66
  v_mov_b32 v66, v69
  s_nop 1
  v_permlane32_swap_b32 v69, v66
  v_add_f32 v69, v69, v66
  v_and_b32 v66, 15, v1
  s_add_u32 s82, s78, 162816
  v_lshl_add_u32 v66, v66, 3, s82
  s_lshl_b32 s82, s3, 7
  v_add_u32 v67, s82, v66
  ds_write_b64 v67, v[68:69]
  s_xor_b32 s78, s78, 512
  s_waitcnt lgkmcnt(0)
  s_barrier
  ds_read_b64 v[72:73], v66 offset:0
  ds_read_b64 v[74:75], v66 offset:128
  ds_read_b64 v[76:77], v66 offset:256
  ds_read_b64 v[78:79], v66 offset:384
  s_add_u32 s80, s79, 36700160
  s_add_u32 s81, s80, 4096
  s_waitcnt lgkmcnt(0)
  v_pk_add_f32 v[70:71], v[72:73], v[74:75]
  v_pk_add_f32 v[70:71], v[70:71], v[76:77]
  v_pk_add_f32 v[70:71], v[70:71], v[78:79]
  v_mul_f32 v70, 0x3e800000, v70
  v_sub_f32 v72, v72, v70
  v_sub_f32 v74, v74, v70
  v_sub_f32 v76, v76, v70
  v_sub_f32 v78, v78, v70
  v_mul_f32 v66, v72, v72
  v_fmac_f32 v66, v74, v74
  v_fmac_f32 v66, v76, v76
  v_fmac_f32 v66, v78, v78
  v_fmac_f32 v71, 0x43200000, v66
  v_mov_b32 v66, 0x3727c5ac
  v_fmac_f32 v66, 0x3acccccd, v71
  v_rsq_f32 v69, v66
  v_sub_f32 v68, v68, v70
  v_mul_f32 v68, v68, v69
  v_pk_fma_f32 v[100:101], v[100:101], v[68:69], v[68:69] op_sel:[0,1,0] op_sel_hi:[1,1,0]
  v_cvt_pk_bf16_f32 v80, v100, v101
  v_pk_fma_f32 v[102:103], v[102:103], v[68:69], v[68:69] op_sel:[0,1,0] op_sel_hi:[1,1,0]
  v_cvt_pk_bf16_f32 v81, v102, v103
  v_pk_fma_f32 v[104:105], v[104:105], v[68:69], v[68:69] op_sel:[0,1,0] op_sel_hi:[1,1,0]
  v_cvt_pk_bf16_f32 v82, v104, v105
  v_pk_fma_f32 v[106:107], v[106:107], v[68:69], v[68:69] op_sel:[0,1,0] op_sel_hi:[1,1,0]
  v_cvt_pk_bf16_f32 v83, v106, v107
  buffer_store_dwordx4 v[80:83], v64, s[4:7], s80 offen offset:0 sc1
  v_pk_fma_f32 v[108:109], v[108:109], v[68:69], v[68:69] op_sel:[0,1,0] op_sel_hi:[1,1,0]
  v_cvt_pk_bf16_f32 v84, v108, v109
  v_pk_fma_f32 v[110:111], v[110:111], v[68:69], v[68:69] op_sel:[0,1,0] op_sel_hi:[1,1,0]
  v_cvt_pk_bf16_f32 v85, v110, v111
  v_pk_fma_f32 v[112:113], v[112:113], v[68:69], v[68:69] op_sel:[0,1,0] op_sel_hi:[1,1,0]
  v_cvt_pk_bf16_f32 v86, v112, v113
  v_pk_fma_f32 v[114:115], v[114:115], v[68:69], v[68:69] op_sel:[0,1,0] op_sel_hi:[1,1,0]
  v_cvt_pk_bf16_f32 v87, v114, v115
  buffer_store_dwordx4 v[84:87], v64, s[4:7], s80 offen offset:1024 sc1
  v_pk_fma_f32 v[116:117], v[116:117], v[68:69], v[68:69] op_sel:[0,1,0] op_sel_hi:[1,1,0]
  v_cvt_pk_bf16_f32 v88, v116, v117
  v_pk_fma_f32 v[118:119], v[118:119], v[68:69], v[68:69] op_sel:[0,1,0] op_sel_hi:[1,1,0]
  v_cvt_pk_bf16_f32 v89, v118, v119
  v_pk_fma_f32 v[120:121], v[120:121], v[68:69], v[68:69] op_sel:[0,1,0] op_sel_hi:[1,1,0]
  v_cvt_pk_bf16_f32 v90, v120, v121
  v_pk_fma_f32 v[122:123], v[122:123], v[68:69], v[68:69] op_sel:[0,1,0] op_sel_hi:[1,1,0]
  v_cvt_pk_bf16_f32 v91, v122, v123
  buffer_store_dwordx4 v[88:91], v64, s[4:7], s80 offen offset:2048 sc1
  v_pk_fma_f32 v[124:125], v[124:125], v[68:69], v[68:69] op_sel:[0,1,0] op_sel_hi:[1,1,0]
  v_cvt_pk_bf16_f32 v92, v124, v125
  v_pk_fma_f32 v[126:127], v[126:127], v[68:69], v[68:69] op_sel:[0,1,0] op_sel_hi:[1,1,0]
  v_cvt_pk_bf16_f32 v93, v126, v127
  v_pk_fma_f32 v[128:129], v[128:129], v[68:69], v[68:69] op_sel:[0,1,0] op_sel_hi:[1,1,0]
  v_cvt_pk_bf16_f32 v94, v128, v129
  v_pk_fma_f32 v[130:131], v[130:131], v[68:69], v[68:69] op_sel:[0,1,0] op_sel_hi:[1,1,0]
  v_cvt_pk_bf16_f32 v95, v130, v131
  buffer_store_dwordx4 v[92:95], v64, s[4:7], s80 offen offset:3072 sc1
  v_pk_fma_f32 v[132:133], v[132:133], v[68:69], v[68:69] op_sel:[0,1,0] op_sel_hi:[1,1,0]
  v_cvt_pk_bf16_f32 v96, v132, v133
  v_pk_fma_f32 v[134:135], v[134:135], v[68:69], v[68:69] op_sel:[0,1,0] op_sel_hi:[1,1,0]
  v_cvt_pk_bf16_f32 v97, v134, v135
  v_pk_fma_f32 v[136:137], v[136:137], v[68:69], v[68:69] op_sel:[0,1,0] op_sel_hi:[1,1,0]
  v_cvt_pk_bf16_f32 v98, v136, v137
  v_pk_fma_f32 v[138:139], v[138:139], v[68:69], v[68:69] op_sel:[0,1,0] op_sel_hi:[1,1,0]
  v_cvt_pk_bf16_f32 v99, v138, v139
  buffer_store_dwordx4 v[96:99], v64, s[4:7], s81 offen offset:0 sc1
  s_lshr_b32 s80, s76, 1
  s_lshl_b32 s80, s80, 7
  s_and_b32 s81, s76, 1
  s_lshl_b32 s81, s81, 2
  s_add_u32 s81, s81, s3
  s_lshl_b32 s81, s81, 2
  s_add_u32 s80, s80, s81
  s_add_u32 s80, s80, 64909312
  s_add_u32 s81, s77, 1
  s_waitcnt vmcnt(0)
  v_mov_b32 v66, s81
  s_mov_b64 exec, 1
  buffer_store_dword v66, off, s[4:7], s80 sc1
  s_mov_b64 exec, -1
  s_add_u32 s66, s66, 1
  s_cmp_ge_u32 s66, 2
  s_cbranch_scc1 mk_end
  s_cmp_ge_u32 s9, 24
  s_cselect_b32 s13, 4, 0
  s_add_u32 s13, s13, s3
  s_cmp_eq_u32 s13, 0
  s_cbranch_scc1 mk_Q0_prime
  s_cmp_eq_u32 s13, 1
  s_cbranch_scc1 mk_Q1_prime
  s_cmp_eq_u32 s13, 2
  s_cbranch_scc1 mk_Q2_prime
  s_cmp_eq_u32 s13, 3
  s_cbranch_scc1 mk_Q3_prime
  s_cmp_eq_u32 s13, 4
  s_cbranch_scc1 mk_S0_prime
  s_cmp_eq_u32 s13, 5
  s_cbranch_scc1 mk_S1_prime
  s_cmp_eq_u32 s13, 6
  s_cbranch_scc1 mk_S2_prime
  s_branch mk_S3_prime

.section .rodata,"a"
.p2align 6
.amdhsa_kernel interleave_layers__memory_aug_recurrent_mem_tr__linear_kernel_hedgehog__prompt_kernel
  .amdhsa_next_free_vgpr 512
  .amdhsa_next_free_sgpr 100
  .amdhsa_accum_offset 256
  .amdhsa_group_segment_fixed_size 0
  .amdhsa_kernarg_size 112
  .amdhsa_user_sgpr_count 2
  .amdhsa_user_sgpr_kernarg_segment_ptr 1
  .amdhsa_system_sgpr_workgroup_id_x 1
  .amdhsa_float_denorm_mode_32 3
.end_amdhsa_kernel
.text
```
